```python
import torch

def _softmax(x, axis=-1):
    return torch.softmax(x, dim=axis)
def _gelu(x):
    return torch.nn.functional.gelu(x, approximate="tanh")
def _silu(x):
    return torch.nn.functional.silu(x)
def _sigmoid(x):
    return torch.sigmoid(x)
def _layernorm(x, axis=-1, eps=1e-5):
    m = x.mean(dim=axis, keepdim=True)
    v = x.var(dim=axis, keepdim=True, unbiased=False)
    return (x - m) / torch.sqrt(v + eps)
def _scatter_add(tgt, idx, src, axis=0):
    return tgt.clone().index_add_(axis, idx, src)
def _segment_sum(src, seg, n):
    out = torch.zeros((n,) + src.shape[1:], dtype=src.dtype)
    return out.index_add_(0, seg, src)
def _pad(x, pw):
    flat = tuple(v for pair in reversed(pw) for v in pair)
    return torch.nn.functional.pad(x, flat)

kernel_name = 'recurrent_scan__gqa_block_cached__glu_gated_glu__prompt'

def setup_inputs():

    _w = (lambda a: (lambda t: t.to(torch.bfloat16) if t.is_floating_point() else t)(torch.as_tensor(a)))
    def _A_setup():
        B, Sq, D = 1, 2048, 512
        Hq, Hkv, Sk, Dh = 32, 8, 2048, 128
        assert Hq % Hkv == 0, (Hq, Hkv)
        return {
            "x": _w((lambda *s: torch.randn(*s, dtype=torch.bfloat16) * 0.05)(B, Sq, D)),
            "k_cache": _w((lambda *s: torch.randn(*s, dtype=torch.bfloat16) * 1.6)(B, Hkv, Sk, Dh)),
            "v_cache": _w((lambda *s: torch.randn(*s, dtype=torch.bfloat16) * 0.2)(B, Hkv, Sk, Dh)),
            "wq": _w((lambda *s: torch.randn(*s, dtype=torch.bfloat16) * 1.6)(D, Hq * Dh) * (D ** -0.5)),
            "wo": _w((lambda *s: torch.randn(*s, dtype=torch.bfloat16) * 0.2)(Hq * Dh, D) * ((Hq * Dh) ** -0.5)),
        }
    _A_in = _A_setup()

    def _B_setup():
        B, S, D, F = 1, 2048, 512, 1792
        return {
            "x": _w((lambda *s: torch.randn(*s, dtype=torch.bfloat16) * 0.05)(B, S, D)),
            "w_gate": _w((lambda *s: torch.randn(*s, dtype=torch.bfloat16) * 0.2)(D, F)),
            "w_up": _w((lambda *s: torch.randn(*s, dtype=torch.bfloat16) * 0.1)(D, F)),
            "w_down": _w((lambda *s: torch.randn(*s, dtype=torch.bfloat16) * 0.1)(F, D)),
        }
    _B_in = _B_setup()

    return {
        "A_x": _A_in["x"],
        "A_k_cache": _A_in["k_cache"],
        "A_v_cache": _A_in["v_cache"],
        "A_wq": _A_in["wq"],
        "A_wo": _A_in["wo"],
        "B_x": _B_in["x"],
        "B_w_gate": _B_in["w_gate"],
        "B_w_up": _B_in["w_up"],
        "B_w_down": _B_in["w_down"],
    }

def reference(A_x, A_k_cache, A_v_cache, A_wq, A_wo, B_x, B_w_gate, B_w_up, B_w_down):
    def _A_ref(x, k_cache, v_cache, wq, wo):
        B, Sq, D = x.shape
        Hq, Dh = 32, 128
        Hkv = k_cache.shape[1]
        rep = Hq // Hkv
        q = (lambda x, *d: x.permute(*d))((x @ wq).reshape(B, Sq, Hq, Dh), 0, 2, 1, 3)
        k = (lambda x, n, axis: torch.repeat_interleave(x, n, dim=axis))(k_cache, rep, axis=1)
        v = (lambda x, n, axis: torch.repeat_interleave(x, n, dim=axis))(v_cache, rep, axis=1)
        scores = torch.einsum("bhqd,bhkd->bhqk", q, k) * (Dh ** -0.5)
        p = _softmax(scores, axis=-1)
        o = torch.einsum("bhqk,bhkd->bhqd", p, v)
        return (lambda x, *d: x.permute(*d))(o, 0, 2, 1, 3).reshape(B, Sq, Hq * Dh) @ wo

    def _B_ref(x, w_gate, w_up, w_down):
        g = torch.einsum("bsd,df->bsf", x, w_gate)
        u = torch.einsum("bsd,df->bsf", x, w_up)
        h = _sigmoid(g) * u
        return torch.einsum("bsf,fd->bsd", h, w_down)

    x = A_x
    xn = _layernorm(x, axis=-1)
    s = _A_ref(xn, A_k_cache, A_v_cache, A_wq, A_wo)
    g = _silu(_B_ref(xn, B_w_gate, B_w_up, B_w_down))
    return x + s * g
```

```asm
; @launch grid=(256,1,1) block=(256,1,1) lds=163840
.amdgcn_target "amdgcn-amd-amdhsa--gfx950"
.text
.globl recurrent_scan__gqa_block_cached__glu_gated_glu__prompt_kernel
.p2align 12
.p2align 8
.type recurrent_scan__gqa_block_cached__glu_gated_glu__prompt_kernel,@function
recurrent_scan__gqa_block_cached__glu_gated_glu__prompt_kernel:
 s_cmp_ge_u32 s2, 256
 s_cbranch_scc1 L_end
 s_load_dwordx2 s[28:29], s[0:1], 0
 s_getpc_b64 s[72:73]
L_pc:
 s_add_u32 s72, s72, L_main-L_pc
 s_addc_u32 s73, s73, 0
 s_mov_b32 s74, L_end-L_main
 s_mov_b32 s75, 0x20000
 v_and_b32 v51, 7, v0
 v_lshrrev_b32 v128, 6, v0
 v_lshlrev_b32 v51, 7, v51
 s_lshr_b32 s89, s2, 3
 v_lshl_or_b32 v51, v128, 10, v51
 s_lshl_b32 s89, s89, 12
 buffer_load_dword a252, v51, s[72:75], s89 offen
 v_and_b32 v1, 63, v0
 s_and_b32 s77, s2, 3
 v_readfirstlane_b32 s76, v128
 s_lshl_b32 s77, s77, 1
 s_bfe_u32 s88, s2, 0x10003
 s_add_u32 s77, s77, s88
 s_lshr_b32 s3, s2, 4
 s_bfe_u32 s88, s2, 0x10002
 s_lshl_b32 s88, s88, 4
 s_add_u32 s78, s3, s88
 s_mov_b32 s30, 0x200000
 s_mov_b32 s31, 0x20000
 v_and_b32 v129, 15, v1
 v_lshrrev_b32 v130, 4, v1
 v_lshlrev_b32 v131, 4, v129
 v_lshl_or_b32 v131, v130, 10, v131
 s_lshl_b32 s88, s78, 16
 s_lshl_b32 s89, s76, 14
 s_add_u32 s88, s88, s89
 s_add_u32 s89, s88, 4096
 s_add_u32 s85, s88, 8192
 s_add_u32 s84, s88, 12288
 s_waitcnt lgkmcnt(0)
 s_load_dwordx2 s[48:49], s[0:1], 48
 s_load_dwordx2 s[52:53], s[0:1], 56
 s_load_dwordx2 s[40:41], s[0:1], 24
 s_load_dwordx2 s[32:33], s[0:1], 8
 s_load_dwordx2 s[36:37], s[0:1], 16
 s_load_dwordx2 s[44:45], s[0:1], 32
 s_load_dwordx2 s[56:57], s[0:1], 64
 s_load_dwordx2 s[60:61], s[0:1], 72
 s_load_dwordx2 s[68:69], s[0:1], 80
 s_load_dwordx2 s[64:65], s[0:1], 88
 buffer_load_dwordx4 v[192:195], v131, s[28:31], s88 offen offset:0
 buffer_load_dwordx4 v[196:199], v131, s[28:31], s88 offen offset:256
 buffer_load_dwordx4 v[200:203], v131, s[28:31], s88 offen offset:512
 buffer_load_dwordx4 v[204:207], v131, s[28:31], s88 offen offset:768
 buffer_load_dwordx4 v[208:211], v131, s[28:31], s89 offen offset:0
 buffer_load_dwordx4 v[212:215], v131, s[28:31], s89 offen offset:256
 buffer_load_dwordx4 v[216:219], v131, s[28:31], s89 offen offset:512
 buffer_load_dwordx4 v[220:223], v131, s[28:31], s89 offen offset:768
 buffer_load_dwordx4 v[224:227], v131, s[28:31], s85 offen offset:0
 buffer_load_dwordx4 v[228:231], v131, s[28:31], s85 offen offset:256
 buffer_load_dwordx4 v[232:235], v131, s[28:31], s85 offen offset:512
 buffer_load_dwordx4 v[236:239], v131, s[28:31], s85 offen offset:768
 buffer_load_dwordx4 v[240:243], v131, s[28:31], s84 offen offset:0
 buffer_load_dwordx4 v[244:247], v131, s[28:31], s84 offen offset:256
 buffer_load_dwordx4 v[248:251], v131, s[28:31], s84 offen offset:512
 buffer_load_dwordx4 v[252:255], v131, s[28:31], s84 offen offset:768
 s_branch L_main
.p2align 12
L_main:
 s_mov_b32 s50, 0x1c0000
 s_mov_b32 s51, 0x20000
 s_mov_b32 s54, 0x1c0000
 s_mov_b32 s55, 0x20000
 s_mov_b32 s42, 0x400000
 s_mov_b32 s43, 0x20000
 s_mov_b32 s46, 0x400000
 s_mov_b32 s47, 0x20000
 s_mov_b32 s58, 0x1c0000
 s_mov_b32 s59, 0x20000
 s_mov_b32 s62, 0x200000
 s_mov_b32 s63, 0x20000
 s_mov_b32 s70, 0x100
 s_mov_b32 s71, 0x20000
 s_mov_b32 s66, 0x2000000
 s_mov_b32 s67, 0x20000
 v_lshrrev_b32 v132, 3, v1
 v_bfe_u32 v133, v1, 1, 2
 v_and_b32 v134, 1, v130
 v_xor_b32 v134, v133, v134
 v_and_b32 v135, 1, v1
 v_lshlrev_b32 v135, 4, v135
 v_lshl_or_b32 v136, v134, 5, v135
 s_mul_i32 s88, s77, 448
 s_and_b32 s89, s77, 1
 s_lshl_b32 s90, s89, 6
 s_add_u32 s88, s88, s90
 s_lshl_b32 s90, s76, 7
 s_add_u32 s90, s88, s90
 s_lshl_b32 s89, s89, 2
 s_add_u32 s89, s89, s76
 s_cmp_eq_u32 s89, 7
 s_cselect_b32 s82, 1, 0
 s_cselect_b32 s90, 0x40000000, s90
 v_mul_u32_u24 v137, 3584, v132
 v_add3_u32 v6, v137, v136, s90
 v_xor_b32 v138, 64, v136
 v_add3_u32 v7, v137, v138, s90
 v_add_u32 v7, 27648, v7
 v_add_u32 v8, 55296, v6
 v_add_u32 v9, 55296, v7
 s_and_b32 s83, s76, 1
 s_lshl_b32 s83, s83, 13
 s_cmp_lt_u32 s76, 2
 s_cselect_b32 s91, 49152, 0
 s_add_u32 s83, s83, s91
 s_lshl_b32 s86, s3, 2
 s_add_u32 s86, s86, s76
 s_mul_i32 s89, s86, 2
 v_lshrrev_b32 v139, 2, v1
 v_min_u32 v140, 1, v139
 v_add_u32 v140, s89, v140
 v_and_b32 v141, 3, v1
 v_lshlrev_b32 v141, 7, v141
 v_mul_u32_u24 v140, 3584, v140
 v_add3_u32 v50, v140, v141, s88
 v_and_b32 v142, 7, v1
 v_lshlrev_b32 v142, 7, v142
 s_lshl_b32 s89, s86, 16
 s_lshl_b32 s90, s77, 10
 s_add_u32 s89, s89, s90
 s_bitcmp1_b32 s77, 0
 s_cselect_b32 s89, 0x40000000, s89
 v_lshl_or_b32 v140, v132, 13, v142
 v_add_u32 v52, s89, v140
 s_mov_b32 s35, 0x20000
 s_mov_b32 s39, 0x20000
 s_mov_b32 s81, 0
 s_and_b32 s79, s2, 7
 s_xor_b32 s79, s79, 4
 s_lshl_b32 s79, s79, 2
 s_lshr_b32 s88, s2, 6
 s_add_u32 s79, s79, s88
 s_bfe_u32 s80, s2, 0x30003
 s_lshl_b32 s87, s76, 12
 s_lshl_b32 s96, s76, 13
 s_add_u32 s96, s96, 65536
 s_lshl_b32 s88, s77, 2
 s_add_u32 s88, s88, s76
 s_lshl_b32 s88, s88, 8
 v_lshlrev_b32 v137, 13, v132
 v_add3_u32 v10, v137, v136, s88
 v_add3_u32 v11, v137, v138, s88
 v_add_u32 v11, 64512, v11
 v_add_u32 v12, 129024, v10
 v_add_u32 v13, 129024, v11
 v_xor_b32 v134, v133, v130
 v_lshl_or_b32 v134, v134, 5, v135
 v_lshl_or_b32 v28, v132, 10, v134
 v_add_u32 v29, 7168, v28
 v_add_u32 v30, 14336, v28
 v_add_u32 v31, 21504, v28
 v_lshrrev_b32 v146, 2, v129
 v_and_b32 v147, 3, v129
 v_lshlrev_b32 v147, 3, v147
 v_and_b32 v148, 1, v130
 v_lshrrev_b32 v149, 3, v129
 v_lshl_or_b32 v149, v148, 1, v149
 v_lshl_or_b32 v150, v148, 2, v146
 v_lshl_or_b32 v149, v149, 5, v147
 v_lshl_or_b32 v150, v150, 5, v147
 v_lshl_add_u32 v151, v130, 3, v146
 v_lshl_add_u32 v152, v130, 2, v146
 v_lshl_or_b32 v153, v151, 7, v149
 v_add_u32 v2, s83, v153
 v_lshl_or_b32 v153, v152, 7, v149
 v_add_u32 v153, s96, v153
 v_lshl_or_b32 v154, v152, 8, v150
 v_add_u32 v154, 65536, v154
 v_accvgpr_write_b32 a248, v153
 v_accvgpr_write_b32 a249, v154
 v_xor_b32 v3, 32, v2
 v_xor_b32 v4, 64, v2
 v_xor_b32 v5, 96, v2
 v_xor_b32 v155, v129, v130
 v_lshlrev_b32 v155, 4, v155
 v_lshl_or_b32 v156, v129, 8, v155
 v_accvgpr_write_b32 a250, v156
 v_lshl_or_b32 v16, v130, 8, v155
 v_xor_b32 v17, 64, v16
 v_xor_b32 v18, 128, v16
 v_xor_b32 v19, 192, v16
 v_lshrrev_b32 v156, 1, v129
 v_xor_b32 v156, v156, v130
 v_lshl_or_b32 v156, v156, 5, v135
 v_lshl_or_b32 v156, v130, 8, v156
 v_accvgpr_write_b32 a251, v156
 v_lshl_or_b32 v156, v130, 8, v155
 v_add_u32 v14, 98304, v156
 v_xor_b32 v15, 64, v14
 v_and_b32 v156, 7, v129
 v_xor_b32 v156, v156, v130
 v_lshlrev_b32 v156, 4, v156
 v_lshl_or_b32 v156, v147, 5, v156
 v_lshl_or_b32 v156, v146, 10, v156
 s_lshl_b32 s88, s76, 14
 s_add_u32 s88, s88, 98304
 v_add_u32 v60, s88, v156
 v_xor_b32 v61, 64, v60
 v_xor_b32 v62, 128, v60
 v_xor_b32 v63, 192, v60
 s_and_b32 s95, s3, 14
 v_subrev_u32 v156, s95, v146
 v_and_b32 v157, 1, v156
 v_and_b32 v158, 3, v129
 v_lshl_or_b32 v157, v157, 2, v158
 v_xor_b32 v157, v157, v130
 v_lshlrev_b32 v157, 4, v157
 v_lshl_or_b32 v157, v158, 8, v157
 v_add_u32 v157, s88, v157
 v_add_u32 v158, 0, v156
 v_and_b32 v158, 15, v158
 v_lshl_add_u32 v60, v158, 10, v157
 v_add_u32 v158, 4, v156
 v_and_b32 v158, 15, v158
 v_lshl_add_u32 v61, v158, 10, v157
 v_add_u32 v158, 8, v156
 v_and_b32 v158, 15, v158
 v_lshl_add_u32 v62, v158, 10, v157
 v_add_u32 v158, 12, v156
 v_and_b32 v158, 15, v158
 v_lshl_add_u32 v63, v158, 10, v157
 v_mov_b32 v24, 0xff800000
 v_mov_b32 v25, 0xff800000
 v_mov_b32 v26, 0xff800000
 v_mov_b32 v27, 0xff800000
 s_mul_i32 s88, s77, 7
 s_and_b32 s89, s77, 1
 s_add_u32 s90, s88, s89
 s_lshl_b32 s91, s76, 1
 s_add_u32 s90, s90, s91
 s_mul_i32 s92, s78, 229376
 s_lshl_b32 s91, s90, 12
 s_add_u32 s92, s92, s91
 s_cmp_eq_u32 s82, 1
 s_cselect_b32 s92, 0x40000000, s92
 s_add_u32 s93, s92, 4096
 s_lshl_b32 s94, s78, 10
 s_lshl_b32 s88, s76, 8
 s_lshl_b32 s89, s77, 2
 s_add_u32 s94, s94, s88
 s_add_u32 s94, s94, s89
 s_add_u32 s94, s94, 25165824
 s_mov_b32 s97, 0xc13504f3
 s_mov_b32 s98, 0x3e0293ee
 s_waitcnt lgkmcnt(0)
 s_mov_b32 s72, s86
 s_mov_b32 s74, s94
 s_lshl_b32 s88, s77, 19
 s_add_u32 s32, s32, s88
 s_addc_u32 s33, s33, 0
 s_add_u32 s36, s36, s88
 s_addc_u32 s37, s37, 0
 s_sub_u32 s34, 0x400000, s88
 s_sub_u32 s38, 0x400000, s88
 s_mov_b64 exec, 0
 s_cmp_eq_u32 s76, 0
 s_cbranch_scc1 L_pg1
 s_cmp_eq_u32 s76, 1
 s_cbranch_scc1 L_pg2
 s_cmp_eq_u32 s76, 2
 s_cbranch_scc1 L_pg3
 s_branch L_pg4
L_site0:
 s_mov_b64 exec, -1
 s_nop 0
 v_mov_b32 v56, 0x3727c5ac
 s_waitcnt vmcnt(12)
 s_and_b32 s95, s3, 14
 s_mul_i32 s84, s95, 114688
 s_add_u32 m0, s83, 16384
 v_lshlrev_b32 v64, 16, v192
 v_and_b32 v65, 0xffff0000, v192
 v_lshlrev_b32 v66, 16, v193
 v_and_b32 v67, 0xffff0000, v193
 v_lshlrev_b32 v68, 16, v194
 v_and_b32 v69, 0xffff0000, v194
 v_lshlrev_b32 v70, 16, v195
 v_and_b32 v71, 0xffff0000, v195
 v_lshlrev_b32 v72, 16, v196
 v_and_b32 v73, 0xffff0000, v196
 v_lshlrev_b32 v74, 16, v197
 buffer_load_dwordx4 v6, s[48:51], s84 offen offset:0 lds
 v_and_b32 v75, 0xffff0000, v197
 v_lshlrev_b32 v76, 16, v198
 v_and_b32 v77, 0xffff0000, v198
 v_lshlrev_b32 v78, 16, v199
 v_and_b32 v79, 0xffff0000, v199
 v_lshlrev_b32 v80, 16, v200
 v_and_b32 v81, 0xffff0000, v200
 v_lshlrev_b32 v82, 16, v201
 v_and_b32 v83, 0xffff0000, v201
 v_lshlrev_b32 v84, 16, v202
 v_and_b32 v85, 0xffff0000, v202
 v_lshlrev_b32 v86, 16, v203
 v_and_b32 v87, 0xffff0000, v203
 v_lshlrev_b32 v88, 16, v204
 v_and_b32 v89, 0xffff0000, v204
 v_lshlrev_b32 v90, 16, v205
 v_and_b32 v91, 0xffff0000, v205
 v_lshlrev_b32 v92, 16, v206
 v_and_b32 v93, 0xffff0000, v206
 v_lshlrev_b32 v94, 16, v207
 buffer_load_dwordx4 v7, s[48:51], s84 offen offset:1024 lds
 v_and_b32 v95, 0xffff0000, v207
 v_pk_add_f32 v[32:33], v[64:65], v[66:67]
 v_pk_add_f32 v[48:49], v[68:69], v[70:71]
 v_pk_add_f32 v[32:33], v[32:33], v[72:73]
 v_pk_add_f32 v[48:49], v[48:49], v[74:75]
 v_pk_add_f32 v[32:33], v[32:33], v[76:77]
 v_pk_add_f32 v[48:49], v[48:49], v[78:79]
 v_pk_add_f32 v[32:33], v[32:33], v[80:81]
 v_pk_add_f32 v[48:49], v[48:49], v[82:83]
 v_pk_add_f32 v[32:33], v[32:33], v[84:85]
 v_pk_add_f32 v[48:49], v[48:49], v[86:87]
 v_pk_add_f32 v[32:33], v[32:33], v[88:89]
 v_pk_add_f32 v[48:49], v[48:49], v[90:91]
 v_pk_add_f32 v[32:33], v[32:33], v[92:93]
 v_pk_add_f32 v[48:49], v[48:49], v[94:95]
 v_pk_add_f32 v[32:33], v[32:33], v[48:49]
 s_waitcnt vmcnt(10)
 v_lshlrev_b32 v96, 16, v208
 v_and_b32 v97, 0xffff0000, v208
 v_lshlrev_b32 v98, 16, v209
 v_and_b32 v99, 0xffff0000, v209
 v_lshlrev_b32 v100, 16, v210
 v_and_b32 v101, 0xffff0000, v210
 v_lshlrev_b32 v102, 16, v211
 v_and_b32 v103, 0xffff0000, v211
 v_lshlrev_b32 v104, 16, v212
 buffer_load_dwordx4 v8, s[48:51], s84 offen offset:2048 lds
 v_and_b32 v105, 0xffff0000, v212
 v_lshlrev_b32 v106, 16, v213
 v_and_b32 v107, 0xffff0000, v213
 v_lshlrev_b32 v108, 16, v214
 v_and_b32 v109, 0xffff0000, v214
 v_lshlrev_b32 v110, 16, v215
 v_and_b32 v111, 0xffff0000, v215
 v_lshlrev_b32 v112, 16, v216
 v_and_b32 v113, 0xffff0000, v216
 v_lshlrev_b32 v114, 16, v217
 v_and_b32 v115, 0xffff0000, v217
 v_lshlrev_b32 v116, 16, v218
 v_and_b32 v117, 0xffff0000, v218
 v_lshlrev_b32 v118, 16, v219
 v_and_b32 v119, 0xffff0000, v219
 v_lshlrev_b32 v120, 16, v220
 v_and_b32 v121, 0xffff0000, v220
 v_lshlrev_b32 v122, 16, v221
 v_and_b32 v123, 0xffff0000, v221
 v_lshlrev_b32 v124, 16, v222
 v_and_b32 v125, 0xffff0000, v222
 v_lshlrev_b32 v126, 16, v223
 v_and_b32 v127, 0xffff0000, v223
 v_pk_add_f32 v[34:35], v[96:97], v[98:99]
 v_pk_add_f32 v[48:49], v[100:101], v[102:103]
 v_pk_add_f32 v[34:35], v[34:35], v[104:105]
 v_pk_add_f32 v[48:49], v[48:49], v[106:107]
 v_pk_add_f32 v[34:35], v[34:35], v[108:109]
 v_pk_add_f32 v[48:49], v[48:49], v[110:111]
 v_pk_add_f32 v[34:35], v[34:35], v[112:113]
 buffer_load_dwordx4 v9, s[48:51], s84 offen offset:3072 lds
 s_add_u32 s95, s95, 1
 s_mul_i32 s99, s95, 114688
 s_add_u32 m0, s83, 20480
 v_pk_add_f32 v[48:49], v[48:49], v[114:115]
 v_pk_add_f32 v[34:35], v[34:35], v[116:117]
 v_pk_add_f32 v[48:49], v[48:49], v[118:119]
 v_pk_add_f32 v[34:35], v[34:35], v[120:121]
 v_pk_add_f32 v[48:49], v[48:49], v[122:123]
 v_pk_add_f32 v[34:35], v[34:35], v[124:125]
 v_pk_add_f32 v[48:49], v[48:49], v[126:127]
 v_pk_add_f32 v[34:35], v[34:35], v[48:49]
 v_add_f32 v40, v32, v33
 v_add_f32 v42, v34, v35
 s_nop 0
 v_add_f32_dpp v40, v40, v40 row_ror:8 row_mask:0xf bank_mask:0xf
 v_add_f32_dpp v42, v42, v42 row_ror:8 row_mask:0xf bank_mask:0xf
 s_nop 0
 v_add_f32_dpp v40, v40, v40 row_ror:4 row_mask:0xf bank_mask:0xf
 v_add_f32_dpp v42, v42, v42 row_ror:4 row_mask:0xf bank_mask:0xf
 s_nop 0
 v_add_f32_dpp v40, v40, v40 row_ror:2 row_mask:0xf bank_mask:0xf
 v_add_f32_dpp v42, v42, v42 row_ror:2 row_mask:0xf bank_mask:0xf
 s_nop 0
 v_add_f32_dpp v40, v40, v40 row_ror:1 row_mask:0xf bank_mask:0xf
 v_add_f32_dpp v42, v42, v42 row_ror:1 row_mask:0xf bank_mask:0xf
 v_mul_f32 v40, 0xbb000000, v40
 v_mul_f32 v42, 0xbb000000, v42
 v_pk_add_f32 v[64:65], v[64:65], v[40:41] op_sel_hi:[1,0]
 v_pk_add_f32 v[96:97], v[96:97], v[42:43] op_sel_hi:[1,0]
 v_pk_add_f32 v[66:67], v[66:67], v[40:41] op_sel_hi:[1,0]
 v_pk_add_f32 v[98:99], v[98:99], v[42:43] op_sel_hi:[1,0]
 v_pk_add_f32 v[68:69], v[68:69], v[40:41] op_sel_hi:[1,0]
 v_pk_add_f32 v[100:101], v[100:101], v[42:43] op_sel_hi:[1,0]
 buffer_load_dwordx4 v6, s[48:51], s99 offen offset:0 lds
 v_pk_add_f32 v[70:71], v[70:71], v[40:41] op_sel_hi:[1,0]
 v_pk_add_f32 v[102:103], v[102:103], v[42:43] op_sel_hi:[1,0]
 v_pk_add_f32 v[72:73], v[72:73], v[40:41] op_sel_hi:[1,0]
 v_pk_add_f32 v[104:105], v[104:105], v[42:43] op_sel_hi:[1,0]
 v_pk_add_f32 v[74:75], v[74:75], v[40:41] op_sel_hi:[1,0]
 v_pk_add_f32 v[106:107], v[106:107], v[42:43] op_sel_hi:[1,0]
 v_pk_add_f32 v[76:77], v[76:77], v[40:41] op_sel_hi:[1,0]
 v_pk_add_f32 v[108:109], v[108:109], v[42:43] op_sel_hi:[1,0]
 v_pk_add_f32 v[78:79], v[78:79], v[40:41] op_sel_hi:[1,0]
 v_pk_add_f32 v[110:111], v[110:111], v[42:43] op_sel_hi:[1,0]
 v_pk_add_f32 v[80:81], v[80:81], v[40:41] op_sel_hi:[1,0]
 v_pk_add_f32 v[112:113], v[112:113], v[42:43] op_sel_hi:[1,0]
 v_pk_add_f32 v[82:83], v[82:83], v[40:41] op_sel_hi:[1,0]
 v_pk_add_f32 v[114:115], v[114:115], v[42:43] op_sel_hi:[1,0]
 v_pk_add_f32 v[84:85], v[84:85], v[40:41] op_sel_hi:[1,0]
 v_pk_add_f32 v[116:117], v[116:117], v[42:43] op_sel_hi:[1,0]
 v_pk_add_f32 v[86:87], v[86:87], v[40:41] op_sel_hi:[1,0]
 v_pk_add_f32 v[118:119], v[118:119], v[42:43] op_sel_hi:[1,0]
 v_pk_add_f32 v[88:89], v[88:89], v[40:41] op_sel_hi:[1,0]
 v_pk_add_f32 v[120:121], v[120:121], v[42:43] op_sel_hi:[1,0]
 v_pk_add_f32 v[90:91], v[90:91], v[40:41] op_sel_hi:[1,0]
 v_pk_add_f32 v[122:123], v[122:123], v[42:43] op_sel_hi:[1,0]
 v_pk_add_f32 v[92:93], v[92:93], v[40:41] op_sel_hi:[1,0]
 v_pk_add_f32 v[124:125], v[124:125], v[42:43] op_sel_hi:[1,0]
 v_pk_add_f32 v[94:95], v[94:95], v[40:41] op_sel_hi:[1,0]
 v_pk_add_f32 v[126:127], v[126:127], v[42:43] op_sel_hi:[1,0]
 v_pk_mul_f32 v[32:33], v[64:65], v[64:65]
 v_pk_mul_f32 v[34:35], v[96:97], v[96:97]
 v_pk_fma_f32 v[32:33], v[66:67], v[66:67], v[32:33]
 v_pk_fma_f32 v[34:35], v[98:99], v[98:99], v[34:35]
 buffer_load_dwordx4 v7, s[48:51], s99 offen offset:1024 lds
 v_pk_fma_f32 v[32:33], v[68:69], v[68:69], v[32:33]
 v_pk_fma_f32 v[34:35], v[100:101], v[100:101], v[34:35]
 v_pk_fma_f32 v[32:33], v[70:71], v[70:71], v[32:33]
 v_pk_fma_f32 v[34:35], v[102:103], v[102:103], v[34:35]
 v_pk_fma_f32 v[32:33], v[72:73], v[72:73], v[32:33]
 v_pk_fma_f32 v[34:35], v[104:105], v[104:105], v[34:35]
 v_pk_fma_f32 v[32:33], v[74:75], v[74:75], v[32:33]
 v_pk_fma_f32 v[34:35], v[106:107], v[106:107], v[34:35]
 v_pk_fma_f32 v[32:33], v[76:77], v[76:77], v[32:33]
 v_pk_fma_f32 v[34:35], v[108:109], v[108:109], v[34:35]
 v_pk_fma_f32 v[32:33], v[78:79], v[78:79], v[32:33]
 v_pk_fma_f32 v[34:35], v[110:111], v[110:111], v[34:35]
 v_pk_fma_f32 v[32:33], v[80:81], v[80:81], v[32:33]
 v_pk_fma_f32 v[34:35], v[112:113], v[112:113], v[34:35]
 v_pk_fma_f32 v[32:33], v[82:83], v[82:83], v[32:33]
 v_pk_fma_f32 v[34:35], v[114:115], v[114:115], v[34:35]
 v_pk_fma_f32 v[32:33], v[84:85], v[84:85], v[32:33]
 v_pk_fma_f32 v[34:35], v[116:117], v[116:117], v[34:35]
 v_pk_fma_f32 v[32:33], v[86:87], v[86:87], v[32:33]
 v_pk_fma_f32 v[34:35], v[118:119], v[118:119], v[34:35]
 v_pk_fma_f32 v[32:33], v[88:89], v[88:89], v[32:33]
 v_pk_fma_f32 v[34:35], v[120:121], v[120:121], v[34:35]
 v_pk_fma_f32 v[32:33], v[90:91], v[90:91], v[32:33]
 v_pk_fma_f32 v[34:35], v[122:123], v[122:123], v[34:35]
 v_pk_fma_f32 v[32:33], v[92:93], v[92:93], v[32:33]
 v_pk_fma_f32 v[34:35], v[124:125], v[124:125], v[34:35]
 v_pk_fma_f32 v[32:33], v[94:95], v[94:95], v[32:33]
 v_pk_fma_f32 v[34:35], v[126:127], v[126:127], v[34:35]
 v_add_f32 v40, v32, v33
 v_add_f32 v42, v34, v35
 buffer_load_dwordx4 v8, s[48:51], s99 offen offset:2048 lds
 s_nop 0
 v_add_f32_dpp v40, v40, v40 row_ror:8 row_mask:0xf bank_mask:0xf
 v_add_f32_dpp v42, v42, v42 row_ror:8 row_mask:0xf bank_mask:0xf
 s_nop 0
 v_add_f32_dpp v40, v40, v40 row_ror:4 row_mask:0xf bank_mask:0xf
 v_add_f32_dpp v42, v42, v42 row_ror:4 row_mask:0xf bank_mask:0xf
 s_nop 0
 v_add_f32_dpp v40, v40, v40 row_ror:2 row_mask:0xf bank_mask:0xf
 v_add_f32_dpp v42, v42, v42 row_ror:2 row_mask:0xf bank_mask:0xf
 s_nop 0
 v_add_f32_dpp v40, v40, v40 row_ror:1 row_mask:0xf bank_mask:0xf
 v_add_f32_dpp v42, v42, v42 row_ror:1 row_mask:0xf bank_mask:0xf
 v_fmamk_f32 v40, v40, 0x3b000000, v56
 v_fmamk_f32 v42, v42, 0x3b000000, v56
 v_rsq_f32 v40, v40
 v_rsq_f32 v42, v42
 s_nop 0
 v_mul_f32 v40, 0x3e0293ee, v40
 v_mul_f32 v42, 0x3e0293ee, v42
 v_pk_mul_f32 v[64:65], v[64:65], v[40:41] op_sel_hi:[1,0]
 v_pk_mul_f32 v[66:67], v[66:67], v[40:41] op_sel_hi:[1,0]
 v_pk_mul_f32 v[68:69], v[68:69], v[40:41] op_sel_hi:[1,0]
 v_pk_mul_f32 v[70:71], v[70:71], v[40:41] op_sel_hi:[1,0]
 v_cvt_pk_bf16_f32 v192, v64, v65
 v_cvt_pk_bf16_f32 v193, v66, v67
 v_cvt_pk_bf16_f32 v194, v68, v69
 v_cvt_pk_bf16_f32 v195, v70, v71
 v_pk_mul_f32 v[72:73], v[72:73], v[40:41] op_sel_hi:[1,0]
 v_pk_mul_f32 v[74:75], v[74:75], v[40:41] op_sel_hi:[1,0]
 v_pk_mul_f32 v[76:77], v[76:77], v[40:41] op_sel_hi:[1,0]
 buffer_load_dwordx4 v9, s[48:51], s99 offen offset:3072 lds
 s_add_u32 s95, s95, 15
 s_and_b32 s95, s95, 15
 s_mul_i32 s84, s95, 114688
 s_add_u32 m0, s83, 32768
 v_pk_mul_f32 v[78:79], v[78:79], v[40:41] op_sel_hi:[1,0]
 ds_write_b128 v60, v[192:195]
 v_xor_b32 v60, 64, v60
 v_cvt_pk_bf16_f32 v196, v72, v73
 v_cvt_pk_bf16_f32 v197, v74, v75
 v_cvt_pk_bf16_f32 v198, v76, v77
 v_cvt_pk_bf16_f32 v199, v78, v79
 v_pk_mul_f32 v[80:81], v[80:81], v[40:41] op_sel_hi:[1,0]
 v_pk_mul_f32 v[82:83], v[82:83], v[40:41] op_sel_hi:[1,0]
 v_pk_mul_f32 v[84:85], v[84:85], v[40:41] op_sel_hi:[1,0]
 v_pk_mul_f32 v[86:87], v[86:87], v[40:41] op_sel_hi:[1,0]
 ds_write_b128 v61, v[196:199]
 v_xor_b32 v61, 64, v61
 v_cvt_pk_bf16_f32 v200, v80, v81
 v_cvt_pk_bf16_f32 v201, v82, v83
 v_cvt_pk_bf16_f32 v202, v84, v85
 v_cvt_pk_bf16_f32 v203, v86, v87
 v_pk_mul_f32 v[88:89], v[88:89], v[40:41] op_sel_hi:[1,0]
 v_pk_mul_f32 v[90:91], v[90:91], v[40:41] op_sel_hi:[1,0]
 v_pk_mul_f32 v[92:93], v[92:93], v[40:41] op_sel_hi:[1,0]
 v_pk_mul_f32 v[94:95], v[94:95], v[40:41] op_sel_hi:[1,0]
 ds_write_b128 v62, v[200:203]
 v_xor_b32 v62, 64, v62
 v_cvt_pk_bf16_f32 v204, v88, v89
 v_cvt_pk_bf16_f32 v205, v90, v91
 v_cvt_pk_bf16_f32 v206, v92, v93
 v_cvt_pk_bf16_f32 v207, v94, v95
 v_pk_mul_f32 v[96:97], v[96:97], v[42:43] op_sel_hi:[1,0]
 v_pk_mul_f32 v[98:99], v[98:99], v[42:43] op_sel_hi:[1,0]
 v_pk_mul_f32 v[100:101], v[100:101], v[42:43] op_sel_hi:[1,0]
 v_pk_mul_f32 v[102:103], v[102:103], v[42:43] op_sel_hi:[1,0]
 ds_write_b128 v63, v[204:207]
 v_xor_b32 v63, 64, v63
 v_cvt_pk_bf16_f32 v208, v96, v97
 v_cvt_pk_bf16_f32 v209, v98, v99
 v_cvt_pk_bf16_f32 v210, v100, v101
 v_cvt_pk_bf16_f32 v211, v102, v103
 v_pk_mul_f32 v[104:105], v[104:105], v[42:43] op_sel_hi:[1,0]
 v_pk_mul_f32 v[106:107], v[106:107], v[42:43] op_sel_hi:[1,0]
 v_pk_mul_f32 v[108:109], v[108:109], v[42:43] op_sel_hi:[1,0]
 v_pk_mul_f32 v[110:111], v[110:111], v[42:43] op_sel_hi:[1,0]
 ds_write_b128 v60, v[208:211]
 v_xor_b32 v60, 192, v60
 v_cvt_pk_bf16_f32 v212, v104, v105
 v_cvt_pk_bf16_f32 v213, v106, v107
 v_cvt_pk_bf16_f32 v214, v108, v109
 v_cvt_pk_bf16_f32 v215, v110, v111
 v_pk_mul_f32 v[112:113], v[112:113], v[42:43] op_sel_hi:[1,0]
 v_pk_mul_f32 v[114:115], v[114:115], v[42:43] op_sel_hi:[1,0]
 v_pk_mul_f32 v[116:117], v[116:117], v[42:43] op_sel_hi:[1,0]
 v_pk_mul_f32 v[118:119], v[118:119], v[42:43] op_sel_hi:[1,0]
 ds_write_b128 v61, v[212:215]
 v_xor_b32 v61, 192, v61
 v_cvt_pk_bf16_f32 v216, v112, v113
 v_cvt_pk_bf16_f32 v217, v114, v115
 v_cvt_pk_bf16_f32 v218, v116, v117
 v_cvt_pk_bf16_f32 v219, v118, v119
 v_pk_mul_f32 v[120:121], v[120:121], v[42:43] op_sel_hi:[1,0]
 v_pk_mul_f32 v[122:123], v[122:123], v[42:43] op_sel_hi:[1,0]
 v_pk_mul_f32 v[124:125], v[124:125], v[42:43] op_sel_hi:[1,0]
 v_pk_mul_f32 v[126:127], v[126:127], v[42:43] op_sel_hi:[1,0]
 ds_write_b128 v62, v[216:219]
 v_xor_b32 v62, 192, v62
 v_cvt_pk_bf16_f32 v220, v120, v121
 v_cvt_pk_bf16_f32 v221, v122, v123
 v_cvt_pk_bf16_f32 v222, v124, v125
 v_cvt_pk_bf16_f32 v223, v126, v127
 ds_write_b128 v63, v[220:223]
 v_xor_b32 v63, 192, v63
 s_waitcnt vmcnt(8)
 v_lshlrev_b32 v128, 16, v224
 v_and_b32 v129, 0xffff0000, v224
 v_lshlrev_b32 v130, 16, v225
 v_and_b32 v131, 0xffff0000, v225
 v_lshlrev_b32 v132, 16, v226
 v_and_b32 v133, 0xffff0000, v226
 v_lshlrev_b32 v134, 16, v227
 v_and_b32 v135, 0xffff0000, v227
 v_lshlrev_b32 v136, 16, v228
 v_and_b32 v137, 0xffff0000, v228
 v_lshlrev_b32 v138, 16, v229
 v_and_b32 v139, 0xffff0000, v229
 v_lshlrev_b32 v140, 16, v230
 v_and_b32 v141, 0xffff0000, v230
 v_lshlrev_b32 v142, 16, v231
 v_and_b32 v143, 0xffff0000, v231
 v_lshlrev_b32 v144, 16, v232
 v_and_b32 v145, 0xffff0000, v232
 v_lshlrev_b32 v146, 16, v233
 v_and_b32 v147, 0xffff0000, v233
 v_lshlrev_b32 v148, 16, v234
 v_and_b32 v149, 0xffff0000, v234
 v_lshlrev_b32 v150, 16, v235
 v_and_b32 v151, 0xffff0000, v235
 v_lshlrev_b32 v152, 16, v236
 v_and_b32 v153, 0xffff0000, v236
 v_lshlrev_b32 v154, 16, v237
 v_and_b32 v155, 0xffff0000, v237
 v_lshlrev_b32 v156, 16, v238
 v_and_b32 v157, 0xffff0000, v238
 v_lshlrev_b32 v158, 16, v239
 v_and_b32 v159, 0xffff0000, v239
 v_pk_add_f32 v[36:37], v[128:129], v[130:131]
 v_pk_add_f32 v[48:49], v[132:133], v[134:135]
 v_pk_add_f32 v[36:37], v[36:37], v[136:137]
 v_pk_add_f32 v[48:49], v[48:49], v[138:139]
 v_pk_add_f32 v[36:37], v[36:37], v[140:141]
 v_pk_add_f32 v[48:49], v[48:49], v[142:143]
 v_pk_add_f32 v[36:37], v[36:37], v[144:145]
 v_pk_add_f32 v[48:49], v[48:49], v[146:147]
 v_pk_add_f32 v[36:37], v[36:37], v[148:149]
 v_pk_add_f32 v[48:49], v[48:49], v[150:151]
 v_pk_add_f32 v[36:37], v[36:37], v[152:153]
 v_pk_add_f32 v[48:49], v[48:49], v[154:155]
 v_pk_add_f32 v[36:37], v[36:37], v[156:157]
 v_pk_add_f32 v[48:49], v[48:49], v[158:159]
 v_pk_add_f32 v[36:37], v[36:37], v[48:49]
 v_lshlrev_b32 v160, 16, v240
 v_and_b32 v161, 0xffff0000, v240
 v_lshlrev_b32 v162, 16, v241
 v_and_b32 v163, 0xffff0000, v241
 v_lshlrev_b32 v164, 16, v242
 v_and_b32 v165, 0xffff0000, v242
 v_lshlrev_b32 v166, 16, v243
 v_and_b32 v167, 0xffff0000, v243
 v_lshlrev_b32 v168, 16, v244
 v_and_b32 v169, 0xffff0000, v244
 v_lshlrev_b32 v170, 16, v245
 v_and_b32 v171, 0xffff0000, v245
 v_lshlrev_b32 v172, 16, v246
 v_and_b32 v173, 0xffff0000, v246
 v_lshlrev_b32 v174, 16, v247
 v_and_b32 v175, 0xffff0000, v247
 v_lshlrev_b32 v176, 16, v248
 v_and_b32 v177, 0xffff0000, v248
 v_lshlrev_b32 v178, 16, v249
 v_and_b32 v179, 0xffff0000, v249
 v_lshlrev_b32 v180, 16, v250
 v_and_b32 v181, 0xffff0000, v250
 v_lshlrev_b32 v182, 16, v251
 v_and_b32 v183, 0xffff0000, v251
 v_lshlrev_b32 v184, 16, v252
 v_and_b32 v185, 0xffff0000, v252
 v_lshlrev_b32 v186, 16, v253
 v_and_b32 v187, 0xffff0000, v253
 v_lshlrev_b32 v188, 16, v254
 v_and_b32 v189, 0xffff0000, v254
 v_lshlrev_b32 v190, 16, v255
 v_and_b32 v191, 0xffff0000, v255
 v_pk_add_f32 v[38:39], v[160:161], v[162:163]
 v_pk_add_f32 v[48:49], v[164:165], v[166:167]
 v_pk_add_f32 v[38:39], v[38:39], v[168:169]
 v_pk_add_f32 v[48:49], v[48:49], v[170:171]
 v_pk_add_f32 v[38:39], v[38:39], v[172:173]
 v_pk_add_f32 v[48:49], v[48:49], v[174:175]
 v_pk_add_f32 v[38:39], v[38:39], v[176:177]
 v_pk_add_f32 v[48:49], v[48:49], v[178:179]
 v_pk_add_f32 v[38:39], v[38:39], v[180:181]
 v_pk_add_f32 v[48:49], v[48:49], v[182:183]
 v_pk_add_f32 v[38:39], v[38:39], v[184:185]
 v_pk_add_f32 v[48:49], v[48:49], v[186:187]
 v_pk_add_f32 v[38:39], v[38:39], v[188:189]
 v_pk_add_f32 v[48:49], v[48:49], v[190:191]
 v_pk_add_f32 v[38:39], v[38:39], v[48:49]
 v_add_f32 v44, v36, v37
 v_add_f32 v46, v38, v39
 s_nop 0
 v_add_f32_dpp v44, v44, v44 row_ror:8 row_mask:0xf bank_mask:0xf
 v_add_f32_dpp v46, v46, v46 row_ror:8 row_mask:0xf bank_mask:0xf
 s_nop 0
 v_add_f32_dpp v44, v44, v44 row_ror:4 row_mask:0xf bank_mask:0xf
 v_add_f32_dpp v46, v46, v46 row_ror:4 row_mask:0xf bank_mask:0xf
 s_nop 0
 v_add_f32_dpp v44, v44, v44 row_ror:2 row_mask:0xf bank_mask:0xf
 v_add_f32_dpp v46, v46, v46 row_ror:2 row_mask:0xf bank_mask:0xf
 s_nop 0
 v_add_f32_dpp v44, v44, v44 row_ror:1 row_mask:0xf bank_mask:0xf
 v_add_f32_dpp v46, v46, v46 row_ror:1 row_mask:0xf bank_mask:0xf
 v_mul_f32 v44, 0xbb000000, v44
 v_mul_f32 v46, 0xbb000000, v46
 v_pk_add_f32 v[128:129], v[128:129], v[44:45] op_sel_hi:[1,0]
 v_pk_add_f32 v[160:161], v[160:161], v[46:47] op_sel_hi:[1,0]
 v_pk_add_f32 v[130:131], v[130:131], v[44:45] op_sel_hi:[1,0]
 v_pk_add_f32 v[162:163], v[162:163], v[46:47] op_sel_hi:[1,0]
 v_pk_add_f32 v[132:133], v[132:133], v[44:45] op_sel_hi:[1,0]
 v_pk_add_f32 v[164:165], v[164:165], v[46:47] op_sel_hi:[1,0]
 v_pk_add_f32 v[134:135], v[134:135], v[44:45] op_sel_hi:[1,0]
L_pg1:
 s_cbranch_execz L_pg5
 v_pk_add_f32 v[166:167], v[166:167], v[46:47] op_sel_hi:[1,0]
 v_pk_add_f32 v[136:137], v[136:137], v[44:45] op_sel_hi:[1,0]
 v_pk_add_f32 v[168:169], v[168:169], v[46:47] op_sel_hi:[1,0]
 v_pk_add_f32 v[138:139], v[138:139], v[44:45] op_sel_hi:[1,0]
 buffer_load_dwordx4 v6, s[52:55], s84 offen offset:0 lds
 v_pk_add_f32 v[170:171], v[170:171], v[46:47] op_sel_hi:[1,0]
 v_pk_add_f32 v[140:141], v[140:141], v[44:45] op_sel_hi:[1,0]
 v_pk_add_f32 v[172:173], v[172:173], v[46:47] op_sel_hi:[1,0]
 v_pk_add_f32 v[142:143], v[142:143], v[44:45] op_sel_hi:[1,0]
 v_pk_add_f32 v[174:175], v[174:175], v[46:47] op_sel_hi:[1,0]
 v_pk_add_f32 v[144:145], v[144:145], v[44:45] op_sel_hi:[1,0]
 v_pk_add_f32 v[176:177], v[176:177], v[46:47] op_sel_hi:[1,0]
 v_pk_add_f32 v[146:147], v[146:147], v[44:45] op_sel_hi:[1,0]
 v_pk_add_f32 v[178:179], v[178:179], v[46:47] op_sel_hi:[1,0]
 v_pk_add_f32 v[148:149], v[148:149], v[44:45] op_sel_hi:[1,0]
 buffer_load_dwordx4 v7, s[52:55], s84 offen offset:1024 lds
 v_pk_add_f32 v[180:181], v[180:181], v[46:47] op_sel_hi:[1,0]
 v_pk_add_f32 v[150:151], v[150:151], v[44:45] op_sel_hi:[1,0]
 v_pk_add_f32 v[182:183], v[182:183], v[46:47] op_sel_hi:[1,0]
 v_pk_add_f32 v[152:153], v[152:153], v[44:45] op_sel_hi:[1,0]
 v_pk_add_f32 v[184:185], v[184:185], v[46:47] op_sel_hi:[1,0]
 v_pk_add_f32 v[154:155], v[154:155], v[44:45] op_sel_hi:[1,0]
 v_pk_add_f32 v[186:187], v[186:187], v[46:47] op_sel_hi:[1,0]
 v_pk_add_f32 v[156:157], v[156:157], v[44:45] op_sel_hi:[1,0]
 v_pk_add_f32 v[188:189], v[188:189], v[46:47] op_sel_hi:[1,0]
 v_pk_add_f32 v[158:159], v[158:159], v[44:45] op_sel_hi:[1,0]
 buffer_load_dwordx4 v8, s[52:55], s84 offen offset:2048 lds
 v_pk_add_f32 v[190:191], v[190:191], v[46:47] op_sel_hi:[1,0]
 v_pk_mul_f32 v[36:37], v[128:129], v[128:129]
 v_pk_mul_f32 v[38:39], v[160:161], v[160:161]
 v_pk_fma_f32 v[36:37], v[130:131], v[130:131], v[36:37]
 v_pk_fma_f32 v[38:39], v[162:163], v[162:163], v[38:39]
 v_pk_fma_f32 v[36:37], v[132:133], v[132:133], v[36:37]
 v_pk_fma_f32 v[38:39], v[164:165], v[164:165], v[38:39]
 v_pk_fma_f32 v[36:37], v[134:135], v[134:135], v[36:37]
 v_pk_fma_f32 v[38:39], v[166:167], v[166:167], v[38:39]
 v_pk_fma_f32 v[36:37], v[136:137], v[136:137], v[36:37]
 buffer_load_dwordx4 v9, s[52:55], s84 offen offset:3072 lds
 s_add_u32 s95, s95, 1
 s_mul_i32 s99, s95, 114688
 s_add_u32 m0, s83, 36864
 v_pk_fma_f32 v[38:39], v[168:169], v[168:169], v[38:39]
 v_pk_fma_f32 v[36:37], v[138:139], v[138:139], v[36:37]
 v_pk_fma_f32 v[38:39], v[170:171], v[170:171], v[38:39]
 v_pk_fma_f32 v[36:37], v[140:141], v[140:141], v[36:37]
 v_pk_fma_f32 v[38:39], v[172:173], v[172:173], v[38:39]
 v_pk_fma_f32 v[36:37], v[142:143], v[142:143], v[36:37]
 v_pk_fma_f32 v[38:39], v[174:175], v[174:175], v[38:39]
 v_pk_fma_f32 v[36:37], v[144:145], v[144:145], v[36:37]
 v_pk_fma_f32 v[38:39], v[176:177], v[176:177], v[38:39]
 v_pk_fma_f32 v[36:37], v[146:147], v[146:147], v[36:37]
 buffer_load_dwordx4 v6, s[52:55], s99 offen offset:0 lds
 v_pk_fma_f32 v[38:39], v[178:179], v[178:179], v[38:39]
 v_pk_fma_f32 v[36:37], v[148:149], v[148:149], v[36:37]
 v_pk_fma_f32 v[38:39], v[180:181], v[180:181], v[38:39]
 v_pk_fma_f32 v[36:37], v[150:151], v[150:151], v[36:37]
 v_pk_fma_f32 v[38:39], v[182:183], v[182:183], v[38:39]
 v_pk_fma_f32 v[36:37], v[152:153], v[152:153], v[36:37]
 v_pk_fma_f32 v[38:39], v[184:185], v[184:185], v[38:39]
 v_pk_fma_f32 v[36:37], v[154:155], v[154:155], v[36:37]
 v_pk_fma_f32 v[38:39], v[186:187], v[186:187], v[38:39]
 v_pk_fma_f32 v[36:37], v[156:157], v[156:157], v[36:37]
 buffer_load_dwordx4 v7, s[52:55], s99 offen offset:1024 lds
 v_pk_fma_f32 v[38:39], v[188:189], v[188:189], v[38:39]
 v_pk_fma_f32 v[36:37], v[158:159], v[158:159], v[36:37]
 v_pk_fma_f32 v[38:39], v[190:191], v[190:191], v[38:39]
 v_add_f32 v44, v36, v37
 v_add_f32 v46, v38, v39
 s_nop 0
 v_add_f32_dpp v44, v44, v44 row_ror:8 row_mask:0xf bank_mask:0xf
 v_add_f32_dpp v46, v46, v46 row_ror:8 row_mask:0xf bank_mask:0xf
 s_nop 0
 v_add_f32_dpp v44, v44, v44 row_ror:4 row_mask:0xf bank_mask:0xf
 buffer_load_dwordx4 v8, s[52:55], s99 offen offset:2048 lds
 v_add_f32_dpp v46, v46, v46 row_ror:4 row_mask:0xf bank_mask:0xf
 s_nop 0
 v_add_f32_dpp v44, v44, v44 row_ror:2 row_mask:0xf bank_mask:0xf
 v_add_f32_dpp v46, v46, v46 row_ror:2 row_mask:0xf bank_mask:0xf
 s_nop 0
 v_add_f32_dpp v44, v44, v44 row_ror:1 row_mask:0xf bank_mask:0xf
 v_add_f32_dpp v46, v46, v46 row_ror:1 row_mask:0xf bank_mask:0xf
 v_fmamk_f32 v44, v44, 0x3b000000, v56
 v_fmamk_f32 v46, v46, 0x3b000000, v56
 v_rsq_f32 v44, v44
 buffer_load_dwordx4 v9, s[52:55], s99 offen offset:3072 lds
 s_add_u32 s95, s95, 1
 s_and_b32 s95, s95, 15
 s_mul_i32 s84, s95, 114688
 s_add_u32 m0, s83, 0
 v_rsq_f32 v46, v46
 s_nop 0
 v_mul_f32 v44, 0x3e0293ee, v44
 v_mul_f32 v46, 0x3e0293ee, v46
 v_pk_mul_f32 v[128:129], v[128:129], v[44:45] op_sel_hi:[1,0]
 v_pk_mul_f32 v[130:131], v[130:131], v[44:45] op_sel_hi:[1,0]
 v_pk_mul_f32 v[132:133], v[132:133], v[44:45] op_sel_hi:[1,0]
 v_pk_mul_f32 v[134:135], v[134:135], v[44:45] op_sel_hi:[1,0]
 v_cvt_pk_bf16_f32 v224, v128, v129
 v_cvt_pk_bf16_f32 v225, v130, v131
 buffer_load_dwordx4 v6, s[48:51], s84 offen offset:0 lds
 v_cvt_pk_bf16_f32 v226, v132, v133
 v_cvt_pk_bf16_f32 v227, v134, v135
 v_pk_mul_f32 v[136:137], v[136:137], v[44:45] op_sel_hi:[1,0]
 v_pk_mul_f32 v[138:139], v[138:139], v[44:45] op_sel_hi:[1,0]
 v_pk_mul_f32 v[140:141], v[140:141], v[44:45] op_sel_hi:[1,0]
 v_pk_mul_f32 v[142:143], v[142:143], v[44:45] op_sel_hi:[1,0]
 ds_write_b128 v60, v[224:227]
 v_xor_b32 v60, 64, v60
 v_cvt_pk_bf16_f32 v228, v136, v137
 v_cvt_pk_bf16_f32 v229, v138, v139
 buffer_load_dwordx4 v7, s[48:51], s84 offen offset:1024 lds
 v_cvt_pk_bf16_f32 v230, v140, v141
 v_cvt_pk_bf16_f32 v231, v142, v143
 v_pk_mul_f32 v[144:145], v[144:145], v[44:45] op_sel_hi:[1,0]
 v_pk_mul_f32 v[146:147], v[146:147], v[44:45] op_sel_hi:[1,0]
 v_pk_mul_f32 v[148:149], v[148:149], v[44:45] op_sel_hi:[1,0]
 v_pk_mul_f32 v[150:151], v[150:151], v[44:45] op_sel_hi:[1,0]
 ds_write_b128 v61, v[228:231]
 v_xor_b32 v61, 64, v61
 v_cvt_pk_bf16_f32 v232, v144, v145
 v_cvt_pk_bf16_f32 v233, v146, v147
 buffer_load_dwordx4 v8, s[48:51], s84 offen offset:2048 lds
 v_cvt_pk_bf16_f32 v234, v148, v149
 v_cvt_pk_bf16_f32 v235, v150, v151
 v_pk_mul_f32 v[152:153], v[152:153], v[44:45] op_sel_hi:[1,0]
 v_pk_mul_f32 v[154:155], v[154:155], v[44:45] op_sel_hi:[1,0]
 v_pk_mul_f32 v[156:157], v[156:157], v[44:45] op_sel_hi:[1,0]
 v_pk_mul_f32 v[158:159], v[158:159], v[44:45] op_sel_hi:[1,0]
 ds_write_b128 v62, v[232:235]
 v_xor_b32 v62, 64, v62
 v_cvt_pk_bf16_f32 v236, v152, v153
 v_cvt_pk_bf16_f32 v237, v154, v155
 buffer_load_dwordx4 v9, s[48:51], s84 offen offset:3072 lds
 s_add_u32 s95, s95, 1
 s_mul_i32 s99, s95, 114688
 s_add_u32 m0, s83, 4096
 v_cvt_pk_bf16_f32 v238, v156, v157
 v_cvt_pk_bf16_f32 v239, v158, v159
 v_pk_mul_f32 v[160:161], v[160:161], v[46:47] op_sel_hi:[1,0]
 v_pk_mul_f32 v[162:163], v[162:163], v[46:47] op_sel_hi:[1,0]
 v_pk_mul_f32 v[164:165], v[164:165], v[46:47] op_sel_hi:[1,0]
 v_pk_mul_f32 v[166:167], v[166:167], v[46:47] op_sel_hi:[1,0]
 ds_write_b128 v63, v[236:239]
 v_xor_b32 v63, 64, v63
 v_cvt_pk_bf16_f32 v240, v160, v161
 v_cvt_pk_bf16_f32 v241, v162, v163
 v_cvt_pk_bf16_f32 v242, v164, v165
 v_cvt_pk_bf16_f32 v243, v166, v167
 v_pk_mul_f32 v[168:169], v[168:169], v[46:47] op_sel_hi:[1,0]
 v_pk_mul_f32 v[170:171], v[170:171], v[46:47] op_sel_hi:[1,0]
 v_pk_mul_f32 v[172:173], v[172:173], v[46:47] op_sel_hi:[1,0]
 v_pk_mul_f32 v[174:175], v[174:175], v[46:47] op_sel_hi:[1,0]
 ds_write_b128 v60, v[240:243]
 v_cvt_pk_bf16_f32 v244, v168, v169
 v_cvt_pk_bf16_f32 v245, v170, v171
 v_cvt_pk_bf16_f32 v246, v172, v173
 v_cvt_pk_bf16_f32 v247, v174, v175
 v_pk_mul_f32 v[176:177], v[176:177], v[46:47] op_sel_hi:[1,0]
 v_pk_mul_f32 v[178:179], v[178:179], v[46:47] op_sel_hi:[1,0]
 v_pk_mul_f32 v[180:181], v[180:181], v[46:47] op_sel_hi:[1,0]
 v_pk_mul_f32 v[182:183], v[182:183], v[46:47] op_sel_hi:[1,0]
 ds_write_b128 v61, v[244:247]
 v_cvt_pk_bf16_f32 v248, v176, v177
 v_cvt_pk_bf16_f32 v249, v178, v179
 v_cvt_pk_bf16_f32 v250, v180, v181
 v_cvt_pk_bf16_f32 v251, v182, v183
 v_pk_mul_f32 v[184:185], v[184:185], v[46:47] op_sel_hi:[1,0]
 v_pk_mul_f32 v[186:187], v[186:187], v[46:47] op_sel_hi:[1,0]
 v_pk_mul_f32 v[188:189], v[188:189], v[46:47] op_sel_hi:[1,0]
 v_pk_mul_f32 v[190:191], v[190:191], v[46:47] op_sel_hi:[1,0]
 ds_write_b128 v62, v[248:251]
 v_cvt_pk_bf16_f32 v252, v184, v185
 v_cvt_pk_bf16_f32 v253, v186, v187
 v_cvt_pk_bf16_f32 v254, v188, v189
 v_cvt_pk_bf16_f32 v255, v190, v191
 ds_write_b128 v63, v[252:255]
 s_waitcnt lgkmcnt(0)
 s_barrier
 s_cmp_eq_u32 s82, 1
 s_cbranch_scc1 L_idle
 s_waitcnt vmcnt(12)
 ds_read_b128 a[192:195], v14 offset:0
 ds_read_b128 a[196:199], v14 offset:16384
 ds_read_b128 a[200:203], v14 offset:32768
 ds_read_b128 a[204:207], v14 offset:49152
 ds_read_b128 a[208:211], v15 offset:1024
 ds_read_b128 a[212:215], v15 offset:17408
 ds_read_b128 a[216:219], v15 offset:33792
 ds_read_b128 a[220:223], v15 offset:50176
 ds_read_b64_tr_b16 a[160:161], v2 offset:16384
 ds_read_b64_tr_b16 a[162:163], v2 offset:16896
 ds_read_b64_tr_b16 a[164:165], v2 offset:20480
 ds_read_b64_tr_b16 a[166:167], v2 offset:20992
 ds_read_b64_tr_b16 a[168:169], v3 offset:16384
 ds_read_b64_tr_b16 a[170:171], v3 offset:16896
 ds_read_b64_tr_b16 a[172:173], v3 offset:20480
 ds_read_b64_tr_b16 a[174:175], v3 offset:20992
 ds_read_b64_tr_b16 a[176:177], v4 offset:16384
 ds_read_b64_tr_b16 a[178:179], v4 offset:16896
 ds_read_b64_tr_b16 a[180:181], v4 offset:20480
 ds_read_b64_tr_b16 a[182:183], v4 offset:20992
 s_waitcnt vmcnt(12) lgkmcnt(8)
 v_mfma_f32_16x16x32_bf16 v[64:67], a[160:163], a[192:195], 0
 ds_read_b64_tr_b16 a[184:185], v5 offset:16384
 v_mfma_f32_16x16x32_bf16 v[64:67], a[164:167], a[208:211], v[64:67]
 buffer_load_dwordx4 v6, s[48:51], s99 offen offset:0 lds
 v_mfma_f32_16x16x32_bf16 v[68:71], a[160:163], a[196:199], 0
 buffer_load_dwordx4 v7, s[48:51], s99 offen offset:1024 lds
 v_mfma_f32_16x16x32_bf16 v[68:71], a[164:167], a[212:215], v[68:71]
 ds_read_b64_tr_b16 a[186:187], v5 offset:16896
 v_mfma_f32_16x16x32_bf16 v[72:75], a[160:163], a[200:203], 0
 ds_read_b64_tr_b16 a[188:189], v5 offset:20480
 v_mfma_f32_16x16x32_bf16 v[72:75], a[164:167], a[216:219], v[72:75]
 buffer_load_dwordx4 v8, s[48:51], s99 offen offset:2048 lds
 v_mfma_f32_16x16x32_bf16 v[76:79], a[160:163], a[204:207], 0
 buffer_load_dwordx4 v9, s[48:51], s99 offen offset:3072 lds
 v_mfma_f32_16x16x32_bf16 v[76:79], a[164:167], a[220:223], v[76:79]
 s_waitcnt vmcnt(8) lgkmcnt(7)
 ds_read_b64_tr_b16 a[190:191], v5 offset:20992
 v_mfma_f32_16x16x32_bf16 v[80:83], a[168:171], a[192:195], 0
 s_add_u32 s95, s95, 15
 ds_read_b64_tr_b16 a[160:161], v2 offset:32768
 v_mfma_f32_16x16x32_bf16 v[80:83], a[172:175], a[208:211], v[80:83]
 s_and_b32 s95, s95, 15
 ds_read_b64_tr_b16 a[162:163], v2 offset:33280
 v_mfma_f32_16x16x32_bf16 v[84:87], a[168:171], a[196:199], 0
 s_mul_i32 s84, s95, 114688
 ds_read_b128 a[128:131], v14 offset:2048
 v_mfma_f32_16x16x32_bf16 v[84:87], a[172:175], a[212:215], v[84:87]
 ds_read_b128 a[132:135], v14 offset:18432
 v_mfma_f32_16x16x32_bf16 v[88:91], a[168:171], a[200:203], 0
 s_add_u32 s95, s95, 1
 ds_read_b64_tr_b16 a[164:165], v2 offset:36864
 v_mfma_f32_16x16x32_bf16 v[88:91], a[172:175], a[216:219], v[88:91]
 s_mul_i32 s99, s95, 114688
 ds_read_b64_tr_b16 a[166:167], v2 offset:37376
 v_mfma_f32_16x16x32_bf16 v[92:95], a[168:171], a[204:207], 0
 ds_read_b128 a[136:139], v14 offset:34816
 v_mfma_f32_16x16x32_bf16 v[92:95], a[172:175], a[220:223], v[92:95]
 s_add_u32 m0, s83, 16384
 ds_read_b128 a[140:143], v14 offset:51200
 s_waitcnt lgkmcnt(8)
 v_mfma_f32_16x16x32_bf16 v[96:99], a[176:179], a[192:195], 0
 ds_read_b64_tr_b16 a[168:169], v3 offset:32768
 v_mfma_f32_16x16x32_bf16 v[96:99], a[180:183], a[208:211], v[96:99]
 buffer_load_dwordx4 v6, s[52:55], s84 offen offset:0 lds
 v_mfma_f32_16x16x32_bf16 v[100:103], a[176:179], a[196:199], 0
 buffer_load_dwordx4 v7, s[52:55], s84 offen offset:1024 lds
 v_mfma_f32_16x16x32_bf16 v[100:103], a[180:183], a[212:215], v[100:103]
 ds_read_b64_tr_b16 a[170:171], v3 offset:33280
 v_mfma_f32_16x16x32_bf16 v[104:107], a[176:179], a[200:203], 0
 ds_read_b64_tr_b16 a[172:173], v3 offset:36864
 v_mfma_f32_16x16x32_bf16 v[104:107], a[180:183], a[216:219], v[104:107]
 buffer_load_dwordx4 v8, s[52:55], s84 offen offset:2048 lds
 v_mfma_f32_16x16x32_bf16 v[108:111], a[176:179], a[204:207], 0
 buffer_load_dwordx4 v9, s[52:55], s84 offen offset:3072 lds
 v_mfma_f32_16x16x32_bf16 v[108:111], a[180:183], a[220:223], v[108:111]
 s_add_u32 m0, s83, 20480
 ds_read_b64_tr_b16 a[174:175], v3 offset:37376
 s_waitcnt lgkmcnt(12)
 v_mfma_f32_16x16x32_bf16 v[112:115], a[184:187], a[192:195], 0
 ds_read_b64_tr_b16 a[176:177], v4 offset:32768
 v_mfma_f32_16x16x32_bf16 v[112:115], a[188:191], a[208:211], v[112:115]
 buffer_load_dwordx4 v6, s[52:55], s99 offen offset:0 lds
 v_mfma_f32_16x16x32_bf16 v[116:119], a[184:187], a[196:199], 0
 buffer_load_dwordx4 v7, s[52:55], s99 offen offset:1024 lds
 v_mfma_f32_16x16x32_bf16 v[116:119], a[188:191], a[212:215], v[116:119]
 ds_read_b64_tr_b16 a[178:179], v4 offset:33280
 v_mfma_f32_16x16x32_bf16 v[120:123], a[184:187], a[200:203], 0
 ds_read_b64_tr_b16 a[180:181], v4 offset:36864
 v_mfma_f32_16x16x32_bf16 v[120:123], a[188:191], a[216:219], v[120:123]
 buffer_load_dwordx4 v8, s[52:55], s99 offen offset:2048 lds
 v_mfma_f32_16x16x32_bf16 v[124:127], a[184:187], a[204:207], 0
 buffer_load_dwordx4 v9, s[52:55], s99 offen offset:3072 lds
 v_mfma_f32_16x16x32_bf16 v[124:127], a[188:191], a[220:223], v[124:127]
 s_waitcnt lgkmcnt(9)
 ds_read_b64_tr_b16 a[182:183], v4 offset:37376
 v_mfma_f32_16x16x32_bf16 a[0:3], a[160:163], a[192:195], 0
 s_add_u32 s95, s95, 1
 ds_read_b64_tr_b16 a[184:185], v5 offset:32768
 v_mfma_f32_16x16x32_bf16 a[0:3], a[164:167], a[208:211], a[0:3]
 s_and_b32 s95, s95, 15
 ds_read_b64_tr_b16 a[186:187], v5 offset:33280
 v_mfma_f32_16x16x32_bf16 a[4:7], a[160:163], a[196:199], 0
 s_mul_i32 s84, s95, 114688
 ds_read_b128 a[144:147], v15 offset:3072
 v_mfma_f32_16x16x32_bf16 a[4:7], a[164:167], a[212:215], a[4:7]
 v_mfma_f32_16x16x32_bf16 a[8:11], a[160:163], a[200:203], 0
 ds_read_b64_tr_b16 a[188:189], v5 offset:36864
 v_mfma_f32_16x16x32_bf16 a[8:11], a[164:167], a[216:219], a[8:11]
 ds_read_b64_tr_b16 a[190:191], v5 offset:37376
 v_mfma_f32_16x16x32_bf16 a[12:15], a[160:163], a[204:207], 0
 ds_read_b128 a[148:151], v15 offset:19456
 v_mfma_f32_16x16x32_bf16 a[12:15], a[164:167], a[220:223], a[12:15]
 s_waitcnt vmcnt(8) lgkmcnt(10)
 v_mfma_f32_16x16x32_bf16 a[16:19], a[168:171], a[192:195], 0
 s_add_u32 s95, s95, 1
 ds_read_b64_tr_b16 a[160:161], v2 offset:0
 v_mfma_f32_16x16x32_bf16 a[16:19], a[172:175], a[208:211], a[16:19]
 s_mul_i32 s99, s95, 114688
 ds_read_b64_tr_b16 a[162:163], v2 offset:512
 v_mfma_f32_16x16x32_bf16 a[20:23], a[168:171], a[196:199], 0
 ds_read_b128 a[152:155], v15 offset:35840
 v_mfma_f32_16x16x32_bf16 a[20:23], a[172:175], a[212:215], a[20:23]
 v_mfma_f32_16x16x32_bf16 a[24:27], a[168:171], a[200:203], 0
 ds_read_b64_tr_b16 a[164:165], v2 offset:4096
 v_mfma_f32_16x16x32_bf16 a[24:27], a[172:175], a[216:219], a[24:27]
 ds_read_b64_tr_b16 a[166:167], v2 offset:4608
 v_mfma_f32_16x16x32_bf16 a[28:31], a[168:171], a[204:207], 0
 ds_read_b128 a[156:159], v15 offset:52224
 v_mfma_f32_16x16x32_bf16 a[28:31], a[172:175], a[220:223], a[28:31]
 s_add_u32 m0, s83, 32768
 s_waitcnt lgkmcnt(7)
 v_mfma_f32_16x16x32_bf16 a[32:35], a[176:179], a[192:195], 0
 ds_read_b64_tr_b16 a[168:169], v3 offset:0
 v_mfma_f32_16x16x32_bf16 a[32:35], a[180:183], a[208:211], a[32:35]
 buffer_load_dwordx4 v6, s[48:51], s84 offen offset:0 lds
 v_mfma_f32_16x16x32_bf16 a[36:39], a[176:179], a[196:199], 0
 buffer_load_dwordx4 v7, s[48:51], s84 offen offset:1024 lds
 v_mfma_f32_16x16x32_bf16 a[36:39], a[180:183], a[212:215], a[36:39]
 ds_read_b64_tr_b16 a[170:171], v3 offset:512
 v_mfma_f32_16x16x32_bf16 a[40:43], a[176:179], a[200:203], 0
 ds_read_b64_tr_b16 a[172:173], v3 offset:4096
 v_mfma_f32_16x16x32_bf16 a[40:43], a[180:183], a[216:219], a[40:43]
 buffer_load_dwordx4 v8, s[48:51], s84 offen offset:2048 lds
 v_mfma_f32_16x16x32_bf16 a[44:47], a[176:179], a[204:207], 0
 buffer_load_dwordx4 v9, s[48:51], s84 offen offset:3072 lds
 v_mfma_f32_16x16x32_bf16 a[44:47], a[180:183], a[220:223], a[44:47]
 s_add_u32 m0, s83, 36864
 ds_read_b64_tr_b16 a[174:175], v3 offset:4608
 s_waitcnt lgkmcnt(11)
 v_mfma_f32_16x16x32_bf16 a[48:51], a[184:187], a[192:195], 0
 ds_read_b64_tr_b16 a[176:177], v4 offset:0
 v_mfma_f32_16x16x32_bf16 a[48:51], a[188:191], a[208:211], a[48:51]
 buffer_load_dwordx4 v6, s[48:51], s99 offen offset:0 lds
 v_mfma_f32_16x16x32_bf16 a[52:55], a[184:187], a[196:199], 0
 buffer_load_dwordx4 v7, s[48:51], s99 offen offset:1024 lds
 v_mfma_f32_16x16x32_bf16 a[52:55], a[188:191], a[212:215], a[52:55]
 ds_read_b64_tr_b16 a[178:179], v4 offset:512
 v_mfma_f32_16x16x32_bf16 a[56:59], a[184:187], a[200:203], 0
 ds_read_b64_tr_b16 a[180:181], v4 offset:4096
 v_mfma_f32_16x16x32_bf16 a[56:59], a[188:191], a[216:219], a[56:59]
 buffer_load_dwordx4 v8, s[48:51], s99 offen offset:2048 lds
 v_mfma_f32_16x16x32_bf16 a[60:63], a[184:187], a[204:207], 0
 buffer_load_dwordx4 v9, s[48:51], s99 offen offset:3072 lds
 v_mfma_f32_16x16x32_bf16 a[60:63], a[188:191], a[220:223], a[60:63]
 s_waitcnt lgkmcnt(7)
 ds_read_b64_tr_b16 a[182:183], v4 offset:4608
 v_mfma_f32_16x16x32_bf16 v[64:67], a[160:163], a[128:131], v[64:67]
 s_add_u32 s95, s95, 15
 ds_read_b64_tr_b16 a[184:185], v5 offset:0
 v_mfma_f32_16x16x32_bf16 v[64:67], a[164:167], a[144:147], v[64:67]
 s_and_b32 s95, s95, 15
 ds_read_b64_tr_b16 a[186:187], v5 offset:512
 v_mfma_f32_16x16x32_bf16 v[68:71], a[160:163], a[132:135], v[68:71]
 s_mul_i32 s84, s95, 114688
 ds_read_b128 a[192:195], v14 offset:4096
 v_mfma_f32_16x16x32_bf16 v[68:71], a[164:167], a[148:151], v[68:71]
 v_mfma_f32_16x16x32_bf16 v[72:75], a[160:163], a[136:139], v[72:75]
 ds_read_b64_tr_b16 a[188:189], v5 offset:4096
 v_mfma_f32_16x16x32_bf16 v[72:75], a[164:167], a[152:155], v[72:75]
 ds_read_b64_tr_b16 a[190:191], v5 offset:4608
 v_mfma_f32_16x16x32_bf16 v[76:79], a[160:163], a[140:143], v[76:79]
 ds_read_b128 a[196:199], v14 offset:20480
 v_mfma_f32_16x16x32_bf16 v[76:79], a[164:167], a[156:159], v[76:79]
 s_waitcnt vmcnt(8) lgkmcnt(10)
 v_mfma_f32_16x16x32_bf16 v[80:83], a[168:171], a[128:131], v[80:83]
 s_add_u32 s95, s95, 1
 ds_read_b64_tr_b16 a[160:161], v2 offset:16384
 v_mfma_f32_16x16x32_bf16 v[80:83], a[172:175], a[144:147], v[80:83]
 s_mul_i32 s99, s95, 114688
 ds_read_b64_tr_b16 a[162:163], v2 offset:16896
 v_mfma_f32_16x16x32_bf16 v[84:87], a[168:171], a[132:135], v[84:87]
 ds_read_b128 a[200:203], v14 offset:36864
 v_mfma_f32_16x16x32_bf16 v[84:87], a[172:175], a[148:151], v[84:87]
 v_mfma_f32_16x16x32_bf16 v[88:91], a[168:171], a[136:139], v[88:91]
 ds_read_b64_tr_b16 a[164:165], v2 offset:20480
 v_mfma_f32_16x16x32_bf16 v[88:91], a[172:175], a[152:155], v[88:91]
 ds_read_b64_tr_b16 a[166:167], v2 offset:20992
 v_mfma_f32_16x16x32_bf16 v[92:95], a[168:171], a[140:143], v[92:95]
 ds_read_b128 a[204:207], v14 offset:53248
 v_mfma_f32_16x16x32_bf16 v[92:95], a[172:175], a[156:159], v[92:95]
 s_add_u32 m0, s83, 0
 s_waitcnt lgkmcnt(7)
 v_mfma_f32_16x16x32_bf16 v[96:99], a[176:179], a[128:131], v[96:99]
 ds_read_b64_tr_b16 a[168:169], v3 offset:16384
 v_mfma_f32_16x16x32_bf16 v[96:99], a[180:183], a[144:147], v[96:99]
 buffer_load_dwordx4 v6, s[52:55], s84 offen offset:0 lds
 v_mfma_f32_16x16x32_bf16 v[100:103], a[176:179], a[132:135], v[100:103]
 buffer_load_dwordx4 v7, s[52:55], s84 offen offset:1024 lds
 v_mfma_f32_16x16x32_bf16 v[100:103], a[180:183], a[148:151], v[100:103]
 ds_read_b64_tr_b16 a[170:171], v3 offset:16896
 v_mfma_f32_16x16x32_bf16 v[104:107], a[176:179], a[136:139], v[104:107]
 ds_read_b64_tr_b16 a[172:173], v3 offset:20480
 v_mfma_f32_16x16x32_bf16 v[104:107], a[180:183], a[152:155], v[104:107]
 buffer_load_dwordx4 v8, s[52:55], s84 offen offset:2048 lds
 v_mfma_f32_16x16x32_bf16 v[108:111], a[176:179], a[140:143], v[108:111]
 buffer_load_dwordx4 v9, s[52:55], s84 offen offset:3072 lds
 v_mfma_f32_16x16x32_bf16 v[108:111], a[180:183], a[156:159], v[108:111]
 s_add_u32 m0, s83, 4096
 ds_read_b64_tr_b16 a[174:175], v3 offset:20992
 s_waitcnt lgkmcnt(11)
 v_mfma_f32_16x16x32_bf16 v[112:115], a[184:187], a[128:131], v[112:115]
 ds_read_b64_tr_b16 a[176:177], v4 offset:16384
 v_mfma_f32_16x16x32_bf16 v[112:115], a[188:191], a[144:147], v[112:115]
 buffer_load_dwordx4 v6, s[52:55], s99 offen offset:0 lds
 v_mfma_f32_16x16x32_bf16 v[116:119], a[184:187], a[132:135], v[116:119]
 buffer_load_dwordx4 v7, s[52:55], s99 offen offset:1024 lds
 v_mfma_f32_16x16x32_bf16 v[116:119], a[188:191], a[148:151], v[116:119]
 ds_read_b64_tr_b16 a[178:179], v4 offset:16896
 v_mfma_f32_16x16x32_bf16 v[120:123], a[184:187], a[136:139], v[120:123]
 ds_read_b64_tr_b16 a[180:181], v4 offset:20480
 v_mfma_f32_16x16x32_bf16 v[120:123], a[188:191], a[152:155], v[120:123]
 buffer_load_dwordx4 v8, s[52:55], s99 offen offset:2048 lds
 v_mfma_f32_16x16x32_bf16 v[124:127], a[184:187], a[140:143], v[124:127]
 buffer_load_dwordx4 v9, s[52:55], s99 offen offset:3072 lds
 v_mfma_f32_16x16x32_bf16 v[124:127], a[188:191], a[156:159], v[124:127]
 s_waitcnt lgkmcnt(8)
 ds_read_b64_tr_b16 a[182:183], v4 offset:20992
 v_mfma_f32_16x16x32_bf16 a[0:3], a[160:163], a[128:131], a[0:3]
 s_add_u32 s95, s95, 1
 ds_read_b64_tr_b16 a[184:185], v5 offset:16384
 v_mfma_f32_16x16x32_bf16 a[0:3], a[164:167], a[144:147], a[0:3]
 s_and_b32 s95, s95, 15
 ds_read_b64_tr_b16 a[186:187], v5 offset:16896
 v_mfma_f32_16x16x32_bf16 a[4:7], a[160:163], a[132:135], a[4:7]
 s_mul_i32 s84, s95, 114688
 ds_read_b128 a[208:211], v15 offset:5120
 v_mfma_f32_16x16x32_bf16 a[4:7], a[164:167], a[148:151], a[4:7]
 v_mfma_f32_16x16x32_bf16 a[8:11], a[160:163], a[136:139], a[8:11]
 ds_read_b64_tr_b16 a[188:189], v5 offset:20480
 v_mfma_f32_16x16x32_bf16 a[8:11], a[164:167], a[152:155], a[8:11]
 ds_read_b64_tr_b16 a[190:191], v5 offset:20992
 v_mfma_f32_16x16x32_bf16 a[12:15], a[160:163], a[140:143], a[12:15]
 ds_read_b128 a[212:215], v15 offset:21504
 v_mfma_f32_16x16x32_bf16 a[12:15], a[164:167], a[156:159], a[12:15]
 s_waitcnt vmcnt(8) lgkmcnt(10)
 v_mfma_f32_16x16x32_bf16 a[16:19], a[168:171], a[128:131], a[16:19]
 s_add_u32 s95, s95, 1
 ds_read_b64_tr_b16 a[160:161], v2 offset:32768
 v_mfma_f32_16x16x32_bf16 a[16:19], a[172:175], a[144:147], a[16:19]
 s_mul_i32 s99, s95, 114688
 ds_read_b64_tr_b16 a[162:163], v2 offset:33280
 v_mfma_f32_16x16x32_bf16 a[20:23], a[168:171], a[132:135], a[20:23]
 ds_read_b128 a[216:219], v15 offset:37888
 v_mfma_f32_16x16x32_bf16 a[20:23], a[172:175], a[148:151], a[20:23]
 v_mfma_f32_16x16x32_bf16 a[24:27], a[168:171], a[136:139], a[24:27]
 ds_read_b64_tr_b16 a[164:165], v2 offset:36864
 v_mfma_f32_16x16x32_bf16 a[24:27], a[172:175], a[152:155], a[24:27]
 ds_read_b64_tr_b16 a[166:167], v2 offset:37376
 v_mfma_f32_16x16x32_bf16 a[28:31], a[168:171], a[140:143], a[28:31]
 ds_read_b128 a[220:223], v15 offset:54272
 v_mfma_f32_16x16x32_bf16 a[28:31], a[172:175], a[156:159], a[28:31]
 s_add_u32 m0, s83, 16384
 s_waitcnt lgkmcnt(7)
 v_mfma_f32_16x16x32_bf16 a[32:35], a[176:179], a[128:131], a[32:35]
 ds_read_b64_tr_b16 a[168:169], v3 offset:32768
 v_mfma_f32_16x16x32_bf16 a[32:35], a[180:183], a[144:147], a[32:35]
 buffer_load_dwordx4 v6, s[48:51], s84 offen offset:0 lds
 v_mfma_f32_16x16x32_bf16 a[36:39], a[176:179], a[132:135], a[36:39]
 buffer_load_dwordx4 v7, s[48:51], s84 offen offset:1024 lds
 v_mfma_f32_16x16x32_bf16 a[36:39], a[180:183], a[148:151], a[36:39]
 ds_read_b64_tr_b16 a[170:171], v3 offset:33280
 v_mfma_f32_16x16x32_bf16 a[40:43], a[176:179], a[136:139], a[40:43]
 ds_read_b64_tr_b16 a[172:173], v3 offset:36864
 v_mfma_f32_16x16x32_bf16 a[40:43], a[180:183], a[152:155], a[40:43]
 buffer_load_dwordx4 v8, s[48:51], s84 offen offset:2048 lds
 v_mfma_f32_16x16x32_bf16 a[44:47], a[176:179], a[140:143], a[44:47]
 buffer_load_dwordx4 v9, s[48:51], s84 offen offset:3072 lds
 v_mfma_f32_16x16x32_bf16 a[44:47], a[180:183], a[156:159], a[44:47]
 s_add_u32 m0, s83, 20480
 ds_read_b64_tr_b16 a[174:175], v3 offset:37376
 s_waitcnt lgkmcnt(11)
 v_mfma_f32_16x16x32_bf16 a[48:51], a[184:187], a[128:131], a[48:51]
 ds_read_b64_tr_b16 a[176:177], v4 offset:32768
 v_mfma_f32_16x16x32_bf16 a[48:51], a[188:191], a[144:147], a[48:51]
 buffer_load_dwordx4 v6, s[48:51], s99 offen offset:0 lds
 v_mfma_f32_16x16x32_bf16 a[52:55], a[184:187], a[132:135], a[52:55]
 buffer_load_dwordx4 v7, s[48:51], s99 offen offset:1024 lds
 v_mfma_f32_16x16x32_bf16 a[52:55], a[188:191], a[148:151], a[52:55]
 ds_read_b64_tr_b16 a[178:179], v4 offset:33280
 v_mfma_f32_16x16x32_bf16 a[56:59], a[184:187], a[136:139], a[56:59]
 ds_read_b64_tr_b16 a[180:181], v4 offset:36864
 v_mfma_f32_16x16x32_bf16 a[56:59], a[188:191], a[152:155], a[56:59]
 buffer_load_dwordx4 v8, s[48:51], s99 offen offset:2048 lds
 v_mfma_f32_16x16x32_bf16 a[60:63], a[184:187], a[140:143], a[60:63]
 buffer_load_dwordx4 v9, s[48:51], s99 offen offset:3072 lds
 v_mfma_f32_16x16x32_bf16 a[60:63], a[188:191], a[156:159], a[60:63]
 s_waitcnt lgkmcnt(7)
 ds_read_b64_tr_b16 a[182:183], v4 offset:37376
 v_mfma_f32_16x16x32_bf16 v[64:67], a[160:163], a[192:195], v[64:67]
 s_add_u32 s95, s95, 15
 ds_read_b64_tr_b16 a[184:185], v5 offset:32768
 v_mfma_f32_16x16x32_bf16 v[64:67], a[164:167], a[208:211], v[64:67]
 s_and_b32 s95, s95, 15
 ds_read_b64_tr_b16 a[186:187], v5 offset:33280
 v_mfma_f32_16x16x32_bf16 v[68:71], a[160:163], a[196:199], v[68:71]
 s_mul_i32 s84, s95, 114688
 ds_read_b128 a[128:131], v14 offset:6144
 v_mfma_f32_16x16x32_bf16 v[68:71], a[164:167], a[212:215], v[68:71]
 v_mfma_f32_16x16x32_bf16 v[72:75], a[160:163], a[200:203], v[72:75]
 ds_read_b64_tr_b16 a[188:189], v5 offset:36864
 v_mfma_f32_16x16x32_bf16 v[72:75], a[164:167], a[216:219], v[72:75]
 ds_read_b64_tr_b16 a[190:191], v5 offset:37376
 v_mfma_f32_16x16x32_bf16 v[76:79], a[160:163], a[204:207], v[76:79]
 ds_read_b128 a[132:135], v14 offset:22528
 v_mfma_f32_16x16x32_bf16 v[76:79], a[164:167], a[220:223], v[76:79]
 s_waitcnt vmcnt(8) lgkmcnt(10)
 v_mfma_f32_16x16x32_bf16 v[80:83], a[168:171], a[192:195], v[80:83]
 s_add_u32 s95, s95, 1
 ds_read_b64_tr_b16 a[160:161], v2 offset:0
 v_mfma_f32_16x16x32_bf16 v[80:83], a[172:175], a[208:211], v[80:83]
 s_mul_i32 s99, s95, 114688
 ds_read_b64_tr_b16 a[162:163], v2 offset:512
 v_mfma_f32_16x16x32_bf16 v[84:87], a[168:171], a[196:199], v[84:87]
 ds_read_b128 a[136:139], v14 offset:38912
 v_mfma_f32_16x16x32_bf16 v[84:87], a[172:175], a[212:215], v[84:87]
 v_mfma_f32_16x16x32_bf16 v[88:91], a[168:171], a[200:203], v[88:91]
 ds_read_b64_tr_b16 a[164:165], v2 offset:4096
 v_mfma_f32_16x16x32_bf16 v[88:91], a[172:175], a[216:219], v[88:91]
 ds_read_b64_tr_b16 a[166:167], v2 offset:4608
 v_mfma_f32_16x16x32_bf16 v[92:95], a[168:171], a[204:207], v[92:95]
 ds_read_b128 a[140:143], v14 offset:55296
 v_mfma_f32_16x16x32_bf16 v[92:95], a[172:175], a[220:223], v[92:95]
 s_add_u32 m0, s83, 32768
 s_waitcnt lgkmcnt(7)
 v_mfma_f32_16x16x32_bf16 v[96:99], a[176:179], a[192:195], v[96:99]
 ds_read_b64_tr_b16 a[168:169], v3 offset:0
 v_mfma_f32_16x16x32_bf16 v[96:99], a[180:183], a[208:211], v[96:99]
 buffer_load_dwordx4 v6, s[52:55], s84 offen offset:0 lds
 v_mfma_f32_16x16x32_bf16 v[100:103], a[176:179], a[196:199], v[100:103]
 buffer_load_dwordx4 v7, s[52:55], s84 offen offset:1024 lds
 v_mfma_f32_16x16x32_bf16 v[100:103], a[180:183], a[212:215], v[100:103]
 ds_read_b64_tr_b16 a[170:171], v3 offset:512
 v_mfma_f32_16x16x32_bf16 v[104:107], a[176:179], a[200:203], v[104:107]
 ds_read_b64_tr_b16 a[172:173], v3 offset:4096
 v_mfma_f32_16x16x32_bf16 v[104:107], a[180:183], a[216:219], v[104:107]
 buffer_load_dwordx4 v8, s[52:55], s84 offen offset:2048 lds
 v_mfma_f32_16x16x32_bf16 v[108:111], a[176:179], a[204:207], v[108:111]
 buffer_load_dwordx4 v9, s[52:55], s84 offen offset:3072 lds
 v_mfma_f32_16x16x32_bf16 v[108:111], a[180:183], a[220:223], v[108:111]
 s_add_u32 m0, s83, 36864
 ds_read_b64_tr_b16 a[174:175], v3 offset:4608
 s_waitcnt lgkmcnt(11)
 v_mfma_f32_16x16x32_bf16 v[112:115], a[184:187], a[192:195], v[112:115]
 ds_read_b64_tr_b16 a[176:177], v4 offset:0
L_pg2:
 s_cbranch_execz L_pg6
 v_mfma_f32_16x16x32_bf16 v[112:115], a[188:191], a[208:211], v[112:115]
 buffer_load_dwordx4 v6, s[52:55], s99 offen offset:0 lds
 v_mfma_f32_16x16x32_bf16 v[116:119], a[184:187], a[196:199], v[116:119]
 buffer_load_dwordx4 v7, s[52:55], s99 offen offset:1024 lds
 v_mfma_f32_16x16x32_bf16 v[116:119], a[188:191], a[212:215], v[116:119]
 ds_read_b64_tr_b16 a[178:179], v4 offset:512
 v_mfma_f32_16x16x32_bf16 v[120:123], a[184:187], a[200:203], v[120:123]
 ds_read_b64_tr_b16 a[180:181], v4 offset:4096
 v_mfma_f32_16x16x32_bf16 v[120:123], a[188:191], a[216:219], v[120:123]
 buffer_load_dwordx4 v8, s[52:55], s99 offen offset:2048 lds
 v_mfma_f32_16x16x32_bf16 v[124:127], a[184:187], a[204:207], v[124:127]
 buffer_load_dwordx4 v9, s[52:55], s99 offen offset:3072 lds
 v_mfma_f32_16x16x32_bf16 v[124:127], a[188:191], a[220:223], v[124:127]
 s_waitcnt lgkmcnt(8)
 ds_read_b64_tr_b16 a[182:183], v4 offset:4608
 v_mfma_f32_16x16x32_bf16 a[0:3], a[160:163], a[192:195], a[0:3]
 s_add_u32 s95, s95, 1
 ds_read_b64_tr_b16 a[184:185], v5 offset:0
 v_mfma_f32_16x16x32_bf16 a[0:3], a[164:167], a[208:211], a[0:3]
 s_and_b32 s95, s95, 15
 ds_read_b64_tr_b16 a[186:187], v5 offset:512
 v_mfma_f32_16x16x32_bf16 a[4:7], a[160:163], a[196:199], a[4:7]
 s_mul_i32 s84, s95, 114688
 ds_read_b128 a[144:147], v15 offset:7168
 v_mfma_f32_16x16x32_bf16 a[4:7], a[164:167], a[212:215], a[4:7]
 v_mfma_f32_16x16x32_bf16 a[8:11], a[160:163], a[200:203], a[8:11]
 ds_read_b64_tr_b16 a[188:189], v5 offset:4096
 v_mfma_f32_16x16x32_bf16 a[8:11], a[164:167], a[216:219], a[8:11]
 ds_read_b64_tr_b16 a[190:191], v5 offset:4608
 v_mfma_f32_16x16x32_bf16 a[12:15], a[160:163], a[204:207], a[12:15]
 ds_read_b128 a[148:151], v15 offset:23552
 v_mfma_f32_16x16x32_bf16 a[12:15], a[164:167], a[220:223], a[12:15]
 s_waitcnt vmcnt(8) lgkmcnt(10)
 v_mfma_f32_16x16x32_bf16 a[16:19], a[168:171], a[192:195], a[16:19]
 s_add_u32 s95, s95, 1
 ds_read_b64_tr_b16 a[160:161], v2 offset:16384
 v_mfma_f32_16x16x32_bf16 a[16:19], a[172:175], a[208:211], a[16:19]
 s_mul_i32 s99, s95, 114688
 ds_read_b64_tr_b16 a[162:163], v2 offset:16896
 v_mfma_f32_16x16x32_bf16 a[20:23], a[168:171], a[196:199], a[20:23]
 ds_read_b128 a[152:155], v15 offset:39936
 v_mfma_f32_16x16x32_bf16 a[20:23], a[172:175], a[212:215], a[20:23]
 v_mfma_f32_16x16x32_bf16 a[24:27], a[168:171], a[200:203], a[24:27]
 ds_read_b64_tr_b16 a[164:165], v2 offset:20480
 v_mfma_f32_16x16x32_bf16 a[24:27], a[172:175], a[216:219], a[24:27]
 ds_read_b64_tr_b16 a[166:167], v2 offset:20992
 v_mfma_f32_16x16x32_bf16 a[28:31], a[168:171], a[204:207], a[28:31]
 ds_read_b128 a[156:159], v15 offset:56320
 v_mfma_f32_16x16x32_bf16 a[28:31], a[172:175], a[220:223], a[28:31]
 s_add_u32 m0, s83, 0
 s_waitcnt lgkmcnt(7)
 v_mfma_f32_16x16x32_bf16 a[32:35], a[176:179], a[192:195], a[32:35]
 ds_read_b64_tr_b16 a[168:169], v3 offset:16384
 v_mfma_f32_16x16x32_bf16 a[32:35], a[180:183], a[208:211], a[32:35]
 buffer_load_dwordx4 v6, s[48:51], s84 offen offset:0 lds
 v_mfma_f32_16x16x32_bf16 a[36:39], a[176:179], a[196:199], a[36:39]
 buffer_load_dwordx4 v7, s[48:51], s84 offen offset:1024 lds
 v_mfma_f32_16x16x32_bf16 a[36:39], a[180:183], a[212:215], a[36:39]
 ds_read_b64_tr_b16 a[170:171], v3 offset:16896
 v_mfma_f32_16x16x32_bf16 a[40:43], a[176:179], a[200:203], a[40:43]
 ds_read_b64_tr_b16 a[172:173], v3 offset:20480
 v_mfma_f32_16x16x32_bf16 a[40:43], a[180:183], a[216:219], a[40:43]
 buffer_load_dwordx4 v8, s[48:51], s84 offen offset:2048 lds
 v_mfma_f32_16x16x32_bf16 a[44:47], a[176:179], a[204:207], a[44:47]
 buffer_load_dwordx4 v9, s[48:51], s84 offen offset:3072 lds
 v_mfma_f32_16x16x32_bf16 a[44:47], a[180:183], a[220:223], a[44:47]
 s_add_u32 m0, s83, 4096
 ds_read_b64_tr_b16 a[174:175], v3 offset:20992
 s_waitcnt lgkmcnt(11)
 v_mfma_f32_16x16x32_bf16 a[48:51], a[184:187], a[192:195], a[48:51]
 ds_read_b64_tr_b16 a[176:177], v4 offset:16384
 v_mfma_f32_16x16x32_bf16 a[48:51], a[188:191], a[208:211], a[48:51]
 buffer_load_dwordx4 v6, s[48:51], s99 offen offset:0 lds
 v_mfma_f32_16x16x32_bf16 a[52:55], a[184:187], a[196:199], a[52:55]
 buffer_load_dwordx4 v7, s[48:51], s99 offen offset:1024 lds
 v_mfma_f32_16x16x32_bf16 a[52:55], a[188:191], a[212:215], a[52:55]
 ds_read_b64_tr_b16 a[178:179], v4 offset:16896
 v_mfma_f32_16x16x32_bf16 a[56:59], a[184:187], a[200:203], a[56:59]
 ds_read_b64_tr_b16 a[180:181], v4 offset:20480
 v_mfma_f32_16x16x32_bf16 a[56:59], a[188:191], a[216:219], a[56:59]
 buffer_load_dwordx4 v8, s[48:51], s99 offen offset:2048 lds
 v_mfma_f32_16x16x32_bf16 a[60:63], a[184:187], a[204:207], a[60:63]
 buffer_load_dwordx4 v9, s[48:51], s99 offen offset:3072 lds
 v_mfma_f32_16x16x32_bf16 a[60:63], a[188:191], a[220:223], a[60:63]
 s_waitcnt lgkmcnt(7)
 ds_read_b64_tr_b16 a[182:183], v4 offset:20992
 v_mfma_f32_16x16x32_bf16 v[64:67], a[160:163], a[128:131], v[64:67]
 s_add_u32 s95, s95, 15
 ds_read_b64_tr_b16 a[184:185], v5 offset:16384
 v_mfma_f32_16x16x32_bf16 v[64:67], a[164:167], a[144:147], v[64:67]
 s_and_b32 s95, s95, 15
 ds_read_b64_tr_b16 a[186:187], v5 offset:16896
 v_mfma_f32_16x16x32_bf16 v[68:71], a[160:163], a[132:135], v[68:71]
 s_mul_i32 s84, s95, 114688
 ds_read_b128 a[192:195], v14 offset:8192
 v_mfma_f32_16x16x32_bf16 v[68:71], a[164:167], a[148:151], v[68:71]
 v_mfma_f32_16x16x32_bf16 v[72:75], a[160:163], a[136:139], v[72:75]
 ds_read_b64_tr_b16 a[188:189], v5 offset:20480
 v_mfma_f32_16x16x32_bf16 v[72:75], a[164:167], a[152:155], v[72:75]
 ds_read_b64_tr_b16 a[190:191], v5 offset:20992
 v_mfma_f32_16x16x32_bf16 v[76:79], a[160:163], a[140:143], v[76:79]
 ds_read_b128 a[196:199], v14 offset:24576
 v_mfma_f32_16x16x32_bf16 v[76:79], a[164:167], a[156:159], v[76:79]
 s_waitcnt vmcnt(8) lgkmcnt(10)
 v_mfma_f32_16x16x32_bf16 v[80:83], a[168:171], a[128:131], v[80:83]
 s_add_u32 s95, s95, 1
 ds_read_b64_tr_b16 a[160:161], v2 offset:32768
 v_mfma_f32_16x16x32_bf16 v[80:83], a[172:175], a[144:147], v[80:83]
 s_mul_i32 s99, s95, 114688
 ds_read_b64_tr_b16 a[162:163], v2 offset:33280
 v_mfma_f32_16x16x32_bf16 v[84:87], a[168:171], a[132:135], v[84:87]
 ds_read_b128 a[200:203], v14 offset:40960
 v_mfma_f32_16x16x32_bf16 v[84:87], a[172:175], a[148:151], v[84:87]
 v_mfma_f32_16x16x32_bf16 v[88:91], a[168:171], a[136:139], v[88:91]
 ds_read_b64_tr_b16 a[164:165], v2 offset:36864
 v_mfma_f32_16x16x32_bf16 v[88:91], a[172:175], a[152:155], v[88:91]
 ds_read_b64_tr_b16 a[166:167], v2 offset:37376
 v_mfma_f32_16x16x32_bf16 v[92:95], a[168:171], a[140:143], v[92:95]
 ds_read_b128 a[204:207], v14 offset:57344
 v_mfma_f32_16x16x32_bf16 v[92:95], a[172:175], a[156:159], v[92:95]
 s_add_u32 m0, s83, 16384
 s_waitcnt lgkmcnt(7)
 v_mfma_f32_16x16x32_bf16 v[96:99], a[176:179], a[128:131], v[96:99]
 ds_read_b64_tr_b16 a[168:169], v3 offset:32768
 v_mfma_f32_16x16x32_bf16 v[96:99], a[180:183], a[144:147], v[96:99]
 buffer_load_dwordx4 v6, s[52:55], s84 offen offset:0 lds
 v_mfma_f32_16x16x32_bf16 v[100:103], a[176:179], a[132:135], v[100:103]
 buffer_load_dwordx4 v7, s[52:55], s84 offen offset:1024 lds
 v_mfma_f32_16x16x32_bf16 v[100:103], a[180:183], a[148:151], v[100:103]
 ds_read_b64_tr_b16 a[170:171], v3 offset:33280
 v_mfma_f32_16x16x32_bf16 v[104:107], a[176:179], a[136:139], v[104:107]
 ds_read_b64_tr_b16 a[172:173], v3 offset:36864
 v_mfma_f32_16x16x32_bf16 v[104:107], a[180:183], a[152:155], v[104:107]
 buffer_load_dwordx4 v8, s[52:55], s84 offen offset:2048 lds
 v_mfma_f32_16x16x32_bf16 v[108:111], a[176:179], a[140:143], v[108:111]
 buffer_load_dwordx4 v9, s[52:55], s84 offen offset:3072 lds
 v_mfma_f32_16x16x32_bf16 v[108:111], a[180:183], a[156:159], v[108:111]
 s_add_u32 m0, s83, 20480
 ds_read_b64_tr_b16 a[174:175], v3 offset:37376
 s_waitcnt lgkmcnt(11)
 v_mfma_f32_16x16x32_bf16 v[112:115], a[184:187], a[128:131], v[112:115]
 ds_read_b64_tr_b16 a[176:177], v4 offset:32768
 v_mfma_f32_16x16x32_bf16 v[112:115], a[188:191], a[144:147], v[112:115]
 buffer_load_dwordx4 v6, s[52:55], s99 offen offset:0 lds
 v_mfma_f32_16x16x32_bf16 v[116:119], a[184:187], a[132:135], v[116:119]
 buffer_load_dwordx4 v7, s[52:55], s99 offen offset:1024 lds
 v_mfma_f32_16x16x32_bf16 v[116:119], a[188:191], a[148:151], v[116:119]
 ds_read_b64_tr_b16 a[178:179], v4 offset:33280
 v_mfma_f32_16x16x32_bf16 v[120:123], a[184:187], a[136:139], v[120:123]
 ds_read_b64_tr_b16 a[180:181], v4 offset:36864
 v_mfma_f32_16x16x32_bf16 v[120:123], a[188:191], a[152:155], v[120:123]
 buffer_load_dwordx4 v8, s[52:55], s99 offen offset:2048 lds
 v_mfma_f32_16x16x32_bf16 v[124:127], a[184:187], a[140:143], v[124:127]
 buffer_load_dwordx4 v9, s[52:55], s99 offen offset:3072 lds
 v_mfma_f32_16x16x32_bf16 v[124:127], a[188:191], a[156:159], v[124:127]
 s_waitcnt lgkmcnt(8)
 ds_read_b64_tr_b16 a[182:183], v4 offset:37376
 v_mfma_f32_16x16x32_bf16 a[0:3], a[160:163], a[128:131], a[0:3]
 s_add_u32 s95, s95, 1
 ds_read_b64_tr_b16 a[184:185], v5 offset:32768
 v_mfma_f32_16x16x32_bf16 a[0:3], a[164:167], a[144:147], a[0:3]
 s_and_b32 s95, s95, 15
 ds_read_b64_tr_b16 a[186:187], v5 offset:33280
 v_mfma_f32_16x16x32_bf16 a[4:7], a[160:163], a[132:135], a[4:7]
 s_mul_i32 s84, s95, 114688
 ds_read_b128 a[208:211], v15 offset:9216
 v_mfma_f32_16x16x32_bf16 a[4:7], a[164:167], a[148:151], a[4:7]
 v_mfma_f32_16x16x32_bf16 a[8:11], a[160:163], a[136:139], a[8:11]
 ds_read_b64_tr_b16 a[188:189], v5 offset:36864
 v_mfma_f32_16x16x32_bf16 a[8:11], a[164:167], a[152:155], a[8:11]
 ds_read_b64_tr_b16 a[190:191], v5 offset:37376
 v_mfma_f32_16x16x32_bf16 a[12:15], a[160:163], a[140:143], a[12:15]
 ds_read_b128 a[212:215], v15 offset:25600
 v_mfma_f32_16x16x32_bf16 a[12:15], a[164:167], a[156:159], a[12:15]
 s_waitcnt vmcnt(8) lgkmcnt(10)
 v_mfma_f32_16x16x32_bf16 a[16:19], a[168:171], a[128:131], a[16:19]
 s_add_u32 s95, s95, 1
 ds_read_b64_tr_b16 a[160:161], v2 offset:0
 v_mfma_f32_16x16x32_bf16 a[16:19], a[172:175], a[144:147], a[16:19]
 s_mul_i32 s99, s95, 114688
 ds_read_b64_tr_b16 a[162:163], v2 offset:512
 v_mfma_f32_16x16x32_bf16 a[20:23], a[168:171], a[132:135], a[20:23]
 ds_read_b128 a[216:219], v15 offset:41984
 v_mfma_f32_16x16x32_bf16 a[20:23], a[172:175], a[148:151], a[20:23]
 v_mfma_f32_16x16x32_bf16 a[24:27], a[168:171], a[136:139], a[24:27]
 ds_read_b64_tr_b16 a[164:165], v2 offset:4096
 v_mfma_f32_16x16x32_bf16 a[24:27], a[172:175], a[152:155], a[24:27]
 ds_read_b64_tr_b16 a[166:167], v2 offset:4608
 v_mfma_f32_16x16x32_bf16 a[28:31], a[168:171], a[140:143], a[28:31]
 ds_read_b128 a[220:223], v15 offset:58368
 v_mfma_f32_16x16x32_bf16 a[28:31], a[172:175], a[156:159], a[28:31]
 s_add_u32 m0, s83, 32768
 s_waitcnt lgkmcnt(7)
 v_mfma_f32_16x16x32_bf16 a[32:35], a[176:179], a[128:131], a[32:35]
 ds_read_b64_tr_b16 a[168:169], v3 offset:0
 v_mfma_f32_16x16x32_bf16 a[32:35], a[180:183], a[144:147], a[32:35]
 buffer_load_dwordx4 v6, s[48:51], s84 offen offset:0 lds
 v_mfma_f32_16x16x32_bf16 a[36:39], a[176:179], a[132:135], a[36:39]
 buffer_load_dwordx4 v7, s[48:51], s84 offen offset:1024 lds
 v_mfma_f32_16x16x32_bf16 a[36:39], a[180:183], a[148:151], a[36:39]
 ds_read_b64_tr_b16 a[170:171], v3 offset:512
 v_mfma_f32_16x16x32_bf16 a[40:43], a[176:179], a[136:139], a[40:43]
 ds_read_b64_tr_b16 a[172:173], v3 offset:4096
 v_mfma_f32_16x16x32_bf16 a[40:43], a[180:183], a[152:155], a[40:43]
 buffer_load_dwordx4 v8, s[48:51], s84 offen offset:2048 lds
 v_mfma_f32_16x16x32_bf16 a[44:47], a[176:179], a[140:143], a[44:47]
 buffer_load_dwordx4 v9, s[48:51], s84 offen offset:3072 lds
 v_mfma_f32_16x16x32_bf16 a[44:47], a[180:183], a[156:159], a[44:47]
 s_add_u32 m0, s83, 36864
 ds_read_b64_tr_b16 a[174:175], v3 offset:4608
 s_waitcnt lgkmcnt(11)
 v_mfma_f32_16x16x32_bf16 a[48:51], a[184:187], a[128:131], a[48:51]
 ds_read_b64_tr_b16 a[176:177], v4 offset:0
 v_mfma_f32_16x16x32_bf16 a[48:51], a[188:191], a[144:147], a[48:51]
 buffer_load_dwordx4 v6, s[48:51], s99 offen offset:0 lds
 v_mfma_f32_16x16x32_bf16 a[52:55], a[184:187], a[132:135], a[52:55]
 buffer_load_dwordx4 v7, s[48:51], s99 offen offset:1024 lds
 v_mfma_f32_16x16x32_bf16 a[52:55], a[188:191], a[148:151], a[52:55]
 ds_read_b64_tr_b16 a[178:179], v4 offset:512
 v_mfma_f32_16x16x32_bf16 a[56:59], a[184:187], a[136:139], a[56:59]
 ds_read_b64_tr_b16 a[180:181], v4 offset:4096
 v_mfma_f32_16x16x32_bf16 a[56:59], a[188:191], a[152:155], a[56:59]
 buffer_load_dwordx4 v8, s[48:51], s99 offen offset:2048 lds
 v_mfma_f32_16x16x32_bf16 a[60:63], a[184:187], a[140:143], a[60:63]
 buffer_load_dwordx4 v9, s[48:51], s99 offen offset:3072 lds
 v_mfma_f32_16x16x32_bf16 a[60:63], a[188:191], a[156:159], a[60:63]
 s_waitcnt lgkmcnt(7)
 ds_read_b64_tr_b16 a[182:183], v4 offset:4608
 v_mfma_f32_16x16x32_bf16 v[64:67], a[160:163], a[192:195], v[64:67]
 s_add_u32 s95, s95, 15
 ds_read_b64_tr_b16 a[184:185], v5 offset:0
 v_mfma_f32_16x16x32_bf16 v[64:67], a[164:167], a[208:211], v[64:67]
 s_and_b32 s95, s95, 15
 ds_read_b64_tr_b16 a[186:187], v5 offset:512
 v_mfma_f32_16x16x32_bf16 v[68:71], a[160:163], a[196:199], v[68:71]
 s_mul_i32 s84, s95, 114688
 ds_read_b128 a[128:131], v14 offset:10240
 v_mfma_f32_16x16x32_bf16 v[68:71], a[164:167], a[212:215], v[68:71]
 v_mfma_f32_16x16x32_bf16 v[72:75], a[160:163], a[200:203], v[72:75]
 ds_read_b64_tr_b16 a[188:189], v5 offset:4096
 v_mfma_f32_16x16x32_bf16 v[72:75], a[164:167], a[216:219], v[72:75]
 ds_read_b64_tr_b16 a[190:191], v5 offset:4608
 v_mfma_f32_16x16x32_bf16 v[76:79], a[160:163], a[204:207], v[76:79]
 ds_read_b128 a[132:135], v14 offset:26624
 v_mfma_f32_16x16x32_bf16 v[76:79], a[164:167], a[220:223], v[76:79]
 s_waitcnt vmcnt(8) lgkmcnt(10)
 v_mfma_f32_16x16x32_bf16 v[80:83], a[168:171], a[192:195], v[80:83]
 s_add_u32 s95, s95, 1
 ds_read_b64_tr_b16 a[160:161], v2 offset:16384
 v_mfma_f32_16x16x32_bf16 v[80:83], a[172:175], a[208:211], v[80:83]
 s_mul_i32 s99, s95, 114688
 ds_read_b64_tr_b16 a[162:163], v2 offset:16896
 v_mfma_f32_16x16x32_bf16 v[84:87], a[168:171], a[196:199], v[84:87]
 ds_read_b128 a[136:139], v14 offset:43008
 v_mfma_f32_16x16x32_bf16 v[84:87], a[172:175], a[212:215], v[84:87]
 v_mfma_f32_16x16x32_bf16 v[88:91], a[168:171], a[200:203], v[88:91]
 ds_read_b64_tr_b16 a[164:165], v2 offset:20480
 v_mfma_f32_16x16x32_bf16 v[88:91], a[172:175], a[216:219], v[88:91]
 ds_read_b64_tr_b16 a[166:167], v2 offset:20992
 v_mfma_f32_16x16x32_bf16 v[92:95], a[168:171], a[204:207], v[92:95]
 ds_read_b128 a[140:143], v14 offset:59392
 v_mfma_f32_16x16x32_bf16 v[92:95], a[172:175], a[220:223], v[92:95]
 s_add_u32 m0, s83, 0
 s_waitcnt lgkmcnt(7)
 v_mfma_f32_16x16x32_bf16 v[96:99], a[176:179], a[192:195], v[96:99]
 ds_read_b64_tr_b16 a[168:169], v3 offset:16384
 v_mfma_f32_16x16x32_bf16 v[96:99], a[180:183], a[208:211], v[96:99]
 buffer_load_dwordx4 v6, s[52:55], s84 offen offset:0 lds
 v_mfma_f32_16x16x32_bf16 v[100:103], a[176:179], a[196:199], v[100:103]
 buffer_load_dwordx4 v7, s[52:55], s84 offen offset:1024 lds
 v_mfma_f32_16x16x32_bf16 v[100:103], a[180:183], a[212:215], v[100:103]
 ds_read_b64_tr_b16 a[170:171], v3 offset:16896
 v_mfma_f32_16x16x32_bf16 v[104:107], a[176:179], a[200:203], v[104:107]
 ds_read_b64_tr_b16 a[172:173], v3 offset:20480
 v_mfma_f32_16x16x32_bf16 v[104:107], a[180:183], a[216:219], v[104:107]
 buffer_load_dwordx4 v8, s[52:55], s84 offen offset:2048 lds
 v_mfma_f32_16x16x32_bf16 v[108:111], a[176:179], a[204:207], v[108:111]
 buffer_load_dwordx4 v9, s[52:55], s84 offen offset:3072 lds
 v_mfma_f32_16x16x32_bf16 v[108:111], a[180:183], a[220:223], v[108:111]
 s_add_u32 m0, s83, 4096
 ds_read_b64_tr_b16 a[174:175], v3 offset:20992
 s_waitcnt lgkmcnt(11)
 v_mfma_f32_16x16x32_bf16 v[112:115], a[184:187], a[192:195], v[112:115]
 ds_read_b64_tr_b16 a[176:177], v4 offset:16384
 v_mfma_f32_16x16x32_bf16 v[112:115], a[188:191], a[208:211], v[112:115]
 buffer_load_dwordx4 v6, s[52:55], s99 offen offset:0 lds
 v_mfma_f32_16x16x32_bf16 v[116:119], a[184:187], a[196:199], v[116:119]
 buffer_load_dwordx4 v7, s[52:55], s99 offen offset:1024 lds
 v_mfma_f32_16x16x32_bf16 v[116:119], a[188:191], a[212:215], v[116:119]
 ds_read_b64_tr_b16 a[178:179], v4 offset:16896
 v_mfma_f32_16x16x32_bf16 v[120:123], a[184:187], a[200:203], v[120:123]
 ds_read_b64_tr_b16 a[180:181], v4 offset:20480
 v_mfma_f32_16x16x32_bf16 v[120:123], a[188:191], a[216:219], v[120:123]
 buffer_load_dwordx4 v8, s[52:55], s99 offen offset:2048 lds
 v_mfma_f32_16x16x32_bf16 v[124:127], a[184:187], a[204:207], v[124:127]
 buffer_load_dwordx4 v9, s[52:55], s99 offen offset:3072 lds
 v_mfma_f32_16x16x32_bf16 v[124:127], a[188:191], a[220:223], v[124:127]
 s_waitcnt lgkmcnt(8)
 ds_read_b64_tr_b16 a[182:183], v4 offset:20992
 v_mfma_f32_16x16x32_bf16 a[0:3], a[160:163], a[192:195], a[0:3]
 s_add_u32 s95, s95, 1
 ds_read_b64_tr_b16 a[184:185], v5 offset:16384
 v_mfma_f32_16x16x32_bf16 a[0:3], a[164:167], a[208:211], a[0:3]
 s_and_b32 s95, s95, 15
 ds_read_b64_tr_b16 a[186:187], v5 offset:16896
 v_mfma_f32_16x16x32_bf16 a[4:7], a[160:163], a[196:199], a[4:7]
 s_mul_i32 s84, s95, 114688
 ds_read_b128 a[144:147], v15 offset:11264
 v_mfma_f32_16x16x32_bf16 a[4:7], a[164:167], a[212:215], a[4:7]
 v_mfma_f32_16x16x32_bf16 a[8:11], a[160:163], a[200:203], a[8:11]
 ds_read_b64_tr_b16 a[188:189], v5 offset:20480
 v_mfma_f32_16x16x32_bf16 a[8:11], a[164:167], a[216:219], a[8:11]
 ds_read_b64_tr_b16 a[190:191], v5 offset:20992
 v_mfma_f32_16x16x32_bf16 a[12:15], a[160:163], a[204:207], a[12:15]
 ds_read_b128 a[148:151], v15 offset:27648
 v_mfma_f32_16x16x32_bf16 a[12:15], a[164:167], a[220:223], a[12:15]
 s_waitcnt vmcnt(8) lgkmcnt(10)
 v_mfma_f32_16x16x32_bf16 a[16:19], a[168:171], a[192:195], a[16:19]
 s_add_u32 s95, s95, 1
 ds_read_b64_tr_b16 a[160:161], v2 offset:32768
 v_mfma_f32_16x16x32_bf16 a[16:19], a[172:175], a[208:211], a[16:19]
 s_mul_i32 s99, s95, 114688
 ds_read_b64_tr_b16 a[162:163], v2 offset:33280
 v_mfma_f32_16x16x32_bf16 a[20:23], a[168:171], a[196:199], a[20:23]
 ds_read_b128 a[152:155], v15 offset:44032
 v_mfma_f32_16x16x32_bf16 a[20:23], a[172:175], a[212:215], a[20:23]
 v_mfma_f32_16x16x32_bf16 a[24:27], a[168:171], a[200:203], a[24:27]
 ds_read_b64_tr_b16 a[164:165], v2 offset:36864
 v_mfma_f32_16x16x32_bf16 a[24:27], a[172:175], a[216:219], a[24:27]
 ds_read_b64_tr_b16 a[166:167], v2 offset:37376
 v_mfma_f32_16x16x32_bf16 a[28:31], a[168:171], a[204:207], a[28:31]
 ds_read_b128 a[156:159], v15 offset:60416
 v_mfma_f32_16x16x32_bf16 a[28:31], a[172:175], a[220:223], a[28:31]
 s_add_u32 m0, s83, 16384
 s_waitcnt lgkmcnt(7)
 v_mfma_f32_16x16x32_bf16 a[32:35], a[176:179], a[192:195], a[32:35]
 ds_read_b64_tr_b16 a[168:169], v3 offset:32768
 v_mfma_f32_16x16x32_bf16 a[32:35], a[180:183], a[208:211], a[32:35]
 buffer_load_dwordx4 v6, s[48:51], s84 offen offset:0 lds
 v_mfma_f32_16x16x32_bf16 a[36:39], a[176:179], a[196:199], a[36:39]
 buffer_load_dwordx4 v7, s[48:51], s84 offen offset:1024 lds
 v_mfma_f32_16x16x32_bf16 a[36:39], a[180:183], a[212:215], a[36:39]
 ds_read_b64_tr_b16 a[170:171], v3 offset:33280
 v_mfma_f32_16x16x32_bf16 a[40:43], a[176:179], a[200:203], a[40:43]
 ds_read_b64_tr_b16 a[172:173], v3 offset:36864
 v_mfma_f32_16x16x32_bf16 a[40:43], a[180:183], a[216:219], a[40:43]
 buffer_load_dwordx4 v8, s[48:51], s84 offen offset:2048 lds
 v_mfma_f32_16x16x32_bf16 a[44:47], a[176:179], a[204:207], a[44:47]
 buffer_load_dwordx4 v9, s[48:51], s84 offen offset:3072 lds
 v_mfma_f32_16x16x32_bf16 a[44:47], a[180:183], a[220:223], a[44:47]
 s_add_u32 m0, s83, 20480
 ds_read_b64_tr_b16 a[174:175], v3 offset:37376
 s_waitcnt lgkmcnt(11)
 v_mfma_f32_16x16x32_bf16 a[48:51], a[184:187], a[192:195], a[48:51]
 ds_read_b64_tr_b16 a[176:177], v4 offset:32768
 v_mfma_f32_16x16x32_bf16 a[48:51], a[188:191], a[208:211], a[48:51]
 buffer_load_dwordx4 v6, s[48:51], s99 offen offset:0 lds
 v_mfma_f32_16x16x32_bf16 a[52:55], a[184:187], a[196:199], a[52:55]
 buffer_load_dwordx4 v7, s[48:51], s99 offen offset:1024 lds
 v_mfma_f32_16x16x32_bf16 a[52:55], a[188:191], a[212:215], a[52:55]
 ds_read_b64_tr_b16 a[178:179], v4 offset:33280
 v_mfma_f32_16x16x32_bf16 a[56:59], a[184:187], a[200:203], a[56:59]
 ds_read_b64_tr_b16 a[180:181], v4 offset:36864
 v_mfma_f32_16x16x32_bf16 a[56:59], a[188:191], a[216:219], a[56:59]
 buffer_load_dwordx4 v8, s[48:51], s99 offen offset:2048 lds
 v_mfma_f32_16x16x32_bf16 a[60:63], a[184:187], a[204:207], a[60:63]
 buffer_load_dwordx4 v9, s[48:51], s99 offen offset:3072 lds
 v_mfma_f32_16x16x32_bf16 a[60:63], a[188:191], a[220:223], a[60:63]
 s_waitcnt lgkmcnt(7)
 ds_read_b64_tr_b16 a[182:183], v4 offset:37376
 v_mfma_f32_16x16x32_bf16 v[64:67], a[160:163], a[128:131], v[64:67]
 s_add_u32 s95, s95, 15
 ds_read_b64_tr_b16 a[184:185], v5 offset:32768
 v_mfma_f32_16x16x32_bf16 v[64:67], a[164:167], a[144:147], v[64:67]
 s_and_b32 s95, s95, 15
 ds_read_b64_tr_b16 a[186:187], v5 offset:33280
 v_mfma_f32_16x16x32_bf16 v[68:71], a[160:163], a[132:135], v[68:71]
 s_mul_i32 s84, s95, 114688
 ds_read_b128 a[192:195], v14 offset:12288
 v_mfma_f32_16x16x32_bf16 v[68:71], a[164:167], a[148:151], v[68:71]
 v_mfma_f32_16x16x32_bf16 v[72:75], a[160:163], a[136:139], v[72:75]
 ds_read_b64_tr_b16 a[188:189], v5 offset:36864
 v_mfma_f32_16x16x32_bf16 v[72:75], a[164:167], a[152:155], v[72:75]
 ds_read_b64_tr_b16 a[190:191], v5 offset:37376
 v_mfma_f32_16x16x32_bf16 v[76:79], a[160:163], a[140:143], v[76:79]
 ds_read_b128 a[196:199], v14 offset:28672
 v_mfma_f32_16x16x32_bf16 v[76:79], a[164:167], a[156:159], v[76:79]
 s_waitcnt vmcnt(8) lgkmcnt(10)
 v_mfma_f32_16x16x32_bf16 v[80:83], a[168:171], a[128:131], v[80:83]
 s_add_u32 s95, s95, 1
 ds_read_b64_tr_b16 a[160:161], v2 offset:0
 v_mfma_f32_16x16x32_bf16 v[80:83], a[172:175], a[144:147], v[80:83]
 s_mul_i32 s99, s95, 114688
 ds_read_b64_tr_b16 a[162:163], v2 offset:512
 v_mfma_f32_16x16x32_bf16 v[84:87], a[168:171], a[132:135], v[84:87]
 ds_read_b128 a[200:203], v14 offset:45056
 v_mfma_f32_16x16x32_bf16 v[84:87], a[172:175], a[148:151], v[84:87]
 v_mfma_f32_16x16x32_bf16 v[88:91], a[168:171], a[136:139], v[88:91]
 ds_read_b64_tr_b16 a[164:165], v2 offset:4096
 v_mfma_f32_16x16x32_bf16 v[88:91], a[172:175], a[152:155], v[88:91]
 ds_read_b64_tr_b16 a[166:167], v2 offset:4608
 v_mfma_f32_16x16x32_bf16 v[92:95], a[168:171], a[140:143], v[92:95]
 ds_read_b128 a[204:207], v14 offset:61440
 v_mfma_f32_16x16x32_bf16 v[92:95], a[172:175], a[156:159], v[92:95]
 s_add_u32 m0, s83, 32768
 s_waitcnt lgkmcnt(7)
 v_mfma_f32_16x16x32_bf16 v[96:99], a[176:179], a[128:131], v[96:99]
 ds_read_b64_tr_b16 a[168:169], v3 offset:0
 v_mfma_f32_16x16x32_bf16 v[96:99], a[180:183], a[144:147], v[96:99]
 buffer_load_dwordx4 v6, s[52:55], s84 offen offset:0 lds
 v_mfma_f32_16x16x32_bf16 v[100:103], a[176:179], a[132:135], v[100:103]
 buffer_load_dwordx4 v7, s[52:55], s84 offen offset:1024 lds
 v_mfma_f32_16x16x32_bf16 v[100:103], a[180:183], a[148:151], v[100:103]
 ds_read_b64_tr_b16 a[170:171], v3 offset:512
 v_mfma_f32_16x16x32_bf16 v[104:107], a[176:179], a[136:139], v[104:107]
 ds_read_b64_tr_b16 a[172:173], v3 offset:4096
 v_mfma_f32_16x16x32_bf16 v[104:107], a[180:183], a[152:155], v[104:107]
 buffer_load_dwordx4 v8, s[52:55], s84 offen offset:2048 lds
 v_mfma_f32_16x16x32_bf16 v[108:111], a[176:179], a[140:143], v[108:111]
 buffer_load_dwordx4 v9, s[52:55], s84 offen offset:3072 lds
 v_mfma_f32_16x16x32_bf16 v[108:111], a[180:183], a[156:159], v[108:111]
 s_add_u32 m0, s83, 36864
 ds_read_b64_tr_b16 a[174:175], v3 offset:4608
 s_waitcnt lgkmcnt(11)
 v_mfma_f32_16x16x32_bf16 v[112:115], a[184:187], a[128:131], v[112:115]
 ds_read_b64_tr_b16 a[176:177], v4 offset:0
 v_mfma_f32_16x16x32_bf16 v[112:115], a[188:191], a[144:147], v[112:115]
 buffer_load_dwordx4 v6, s[52:55], s99 offen offset:0 lds
 v_mfma_f32_16x16x32_bf16 v[116:119], a[184:187], a[132:135], v[116:119]
 buffer_load_dwordx4 v7, s[52:55], s99 offen offset:1024 lds
 v_mfma_f32_16x16x32_bf16 v[116:119], a[188:191], a[148:151], v[116:119]
 ds_read_b64_tr_b16 a[178:179], v4 offset:512
 v_mfma_f32_16x16x32_bf16 v[120:123], a[184:187], a[136:139], v[120:123]
 ds_read_b64_tr_b16 a[180:181], v4 offset:4096
 v_mfma_f32_16x16x32_bf16 v[120:123], a[188:191], a[152:155], v[120:123]
 buffer_load_dwordx4 v8, s[52:55], s99 offen offset:2048 lds
 v_mfma_f32_16x16x32_bf16 v[124:127], a[184:187], a[140:143], v[124:127]
 buffer_load_dwordx4 v9, s[52:55], s99 offen offset:3072 lds
 v_mfma_f32_16x16x32_bf16 v[124:127], a[188:191], a[156:159], v[124:127]
 s_waitcnt lgkmcnt(8)
 ds_read_b64_tr_b16 a[182:183], v4 offset:4608
 v_mfma_f32_16x16x32_bf16 a[0:3], a[160:163], a[128:131], a[0:3]
 s_add_u32 s95, s95, 1
 ds_read_b64_tr_b16 a[184:185], v5 offset:0
 v_mfma_f32_16x16x32_bf16 a[0:3], a[164:167], a[144:147], a[0:3]
 s_and_b32 s95, s95, 15
 ds_read_b64_tr_b16 a[186:187], v5 offset:512
 v_mfma_f32_16x16x32_bf16 a[4:7], a[160:163], a[132:135], a[4:7]
 s_mul_i32 s84, s95, 114688
 ds_read_b128 a[208:211], v15 offset:13312
 v_mfma_f32_16x16x32_bf16 a[4:7], a[164:167], a[148:151], a[4:7]
 v_mfma_f32_16x16x32_bf16 a[8:11], a[160:163], a[136:139], a[8:11]
 ds_read_b64_tr_b16 a[188:189], v5 offset:4096
 v_mfma_f32_16x16x32_bf16 a[8:11], a[164:167], a[152:155], a[8:11]
 ds_read_b64_tr_b16 a[190:191], v5 offset:4608
 v_mfma_f32_16x16x32_bf16 a[12:15], a[160:163], a[140:143], a[12:15]
 ds_read_b128 a[212:215], v15 offset:29696
 v_mfma_f32_16x16x32_bf16 a[12:15], a[164:167], a[156:159], a[12:15]
 s_waitcnt vmcnt(8) lgkmcnt(10)
 v_mfma_f32_16x16x32_bf16 a[16:19], a[168:171], a[128:131], a[16:19]
 s_add_u32 s95, s95, 1
 ds_read_b64_tr_b16 a[160:161], v2 offset:16384
 v_mfma_f32_16x16x32_bf16 a[16:19], a[172:175], a[144:147], a[16:19]
 s_mul_i32 s99, s95, 114688
 ds_read_b64_tr_b16 a[162:163], v2 offset:16896
 v_mfma_f32_16x16x32_bf16 a[20:23], a[168:171], a[132:135], a[20:23]
 ds_read_b128 a[216:219], v15 offset:46080
 v_mfma_f32_16x16x32_bf16 a[20:23], a[172:175], a[148:151], a[20:23]
 v_mfma_f32_16x16x32_bf16 a[24:27], a[168:171], a[136:139], a[24:27]
 ds_read_b64_tr_b16 a[164:165], v2 offset:20480
 v_mfma_f32_16x16x32_bf16 a[24:27], a[172:175], a[152:155], a[24:27]
 ds_read_b64_tr_b16 a[166:167], v2 offset:20992
 v_mfma_f32_16x16x32_bf16 a[28:31], a[168:171], a[140:143], a[28:31]
 ds_read_b128 a[220:223], v15 offset:62464
 v_mfma_f32_16x16x32_bf16 a[28:31], a[172:175], a[156:159], a[28:31]
 s_add_u32 m0, s83, 0
 s_waitcnt lgkmcnt(7)
 v_mfma_f32_16x16x32_bf16 a[32:35], a[176:179], a[128:131], a[32:35]
 ds_read_b64_tr_b16 a[168:169], v3 offset:16384
 v_mfma_f32_16x16x32_bf16 a[32:35], a[180:183], a[144:147], a[32:35]
 buffer_load_dwordx4 v6, s[48:51], s84 offen offset:0 lds
 v_mfma_f32_16x16x32_bf16 a[36:39], a[176:179], a[132:135], a[36:39]
 buffer_load_dwordx4 v7, s[48:51], s84 offen offset:1024 lds
 v_mfma_f32_16x16x32_bf16 a[36:39], a[180:183], a[148:151], a[36:39]
 ds_read_b64_tr_b16 a[170:171], v3 offset:16896
 v_mfma_f32_16x16x32_bf16 a[40:43], a[176:179], a[136:139], a[40:43]
 ds_read_b64_tr_b16 a[172:173], v3 offset:20480
 v_mfma_f32_16x16x32_bf16 a[40:43], a[180:183], a[152:155], a[40:43]
 buffer_load_dwordx4 v8, s[48:51], s84 offen offset:2048 lds
 v_mfma_f32_16x16x32_bf16 a[44:47], a[176:179], a[140:143], a[44:47]
 buffer_load_dwordx4 v9, s[48:51], s84 offen offset:3072 lds
 v_mfma_f32_16x16x32_bf16 a[44:47], a[180:183], a[156:159], a[44:47]
 s_add_u32 m0, s83, 4096
 ds_read_b64_tr_b16 a[174:175], v3 offset:20992
 s_waitcnt lgkmcnt(11)
 v_mfma_f32_16x16x32_bf16 a[48:51], a[184:187], a[128:131], a[48:51]
 ds_read_b64_tr_b16 a[176:177], v4 offset:16384
 v_mfma_f32_16x16x32_bf16 a[48:51], a[188:191], a[144:147], a[48:51]
 buffer_load_dwordx4 v6, s[48:51], s99 offen offset:0 lds
 v_mfma_f32_16x16x32_bf16 a[52:55], a[184:187], a[132:135], a[52:55]
 buffer_load_dwordx4 v7, s[48:51], s99 offen offset:1024 lds
 v_mfma_f32_16x16x32_bf16 a[52:55], a[188:191], a[148:151], a[52:55]
 ds_read_b64_tr_b16 a[178:179], v4 offset:16896
 v_mfma_f32_16x16x32_bf16 a[56:59], a[184:187], a[136:139], a[56:59]
 ds_read_b64_tr_b16 a[180:181], v4 offset:20480
 v_mfma_f32_16x16x32_bf16 a[56:59], a[188:191], a[152:155], a[56:59]
 buffer_load_dwordx4 v8, s[48:51], s99 offen offset:2048 lds
 v_mfma_f32_16x16x32_bf16 a[60:63], a[184:187], a[140:143], a[60:63]
 buffer_load_dwordx4 v9, s[48:51], s99 offen offset:3072 lds
 v_mfma_f32_16x16x32_bf16 a[60:63], a[188:191], a[156:159], a[60:63]
 s_waitcnt lgkmcnt(7)
 ds_read_b64_tr_b16 a[182:183], v4 offset:20992
 v_mfma_f32_16x16x32_bf16 v[64:67], a[160:163], a[192:195], v[64:67]
 s_add_u32 s95, s95, 15
 ds_read_b64_tr_b16 a[184:185], v5 offset:16384
 v_mfma_f32_16x16x32_bf16 v[64:67], a[164:167], a[208:211], v[64:67]
 s_and_b32 s95, s95, 15
 ds_read_b64_tr_b16 a[186:187], v5 offset:16896
 v_mfma_f32_16x16x32_bf16 v[68:71], a[160:163], a[196:199], v[68:71]
 s_mul_i32 s84, s95, 114688
 ds_read_b128 a[128:131], v14 offset:14336
 v_mfma_f32_16x16x32_bf16 v[68:71], a[164:167], a[212:215], v[68:71]
 v_mfma_f32_16x16x32_bf16 v[72:75], a[160:163], a[200:203], v[72:75]
 ds_read_b64_tr_b16 a[188:189], v5 offset:20480
 v_mfma_f32_16x16x32_bf16 v[72:75], a[164:167], a[216:219], v[72:75]
 ds_read_b64_tr_b16 a[190:191], v5 offset:20992
 v_mfma_f32_16x16x32_bf16 v[76:79], a[160:163], a[204:207], v[76:79]
 ds_read_b128 a[132:135], v14 offset:30720
 v_mfma_f32_16x16x32_bf16 v[76:79], a[164:167], a[220:223], v[76:79]
 s_waitcnt vmcnt(8) lgkmcnt(10)
 v_mfma_f32_16x16x32_bf16 v[80:83], a[168:171], a[192:195], v[80:83]
 s_add_u32 s95, s95, 1
 ds_read_b64_tr_b16 a[160:161], v2 offset:32768
 v_mfma_f32_16x16x32_bf16 v[80:83], a[172:175], a[208:211], v[80:83]
 s_mul_i32 s99, s95, 114688
 ds_read_b64_tr_b16 a[162:163], v2 offset:33280
 v_mfma_f32_16x16x32_bf16 v[84:87], a[168:171], a[196:199], v[84:87]
 ds_read_b128 a[136:139], v14 offset:47104
L_pg3:
 s_cbranch_execz L_pg7
 v_mfma_f32_16x16x32_bf16 v[84:87], a[172:175], a[212:215], v[84:87]
 v_mfma_f32_16x16x32_bf16 v[88:91], a[168:171], a[200:203], v[88:91]
 ds_read_b64_tr_b16 a[164:165], v2 offset:36864
 v_mfma_f32_16x16x32_bf16 v[88:91], a[172:175], a[216:219], v[88:91]
 ds_read_b64_tr_b16 a[166:167], v2 offset:37376
 v_mfma_f32_16x16x32_bf16 v[92:95], a[168:171], a[204:207], v[92:95]
 ds_read_b128 a[140:143], v14 offset:63488
 v_mfma_f32_16x16x32_bf16 v[92:95], a[172:175], a[220:223], v[92:95]
 s_add_u32 m0, s83, 16384
 s_waitcnt lgkmcnt(7)
 v_mfma_f32_16x16x32_bf16 v[96:99], a[176:179], a[192:195], v[96:99]
 ds_read_b64_tr_b16 a[168:169], v3 offset:32768
 v_mfma_f32_16x16x32_bf16 v[96:99], a[180:183], a[208:211], v[96:99]
 buffer_load_dwordx4 v6, s[52:55], s84 offen offset:0 lds
 v_mfma_f32_16x16x32_bf16 v[100:103], a[176:179], a[196:199], v[100:103]
 buffer_load_dwordx4 v7, s[52:55], s84 offen offset:1024 lds
 v_mfma_f32_16x16x32_bf16 v[100:103], a[180:183], a[212:215], v[100:103]
 ds_read_b64_tr_b16 a[170:171], v3 offset:33280
 v_mfma_f32_16x16x32_bf16 v[104:107], a[176:179], a[200:203], v[104:107]
 ds_read_b64_tr_b16 a[172:173], v3 offset:36864
 v_mfma_f32_16x16x32_bf16 v[104:107], a[180:183], a[216:219], v[104:107]
 buffer_load_dwordx4 v8, s[52:55], s84 offen offset:2048 lds
 v_mfma_f32_16x16x32_bf16 v[108:111], a[176:179], a[204:207], v[108:111]
 buffer_load_dwordx4 v9, s[52:55], s84 offen offset:3072 lds
 v_mfma_f32_16x16x32_bf16 v[108:111], a[180:183], a[220:223], v[108:111]
 s_add_u32 m0, s83, 20480
 ds_read_b64_tr_b16 a[174:175], v3 offset:37376
 s_waitcnt lgkmcnt(11)
 v_mfma_f32_16x16x32_bf16 v[112:115], a[184:187], a[192:195], v[112:115]
 ds_read_b64_tr_b16 a[176:177], v4 offset:32768
 v_mfma_f32_16x16x32_bf16 v[112:115], a[188:191], a[208:211], v[112:115]
 buffer_load_dwordx4 v6, s[52:55], s99 offen offset:0 lds
 v_mfma_f32_16x16x32_bf16 v[116:119], a[184:187], a[196:199], v[116:119]
 buffer_load_dwordx4 v7, s[52:55], s99 offen offset:1024 lds
 v_mfma_f32_16x16x32_bf16 v[116:119], a[188:191], a[212:215], v[116:119]
 ds_read_b64_tr_b16 a[178:179], v4 offset:33280
 v_mfma_f32_16x16x32_bf16 v[120:123], a[184:187], a[200:203], v[120:123]
 ds_read_b64_tr_b16 a[180:181], v4 offset:36864
 v_mfma_f32_16x16x32_bf16 v[120:123], a[188:191], a[216:219], v[120:123]
 buffer_load_dwordx4 v8, s[52:55], s99 offen offset:2048 lds
 v_mfma_f32_16x16x32_bf16 v[124:127], a[184:187], a[204:207], v[124:127]
 buffer_load_dwordx4 v9, s[52:55], s99 offen offset:3072 lds
 v_mfma_f32_16x16x32_bf16 v[124:127], a[188:191], a[220:223], v[124:127]
 s_waitcnt lgkmcnt(8)
 ds_read_b64_tr_b16 a[182:183], v4 offset:37376
 v_mfma_f32_16x16x32_bf16 a[0:3], a[160:163], a[192:195], a[0:3]
 s_and_b32 s95, s3, 14
 ds_read_b64_tr_b16 a[184:185], v5 offset:32768
 v_mfma_f32_16x16x32_bf16 a[0:3], a[164:167], a[208:211], a[0:3]
 s_lshl_b32 s84, s95, 18
 ds_read_b64_tr_b16 a[186:187], v5 offset:33280
 v_mfma_f32_16x16x32_bf16 a[4:7], a[160:163], a[196:199], a[4:7]
 ds_read_b128 a[144:147], v15 offset:15360
 v_mfma_f32_16x16x32_bf16 a[4:7], a[164:167], a[212:215], a[4:7]
 v_mfma_f32_16x16x32_bf16 a[8:11], a[160:163], a[200:203], a[8:11]
 ds_read_b64_tr_b16 a[188:189], v5 offset:36864
 v_mfma_f32_16x16x32_bf16 a[8:11], a[164:167], a[216:219], a[8:11]
 ds_read_b64_tr_b16 a[190:191], v5 offset:37376
 v_mfma_f32_16x16x32_bf16 a[12:15], a[160:163], a[204:207], a[12:15]
 ds_read_b128 a[148:151], v15 offset:31744
 v_mfma_f32_16x16x32_bf16 a[12:15], a[164:167], a[220:223], a[12:15]
 s_waitcnt vmcnt(8) lgkmcnt(10)
 v_mfma_f32_16x16x32_bf16 a[16:19], a[168:171], a[192:195], a[16:19]
 s_add_u32 s95, s95, 1
 ds_read_b64_tr_b16 a[160:161], v2 offset:0
 v_mfma_f32_16x16x32_bf16 a[16:19], a[172:175], a[208:211], a[16:19]
 s_lshl_b32 s99, s95, 18
 ds_read_b64_tr_b16 a[162:163], v2 offset:512
 v_mfma_f32_16x16x32_bf16 a[20:23], a[168:171], a[196:199], a[20:23]
 ds_read_b128 a[152:155], v15 offset:48128
 v_mfma_f32_16x16x32_bf16 a[20:23], a[172:175], a[212:215], a[20:23]
 v_mfma_f32_16x16x32_bf16 a[24:27], a[168:171], a[200:203], a[24:27]
 ds_read_b64_tr_b16 a[164:165], v2 offset:4096
 v_mfma_f32_16x16x32_bf16 a[24:27], a[172:175], a[216:219], a[24:27]
 ds_read_b64_tr_b16 a[166:167], v2 offset:4608
 v_mfma_f32_16x16x32_bf16 a[28:31], a[168:171], a[204:207], a[28:31]
 ds_read_b128 a[156:159], v15 offset:64512
 v_mfma_f32_16x16x32_bf16 a[28:31], a[172:175], a[220:223], a[28:31]
 s_add_u32 m0, s83, 32768
 s_waitcnt lgkmcnt(7)
 v_mfma_f32_16x16x32_bf16 a[32:35], a[176:179], a[192:195], a[32:35]
 ds_read_b64_tr_b16 a[168:169], v3 offset:0
 v_mfma_f32_16x16x32_bf16 a[32:35], a[180:183], a[208:211], a[32:35]
 buffer_load_dwordx4 v10, s[40:43], s84 offen offset:0 lds
 v_mfma_f32_16x16x32_bf16 a[36:39], a[176:179], a[196:199], a[36:39]
 buffer_load_dwordx4 v11, s[40:43], s84 offen offset:1024 lds
 v_mfma_f32_16x16x32_bf16 a[36:39], a[180:183], a[212:215], a[36:39]
 ds_read_b64_tr_b16 a[170:171], v3 offset:512
 v_mfma_f32_16x16x32_bf16 a[40:43], a[176:179], a[200:203], a[40:43]
 ds_read_b64_tr_b16 a[172:173], v3 offset:4096
 v_mfma_f32_16x16x32_bf16 a[40:43], a[180:183], a[216:219], a[40:43]
 buffer_load_dwordx4 v12, s[40:43], s84 offen offset:2048 lds
 v_mfma_f32_16x16x32_bf16 a[44:47], a[176:179], a[204:207], a[44:47]
 buffer_load_dwordx4 v13, s[40:43], s84 offen offset:3072 lds
 v_mfma_f32_16x16x32_bf16 a[44:47], a[180:183], a[220:223], a[44:47]
 s_add_u32 m0, s83, 36864
 ds_read_b64_tr_b16 a[174:175], v3 offset:4608
 s_waitcnt lgkmcnt(11)
 v_mfma_f32_16x16x32_bf16 a[48:51], a[184:187], a[192:195], a[48:51]
 ds_read_b64_tr_b16 a[176:177], v4 offset:0
 v_mfma_f32_16x16x32_bf16 a[48:51], a[188:191], a[208:211], a[48:51]
 buffer_load_dwordx4 v10, s[40:43], s99 offen offset:0 lds
 v_mfma_f32_16x16x32_bf16 a[52:55], a[184:187], a[196:199], a[52:55]
 buffer_load_dwordx4 v11, s[40:43], s99 offen offset:1024 lds
 v_mfma_f32_16x16x32_bf16 a[52:55], a[188:191], a[212:215], a[52:55]
 ds_read_b64_tr_b16 a[178:179], v4 offset:512
 v_mfma_f32_16x16x32_bf16 a[56:59], a[184:187], a[200:203], a[56:59]
 ds_read_b64_tr_b16 a[180:181], v4 offset:4096
 v_mfma_f32_16x16x32_bf16 a[56:59], a[188:191], a[216:219], a[56:59]
 buffer_load_dwordx4 v12, s[40:43], s99 offen offset:2048 lds
 v_mfma_f32_16x16x32_bf16 a[60:63], a[184:187], a[204:207], a[60:63]
 buffer_load_dwordx4 v13, s[40:43], s99 offen offset:3072 lds
 v_mfma_f32_16x16x32_bf16 a[60:63], a[188:191], a[220:223], a[60:63]
 s_waitcnt lgkmcnt(7)
 ds_read_b64_tr_b16 a[182:183], v4 offset:4608
 v_mfma_f32_16x16x32_bf16 v[64:67], a[160:163], a[128:131], v[64:67]
 s_add_u32 s95, s95, 15
 ds_read_b64_tr_b16 a[184:185], v5 offset:0
 v_mfma_f32_16x16x32_bf16 v[64:67], a[164:167], a[144:147], v[64:67]
 s_and_b32 s95, s95, 15
 ds_read_b64_tr_b16 a[186:187], v5 offset:512
 v_mfma_f32_16x16x32_bf16 v[68:71], a[160:163], a[132:135], v[68:71]
 s_lshl_b32 s84, s95, 18
 ds_read_b128 a[192:195], v14 offset:0
 v_mfma_f32_16x16x32_bf16 v[68:71], a[164:167], a[148:151], v[68:71]
 s_add_u32 s84, s84, 128
 v_mfma_f32_16x16x32_bf16 v[72:75], a[160:163], a[136:139], v[72:75]
 ds_read_b64_tr_b16 a[188:189], v5 offset:4096
 v_mfma_f32_16x16x32_bf16 v[72:75], a[164:167], a[152:155], v[72:75]
 ds_read_b64_tr_b16 a[190:191], v5 offset:4608
 v_mfma_f32_16x16x32_bf16 v[76:79], a[160:163], a[140:143], v[76:79]
 ds_read_b128 a[196:199], v14 offset:16384
 v_mfma_f32_16x16x32_bf16 v[76:79], a[164:167], a[156:159], v[76:79]
 s_waitcnt vmcnt(8) lgkmcnt(10)
 v_mfma_f32_16x16x32_bf16 v[80:83], a[168:171], a[128:131], v[80:83]
 s_add_u32 s95, s95, 1
 ds_read_b64_tr_b16 a[160:161], v2 offset:16384
 v_mfma_f32_16x16x32_bf16 v[80:83], a[172:175], a[144:147], v[80:83]
 s_lshl_b32 s99, s95, 18
 ds_read_b64_tr_b16 a[162:163], v2 offset:16896
 v_mfma_f32_16x16x32_bf16 v[84:87], a[168:171], a[132:135], v[84:87]
 s_add_u32 s99, s99, 128
 ds_read_b128 a[200:203], v14 offset:32768
 v_mfma_f32_16x16x32_bf16 v[84:87], a[172:175], a[148:151], v[84:87]
 v_mfma_f32_16x16x32_bf16 v[88:91], a[168:171], a[136:139], v[88:91]
 ds_read_b64_tr_b16 a[164:165], v2 offset:20480
 v_mfma_f32_16x16x32_bf16 v[88:91], a[172:175], a[152:155], v[88:91]
 ds_read_b64_tr_b16 a[166:167], v2 offset:20992
 v_mfma_f32_16x16x32_bf16 v[92:95], a[168:171], a[140:143], v[92:95]
 ds_read_b128 a[204:207], v14 offset:49152
 v_mfma_f32_16x16x32_bf16 v[92:95], a[172:175], a[156:159], v[92:95]
 s_add_u32 m0, s83, 0
 s_waitcnt lgkmcnt(7)
 v_mfma_f32_16x16x32_bf16 v[96:99], a[176:179], a[128:131], v[96:99]
 ds_read_b64_tr_b16 a[168:169], v3 offset:16384
 v_mfma_f32_16x16x32_bf16 v[96:99], a[180:183], a[144:147], v[96:99]
 buffer_load_dwordx4 v10, s[40:43], s84 offen offset:0 lds
 v_mfma_f32_16x16x32_bf16 v[100:103], a[176:179], a[132:135], v[100:103]
 buffer_load_dwordx4 v11, s[40:43], s84 offen offset:1024 lds
 v_mfma_f32_16x16x32_bf16 v[100:103], a[180:183], a[148:151], v[100:103]
 ds_read_b64_tr_b16 a[170:171], v3 offset:16896
 v_mfma_f32_16x16x32_bf16 v[104:107], a[176:179], a[136:139], v[104:107]
 ds_read_b64_tr_b16 a[172:173], v3 offset:20480
 v_mfma_f32_16x16x32_bf16 v[104:107], a[180:183], a[152:155], v[104:107]
 buffer_load_dwordx4 v12, s[40:43], s84 offen offset:2048 lds
 v_mfma_f32_16x16x32_bf16 v[108:111], a[176:179], a[140:143], v[108:111]
 buffer_load_dwordx4 v13, s[40:43], s84 offen offset:3072 lds
 v_mfma_f32_16x16x32_bf16 v[108:111], a[180:183], a[156:159], v[108:111]
 s_add_u32 m0, s83, 4096
 ds_read_b64_tr_b16 a[174:175], v3 offset:20992
 s_waitcnt lgkmcnt(11)
 v_mfma_f32_16x16x32_bf16 v[112:115], a[184:187], a[128:131], v[112:115]
 ds_read_b64_tr_b16 a[176:177], v4 offset:16384
 v_mfma_f32_16x16x32_bf16 v[112:115], a[188:191], a[144:147], v[112:115]
 buffer_load_dwordx4 v10, s[40:43], s99 offen offset:0 lds
 v_mfma_f32_16x16x32_bf16 v[116:119], a[184:187], a[132:135], v[116:119]
 buffer_load_dwordx4 v11, s[40:43], s99 offen offset:1024 lds
 v_mfma_f32_16x16x32_bf16 v[116:119], a[188:191], a[148:151], v[116:119]
 ds_read_b64_tr_b16 a[178:179], v4 offset:16896
 v_mfma_f32_16x16x32_bf16 v[120:123], a[184:187], a[136:139], v[120:123]
 ds_read_b64_tr_b16 a[180:181], v4 offset:20480
 v_mfma_f32_16x16x32_bf16 v[120:123], a[188:191], a[152:155], v[120:123]
 buffer_load_dwordx4 v12, s[40:43], s99 offen offset:2048 lds
 v_mfma_f32_16x16x32_bf16 v[124:127], a[184:187], a[140:143], v[124:127]
 buffer_load_dwordx4 v13, s[40:43], s99 offen offset:3072 lds
 v_mfma_f32_16x16x32_bf16 v[124:127], a[188:191], a[156:159], v[124:127]
 s_waitcnt lgkmcnt(8)
 ds_read_b64_tr_b16 a[182:183], v4 offset:20992
 v_mfma_f32_16x16x32_bf16 a[0:3], a[160:163], a[128:131], a[0:3]
 s_add_u32 s95, s95, 1
 ds_read_b64_tr_b16 a[184:185], v5 offset:16384
 v_mfma_f32_16x16x32_bf16 a[0:3], a[164:167], a[144:147], a[0:3]
 s_and_b32 s95, s95, 15
 ds_read_b64_tr_b16 a[186:187], v5 offset:16896
 v_mfma_f32_16x16x32_bf16 a[4:7], a[160:163], a[132:135], a[4:7]
 s_lshl_b32 s84, s95, 18
 ds_read_b128 a[208:211], v15 offset:1024
 v_mfma_f32_16x16x32_bf16 a[4:7], a[164:167], a[148:151], a[4:7]
 v_mfma_f32_16x16x32_bf16 a[8:11], a[160:163], a[136:139], a[8:11]
 ds_read_b64_tr_b16 a[188:189], v5 offset:20480
 v_mfma_f32_16x16x32_bf16 a[8:11], a[164:167], a[152:155], a[8:11]
 ds_read_b64_tr_b16 a[190:191], v5 offset:20992
 v_mfma_f32_16x16x32_bf16 a[12:15], a[160:163], a[140:143], a[12:15]
 ds_read_b128 a[212:215], v15 offset:17408
 v_mfma_f32_16x16x32_bf16 a[12:15], a[164:167], a[156:159], a[12:15]
 s_waitcnt vmcnt(8) lgkmcnt(10)
 v_mfma_f32_16x16x32_bf16 a[16:19], a[168:171], a[128:131], a[16:19]
 s_add_u32 s95, s95, 1
 ds_read_b64_tr_b16 a[160:161], v2 offset:32768
 v_mfma_f32_16x16x32_bf16 a[16:19], a[172:175], a[144:147], a[16:19]
 s_lshl_b32 s99, s95, 18
 ds_read_b64_tr_b16 a[162:163], v2 offset:33280
 v_mfma_f32_16x16x32_bf16 a[20:23], a[168:171], a[132:135], a[20:23]
 ds_read_b128 a[216:219], v15 offset:33792
 v_mfma_f32_16x16x32_bf16 a[20:23], a[172:175], a[148:151], a[20:23]
 v_mfma_f32_16x16x32_bf16 a[24:27], a[168:171], a[136:139], a[24:27]
 ds_read_b64_tr_b16 a[164:165], v2 offset:36864
 v_mfma_f32_16x16x32_bf16 a[24:27], a[172:175], a[152:155], a[24:27]
 ds_read_b64_tr_b16 a[166:167], v2 offset:37376
 v_mfma_f32_16x16x32_bf16 a[28:31], a[168:171], a[140:143], a[28:31]
 ds_read_b128 a[220:223], v15 offset:50176
 v_mfma_f32_16x16x32_bf16 a[28:31], a[172:175], a[156:159], a[28:31]
 s_add_u32 m0, s83, 16384
 s_waitcnt lgkmcnt(7)
 v_mfma_f32_16x16x32_bf16 a[32:35], a[176:179], a[128:131], a[32:35]
 ds_read_b64_tr_b16 a[168:169], v3 offset:32768
 v_mfma_f32_16x16x32_bf16 a[32:35], a[180:183], a[144:147], a[32:35]
 buffer_load_dwordx4 v10, s[40:43], s84 offen offset:0 lds
 v_mfma_f32_16x16x32_bf16 a[36:39], a[176:179], a[132:135], a[36:39]
 buffer_load_dwordx4 v11, s[40:43], s84 offen offset:1024 lds
 v_mfma_f32_16x16x32_bf16 a[36:39], a[180:183], a[148:151], a[36:39]
 ds_read_b64_tr_b16 a[170:171], v3 offset:33280
 v_mfma_f32_16x16x32_bf16 a[40:43], a[176:179], a[136:139], a[40:43]
 ds_read_b64_tr_b16 a[172:173], v3 offset:36864
 v_mfma_f32_16x16x32_bf16 a[40:43], a[180:183], a[152:155], a[40:43]
 buffer_load_dwordx4 v12, s[40:43], s84 offen offset:2048 lds
 v_mfma_f32_16x16x32_bf16 a[44:47], a[176:179], a[140:143], a[44:47]
 buffer_load_dwordx4 v13, s[40:43], s84 offen offset:3072 lds
 v_mfma_f32_16x16x32_bf16 a[44:47], a[180:183], a[156:159], a[44:47]
 s_add_u32 m0, s83, 20480
 ds_read_b64_tr_b16 a[174:175], v3 offset:37376
 s_waitcnt lgkmcnt(11)
 v_mfma_f32_16x16x32_bf16 a[48:51], a[184:187], a[128:131], a[48:51]
 ds_read_b64_tr_b16 a[176:177], v4 offset:32768
 v_mfma_f32_16x16x32_bf16 a[48:51], a[188:191], a[144:147], a[48:51]
 buffer_load_dwordx4 v10, s[40:43], s99 offen offset:0 lds
 v_mfma_f32_16x16x32_bf16 a[52:55], a[184:187], a[132:135], a[52:55]
 buffer_load_dwordx4 v11, s[40:43], s99 offen offset:1024 lds
 v_mfma_f32_16x16x32_bf16 a[52:55], a[188:191], a[148:151], a[52:55]
 ds_read_b64_tr_b16 a[178:179], v4 offset:33280
 v_mfma_f32_16x16x32_bf16 a[56:59], a[184:187], a[136:139], a[56:59]
 ds_read_b64_tr_b16 a[180:181], v4 offset:36864
 v_mfma_f32_16x16x32_bf16 a[56:59], a[188:191], a[152:155], a[56:59]
 buffer_load_dwordx4 v12, s[40:43], s99 offen offset:2048 lds
 v_mfma_f32_16x16x32_bf16 a[60:63], a[184:187], a[140:143], a[60:63]
 buffer_load_dwordx4 v13, s[40:43], s99 offen offset:3072 lds
 v_mfma_f32_16x16x32_bf16 a[60:63], a[188:191], a[156:159], a[60:63]
 s_waitcnt lgkmcnt(7)
 ds_read_b64_tr_b16 a[182:183], v4 offset:37376
L_p2:
 v_mfma_f32_16x16x32_bf16 v[128:131], a[160:163], a[192:195], 0
 s_add_u32 s95, s95, 15
 ds_read_b64_tr_b16 a[184:185], v5 offset:32768
 v_mfma_f32_16x16x32_bf16 v[128:131], a[164:167], a[208:211], v[128:131]
 s_and_b32 s95, s95, 15
 ds_read_b64_tr_b16 a[186:187], v5 offset:33280
 v_mfma_f32_16x16x32_bf16 v[132:135], a[160:163], a[196:199], 0
 s_lshl_b32 s84, s95, 18
 ds_read_b128 a[128:131], v14 offset:2048
 v_mfma_f32_16x16x32_bf16 v[132:135], a[164:167], a[212:215], v[132:135]
 s_add_u32 s84, s84, 128
 v_mfma_f32_16x16x32_bf16 v[136:139], a[160:163], a[200:203], 0
 ds_read_b64_tr_b16 a[188:189], v5 offset:36864
 v_mul_f32 v64, s97, v64
 v_mfma_f32_16x16x32_bf16 v[136:139], a[164:167], a[216:219], v[136:139]
 ds_read_b64_tr_b16 a[190:191], v5 offset:37376
 v_mul_f32 v65, s97, v65
 v_mfma_f32_16x16x32_bf16 v[140:143], a[160:163], a[204:207], 0
 ds_read_b128 a[132:135], v14 offset:18432
 v_mul_f32 v66, s97, v66
 v_mfma_f32_16x16x32_bf16 v[140:143], a[164:167], a[220:223], v[140:143]
 s_waitcnt vmcnt(8) lgkmcnt(10)
 v_mul_f32 v67, s97, v67
 v_mfma_f32_16x16x32_bf16 v[144:147], a[168:171], a[192:195], 0
 s_add_u32 s95, s95, 1
 ds_read_b64_tr_b16 a[160:161], v2 offset:0
 v_mfma_f32_16x16x32_bf16 v[144:147], a[172:175], a[208:211], v[144:147]
 s_lshl_b32 s99, s95, 18
 ds_read_b64_tr_b16 a[162:163], v2 offset:512
 v_mfma_f32_16x16x32_bf16 v[148:151], a[168:171], a[196:199], 0
 s_add_u32 s99, s99, 128
 ds_read_b128 a[136:139], v14 offset:34816
 v_mfma_f32_16x16x32_bf16 v[148:151], a[172:175], a[212:215], v[148:151]
 v_exp_f32 v64, v64
 v_mfma_f32_16x16x32_bf16 v[152:155], a[168:171], a[200:203], 0
 ds_read_b64_tr_b16 a[164:165], v2 offset:4096
 v_accvgpr_read_b32 v20, a0
 v_mfma_f32_16x16x32_bf16 v[152:155], a[172:175], a[216:219], v[152:155]
 ds_read_b64_tr_b16 a[166:167], v2 offset:4608
 v_mfma_f32_16x16x32_bf16 v[156:159], a[168:171], a[204:207], 0
 ds_read_b128 a[140:143], v14 offset:51200
 v_mfma_f32_16x16x32_bf16 v[156:159], a[172:175], a[220:223], v[156:159]
 s_add_u32 m0, s83, 32768
 s_waitcnt lgkmcnt(7)
 v_mfma_f32_16x16x32_bf16 v[160:163], a[176:179], a[192:195], 0
 ds_read_b64_tr_b16 a[168:169], v3 offset:0
 v_exp_f32 v65, v65
 v_mfma_f32_16x16x32_bf16 v[160:163], a[180:183], a[208:211], v[160:163]
 buffer_load_dwordx4 v10, s[40:43], s84 offen offset:0 lds
 v_accvgpr_read_b32 v21, a1
 v_mfma_f32_16x16x32_bf16 v[164:167], a[176:179], a[196:199], 0
 buffer_load_dwordx4 v11, s[40:43], s84 offen offset:1024 lds
 v_exp_f32 v66, v66
 v_mfma_f32_16x16x32_bf16 v[164:167], a[180:183], a[212:215], v[164:167]
 ds_read_b64_tr_b16 a[170:171], v3 offset:512
 v_accvgpr_read_b32 v22, a2
 v_mfma_f32_16x16x32_bf16 v[168:171], a[176:179], a[200:203], 0
 ds_read_b64_tr_b16 a[172:173], v3 offset:4096
 v_mfma_f32_16x16x32_bf16 v[168:171], a[180:183], a[216:219], v[168:171]
 buffer_load_dwordx4 v12, s[40:43], s84 offen offset:2048 lds
 v_exp_f32 v67, v67
 v_mfma_f32_16x16x32_bf16 v[172:175], a[176:179], a[204:207], 0
 buffer_load_dwordx4 v13, s[40:43], s84 offen offset:3072 lds
 v_accvgpr_read_b32 v23, a3
 v_mfma_f32_16x16x32_bf16 v[172:175], a[180:183], a[220:223], v[172:175]
 s_add_u32 m0, s83, 36864
 ds_read_b64_tr_b16 a[174:175], v3 offset:4608
 s_waitcnt lgkmcnt(11)
 v_fma_f32 v64, v64, s98, s98
 v_mfma_f32_16x16x32_bf16 v[176:179], a[184:187], a[192:195], 0
 ds_read_b64_tr_b16 a[176:177], v4 offset:0
 v_fma_f32 v65, v65, s98, s98
 v_fma_f32 v66, v66, s98, s98
 v_mfma_f32_16x16x32_bf16 v[176:179], a[188:191], a[208:211], v[176:179]
 buffer_load_dwordx4 v10, s[40:43], s99 offen offset:0 lds
 v_fma_f32 v67, v67, s98, s98
 v_mfma_f32_16x16x32_bf16 v[180:183], a[184:187], a[196:199], 0
 buffer_load_dwordx4 v11, s[40:43], s99 offen offset:1024 lds
 v_rcp_f32 v64, v64
 v_mfma_f32_16x16x32_bf16 v[180:183], a[188:191], a[212:215], v[180:183]
 ds_read_b64_tr_b16 a[178:179], v4 offset:512
 v_mfma_f32_16x16x32_bf16 v[184:187], a[184:187], a[200:203], 0
 ds_read_b64_tr_b16 a[180:181], v4 offset:4096
 v_rcp_f32 v65, v65
 v_mfma_f32_16x16x32_bf16 v[184:187], a[188:191], a[216:219], v[184:187]
 buffer_load_dwordx4 v12, s[40:43], s99 offen offset:2048 lds
 v_mfma_f32_16x16x32_bf16 v[188:191], a[184:187], a[204:207], 0
 buffer_load_dwordx4 v13, s[40:43], s99 offen offset:3072 lds
 v_rcp_f32 v66, v66
 v_mfma_f32_16x16x32_bf16 v[188:191], a[188:191], a[220:223], v[188:191]
 s_waitcnt lgkmcnt(8)
 ds_read_b64_tr_b16 a[182:183], v4 offset:4608
 v_rcp_f32 v67, v67
 v_mfma_f32_16x16x32_bf16 v[192:195], a[160:163], a[192:195], 0
 s_add_u32 s95, s95, 1
 ds_read_b64_tr_b16 a[184:185], v5 offset:0
 v_mul_f32 v64, v64, v20
 v_mfma_f32_16x16x32_bf16 v[192:195], a[164:167], a[208:211], v[192:195]
 s_and_b32 s95, s95, 15
 ds_read_b64_tr_b16 a[186:187], v5 offset:512
 v_mul_f32 v65, v65, v21
 v_mfma_f32_16x16x32_bf16 v[196:199], a[160:163], a[196:199], 0
 s_lshl_b32 s84, s95, 18
 ds_read_b128 a[144:147], v15 offset:3072
 v_mul_f32 v66, v66, v22
 v_mfma_f32_16x16x32_bf16 v[196:199], a[164:167], a[212:215], v[196:199]
 v_mul_f32 v67, v67, v23
 v_cvt_pk_bf16_f32 v32, v64, v65
 v_mfma_f32_16x16x32_bf16 v[200:203], a[160:163], a[200:203], 0
 ds_read_b64_tr_b16 a[188:189], v5 offset:4096
 v_cvt_pk_bf16_f32 v33, v66, v67
 v_mfma_f32_16x16x32_bf16 v[200:203], a[164:167], a[216:219], v[200:203]
 ds_read_b64_tr_b16 a[190:191], v5 offset:4608
 v_mul_f32 v80, s97, v80
 v_mfma_f32_16x16x32_bf16 v[204:207], a[160:163], a[204:207], 0
 ds_read_b128 a[148:151], v15 offset:19456
 v_mul_f32 v81, s97, v81
 v_mfma_f32_16x16x32_bf16 v[204:207], a[164:167], a[220:223], v[204:207]
 s_waitcnt vmcnt(8) lgkmcnt(10)
 v_mul_f32 v82, s97, v82
 v_mul_f32 v83, s97, v83
 v_mfma_f32_16x16x32_bf16 v[208:211], a[168:171], a[192:195], 0
 s_add_u32 s95, s95, 1
 ds_read_b64_tr_b16 a[160:161], v2 offset:16384
 v_mfma_f32_16x16x32_bf16 v[208:211], a[172:175], a[208:211], v[208:211]
 s_lshl_b32 s99, s95, 18
 ds_read_b64_tr_b16 a[162:163], v2 offset:16896
 v_exp_f32 v80, v80
 v_mfma_f32_16x16x32_bf16 v[212:215], a[168:171], a[196:199], 0
 ds_read_b128 a[152:155], v15 offset:35840
 v_accvgpr_read_b32 v20, a16
 v_mfma_f32_16x16x32_bf16 v[212:215], a[172:175], a[212:215], v[212:215]
 v_exp_f32 v81, v81
 v_mfma_f32_16x16x32_bf16 v[216:219], a[168:171], a[200:203], 0
 ds_read_b64_tr_b16 a[164:165], v2 offset:20480
 v_accvgpr_read_b32 v21, a17
 v_mfma_f32_16x16x32_bf16 v[216:219], a[172:175], a[216:219], v[216:219]
 ds_read_b64_tr_b16 a[166:167], v2 offset:20992
 v_mfma_f32_16x16x32_bf16 v[220:223], a[168:171], a[204:207], 0
 ds_read_b128 a[156:159], v15 offset:52224
 v_exp_f32 v82, v82
 v_mfma_f32_16x16x32_bf16 v[220:223], a[172:175], a[220:223], v[220:223]
 s_add_u32 m0, s83, 0
 s_waitcnt lgkmcnt(7)
 v_accvgpr_read_b32 v22, a18
 v_mfma_f32_16x16x32_bf16 v[224:227], a[176:179], a[192:195], 0
 ds_read_b64_tr_b16 a[168:169], v3 offset:16384
 v_exp_f32 v83, v83
 v_mfma_f32_16x16x32_bf16 v[224:227], a[180:183], a[208:211], v[224:227]
 buffer_load_dwordx4 v10, s[40:43], s84 offen offset:0 lds
 v_accvgpr_read_b32 v23, a19
 v_mfma_f32_16x16x32_bf16 v[228:231], a[176:179], a[196:199], 0
 buffer_load_dwordx4 v11, s[40:43], s84 offen offset:1024 lds
 v_fma_f32 v80, v80, s98, s98
 v_mfma_f32_16x16x32_bf16 v[228:231], a[180:183], a[212:215], v[228:231]
 ds_read_b64_tr_b16 a[170:171], v3 offset:16896
 v_fma_f32 v81, v81, s98, s98
 v_mfma_f32_16x16x32_bf16 v[232:235], a[176:179], a[200:203], 0
 ds_read_b64_tr_b16 a[172:173], v3 offset:20480
 v_fma_f32 v82, v82, s98, s98
 v_fma_f32 v83, v83, s98, s98
 v_mfma_f32_16x16x32_bf16 v[232:235], a[180:183], a[216:219], v[232:235]
 buffer_load_dwordx4 v12, s[40:43], s84 offen offset:2048 lds
 v_mfma_f32_16x16x32_bf16 v[236:239], a[176:179], a[204:207], 0
 buffer_load_dwordx4 v13, s[40:43], s84 offen offset:3072 lds
 v_rcp_f32 v80, v80
 v_mfma_f32_16x16x32_bf16 v[236:239], a[180:183], a[220:223], v[236:239]
 s_add_u32 m0, s83, 4096
 ds_read_b64_tr_b16 a[174:175], v3 offset:20992
 s_waitcnt lgkmcnt(11)
 v_mfma_f32_16x16x32_bf16 v[240:243], a[184:187], a[192:195], 0
 ds_read_b64_tr_b16 a[176:177], v4 offset:16384
 v_rcp_f32 v81, v81
 v_mfma_f32_16x16x32_bf16 v[240:243], a[188:191], a[208:211], v[240:243]
 buffer_load_dwordx4 v10, s[40:43], s99 offen offset:0 lds
 v_rcp_f32 v82, v82
 v_mfma_f32_16x16x32_bf16 v[244:247], a[184:187], a[196:199], 0
 buffer_load_dwordx4 v11, s[40:43], s99 offen offset:1024 lds
 v_mfma_f32_16x16x32_bf16 v[244:247], a[188:191], a[212:215], v[244:247]
 ds_read_b64_tr_b16 a[178:179], v4 offset:16896
 v_rcp_f32 v83, v83
 v_mfma_f32_16x16x32_bf16 v[248:251], a[184:187], a[200:203], 0
 ds_read_b64_tr_b16 a[180:181], v4 offset:20480
 v_mul_f32 v80, v80, v20
 v_mfma_f32_16x16x32_bf16 v[248:251], a[188:191], a[216:219], v[248:251]
 buffer_load_dwordx4 v12, s[40:43], s99 offen offset:2048 lds
 v_mul_f32 v81, v81, v21
 v_mfma_f32_16x16x32_bf16 v[252:255], a[184:187], a[204:207], 0
 buffer_load_dwordx4 v13, s[40:43], s99 offen offset:3072 lds
 v_mul_f32 v82, v82, v22
 v_mfma_f32_16x16x32_bf16 v[252:255], a[188:191], a[220:223], v[252:255]
 s_waitcnt lgkmcnt(7)
 ds_read_b64_tr_b16 a[182:183], v4 offset:20992
 v_mul_f32 v83, v83, v23
 v_cvt_pk_bf16_f32 v34, v80, v81
 v_mfma_f32_16x16x32_bf16 v[128:131], a[160:163], a[128:131], v[128:131]
 s_add_u32 s95, s95, 15
 ds_read_b64_tr_b16 a[184:185], v5 offset:16384
 v_cvt_pk_bf16_f32 v35, v82, v83
 v_mfma_f32_16x16x32_bf16 v[128:131], a[164:167], a[144:147], v[128:131]
 s_and_b32 s95, s95, 15
 ds_read_b64_tr_b16 a[186:187], v5 offset:16896
 v_mul_f32 v68, s97, v68
 v_mfma_f32_16x16x32_bf16 v[132:135], a[160:163], a[132:135], v[132:135]
 s_lshl_b32 s84, s95, 18
 ds_read_b128 a[192:195], v14 offset:4096
 v_mul_f32 v69, s97, v69
 v_mul_f32 v70, s97, v70
 v_mfma_f32_16x16x32_bf16 v[132:135], a[164:167], a[148:151], v[132:135]
 s_add_u32 s84, s84, 128
 v_mul_f32 v71, s97, v71
 v_mfma_f32_16x16x32_bf16 v[136:139], a[160:163], a[136:139], v[136:139]
 ds_read_b64_tr_b16 a[188:189], v5 offset:20480
 v_mfma_f32_16x16x32_bf16 v[136:139], a[164:167], a[152:155], v[136:139]
 ds_read_b64_tr_b16 a[190:191], v5 offset:20992
 v_exp_f32 v68, v68
 v_mfma_f32_16x16x32_bf16 v[140:143], a[160:163], a[140:143], v[140:143]
 ds_read_b128 a[196:199], v14 offset:20480
 v_accvgpr_read_b32 v20, a4
 v_mfma_f32_16x16x32_bf16 v[140:143], a[164:167], a[156:159], v[140:143]
 s_waitcnt vmcnt(8) lgkmcnt(10)
 v_exp_f32 v69, v69
 v_mfma_f32_16x16x32_bf16 v[144:147], a[168:171], a[128:131], v[144:147]
 s_add_u32 s95, s95, 1
 ds_read_b64_tr_b16 a[160:161], v2 offset:32768
 v_accvgpr_read_b32 v21, a5
 v_mfma_f32_16x16x32_bf16 v[144:147], a[172:175], a[144:147], v[144:147]
 s_lshl_b32 s99, s95, 18
 ds_read_b64_tr_b16 a[162:163], v2 offset:33280
 v_mfma_f32_16x16x32_bf16 v[148:151], a[168:171], a[132:135], v[148:151]
 s_add_u32 s99, s99, 128
 ds_read_b128 a[200:203], v14 offset:36864
 v_exp_f32 v70, v70
 v_mfma_f32_16x16x32_bf16 v[148:151], a[172:175], a[148:151], v[148:151]
 v_accvgpr_read_b32 v22, a6
 v_mfma_f32_16x16x32_bf16 v[152:155], a[168:171], a[136:139], v[152:155]
 ds_read_b64_tr_b16 a[164:165], v2 offset:36864
 v_exp_f32 v71, v71
 v_mfma_f32_16x16x32_bf16 v[152:155], a[172:175], a[152:155], v[152:155]
 ds_read_b64_tr_b16 a[166:167], v2 offset:37376
 v_accvgpr_read_b32 v23, a7
 v_mfma_f32_16x16x32_bf16 v[156:159], a[168:171], a[140:143], v[156:159]
 ds_read_b128 a[204:207], v14 offset:53248
 v_fma_f32 v68, v68, s98, s98
 v_mfma_f32_16x16x32_bf16 v[156:159], a[172:175], a[156:159], v[156:159]
 s_add_u32 m0, s83, 16384
 s_waitcnt lgkmcnt(7)
 v_fma_f32 v69, v69, s98, s98
 v_fma_f32 v70, v70, s98, s98
 v_mfma_f32_16x16x32_bf16 v[160:163], a[176:179], a[128:131], v[160:163]
 ds_read_b64_tr_b16 a[168:169], v3 offset:32768
 v_fma_f32 v71, v71, s98, s98
 v_mfma_f32_16x16x32_bf16 v[160:163], a[180:183], a[144:147], v[160:163]
 buffer_load_dwordx4 v10, s[40:43], s84 offen offset:0 lds
 v_mfma_f32_16x16x32_bf16 v[164:167], a[176:179], a[132:135], v[164:167]
 buffer_load_dwordx4 v11, s[40:43], s84 offen offset:1024 lds
 v_rcp_f32 v68, v68
 v_mfma_f32_16x16x32_bf16 v[164:167], a[180:183], a[148:151], v[164:167]
 ds_read_b64_tr_b16 a[170:171], v3 offset:33280
 v_rcp_f32 v69, v69
 v_mfma_f32_16x16x32_bf16 v[168:171], a[176:179], a[136:139], v[168:171]
 ds_read_b64_tr_b16 a[172:173], v3 offset:36864
 v_mfma_f32_16x16x32_bf16 v[168:171], a[180:183], a[152:155], v[168:171]
 buffer_load_dwordx4 v12, s[40:43], s84 offen offset:2048 lds
 v_rcp_f32 v70, v70
 v_mfma_f32_16x16x32_bf16 v[172:175], a[176:179], a[140:143], v[172:175]
 buffer_load_dwordx4 v13, s[40:43], s84 offen offset:3072 lds
 v_mfma_f32_16x16x32_bf16 v[172:175], a[180:183], a[156:159], v[172:175]
 s_add_u32 m0, s83, 20480
 ds_read_b64_tr_b16 a[174:175], v3 offset:37376
 s_waitcnt lgkmcnt(11)
 v_rcp_f32 v71, v71
 v_mfma_f32_16x16x32_bf16 v[176:179], a[184:187], a[128:131], v[176:179]
 ds_read_b64_tr_b16 a[176:177], v4 offset:32768
 v_mul_f32 v68, v68, v20
 v_mul_f32 v69, v69, v21
 v_mfma_f32_16x16x32_bf16 v[176:179], a[188:191], a[144:147], v[176:179]
 buffer_load_dwordx4 v10, s[40:43], s99 offen offset:0 lds
 v_mul_f32 v70, v70, v22
 v_mfma_f32_16x16x32_bf16 v[180:183], a[184:187], a[132:135], v[180:183]
 buffer_load_dwordx4 v11, s[40:43], s99 offen offset:1024 lds
 v_mul_f32 v71, v71, v23
 v_mfma_f32_16x16x32_bf16 v[180:183], a[188:191], a[148:151], v[180:183]
 ds_read_b64_tr_b16 a[178:179], v4 offset:33280
 v_cvt_pk_bf16_f32 v36, v68, v69
 v_mfma_f32_16x16x32_bf16 v[184:187], a[184:187], a[136:139], v[184:187]
 ds_read_b64_tr_b16 a[180:181], v4 offset:36864
 v_cvt_pk_bf16_f32 v37, v70, v71
 v_mul_f32 v84, s97, v84
 v_mfma_f32_16x16x32_bf16 v[184:187], a[188:191], a[152:155], v[184:187]
 buffer_load_dwordx4 v12, s[40:43], s99 offen offset:2048 lds
 v_mul_f32 v85, s97, v85
 v_mfma_f32_16x16x32_bf16 v[188:191], a[184:187], a[140:143], v[188:191]
 buffer_load_dwordx4 v13, s[40:43], s99 offen offset:3072 lds
 v_mul_f32 v86, s97, v86
 v_mfma_f32_16x16x32_bf16 v[188:191], a[188:191], a[156:159], v[188:191]
 s_waitcnt lgkmcnt(8)
 ds_read_b64_tr_b16 a[182:183], v4 offset:37376
 v_mul_f32 v87, s97, v87
 v_mfma_f32_16x16x32_bf16 v[192:195], a[160:163], a[128:131], v[192:195]
 s_add_u32 s95, s95, 1
 ds_read_b64_tr_b16 a[184:185], v5 offset:32768
 v_mfma_f32_16x16x32_bf16 v[192:195], a[164:167], a[144:147], v[192:195]
 s_and_b32 s95, s95, 15
 ds_read_b64_tr_b16 a[186:187], v5 offset:33280
 v_exp_f32 v84, v84
 v_mfma_f32_16x16x32_bf16 v[196:199], a[160:163], a[132:135], v[196:199]
 s_lshl_b32 s84, s95, 18
 ds_read_b128 a[208:211], v15 offset:5120
 v_accvgpr_read_b32 v20, a20
 v_mfma_f32_16x16x32_bf16 v[196:199], a[164:167], a[148:151], v[196:199]
 v_exp_f32 v85, v85
 v_mfma_f32_16x16x32_bf16 v[200:203], a[160:163], a[136:139], v[200:203]
 ds_read_b64_tr_b16 a[188:189], v5 offset:36864
L_pg4:
 s_cbranch_execz L_pg8
 v_accvgpr_read_b32 v21, a21
 v_mfma_f32_16x16x32_bf16 v[200:203], a[164:167], a[152:155], v[200:203]
 ds_read_b64_tr_b16 a[190:191], v5 offset:37376
 v_exp_f32 v86, v86
 v_mfma_f32_16x16x32_bf16 v[204:207], a[160:163], a[140:143], v[204:207]
 ds_read_b128 a[212:215], v15 offset:21504
 v_accvgpr_read_b32 v22, a22
 v_mfma_f32_16x16x32_bf16 v[204:207], a[164:167], a[156:159], v[204:207]
 s_waitcnt vmcnt(8) lgkmcnt(10)
 v_exp_f32 v87, v87
 v_mfma_f32_16x16x32_bf16 v[208:211], a[168:171], a[128:131], v[208:211]
 s_add_u32 s95, s95, 1
 ds_read_b64_tr_b16 a[160:161], v2 offset:0
 v_accvgpr_read_b32 v23, a23
 v_mfma_f32_16x16x32_bf16 v[208:211], a[172:175], a[144:147], v[208:211]
 s_lshl_b32 s99, s95, 18
 ds_read_b64_tr_b16 a[162:163], v2 offset:512
 v_fma_f32 v84, v84, s98, s98
 v_mfma_f32_16x16x32_bf16 v[212:215], a[168:171], a[132:135], v[212:215]
 ds_read_b128 a[216:219], v15 offset:37888
 v_fma_f32 v85, v85, s98, s98
 v_mfma_f32_16x16x32_bf16 v[212:215], a[172:175], a[148:151], v[212:215]
 v_fma_f32 v86, v86, s98, s98
 v_fma_f32 v87, v87, s98, s98
 v_mfma_f32_16x16x32_bf16 v[216:219], a[168:171], a[136:139], v[216:219]
 ds_read_b64_tr_b16 a[164:165], v2 offset:4096
 v_mfma_f32_16x16x32_bf16 v[216:219], a[172:175], a[152:155], v[216:219]
 ds_read_b64_tr_b16 a[166:167], v2 offset:4608
 v_mfma_f32_16x16x32_bf16 v[220:223], a[168:171], a[140:143], v[220:223]
 ds_read_b128 a[220:223], v15 offset:54272
 v_rcp_f32 v84, v84
 v_mfma_f32_16x16x32_bf16 v[220:223], a[172:175], a[156:159], v[220:223]
 s_add_u32 m0, s83, 32768
 s_waitcnt lgkmcnt(7)
 v_rcp_f32 v85, v85
 v_mfma_f32_16x16x32_bf16 v[224:227], a[176:179], a[128:131], v[224:227]
 ds_read_b64_tr_b16 a[168:169], v3 offset:0
 v_mfma_f32_16x16x32_bf16 v[224:227], a[180:183], a[144:147], v[224:227]
 buffer_load_dwordx4 v10, s[40:43], s84 offen offset:0 lds
 v_rcp_f32 v86, v86
 v_mfma_f32_16x16x32_bf16 v[228:231], a[176:179], a[132:135], v[228:231]
 buffer_load_dwordx4 v11, s[40:43], s84 offen offset:1024 lds
 v_rcp_f32 v87, v87
 v_mfma_f32_16x16x32_bf16 v[228:231], a[180:183], a[148:151], v[228:231]
 ds_read_b64_tr_b16 a[170:171], v3 offset:512
 v_mul_f32 v84, v84, v20
 v_mfma_f32_16x16x32_bf16 v[232:235], a[176:179], a[136:139], v[232:235]
 ds_read_b64_tr_b16 a[172:173], v3 offset:4096
 v_mul_f32 v85, v85, v21
 v_mfma_f32_16x16x32_bf16 v[232:235], a[180:183], a[152:155], v[232:235]
 buffer_load_dwordx4 v12, s[40:43], s84 offen offset:2048 lds
 v_mul_f32 v86, v86, v22
 v_mfma_f32_16x16x32_bf16 v[236:239], a[176:179], a[140:143], v[236:239]
 buffer_load_dwordx4 v13, s[40:43], s84 offen offset:3072 lds
 v_mul_f32 v87, v87, v23
 v_mfma_f32_16x16x32_bf16 v[236:239], a[180:183], a[156:159], v[236:239]
 s_add_u32 m0, s83, 36864
 ds_read_b64_tr_b16 a[174:175], v3 offset:4608
 s_waitcnt lgkmcnt(11)
 v_cvt_pk_bf16_f32 v38, v84, v85
 v_mfma_f32_16x16x32_bf16 v[240:243], a[184:187], a[128:131], v[240:243]
 ds_read_b64_tr_b16 a[176:177], v4 offset:0
 v_cvt_pk_bf16_f32 v39, v86, v87
 v_mul_f32 v72, s97, v72
 v_mfma_f32_16x16x32_bf16 v[240:243], a[188:191], a[144:147], v[240:243]
 buffer_load_dwordx4 v10, s[40:43], s99 offen offset:0 lds
 v_mul_f32 v73, s97, v73
 v_mfma_f32_16x16x32_bf16 v[244:247], a[184:187], a[132:135], v[244:247]
 buffer_load_dwordx4 v11, s[40:43], s99 offen offset:1024 lds
 v_mul_f32 v74, s97, v74
 v_mfma_f32_16x16x32_bf16 v[244:247], a[188:191], a[148:151], v[244:247]
 ds_read_b64_tr_b16 a[178:179], v4 offset:512
 v_mul_f32 v75, s97, v75
 v_mfma_f32_16x16x32_bf16 v[248:251], a[184:187], a[136:139], v[248:251]
 ds_read_b64_tr_b16 a[180:181], v4 offset:4096
 v_exp_f32 v72, v72
 v_mfma_f32_16x16x32_bf16 v[248:251], a[188:191], a[152:155], v[248:251]
 buffer_load_dwordx4 v12, s[40:43], s99 offen offset:2048 lds
 v_accvgpr_read_b32 v20, a8
 v_mfma_f32_16x16x32_bf16 v[252:255], a[184:187], a[140:143], v[252:255]
 buffer_load_dwordx4 v13, s[40:43], s99 offen offset:3072 lds
 v_mfma_f32_16x16x32_bf16 v[252:255], a[188:191], a[156:159], v[252:255]
 s_waitcnt lgkmcnt(7)
 ds_read_b64_tr_b16 a[182:183], v4 offset:4608
 v_exp_f32 v73, v73
 v_mfma_f32_16x16x32_bf16 v[128:131], a[160:163], a[192:195], v[128:131]
 s_add_u32 s95, s95, 15
 ds_read_b64_tr_b16 a[184:185], v5 offset:0
 v_accvgpr_read_b32 v21, a9
 v_mfma_f32_16x16x32_bf16 v[128:131], a[164:167], a[208:211], v[128:131]
 s_and_b32 s95, s95, 15
 ds_read_b64_tr_b16 a[186:187], v5 offset:512
 v_exp_f32 v74, v74
 v_mfma_f32_16x16x32_bf16 v[132:135], a[160:163], a[196:199], v[132:135]
 s_lshl_b32 s84, s95, 18
 ds_read_b128 a[128:131], v14 offset:6144
 v_accvgpr_read_b32 v22, a10
 v_mfma_f32_16x16x32_bf16 v[132:135], a[164:167], a[212:215], v[132:135]
 s_add_u32 s84, s84, 128
 v_exp_f32 v75, v75
 v_mfma_f32_16x16x32_bf16 v[136:139], a[160:163], a[200:203], v[136:139]
 ds_read_b64_tr_b16 a[188:189], v5 offset:4096
 v_accvgpr_read_b32 v23, a11
 v_mfma_f32_16x16x32_bf16 v[136:139], a[164:167], a[216:219], v[136:139]
 ds_read_b64_tr_b16 a[190:191], v5 offset:4608
 v_fma_f32 v72, v72, s98, s98
 v_mfma_f32_16x16x32_bf16 v[140:143], a[160:163], a[204:207], v[140:143]
 ds_read_b128 a[132:135], v14 offset:22528
 v_fma_f32 v73, v73, s98, s98
 v_mfma_f32_16x16x32_bf16 v[140:143], a[164:167], a[220:223], v[140:143]
 s_waitcnt vmcnt(8) lgkmcnt(10)
 v_fma_f32 v74, v74, s98, s98
 v_fma_f32 v75, v75, s98, s98
 v_mfma_f32_16x16x32_bf16 v[144:147], a[168:171], a[192:195], v[144:147]
 s_add_u32 s95, s95, 1
 ds_read_b64_tr_b16 a[160:161], v2 offset:16384
 v_mfma_f32_16x16x32_bf16 v[144:147], a[172:175], a[208:211], v[144:147]
 s_lshl_b32 s99, s95, 18
 ds_read_b64_tr_b16 a[162:163], v2 offset:16896
 v_rcp_f32 v72, v72
 v_mfma_f32_16x16x32_bf16 v[148:151], a[168:171], a[196:199], v[148:151]
 s_add_u32 s99, s99, 128
 ds_read_b128 a[136:139], v14 offset:38912
 v_mfma_f32_16x16x32_bf16 v[148:151], a[172:175], a[212:215], v[148:151]
 v_rcp_f32 v73, v73
 v_mfma_f32_16x16x32_bf16 v[152:155], a[168:171], a[200:203], v[152:155]
 ds_read_b64_tr_b16 a[164:165], v2 offset:20480
 v_mfma_f32_16x16x32_bf16 v[152:155], a[172:175], a[216:219], v[152:155]
 ds_read_b64_tr_b16 a[166:167], v2 offset:20992
 v_rcp_f32 v74, v74
 v_mfma_f32_16x16x32_bf16 v[156:159], a[168:171], a[204:207], v[156:159]
 ds_read_b128 a[140:143], v14 offset:55296
 v_rcp_f32 v75, v75
 v_mfma_f32_16x16x32_bf16 v[156:159], a[172:175], a[220:223], v[156:159]
 s_add_u32 m0, s83, 0
 s_waitcnt lgkmcnt(7)
 v_mul_f32 v72, v72, v20
 v_mfma_f32_16x16x32_bf16 v[160:163], a[176:179], a[192:195], v[160:163]
 ds_read_b64_tr_b16 a[168:169], v3 offset:16384
 v_mul_f32 v73, v73, v21
 v_mfma_f32_16x16x32_bf16 v[160:163], a[180:183], a[208:211], v[160:163]
 buffer_load_dwordx4 v10, s[40:43], s84 offen offset:0 lds
 v_mul_f32 v74, v74, v22
 v_mfma_f32_16x16x32_bf16 v[164:167], a[176:179], a[196:199], v[164:167]
 buffer_load_dwordx4 v11, s[40:43], s84 offen offset:1024 lds
 v_mul_f32 v75, v75, v23
 v_mfma_f32_16x16x32_bf16 v[164:167], a[180:183], a[212:215], v[164:167]
 ds_read_b64_tr_b16 a[170:171], v3 offset:16896
 v_cvt_pk_bf16_f32 v40, v72, v73
 v_cvt_pk_bf16_f32 v41, v74, v75
 v_mfma_f32_16x16x32_bf16 v[168:171], a[176:179], a[200:203], v[168:171]
 ds_read_b64_tr_b16 a[172:173], v3 offset:20480
 v_mul_f32 v88, s97, v88
 v_mfma_f32_16x16x32_bf16 v[168:171], a[180:183], a[216:219], v[168:171]
 buffer_load_dwordx4 v12, s[40:43], s84 offen offset:2048 lds
 v_mul_f32 v89, s97, v89
 v_mfma_f32_16x16x32_bf16 v[172:175], a[176:179], a[204:207], v[172:175]
 buffer_load_dwordx4 v13, s[40:43], s84 offen offset:3072 lds
 v_mul_f32 v90, s97, v90
 v_mfma_f32_16x16x32_bf16 v[172:175], a[180:183], a[220:223], v[172:175]
 s_add_u32 m0, s83, 4096
 ds_read_b64_tr_b16 a[174:175], v3 offset:20992
 s_waitcnt lgkmcnt(11)
 v_mul_f32 v91, s97, v91
 v_mfma_f32_16x16x32_bf16 v[176:179], a[184:187], a[192:195], v[176:179]
 ds_read_b64_tr_b16 a[176:177], v4 offset:16384
 v_exp_f32 v88, v88
 v_mfma_f32_16x16x32_bf16 v[176:179], a[188:191], a[208:211], v[176:179]
 buffer_load_dwordx4 v10, s[40:43], s99 offen offset:0 lds
 v_accvgpr_read_b32 v20, a24
 v_mfma_f32_16x16x32_bf16 v[180:183], a[184:187], a[196:199], v[180:183]
 buffer_load_dwordx4 v11, s[40:43], s99 offen offset:1024 lds
 v_exp_f32 v89, v89
 v_mfma_f32_16x16x32_bf16 v[180:183], a[188:191], a[212:215], v[180:183]
 ds_read_b64_tr_b16 a[178:179], v4 offset:16896
 v_accvgpr_read_b32 v21, a25
 v_mfma_f32_16x16x32_bf16 v[184:187], a[184:187], a[200:203], v[184:187]
 ds_read_b64_tr_b16 a[180:181], v4 offset:20480
 v_mfma_f32_16x16x32_bf16 v[184:187], a[188:191], a[216:219], v[184:187]
 buffer_load_dwordx4 v12, s[40:43], s99 offen offset:2048 lds
 v_exp_f32 v90, v90
 v_mfma_f32_16x16x32_bf16 v[188:191], a[184:187], a[204:207], v[188:191]
 buffer_load_dwordx4 v13, s[40:43], s99 offen offset:3072 lds
 v_accvgpr_read_b32 v22, a26
 v_mfma_f32_16x16x32_bf16 v[188:191], a[188:191], a[220:223], v[188:191]
 s_waitcnt lgkmcnt(8)
 ds_read_b64_tr_b16 a[182:183], v4 offset:20992
 v_exp_f32 v91, v91
 v_mfma_f32_16x16x32_bf16 v[192:195], a[160:163], a[192:195], v[192:195]
 s_add_u32 s95, s95, 1
 ds_read_b64_tr_b16 a[184:185], v5 offset:16384
 v_accvgpr_read_b32 v23, a27
 v_mfma_f32_16x16x32_bf16 v[192:195], a[164:167], a[208:211], v[192:195]
 s_and_b32 s95, s95, 15
 ds_read_b64_tr_b16 a[186:187], v5 offset:16896
 v_fma_f32 v88, v88, s98, s98
 v_mfma_f32_16x16x32_bf16 v[196:199], a[160:163], a[196:199], v[196:199]
 s_lshl_b32 s84, s95, 18
 ds_read_b128 a[144:147], v15 offset:7168
 v_fma_f32 v89, v89, s98, s98
 v_mfma_f32_16x16x32_bf16 v[196:199], a[164:167], a[212:215], v[196:199]
 v_fma_f32 v90, v90, s98, s98
 v_fma_f32 v91, v91, s98, s98
 v_mfma_f32_16x16x32_bf16 v[200:203], a[160:163], a[200:203], v[200:203]
 ds_read_b64_tr_b16 a[188:189], v5 offset:20480
 v_mfma_f32_16x16x32_bf16 v[200:203], a[164:167], a[216:219], v[200:203]
 ds_read_b64_tr_b16 a[190:191], v5 offset:20992
 v_rcp_f32 v88, v88
 v_mfma_f32_16x16x32_bf16 v[204:207], a[160:163], a[204:207], v[204:207]
 ds_read_b128 a[148:151], v15 offset:23552
 v_mfma_f32_16x16x32_bf16 v[204:207], a[164:167], a[220:223], v[204:207]
 s_waitcnt vmcnt(8) lgkmcnt(10)
 v_rcp_f32 v89, v89
 v_mfma_f32_16x16x32_bf16 v[208:211], a[168:171], a[192:195], v[208:211]
 s_add_u32 s95, s95, 1
 ds_read_b64_tr_b16 a[160:161], v2 offset:32768
 v_rcp_f32 v90, v90
 v_mfma_f32_16x16x32_bf16 v[208:211], a[172:175], a[208:211], v[208:211]
 s_lshl_b32 s99, s95, 18
 ds_read_b64_tr_b16 a[162:163], v2 offset:33280
 v_mfma_f32_16x16x32_bf16 v[212:215], a[168:171], a[196:199], v[212:215]
 ds_read_b128 a[152:155], v15 offset:39936
 v_rcp_f32 v91, v91
 v_mfma_f32_16x16x32_bf16 v[212:215], a[172:175], a[212:215], v[212:215]
 v_mul_f32 v88, v88, v20
 v_mul_f32 v89, v89, v21
 v_mfma_f32_16x16x32_bf16 v[216:219], a[168:171], a[200:203], v[216:219]
 ds_read_b64_tr_b16 a[164:165], v2 offset:36864
 v_mul_f32 v90, v90, v22
 v_mfma_f32_16x16x32_bf16 v[216:219], a[172:175], a[216:219], v[216:219]
 ds_read_b64_tr_b16 a[166:167], v2 offset:37376
 v_mul_f32 v91, v91, v23
 v_mfma_f32_16x16x32_bf16 v[220:223], a[168:171], a[204:207], v[220:223]
 ds_read_b128 a[156:159], v15 offset:56320
 v_cvt_pk_bf16_f32 v42, v88, v89
 v_mfma_f32_16x16x32_bf16 v[220:223], a[172:175], a[220:223], v[220:223]
 s_add_u32 m0, s83, 16384
 s_waitcnt lgkmcnt(7)
 v_cvt_pk_bf16_f32 v43, v90, v91
 v_mfma_f32_16x16x32_bf16 v[224:227], a[176:179], a[192:195], v[224:227]
 ds_read_b64_tr_b16 a[168:169], v3 offset:32768
 v_mul_f32 v76, s97, v76
 v_mfma_f32_16x16x32_bf16 v[224:227], a[180:183], a[208:211], v[224:227]
 buffer_load_dwordx4 v10, s[40:43], s84 offen offset:0 lds
 v_mul_f32 v77, s97, v77
 v_mfma_f32_16x16x32_bf16 v[228:231], a[176:179], a[196:199], v[228:231]
 buffer_load_dwordx4 v11, s[40:43], s84 offen offset:1024 lds
 v_mul_f32 v78, s97, v78
 v_mfma_f32_16x16x32_bf16 v[228:231], a[180:183], a[212:215], v[228:231]
 ds_read_b64_tr_b16 a[170:171], v3 offset:33280
 v_mul_f32 v79, s97, v79
 v_mfma_f32_16x16x32_bf16 v[232:235], a[176:179], a[200:203], v[232:235]
 ds_read_b64_tr_b16 a[172:173], v3 offset:36864
 v_exp_f32 v76, v76
 v_mfma_f32_16x16x32_bf16 v[232:235], a[180:183], a[216:219], v[232:235]
 buffer_load_dwordx4 v12, s[40:43], s84 offen offset:2048 lds
 v_accvgpr_read_b32 v20, a12
 v_mfma_f32_16x16x32_bf16 v[236:239], a[176:179], a[204:207], v[236:239]
 buffer_load_dwordx4 v13, s[40:43], s84 offen offset:3072 lds
 v_exp_f32 v77, v77
 v_mfma_f32_16x16x32_bf16 v[236:239], a[180:183], a[220:223], v[236:239]
 s_add_u32 m0, s83, 20480
 ds_read_b64_tr_b16 a[174:175], v3 offset:37376
 s_waitcnt lgkmcnt(11)
 v_accvgpr_read_b32 v21, a13
 v_mfma_f32_16x16x32_bf16 v[240:243], a[184:187], a[192:195], v[240:243]
 ds_read_b64_tr_b16 a[176:177], v4 offset:32768
 v_mfma_f32_16x16x32_bf16 v[240:243], a[188:191], a[208:211], v[240:243]
 buffer_load_dwordx4 v10, s[40:43], s99 offen offset:0 lds
 v_exp_f32 v78, v78
 v_mfma_f32_16x16x32_bf16 v[244:247], a[184:187], a[196:199], v[244:247]
 buffer_load_dwordx4 v11, s[40:43], s99 offen offset:1024 lds
 v_accvgpr_read_b32 v22, a14
 v_mfma_f32_16x16x32_bf16 v[244:247], a[188:191], a[212:215], v[244:247]
 ds_read_b64_tr_b16 a[178:179], v4 offset:33280
 v_exp_f32 v79, v79
 v_mfma_f32_16x16x32_bf16 v[248:251], a[184:187], a[200:203], v[248:251]
 ds_read_b64_tr_b16 a[180:181], v4 offset:36864
 v_accvgpr_read_b32 v23, a15
 v_mfma_f32_16x16x32_bf16 v[248:251], a[188:191], a[216:219], v[248:251]
 buffer_load_dwordx4 v12, s[40:43], s99 offen offset:2048 lds
 v_fma_f32 v76, v76, s98, s98
 v_mfma_f32_16x16x32_bf16 v[252:255], a[184:187], a[204:207], v[252:255]
 buffer_load_dwordx4 v13, s[40:43], s99 offen offset:3072 lds
 v_fma_f32 v77, v77, s98, s98
 v_mfma_f32_16x16x32_bf16 v[252:255], a[188:191], a[220:223], v[252:255]
 s_waitcnt lgkmcnt(7)
 ds_read_b64_tr_b16 a[182:183], v4 offset:37376
 v_fma_f32 v78, v78, s98, s98
 v_fma_f32 v79, v79, s98, s98
 v_mfma_f32_16x16x32_bf16 v[128:131], a[160:163], a[128:131], v[128:131]
 s_add_u32 s95, s95, 15
 ds_read_b64_tr_b16 a[184:185], v5 offset:32768
 v_mfma_f32_16x16x32_bf16 v[128:131], a[164:167], a[144:147], v[128:131]
 s_and_b32 s95, s95, 15
 ds_read_b64_tr_b16 a[186:187], v5 offset:33280
 v_rcp_f32 v76, v76
 v_mfma_f32_16x16x32_bf16 v[132:135], a[160:163], a[132:135], v[132:135]
 s_lshl_b32 s84, s95, 18
 ds_read_b128 a[192:195], v14 offset:8192
 v_rcp_f32 v77, v77
 v_mfma_f32_16x16x32_bf16 v[132:135], a[164:167], a[148:151], v[132:135]
 s_add_u32 s84, s84, 128
 v_rcp_f32 v78, v78
 v_mfma_f32_16x16x32_bf16 v[136:139], a[160:163], a[136:139], v[136:139]
 ds_read_b64_tr_b16 a[188:189], v5 offset:36864
 v_mfma_f32_16x16x32_bf16 v[136:139], a[164:167], a[152:155], v[136:139]
 ds_read_b64_tr_b16 a[190:191], v5 offset:37376
 v_mfma_f32_16x16x32_bf16 v[140:143], a[160:163], a[140:143], v[140:143]
 ds_read_b128 a[196:199], v14 offset:24576
 v_rcp_f32 v79, v79
 v_mfma_f32_16x16x32_bf16 v[140:143], a[164:167], a[156:159], v[140:143]
 s_waitcnt vmcnt(8) lgkmcnt(10)
 v_mul_f32 v76, v76, v20
 v_mul_f32 v77, v77, v21
 v_mfma_f32_16x16x32_bf16 v[144:147], a[168:171], a[128:131], v[144:147]
 s_add_u32 s95, s95, 1
 ds_read_b64_tr_b16 a[160:161], v2 offset:0
 v_mul_f32 v78, v78, v22
 v_mfma_f32_16x16x32_bf16 v[144:147], a[172:175], a[144:147], v[144:147]
 s_lshl_b32 s99, s95, 18
 ds_read_b64_tr_b16 a[162:163], v2 offset:512
 v_mul_f32 v79, v79, v23
 v_mfma_f32_16x16x32_bf16 v[148:151], a[168:171], a[132:135], v[148:151]
 s_add_u32 s99, s99, 128
 ds_read_b128 a[200:203], v14 offset:40960
 v_cvt_pk_bf16_f32 v44, v76, v77
 v_mfma_f32_16x16x32_bf16 v[148:151], a[172:175], a[148:151], v[148:151]
 v_cvt_pk_bf16_f32 v45, v78, v79
 v_mul_f32 v92, s97, v92
 v_mfma_f32_16x16x32_bf16 v[152:155], a[168:171], a[136:139], v[152:155]
 ds_read_b64_tr_b16 a[164:165], v2 offset:4096
 v_mul_f32 v93, s97, v93
 v_mfma_f32_16x16x32_bf16 v[152:155], a[172:175], a[152:155], v[152:155]
 ds_read_b64_tr_b16 a[166:167], v2 offset:4608
 v_mul_f32 v94, s97, v94
 v_mfma_f32_16x16x32_bf16 v[156:159], a[168:171], a[140:143], v[156:159]
 ds_read_b128 a[204:207], v14 offset:57344
 v_mul_f32 v95, s97, v95
 v_mfma_f32_16x16x32_bf16 v[156:159], a[172:175], a[156:159], v[156:159]
 s_add_u32 m0, s83, 32768
 s_waitcnt lgkmcnt(7)
 v_mfma_f32_16x16x32_bf16 v[160:163], a[176:179], a[128:131], v[160:163]
 ds_read_b64_tr_b16 a[168:169], v3 offset:0
 v_exp_f32 v92, v92
 v_mfma_f32_16x16x32_bf16 v[160:163], a[180:183], a[144:147], v[160:163]
 buffer_load_dwordx4 v10, s[40:43], s84 offen offset:0 lds
 v_accvgpr_read_b32 v20, a28
 v_mfma_f32_16x16x32_bf16 v[164:167], a[176:179], a[132:135], v[164:167]
 buffer_load_dwordx4 v11, s[40:43], s84 offen offset:1024 lds
 v_exp_f32 v93, v93
 v_mfma_f32_16x16x32_bf16 v[164:167], a[180:183], a[148:151], v[164:167]
 ds_read_b64_tr_b16 a[170:171], v3 offset:512
 v_accvgpr_read_b32 v21, a29
 v_mfma_f32_16x16x32_bf16 v[168:171], a[176:179], a[136:139], v[168:171]
 ds_read_b64_tr_b16 a[172:173], v3 offset:4096
 v_exp_f32 v94, v94
 v_mfma_f32_16x16x32_bf16 v[168:171], a[180:183], a[152:155], v[168:171]
 buffer_load_dwordx4 v12, s[40:43], s84 offen offset:2048 lds
 v_accvgpr_read_b32 v22, a30
 v_mfma_f32_16x16x32_bf16 v[172:175], a[176:179], a[140:143], v[172:175]
 buffer_load_dwordx4 v13, s[40:43], s84 offen offset:3072 lds
 v_mfma_f32_16x16x32_bf16 v[172:175], a[180:183], a[156:159], v[172:175]
 s_add_u32 m0, s83, 36864
 ds_read_b64_tr_b16 a[174:175], v3 offset:4608
 s_waitcnt lgkmcnt(11)
 v_exp_f32 v95, v95
 v_mfma_f32_16x16x32_bf16 v[176:179], a[184:187], a[128:131], v[176:179]
 ds_read_b64_tr_b16 a[176:177], v4 offset:0
 v_accvgpr_read_b32 v23, a31
 v_mfma_f32_16x16x32_bf16 v[176:179], a[188:191], a[144:147], v[176:179]
 buffer_load_dwordx4 v10, s[40:43], s99 offen offset:0 lds
 v_fma_f32 v92, v92, s98, s98
 v_mfma_f32_16x16x32_bf16 v[180:183], a[184:187], a[132:135], v[180:183]
 buffer_load_dwordx4 v11, s[40:43], s99 offen offset:1024 lds
 v_fma_f32 v93, v93, s98, s98
 v_mfma_f32_16x16x32_bf16 v[180:183], a[188:191], a[148:151], v[180:183]
 ds_read_b64_tr_b16 a[178:179], v4 offset:512
 v_fma_f32 v94, v94, s98, s98
 v_fma_f32 v95, v95, s98, s98
 v_mfma_f32_16x16x32_bf16 v[184:187], a[184:187], a[136:139], v[184:187]
 ds_read_b64_tr_b16 a[180:181], v4 offset:4096
 v_mfma_f32_16x16x32_bf16 v[184:187], a[188:191], a[152:155], v[184:187]
 buffer_load_dwordx4 v12, s[40:43], s99 offen offset:2048 lds
 v_rcp_f32 v92, v92
 v_mfma_f32_16x16x32_bf16 v[188:191], a[184:187], a[140:143], v[188:191]
 buffer_load_dwordx4 v13, s[40:43], s99 offen offset:3072 lds
 v_rcp_f32 v93, v93
 v_mfma_f32_16x16x32_bf16 v[188:191], a[188:191], a[156:159], v[188:191]
 s_waitcnt lgkmcnt(8)
 ds_read_b64_tr_b16 a[182:183], v4 offset:4608
 v_mfma_f32_16x16x32_bf16 v[192:195], a[160:163], a[128:131], v[192:195]
 s_add_u32 s95, s95, 1
 ds_read_b64_tr_b16 a[184:185], v5 offset:0
 v_rcp_f32 v94, v94
 v_mfma_f32_16x16x32_bf16 v[192:195], a[164:167], a[144:147], v[192:195]
 s_and_b32 s95, s95, 15
 ds_read_b64_tr_b16 a[186:187], v5 offset:512
 v_rcp_f32 v95, v95
 v_mfma_f32_16x16x32_bf16 v[196:199], a[160:163], a[132:135], v[196:199]
 s_lshl_b32 s84, s95, 18
 ds_read_b128 a[208:211], v15 offset:9216
 v_mul_f32 v92, v92, v20
 v_mfma_f32_16x16x32_bf16 v[196:199], a[164:167], a[148:151], v[196:199]
 v_mul_f32 v93, v93, v21
 v_mul_f32 v94, v94, v22
 v_mfma_f32_16x16x32_bf16 v[200:203], a[160:163], a[136:139], v[200:203]
 ds_read_b64_tr_b16 a[188:189], v5 offset:4096
 v_mul_f32 v95, v95, v23
 v_mfma_f32_16x16x32_bf16 v[200:203], a[164:167], a[152:155], v[200:203]
 ds_read_b64_tr_b16 a[190:191], v5 offset:4608
 v_cvt_pk_bf16_f32 v46, v92, v93
 v_mfma_f32_16x16x32_bf16 v[204:207], a[160:163], a[140:143], v[204:207]
 ds_read_b128 a[212:215], v15 offset:25600
 v_cvt_pk_bf16_f32 v47, v94, v95
 v_mfma_f32_16x16x32_bf16 v[204:207], a[164:167], a[156:159], v[204:207]
 s_waitcnt vmcnt(8) lgkmcnt(10)
 v_mul_f32 v96, s97, v96
 v_mul_f32 v97, s97, v97
 v_mfma_f32_16x16x32_bf16 v[208:211], a[168:171], a[128:131], v[208:211]
 s_add_u32 s95, s95, 1
 ds_read_b64_tr_b16 a[160:161], v2 offset:16384
 v_mul_f32 v98, s97, v98
 v_mfma_f32_16x16x32_bf16 v[208:211], a[172:175], a[144:147], v[208:211]
 s_lshl_b32 s99, s95, 18
 ds_read_b64_tr_b16 a[162:163], v2 offset:16896
 v_mul_f32 v99, s97, v99
 v_mfma_f32_16x16x32_bf16 v[212:215], a[168:171], a[132:135], v[212:215]
 ds_read_b128 a[216:219], v15 offset:41984
 v_mfma_f32_16x16x32_bf16 v[212:215], a[172:175], a[148:151], v[212:215]
 v_exp_f32 v96, v96
 v_mfma_f32_16x16x32_bf16 v[216:219], a[168:171], a[136:139], v[216:219]
 ds_read_b64_tr_b16 a[164:165], v2 offset:20480
 v_accvgpr_read_b32 v20, a32
 v_mfma_f32_16x16x32_bf16 v[216:219], a[172:175], a[152:155], v[216:219]
 ds_read_b64_tr_b16 a[166:167], v2 offset:20992
 v_mfma_f32_16x16x32_bf16 v[220:223], a[168:171], a[140:143], v[220:223]
 ds_read_b128 a[220:223], v15 offset:58368
 v_exp_f32 v97, v97
 v_mfma_f32_16x16x32_bf16 v[220:223], a[172:175], a[156:159], v[220:223]
 s_add_u32 m0, s83, 0
 s_waitcnt lgkmcnt(7)
 v_accvgpr_read_b32 v21, a33
 v_mfma_f32_16x16x32_bf16 v[224:227], a[176:179], a[128:131], v[224:227]
 ds_read_b64_tr_b16 a[168:169], v3 offset:16384
 v_exp_f32 v98, v98
 v_mfma_f32_16x16x32_bf16 v[224:227], a[180:183], a[144:147], v[224:227]
 buffer_load_dwordx4 v10, s[40:43], s84 offen offset:0 lds
 v_accvgpr_read_b32 v22, a34
 v_mfma_f32_16x16x32_bf16 v[228:231], a[176:179], a[132:135], v[228:231]
 buffer_load_dwordx4 v11, s[40:43], s84 offen offset:1024 lds
 v_mfma_f32_16x16x32_bf16 v[228:231], a[180:183], a[148:151], v[228:231]
 ds_read_b64_tr_b16 a[170:171], v3 offset:16896
 v_exp_f32 v99, v99
 v_mfma_f32_16x16x32_bf16 v[232:235], a[176:179], a[136:139], v[232:235]
 ds_read_b64_tr_b16 a[172:173], v3 offset:20480
 v_accvgpr_read_b32 v23, a35
 v_fma_f32 v96, v96, s98, s98
 v_mfma_f32_16x16x32_bf16 v[232:235], a[180:183], a[152:155], v[232:235]
 buffer_load_dwordx4 v12, s[40:43], s84 offen offset:2048 lds
 v_fma_f32 v97, v97, s98, s98
 v_mfma_f32_16x16x32_bf16 v[236:239], a[176:179], a[140:143], v[236:239]
 buffer_load_dwordx4 v13, s[40:43], s84 offen offset:3072 lds
 v_fma_f32 v98, v98, s98, s98
 v_mfma_f32_16x16x32_bf16 v[236:239], a[180:183], a[156:159], v[236:239]
 s_add_u32 m0, s83, 4096
 ds_read_b64_tr_b16 a[174:175], v3 offset:20992
 s_waitcnt lgkmcnt(11)
 v_fma_f32 v99, v99, s98, s98
 v_mfma_f32_16x16x32_bf16 v[240:243], a[184:187], a[128:131], v[240:243]
 ds_read_b64_tr_b16 a[176:177], v4 offset:16384
 v_rcp_f32 v96, v96
 v_mfma_f32_16x16x32_bf16 v[240:243], a[188:191], a[144:147], v[240:243]
 buffer_load_dwordx4 v10, s[40:43], s99 offen offset:0 lds
 v_mfma_f32_16x16x32_bf16 v[244:247], a[184:187], a[132:135], v[244:247]
 buffer_load_dwordx4 v11, s[40:43], s99 offen offset:1024 lds
 v_rcp_f32 v97, v97
 v_mfma_f32_16x16x32_bf16 v[244:247], a[188:191], a[148:151], v[244:247]
 ds_read_b64_tr_b16 a[178:179], v4 offset:16896
 v_mfma_f32_16x16x32_bf16 v[248:251], a[184:187], a[136:139], v[248:251]
 ds_read_b64_tr_b16 a[180:181], v4 offset:20480
 v_rcp_f32 v98, v98
 v_mfma_f32_16x16x32_bf16 v[248:251], a[188:191], a[152:155], v[248:251]
 buffer_load_dwordx4 v12, s[40:43], s99 offen offset:2048 lds
 v_rcp_f32 v99, v99
 v_mfma_f32_16x16x32_bf16 v[252:255], a[184:187], a[140:143], v[252:255]
 buffer_load_dwordx4 v13, s[40:43], s99 offen offset:3072 lds
 v_mul_f32 v96, v96, v20
 v_mfma_f32_16x16x32_bf16 v[252:255], a[188:191], a[156:159], v[252:255]
 s_waitcnt lgkmcnt(7)
 ds_read_b64_tr_b16 a[182:183], v4 offset:20992
 v_mul_f32 v97, v97, v21
 v_mfma_f32_16x16x32_bf16 v[128:131], a[160:163], a[192:195], v[128:131]
 s_add_u32 s95, s95, 15
 ds_read_b64_tr_b16 a[184:185], v5 offset:16384
 v_mul_f32 v98, v98, v22
 v_mfma_f32_16x16x32_bf16 v[128:131], a[164:167], a[208:211], v[128:131]
 s_and_b32 s95, s95, 15
 ds_read_b64_tr_b16 a[186:187], v5 offset:16896
 v_mul_f32 v99, v99, v23
 v_cvt_pk_bf16_f32 v48, v96, v97
 v_mfma_f32_16x16x32_bf16 v[132:135], a[160:163], a[196:199], v[132:135]
 s_lshl_b32 s84, s95, 18
 ds_read_b128 a[128:131], v14 offset:10240
 v_cvt_pk_bf16_f32 v49, v98, v99
 v_mfma_f32_16x16x32_bf16 v[132:135], a[164:167], a[212:215], v[132:135]
 s_add_u32 s84, s84, 128
 v_mul_f32 v112, s97, v112
 v_mul_f32 v113, s97, v113
 v_mfma_f32_16x16x32_bf16 v[136:139], a[160:163], a[200:203], v[136:139]
 ds_read_b64_tr_b16 a[188:189], v5 offset:20480
 v_mul_f32 v114, s97, v114
 v_mfma_f32_16x16x32_bf16 v[136:139], a[164:167], a[216:219], v[136:139]
 ds_read_b64_tr_b16 a[190:191], v5 offset:20992
 v_mul_f32 v115, s97, v115
 v_mfma_f32_16x16x32_bf16 v[140:143], a[160:163], a[204:207], v[140:143]
 ds_read_b128 a[132:135], v14 offset:26624
 v_mfma_f32_16x16x32_bf16 v[140:143], a[164:167], a[220:223], v[140:143]
 s_waitcnt vmcnt(8) lgkmcnt(10)
 v_exp_f32 v112, v112
 v_mfma_f32_16x16x32_bf16 v[144:147], a[168:171], a[192:195], v[144:147]
 s_add_u32 s95, s95, 1
 ds_read_b64_tr_b16 a[160:161], v2 offset:32768
 v_accvgpr_read_b32 v20, a48
 v_mfma_f32_16x16x32_bf16 v[144:147], a[172:175], a[208:211], v[144:147]
 s_lshl_b32 s99, s95, 18
 ds_read_b64_tr_b16 a[162:163], v2 offset:33280
 v_exp_f32 v113, v113
 v_mfma_f32_16x16x32_bf16 v[148:151], a[168:171], a[196:199], v[148:151]
 s_add_u32 s99, s99, 128
 ds_read_b128 a[136:139], v14 offset:43008
 v_accvgpr_read_b32 v21, a49
 v_mfma_f32_16x16x32_bf16 v[148:151], a[172:175], a[212:215], v[148:151]
 v_exp_f32 v114, v114
 v_mfma_f32_16x16x32_bf16 v[152:155], a[168:171], a[200:203], v[152:155]
 ds_read_b64_tr_b16 a[164:165], v2 offset:36864
 v_accvgpr_read_b32 v22, a50
 v_mfma_f32_16x16x32_bf16 v[152:155], a[172:175], a[216:219], v[152:155]
 ds_read_b64_tr_b16 a[166:167], v2 offset:37376
 v_mfma_f32_16x16x32_bf16 v[156:159], a[168:171], a[204:207], v[156:159]
 ds_read_b128 a[140:143], v14 offset:59392
 v_exp_f32 v115, v115
 v_mfma_f32_16x16x32_bf16 v[156:159], a[172:175], a[220:223], v[156:159]
 s_add_u32 m0, s83, 16384
 s_waitcnt lgkmcnt(7)
 v_accvgpr_read_b32 v23, a51
 v_mfma_f32_16x16x32_bf16 v[160:163], a[176:179], a[192:195], v[160:163]
 ds_read_b64_tr_b16 a[168:169], v3 offset:32768
 v_fma_f32 v112, v112, s98, s98
 v_mfma_f32_16x16x32_bf16 v[160:163], a[180:183], a[208:211], v[160:163]
 buffer_load_dwordx4 v10, s[40:43], s84 offen offset:0 lds
 v_fma_f32 v113, v113, s98, s98
 v_mfma_f32_16x16x32_bf16 v[164:167], a[176:179], a[196:199], v[164:167]
 buffer_load_dwordx4 v11, s[40:43], s84 offen offset:1024 lds
 v_fma_f32 v114, v114, s98, s98
 v_mfma_f32_16x16x32_bf16 v[164:167], a[180:183], a[212:215], v[164:167]
 ds_read_b64_tr_b16 a[170:171], v3 offset:33280
 v_fma_f32 v115, v115, s98, s98
 v_mfma_f32_16x16x32_bf16 v[168:171], a[176:179], a[200:203], v[168:171]
 ds_read_b64_tr_b16 a[172:173], v3 offset:36864
 v_rcp_f32 v112, v112
 v_mfma_f32_16x16x32_bf16 v[168:171], a[180:183], a[216:219], v[168:171]
 buffer_load_dwordx4 v12, s[40:43], s84 offen offset:2048 lds
 v_mfma_f32_16x16x32_bf16 v[172:175], a[176:179], a[204:207], v[172:175]
 buffer_load_dwordx4 v13, s[40:43], s84 offen offset:3072 lds
 v_rcp_f32 v113, v113
 v_mfma_f32_16x16x32_bf16 v[172:175], a[180:183], a[220:223], v[172:175]
 s_add_u32 m0, s83, 20480
 ds_read_b64_tr_b16 a[174:175], v3 offset:37376
 s_waitcnt lgkmcnt(11)
 v_rcp_f32 v114, v114
 v_mfma_f32_16x16x32_bf16 v[176:179], a[184:187], a[192:195], v[176:179]
 ds_read_b64_tr_b16 a[176:177], v4 offset:32768
 v_mfma_f32_16x16x32_bf16 v[176:179], a[188:191], a[208:211], v[176:179]
 buffer_load_dwordx4 v10, s[40:43], s99 offen offset:0 lds
 v_rcp_f32 v115, v115
 v_mfma_f32_16x16x32_bf16 v[180:183], a[184:187], a[196:199], v[180:183]
 buffer_load_dwordx4 v11, s[40:43], s99 offen offset:1024 lds
 v_mul_f32 v112, v112, v20
 v_mfma_f32_16x16x32_bf16 v[180:183], a[188:191], a[212:215], v[180:183]
 ds_read_b64_tr_b16 a[178:179], v4 offset:33280
 v_mul_f32 v113, v113, v21
 v_mul_f32 v114, v114, v22
 v_mfma_f32_16x16x32_bf16 v[184:187], a[184:187], a[200:203], v[184:187]
 ds_read_b64_tr_b16 a[180:181], v4 offset:36864
 v_mul_f32 v115, v115, v23
 v_mfma_f32_16x16x32_bf16 v[184:187], a[188:191], a[216:219], v[184:187]
 buffer_load_dwordx4 v12, s[40:43], s99 offen offset:2048 lds
 v_cvt_pk_bf16_f32 v50, v112, v113
 v_mfma_f32_16x16x32_bf16 v[188:191], a[184:187], a[204:207], v[188:191]
L_pg5:
 s_cbranch_execz L_site0
 buffer_load_dwordx4 v13, s[40:43], s99 offen offset:3072 lds
 v_cvt_pk_bf16_f32 v51, v114, v115
 v_mfma_f32_16x16x32_bf16 v[188:191], a[188:191], a[220:223], v[188:191]
 s_waitcnt lgkmcnt(8)
 ds_read_b64_tr_b16 a[182:183], v4 offset:37376
 v_mul_f32 v100, s97, v100
 v_mfma_f32_16x16x32_bf16 v[192:195], a[160:163], a[192:195], v[192:195]
 s_add_u32 s95, s95, 1
 ds_read_b64_tr_b16 a[184:185], v5 offset:32768
 v_mul_f32 v101, s97, v101
 v_mul_f32 v102, s97, v102
 v_mfma_f32_16x16x32_bf16 v[192:195], a[164:167], a[208:211], v[192:195]
 s_and_b32 s95, s95, 15
 ds_read_b64_tr_b16 a[186:187], v5 offset:33280
 v_mul_f32 v103, s97, v103
 v_mfma_f32_16x16x32_bf16 v[196:199], a[160:163], a[196:199], v[196:199]
 s_lshl_b32 s84, s95, 18
 ds_read_b128 a[144:147], v15 offset:11264
 v_mfma_f32_16x16x32_bf16 v[196:199], a[164:167], a[212:215], v[196:199]
 v_exp_f32 v100, v100
 v_mfma_f32_16x16x32_bf16 v[200:203], a[160:163], a[200:203], v[200:203]
 ds_read_b64_tr_b16 a[188:189], v5 offset:36864
 v_accvgpr_read_b32 v20, a36
 v_mfma_f32_16x16x32_bf16 v[200:203], a[164:167], a[216:219], v[200:203]
 ds_read_b64_tr_b16 a[190:191], v5 offset:37376
 v_exp_f32 v101, v101
 v_mfma_f32_16x16x32_bf16 v[204:207], a[160:163], a[204:207], v[204:207]
 ds_read_b128 a[148:151], v15 offset:27648
 v_accvgpr_read_b32 v21, a37
 v_mfma_f32_16x16x32_bf16 v[204:207], a[164:167], a[220:223], v[204:207]
 s_waitcnt vmcnt(8) lgkmcnt(10)
 v_exp_f32 v102, v102
 v_mfma_f32_16x16x32_bf16 v[208:211], a[168:171], a[192:195], v[208:211]
 s_add_u32 s95, s95, 1
 ds_read_b64_tr_b16 a[160:161], v2 offset:0
 v_accvgpr_read_b32 v22, a38
 v_mfma_f32_16x16x32_bf16 v[208:211], a[172:175], a[208:211], v[208:211]
 s_lshl_b32 s99, s95, 18
 ds_read_b64_tr_b16 a[162:163], v2 offset:512
 v_mfma_f32_16x16x32_bf16 v[212:215], a[168:171], a[196:199], v[212:215]
 ds_read_b128 a[152:155], v15 offset:44032
 v_exp_f32 v103, v103
 v_mfma_f32_16x16x32_bf16 v[212:215], a[172:175], a[212:215], v[212:215]
 v_accvgpr_read_b32 v23, a39
 v_fma_f32 v100, v100, s98, s98
 v_mfma_f32_16x16x32_bf16 v[216:219], a[168:171], a[200:203], v[216:219]
 ds_read_b64_tr_b16 a[164:165], v2 offset:4096
 v_fma_f32 v101, v101, s98, s98
 v_mfma_f32_16x16x32_bf16 v[216:219], a[172:175], a[216:219], v[216:219]
 ds_read_b64_tr_b16 a[166:167], v2 offset:4608
 v_fma_f32 v102, v102, s98, s98
 v_mfma_f32_16x16x32_bf16 v[220:223], a[168:171], a[204:207], v[220:223]
 ds_read_b128 a[156:159], v15 offset:60416
 v_fma_f32 v103, v103, s98, s98
 v_mfma_f32_16x16x32_bf16 v[220:223], a[172:175], a[220:223], v[220:223]
 s_add_u32 m0, s83, 32768
 s_waitcnt lgkmcnt(7)
 v_mfma_f32_16x16x32_bf16 v[224:227], a[176:179], a[192:195], v[224:227]
 ds_read_b64_tr_b16 a[168:169], v3 offset:0
 v_rcp_f32 v100, v100
 v_mfma_f32_16x16x32_bf16 v[224:227], a[180:183], a[208:211], v[224:227]
 buffer_load_dwordx4 v10, s[40:43], s84 offen offset:0 lds
 v_rcp_f32 v101, v101
 v_mfma_f32_16x16x32_bf16 v[228:231], a[176:179], a[196:199], v[228:231]
 buffer_load_dwordx4 v11, s[40:43], s84 offen offset:1024 lds
 v_mfma_f32_16x16x32_bf16 v[228:231], a[180:183], a[212:215], v[228:231]
 ds_read_b64_tr_b16 a[170:171], v3 offset:512
 v_rcp_f32 v102, v102
 v_mfma_f32_16x16x32_bf16 v[232:235], a[176:179], a[200:203], v[232:235]
 ds_read_b64_tr_b16 a[172:173], v3 offset:4096
 v_mfma_f32_16x16x32_bf16 v[232:235], a[180:183], a[216:219], v[232:235]
 buffer_load_dwordx4 v12, s[40:43], s84 offen offset:2048 lds
 v_rcp_f32 v103, v103
 v_mfma_f32_16x16x32_bf16 v[236:239], a[176:179], a[204:207], v[236:239]
 buffer_load_dwordx4 v13, s[40:43], s84 offen offset:3072 lds
 v_mul_f32 v100, v100, v20
 v_mfma_f32_16x16x32_bf16 v[236:239], a[180:183], a[220:223], v[236:239]
 s_add_u32 m0, s83, 36864
 ds_read_b64_tr_b16 a[174:175], v3 offset:4608
 s_waitcnt lgkmcnt(11)
 v_mul_f32 v101, v101, v21
 v_mfma_f32_16x16x32_bf16 v[240:243], a[184:187], a[192:195], v[240:243]
 ds_read_b64_tr_b16 a[176:177], v4 offset:0
 v_mul_f32 v102, v102, v22
 v_mul_f32 v103, v103, v23
 v_mfma_f32_16x16x32_bf16 v[240:243], a[188:191], a[208:211], v[240:243]
 buffer_load_dwordx4 v10, s[40:43], s99 offen offset:0 lds
 v_cvt_pk_bf16_f32 v52, v100, v101
 v_mfma_f32_16x16x32_bf16 v[244:247], a[184:187], a[196:199], v[244:247]
 buffer_load_dwordx4 v11, s[40:43], s99 offen offset:1024 lds
 v_cvt_pk_bf16_f32 v53, v102, v103
 v_mfma_f32_16x16x32_bf16 v[244:247], a[188:191], a[212:215], v[244:247]
 ds_read_b64_tr_b16 a[178:179], v4 offset:512
 v_mul_f32 v116, s97, v116
 v_mul_f32 v117, s97, v117
 v_mfma_f32_16x16x32_bf16 v[248:251], a[184:187], a[200:203], v[248:251]
 ds_read_b64_tr_b16 a[180:181], v4 offset:4096
 v_mul_f32 v118, s97, v118
 v_mfma_f32_16x16x32_bf16 v[248:251], a[188:191], a[216:219], v[248:251]
 buffer_load_dwordx4 v12, s[40:43], s99 offen offset:2048 lds
 v_mul_f32 v119, s97, v119
 v_mfma_f32_16x16x32_bf16 v[252:255], a[184:187], a[204:207], v[252:255]
 buffer_load_dwordx4 v13, s[40:43], s99 offen offset:3072 lds
 v_mfma_f32_16x16x32_bf16 v[252:255], a[188:191], a[220:223], v[252:255]
 s_waitcnt lgkmcnt(7)
 ds_read_b64_tr_b16 a[182:183], v4 offset:4608
 v_exp_f32 v116, v116
 v_mfma_f32_16x16x32_bf16 v[128:131], a[160:163], a[128:131], v[128:131]
 s_add_u32 s95, s95, 1
 ds_read_b64_tr_b16 a[184:185], v5 offset:0
 v_accvgpr_read_b32 v20, a52
 v_mfma_f32_16x16x32_bf16 v[128:131], a[164:167], a[144:147], v[128:131]
 s_and_b32 s95, s95, 15
 ds_read_b64_tr_b16 a[186:187], v5 offset:512
 v_exp_f32 v117, v117
 v_mfma_f32_16x16x32_bf16 v[132:135], a[160:163], a[132:135], v[132:135]
 s_lshl_b32 s84, s95, 18
 ds_read_b128 a[64:67], v14 offset:12288
 v_accvgpr_read_b32 v21, a53
 v_mfma_f32_16x16x32_bf16 v[132:135], a[164:167], a[148:151], v[132:135]
 ds_read_b128 a[68:71], v14 offset:28672
 v_exp_f32 v118, v118
 v_mfma_f32_16x16x32_bf16 v[136:139], a[160:163], a[136:139], v[136:139]
 ds_read_b64_tr_b16 a[188:189], v5 offset:4096
 v_accvgpr_read_b32 v22, a54
 v_mfma_f32_16x16x32_bf16 v[136:139], a[164:167], a[152:155], v[136:139]
 ds_read_b64_tr_b16 a[190:191], v5 offset:4608
 v_mfma_f32_16x16x32_bf16 v[140:143], a[160:163], a[140:143], v[140:143]
 ds_read_b128 a[72:75], v14 offset:45056
 v_exp_f32 v119, v119
 v_mfma_f32_16x16x32_bf16 v[140:143], a[164:167], a[156:159], v[140:143]
 s_waitcnt vmcnt(8) lgkmcnt(11)
 ds_read_b128 a[76:79], v14 offset:61440
 v_accvgpr_read_b32 v23, a55
 v_mfma_f32_16x16x32_bf16 v[144:147], a[168:171], a[128:131], v[144:147]
 s_add_u32 s95, s95, 1
 ds_read_b64_tr_b16 a[160:161], v2 offset:16384
 v_fma_f32 v116, v116, s98, s98
 v_fma_f32 v117, v117, s98, s98
 v_mfma_f32_16x16x32_bf16 v[144:147], a[172:175], a[144:147], v[144:147]
 s_lshl_b32 s99, s95, 18
 ds_read_b64_tr_b16 a[162:163], v2 offset:16896
 v_fma_f32 v118, v118, s98, s98
 v_mfma_f32_16x16x32_bf16 v[148:151], a[168:171], a[132:135], v[148:151]
 ds_read_b128 a[80:83], v15 offset:13312
 v_fma_f32 v119, v119, s98, s98
 v_mfma_f32_16x16x32_bf16 v[148:151], a[172:175], a[148:151], v[148:151]
 ds_read_b128 a[84:87], v15 offset:29696
 v_mfma_f32_16x16x32_bf16 v[152:155], a[168:171], a[136:139], v[152:155]
 ds_read_b64_tr_b16 a[164:165], v2 offset:20480
 v_rcp_f32 v116, v116
 v_mfma_f32_16x16x32_bf16 v[152:155], a[172:175], a[152:155], v[152:155]
 ds_read_b64_tr_b16 a[166:167], v2 offset:20992
 v_rcp_f32 v117, v117
 v_mfma_f32_16x16x32_bf16 v[156:159], a[168:171], a[140:143], v[156:159]
 ds_read_b128 a[88:91], v15 offset:46080
 v_mfma_f32_16x16x32_bf16 v[156:159], a[172:175], a[156:159], v[156:159]
 s_add_u32 m0, s83, 0
 ds_read_b128 a[92:95], v15 offset:62464
 s_waitcnt lgkmcnt(10)
 v_rcp_f32 v118, v118
 v_mfma_f32_16x16x32_bf16 v[160:163], a[176:179], a[128:131], v[160:163]
 ds_read_b64_tr_b16 a[168:169], v3 offset:16384
 v_rcp_f32 v119, v119
 v_mfma_f32_16x16x32_bf16 v[160:163], a[180:183], a[144:147], v[160:163]
 buffer_load_dwordx4 v10, s[40:43], s84 offen offset:0 lds
 v_mul_f32 v116, v116, v20
 v_mfma_f32_16x16x32_bf16 v[164:167], a[176:179], a[132:135], v[164:167]
 buffer_load_dwordx4 v11, s[40:43], s84 offen offset:1024 lds
 v_mul_f32 v117, v117, v21
 v_mfma_f32_16x16x32_bf16 v[164:167], a[180:183], a[148:151], v[164:167]
 ds_read_b64_tr_b16 a[170:171], v3 offset:16896
 v_mul_f32 v118, v118, v22
 v_mfma_f32_16x16x32_bf16 v[168:171], a[176:179], a[136:139], v[168:171]
 ds_read_b64_tr_b16 a[172:173], v3 offset:20480
 v_mul_f32 v119, v119, v23
 v_mfma_f32_16x16x32_bf16 v[168:171], a[180:183], a[152:155], v[168:171]
 buffer_load_dwordx4 v12, s[40:43], s84 offen offset:2048 lds
 v_cvt_pk_bf16_f32 v54, v116, v117
 v_mfma_f32_16x16x32_bf16 v[172:175], a[176:179], a[140:143], v[172:175]
 buffer_load_dwordx4 v13, s[40:43], s84 offen offset:3072 lds
 v_cvt_pk_bf16_f32 v55, v118, v119
 v_mfma_f32_16x16x32_bf16 v[172:175], a[180:183], a[156:159], v[172:175]
 s_add_u32 m0, s83, 4096
 ds_read_b64_tr_b16 a[174:175], v3 offset:20992
 s_waitcnt lgkmcnt(14)
 v_mul_f32 v104, s97, v104
 v_mfma_f32_16x16x32_bf16 v[176:179], a[184:187], a[128:131], v[176:179]
 ds_read_b64_tr_b16 a[176:177], v4 offset:16384
 v_mul_f32 v105, s97, v105
 v_mul_f32 v106, s97, v106
 v_mfma_f32_16x16x32_bf16 v[176:179], a[188:191], a[144:147], v[176:179]
 buffer_load_dwordx4 v10, s[40:43], s99 offen offset:0 lds
 v_mul_f32 v107, s97, v107
 v_mfma_f32_16x16x32_bf16 v[180:183], a[184:187], a[132:135], v[180:183]
 buffer_load_dwordx4 v11, s[40:43], s99 offen offset:1024 lds
 v_exp_f32 v104, v104
 v_mfma_f32_16x16x32_bf16 v[180:183], a[188:191], a[148:151], v[180:183]
 ds_read_b64_tr_b16 a[178:179], v4 offset:16896
 v_accvgpr_read_b32 v20, a40
 v_mfma_f32_16x16x32_bf16 v[184:187], a[184:187], a[136:139], v[184:187]
 ds_read_b64_tr_b16 a[180:181], v4 offset:20480
 v_mfma_f32_16x16x32_bf16 v[184:187], a[188:191], a[152:155], v[184:187]
 buffer_load_dwordx4 v12, s[40:43], s99 offen offset:2048 lds
 v_exp_f32 v105, v105
 v_mfma_f32_16x16x32_bf16 v[188:191], a[184:187], a[140:143], v[188:191]
 buffer_load_dwordx4 v13, s[40:43], s99 offen offset:3072 lds
 v_accvgpr_read_b32 v21, a41
 v_mfma_f32_16x16x32_bf16 v[188:191], a[188:191], a[156:159], v[188:191]
 s_waitcnt lgkmcnt(9)
 ds_read_b64_tr_b16 a[182:183], v4 offset:20992
 v_exp_f32 v106, v106
 v_mfma_f32_16x16x32_bf16 v[192:195], a[160:163], a[128:131], v[192:195]
 s_add_u32 s95, s95, 13
 ds_read_b64_tr_b16 a[184:185], v5 offset:16384
 v_accvgpr_read_b32 v22, a42
 v_mfma_f32_16x16x32_bf16 v[192:195], a[164:167], a[144:147], v[192:195]
 s_and_b32 s95, s95, 15
 ds_read_b64_tr_b16 a[186:187], v5 offset:16896
 v_mfma_f32_16x16x32_bf16 v[196:199], a[160:163], a[132:135], v[196:199]
 s_lshl_b32 s84, s95, 18
 ds_read_b128 a[96:99], v14 offset:14336
 v_exp_f32 v107, v107
 v_mfma_f32_16x16x32_bf16 v[196:199], a[164:167], a[148:151], v[196:199]
 s_add_u32 s84, s84, 128
 ds_read_b128 a[100:103], v14 offset:30720
 v_accvgpr_read_b32 v23, a43
 v_fma_f32 v104, v104, s98, s98
 v_mfma_f32_16x16x32_bf16 v[200:203], a[160:163], a[136:139], v[200:203]
 ds_read_b64_tr_b16 a[188:189], v5 offset:20480
 v_fma_f32 v105, v105, s98, s98
 v_mfma_f32_16x16x32_bf16 v[200:203], a[164:167], a[152:155], v[200:203]
 ds_read_b64_tr_b16 a[190:191], v5 offset:20992
 v_fma_f32 v106, v106, s98, s98
 v_mfma_f32_16x16x32_bf16 v[204:207], a[160:163], a[140:143], v[204:207]
 ds_read_b128 a[104:107], v14 offset:47104
 v_fma_f32 v107, v107, s98, s98
 v_mfma_f32_16x16x32_bf16 v[204:207], a[164:167], a[156:159], v[204:207]
 s_waitcnt vmcnt(8) lgkmcnt(11)
 ds_read_b128 a[108:111], v14 offset:63488
 v_rcp_f32 v104, v104
 v_mfma_f32_16x16x32_bf16 v[208:211], a[168:171], a[128:131], v[208:211]
 s_add_u32 s95, s95, 1
 ds_read_b64_tr_b16 a[160:161], v2 offset:32768
 v_mfma_f32_16x16x32_bf16 v[208:211], a[172:175], a[144:147], v[208:211]
 s_lshl_b32 s99, s95, 18
 ds_read_b64_tr_b16 a[162:163], v2 offset:33280
 v_rcp_f32 v105, v105
 v_mfma_f32_16x16x32_bf16 v[212:215], a[168:171], a[132:135], v[212:215]
 s_add_u32 s99, s99, 128
 ds_read_b128 a[112:115], v15 offset:15360
 v_mfma_f32_16x16x32_bf16 v[212:215], a[172:175], a[148:151], v[212:215]
 ds_read_b128 a[116:119], v15 offset:31744
 v_rcp_f32 v106, v106
 v_mfma_f32_16x16x32_bf16 v[216:219], a[168:171], a[136:139], v[216:219]
 ds_read_b64_tr_b16 a[164:165], v2 offset:36864
 v_rcp_f32 v107, v107
 v_mfma_f32_16x16x32_bf16 v[216:219], a[172:175], a[152:155], v[216:219]
 ds_read_b64_tr_b16 a[166:167], v2 offset:37376
 v_mul_f32 v104, v104, v20
 v_mfma_f32_16x16x32_bf16 v[220:223], a[168:171], a[140:143], v[220:223]
 ds_read_b128 a[120:123], v15 offset:48128
 v_mul_f32 v105, v105, v21
 v_mfma_f32_16x16x32_bf16 v[220:223], a[172:175], a[156:159], v[220:223]
 s_add_u32 m0, s83, 16384
 ds_read_b128 a[124:127], v15 offset:64512
 s_waitcnt lgkmcnt(10)
 v_mul_f32 v106, v106, v22
 v_mfma_f32_16x16x32_bf16 v[224:227], a[176:179], a[128:131], v[224:227]
 ds_read_b64_tr_b16 a[168:169], v3 offset:32768
 v_mul_f32 v107, v107, v23
 v_cvt_pk_bf16_f32 v56, v104, v105
 v_mfma_f32_16x16x32_bf16 v[224:227], a[180:183], a[144:147], v[224:227]
 buffer_load_dwordx4 v10, s[40:43], s84 offen offset:0 lds
 v_cvt_pk_bf16_f32 v57, v106, v107
 v_mfma_f32_16x16x32_bf16 v[228:231], a[176:179], a[132:135], v[228:231]
 buffer_load_dwordx4 v11, s[40:43], s84 offen offset:1024 lds
 v_mul_f32 v120, s97, v120
 v_mfma_f32_16x16x32_bf16 v[228:231], a[180:183], a[148:151], v[228:231]
 ds_read_b64_tr_b16 a[170:171], v3 offset:33280
 v_mul_f32 v121, s97, v121
 v_mfma_f32_16x16x32_bf16 v[232:235], a[176:179], a[136:139], v[232:235]
 ds_read_b64_tr_b16 a[172:173], v3 offset:36864
 v_mul_f32 v122, s97, v122
 v_mul_f32 v123, s97, v123
 v_mfma_f32_16x16x32_bf16 v[232:235], a[180:183], a[152:155], v[232:235]
 buffer_load_dwordx4 v12, s[40:43], s84 offen offset:2048 lds
 v_mfma_f32_16x16x32_bf16 v[236:239], a[176:179], a[140:143], v[236:239]
 buffer_load_dwordx4 v13, s[40:43], s84 offen offset:3072 lds
 v_exp_f32 v120, v120
 v_mfma_f32_16x16x32_bf16 v[236:239], a[180:183], a[156:159], v[236:239]
 s_add_u32 m0, s83, 20480
 ds_read_b64_tr_b16 a[174:175], v3 offset:37376
 s_waitcnt lgkmcnt(14)
 v_accvgpr_read_b32 v20, a56
 v_mfma_f32_16x16x32_bf16 v[240:243], a[184:187], a[128:131], v[240:243]
 ds_read_b64_tr_b16 a[176:177], v4 offset:32768
 v_exp_f32 v121, v121
 v_mfma_f32_16x16x32_bf16 v[240:243], a[188:191], a[144:147], v[240:243]
 buffer_load_dwordx4 v10, s[40:43], s99 offen offset:0 lds
 v_accvgpr_read_b32 v21, a57
 v_mfma_f32_16x16x32_bf16 v[244:247], a[184:187], a[132:135], v[244:247]
 buffer_load_dwordx4 v11, s[40:43], s99 offen offset:1024 lds
 v_mfma_f32_16x16x32_bf16 v[244:247], a[188:191], a[148:151], v[244:247]
 ds_read_b64_tr_b16 a[178:179], v4 offset:33280
 v_exp_f32 v122, v122
 v_mfma_f32_16x16x32_bf16 v[248:251], a[184:187], a[136:139], v[248:251]
 ds_read_b64_tr_b16 a[180:181], v4 offset:36864
 v_accvgpr_read_b32 v22, a58
 v_mfma_f32_16x16x32_bf16 v[248:251], a[188:191], a[152:155], v[248:251]
 buffer_load_dwordx4 v12, s[40:43], s99 offen offset:2048 lds
 v_exp_f32 v123, v123
 v_mfma_f32_16x16x32_bf16 v[252:255], a[184:187], a[140:143], v[252:255]
 buffer_load_dwordx4 v13, s[40:43], s99 offen offset:3072 lds
 v_accvgpr_read_b32 v23, a59
 v_mfma_f32_16x16x32_bf16 v[252:255], a[188:191], a[156:159], v[252:255]
 s_waitcnt lgkmcnt(9)
 ds_read_b64_tr_b16 a[182:183], v4 offset:37376
 v_fma_f32 v120, v120, s98, s98
 v_mfma_f32_16x16x32_bf16 v[128:131], a[160:163], a[64:67], v[128:131]
 s_add_u32 s95, s95, 1
 ds_read_b64_tr_b16 a[184:185], v5 offset:32768
 v_fma_f32 v121, v121, s98, s98
 v_mfma_f32_16x16x32_bf16 v[128:131], a[164:167], a[80:83], v[128:131]
 s_and_b32 s95, s95, 15
 ds_read_b64_tr_b16 a[186:187], v5 offset:33280
 v_fma_f32 v122, v122, s98, s98
 v_fma_f32 v123, v123, s98, s98
 v_mfma_f32_16x16x32_bf16 v[132:135], a[160:163], a[68:71], v[132:135]
 s_lshl_b32 s84, s95, 18
 v_rcp_f32 v120, v120
 v_mfma_f32_16x16x32_bf16 v[132:135], a[164:167], a[84:87], v[132:135]
 s_add_u32 s84, s84, 128
 v_rcp_f32 v121, v121
 v_mfma_f32_16x16x32_bf16 v[136:139], a[160:163], a[72:75], v[136:139]
 ds_read_b64_tr_b16 a[188:189], v5 offset:36864
 v_mfma_f32_16x16x32_bf16 v[136:139], a[164:167], a[88:91], v[136:139]
 ds_read_b64_tr_b16 a[190:191], v5 offset:37376
 v_mfma_f32_16x16x32_bf16 v[140:143], a[160:163], a[76:79], v[140:143]
 v_rcp_f32 v122, v122
 v_mfma_f32_16x16x32_bf16 v[140:143], a[164:167], a[92:95], v[140:143]
 s_waitcnt vmcnt(8) lgkmcnt(8)
 v_rcp_f32 v123, v123
 v_mfma_f32_16x16x32_bf16 v[144:147], a[168:171], a[64:67], v[144:147]
 s_add_u32 s95, s95, 1
 ds_read_b64_tr_b16 a[160:161], v2 offset:0
 v_mul_f32 v120, v120, v20
 v_mfma_f32_16x16x32_bf16 v[144:147], a[172:175], a[80:83], v[144:147]
 s_lshl_b32 s99, s95, 18
 ds_read_b64_tr_b16 a[162:163], v2 offset:512
 v_mul_f32 v121, v121, v21
 v_mfma_f32_16x16x32_bf16 v[148:151], a[168:171], a[68:71], v[148:151]
 s_add_u32 s99, s99, 128
 v_mul_f32 v122, v122, v22
 v_mul_f32 v123, v123, v23
 v_mfma_f32_16x16x32_bf16 v[148:151], a[172:175], a[84:87], v[148:151]
 v_cvt_pk_bf16_f32 v58, v120, v121
 v_cvt_pk_bf16_f32 v59, v122, v123
 v_mfma_f32_16x16x32_bf16 v[152:155], a[168:171], a[72:75], v[152:155]
 ds_read_b64_tr_b16 a[164:165], v2 offset:4096
 v_mul_f32 v108, s97, v108
 v_mfma_f32_16x16x32_bf16 v[152:155], a[172:175], a[88:91], v[152:155]
 ds_read_b64_tr_b16 a[166:167], v2 offset:4608
 v_mul_f32 v109, s97, v109
 v_mfma_f32_16x16x32_bf16 v[156:159], a[168:171], a[76:79], v[156:159]
 v_mul_f32 v110, s97, v110
 v_mul_f32 v111, s97, v111
 v_mfma_f32_16x16x32_bf16 v[156:159], a[172:175], a[92:95], v[156:159]
 s_add_u32 m0, s83, 32768
 s_waitcnt lgkmcnt(4)
 v_mfma_f32_16x16x32_bf16 v[160:163], a[176:179], a[64:67], v[160:163]
 ds_read_b64_tr_b16 a[168:169], v3 offset:0
 v_mfma_f32_16x16x32_bf16 v[160:163], a[180:183], a[80:83], v[160:163]
 buffer_load_dwordx4 v10, s[40:43], s84 offen offset:0 lds
 v_mfma_f32_16x16x32_bf16 v[164:167], a[176:179], a[68:71], v[164:167]
 buffer_load_dwordx4 v11, s[40:43], s84 offen offset:1024 lds
 v_exp_f32 v108, v108
 v_mfma_f32_16x16x32_bf16 v[164:167], a[180:183], a[84:87], v[164:167]
 ds_read_b64_tr_b16 a[170:171], v3 offset:512
 v_accvgpr_read_b32 v20, a44
 v_mfma_f32_16x16x32_bf16 v[168:171], a[176:179], a[72:75], v[168:171]
 ds_read_b64_tr_b16 a[172:173], v3 offset:4096
 v_exp_f32 v109, v109
 v_mfma_f32_16x16x32_bf16 v[168:171], a[180:183], a[88:91], v[168:171]
 buffer_load_dwordx4 v12, s[40:43], s84 offen offset:2048 lds
 v_accvgpr_read_b32 v21, a45
 v_mfma_f32_16x16x32_bf16 v[172:175], a[176:179], a[76:79], v[172:175]
 buffer_load_dwordx4 v13, s[40:43], s84 offen offset:3072 lds
 v_mfma_f32_16x16x32_bf16 v[172:175], a[180:183], a[92:95], v[172:175]
 s_add_u32 m0, s83, 36864
 ds_read_b64_tr_b16 a[174:175], v3 offset:4608
 s_waitcnt lgkmcnt(8)
 v_exp_f32 v110, v110
 v_mfma_f32_16x16x32_bf16 v[176:179], a[184:187], a[64:67], v[176:179]
 ds_read_b64_tr_b16 a[176:177], v4 offset:0
 v_accvgpr_read_b32 v22, a46
 v_mfma_f32_16x16x32_bf16 v[176:179], a[188:191], a[80:83], v[176:179]
 buffer_load_dwordx4 v10, s[40:43], s99 offen offset:0 lds
 v_exp_f32 v111, v111
 v_mfma_f32_16x16x32_bf16 v[180:183], a[184:187], a[68:71], v[180:183]
 buffer_load_dwordx4 v11, s[40:43], s99 offen offset:1024 lds
 v_accvgpr_read_b32 v23, a47
 v_mfma_f32_16x16x32_bf16 v[180:183], a[188:191], a[84:87], v[180:183]
 ds_read_b64_tr_b16 a[178:179], v4 offset:512
 v_fma_f32 v108, v108, s98, s98
 v_mfma_f32_16x16x32_bf16 v[184:187], a[184:187], a[72:75], v[184:187]
 ds_read_b64_tr_b16 a[180:181], v4 offset:4096
 v_fma_f32 v109, v109, s98, s98
 v_fma_f32 v110, v110, s98, s98
 v_mfma_f32_16x16x32_bf16 v[184:187], a[188:191], a[88:91], v[184:187]
 buffer_load_dwordx4 v12, s[40:43], s99 offen offset:2048 lds
 v_fma_f32 v111, v111, s98, s98
 v_mfma_f32_16x16x32_bf16 v[188:191], a[184:187], a[76:79], v[188:191]
 buffer_load_dwordx4 v13, s[40:43], s99 offen offset:3072 lds
 v_mfma_f32_16x16x32_bf16 v[188:191], a[188:191], a[92:95], v[188:191]
 s_waitcnt lgkmcnt(7)
 ds_read_b64_tr_b16 a[182:183], v4 offset:4608
 v_rcp_f32 v108, v108
 v_mfma_f32_16x16x32_bf16 v[128:131], a[160:163], a[96:99], v[128:131]
 ds_read_b64_tr_b16 a[184:185], v5 offset:0
 v_rcp_f32 v109, v109
 v_mfma_f32_16x16x32_bf16 v[128:131], a[164:167], a[112:115], v[128:131]
 ds_read_b64_tr_b16 a[186:187], v5 offset:512
 v_mfma_f32_16x16x32_bf16 v[132:135], a[160:163], a[100:103], v[132:135]
 v_rcp_f32 v110, v110
 v_mfma_f32_16x16x32_bf16 v[132:135], a[164:167], a[116:119], v[132:135]
 v_rcp_f32 v111, v111
 v_mfma_f32_16x16x32_bf16 v[136:139], a[160:163], a[104:107], v[136:139]
 ds_read_b64_tr_b16 a[188:189], v5 offset:4096
 v_mul_f32 v108, v108, v20
 v_mfma_f32_16x16x32_bf16 v[136:139], a[164:167], a[120:123], v[136:139]
 ds_read_b64_tr_b16 a[190:191], v5 offset:4608
 v_mul_f32 v109, v109, v21
 v_mfma_f32_16x16x32_bf16 v[140:143], a[160:163], a[108:111], v[140:143]
 v_mul_f32 v110, v110, v22
 v_mul_f32 v111, v111, v23
 v_mfma_f32_16x16x32_bf16 v[140:143], a[164:167], a[124:127], v[140:143]
 s_waitcnt vmcnt(8) lgkmcnt(8)
 v_cvt_pk_bf16_f32 v60, v108, v109
 v_cvt_pk_bf16_f32 v61, v110, v111
 v_mfma_f32_16x16x32_bf16 v[144:147], a[168:171], a[96:99], v[144:147]
 ds_read_b64_tr_b16 a[160:161], v2 offset:16384
 v_mul_f32 v124, s97, v124
 v_mfma_f32_16x16x32_bf16 v[144:147], a[172:175], a[112:115], v[144:147]
 ds_read_b64_tr_b16 a[162:163], v2 offset:16896
 v_mul_f32 v125, s97, v125
 v_mfma_f32_16x16x32_bf16 v[148:151], a[168:171], a[100:103], v[148:151]
 v_mul_f32 v126, s97, v126
 v_mul_f32 v127, s97, v127
 v_mfma_f32_16x16x32_bf16 v[148:151], a[172:175], a[116:119], v[148:151]
 v_exp_f32 v124, v124
 v_mfma_f32_16x16x32_bf16 v[152:155], a[168:171], a[104:107], v[152:155]
 ds_read_b64_tr_b16 a[164:165], v2 offset:20480
 v_accvgpr_read_b32 v20, a60
 v_mfma_f32_16x16x32_bf16 v[152:155], a[172:175], a[120:123], v[152:155]
 ds_read_b64_tr_b16 a[166:167], v2 offset:20992
 v_mfma_f32_16x16x32_bf16 v[156:159], a[168:171], a[108:111], v[156:159]
 s_mov_b32 s85, s87
 s_add_u32 s86, s87, 16384
 v_mfma_f32_16x16x32_bf16 v[156:159], a[172:175], a[124:127], v[156:159]
 s_waitcnt lgkmcnt(4)
 v_exp_f32 v125, v125
 v_mfma_f32_16x16x32_bf16 v[160:163], a[176:179], a[96:99], v[160:163]
 ds_read_b64_tr_b16 a[168:169], v3 offset:16384
 v_accvgpr_read_b32 v21, a61
 v_mfma_f32_16x16x32_bf16 v[160:163], a[180:183], a[112:115], v[160:163]
 ds_read_b64_tr_b16 a[170:171], v3 offset:16896
 v_mfma_f32_16x16x32_bf16 v[164:167], a[176:179], a[100:103], v[164:167]
 v_exp_f32 v126, v126
 v_mfma_f32_16x16x32_bf16 v[164:167], a[180:183], a[116:119], v[164:167]
 v_accvgpr_read_b32 v22, a62
 v_mfma_f32_16x16x32_bf16 v[168:171], a[176:179], a[104:107], v[168:171]
 ds_read_b64_tr_b16 a[172:173], v3 offset:20480
 v_mfma_f32_16x16x32_bf16 v[168:171], a[180:183], a[120:123], v[168:171]
 ds_read_b64_tr_b16 a[174:175], v3 offset:20992
 v_exp_f32 v127, v127
 v_mfma_f32_16x16x32_bf16 v[172:175], a[176:179], a[108:111], v[172:175]
 v_accvgpr_read_b32 v23, a63
 v_fma_f32 v124, v124, s98, s98
 v_mfma_f32_16x16x32_bf16 v[172:175], a[180:183], a[124:127], v[172:175]
 s_waitcnt lgkmcnt(8)
 v_fma_f32 v125, v125, s98, s98
 v_fma_f32 v126, v126, s98, s98
 v_mfma_f32_16x16x32_bf16 v[176:179], a[184:187], a[96:99], v[176:179]
 ds_read_b64_tr_b16 a[176:177], v4 offset:16384
 v_fma_f32 v127, v127, s98, s98
 v_mfma_f32_16x16x32_bf16 v[176:179], a[188:191], a[112:115], v[176:179]
 ds_read_b64_tr_b16 a[178:179], v4 offset:16896
 v_mfma_f32_16x16x32_bf16 v[180:183], a[184:187], a[100:103], v[180:183]
 v_rcp_f32 v124, v124
 v_mfma_f32_16x16x32_bf16 v[180:183], a[188:191], a[116:119], v[180:183]
 v_rcp_f32 v125, v125
 v_mfma_f32_16x16x32_bf16 v[184:187], a[184:187], a[104:107], v[184:187]
 ds_read_b64_tr_b16 a[180:181], v4 offset:20480
 v_mfma_f32_16x16x32_bf16 v[184:187], a[188:191], a[120:123], v[184:187]
 ds_read_b64_tr_b16 a[182:183], v4 offset:20992
 v_mfma_f32_16x16x32_bf16 v[188:191], a[184:187], a[108:111], v[188:191]
 s_add_u32 m0, s87, 49152
 s_barrier
 v_rcp_f32 v126, v126
 v_mfma_f32_16x16x32_bf16 v[188:191], a[188:191], a[124:127], v[188:191]
 s_waitcnt lgkmcnt(8)
 v_rcp_f32 v127, v127
 v_mul_f32 v124, v124, v20
 v_mul_f32 v125, v125, v21
 v_mul_f32 v126, v126, v22
 v_mul_f32 v127, v127, v23
 v_cvt_pk_bf16_f32 v62, v124, v125
 v_cvt_pk_bf16_f32 v63, v126, v127
 v_mfma_f32_16x16x32_bf16 v[192:195], a[160:163], a[64:67], v[192:195]
 ds_read_b64_tr_b16 a[184:185], v5 offset:16384
 v_accvgpr_read_b32 v10, a250
 v_mfma_f32_16x16x32_bf16 v[192:195], a[164:167], a[80:83], v[192:195]
 buffer_load_dwordx4 v16, s[32:35], s85 offen offset:0 lds
 v_mfma_f32_16x16x32_bf16 v[196:199], a[160:163], a[68:71], v[196:199]
 ds_read_b64_tr_b16 a[186:187], v5 offset:16896
 v_accvgpr_read_b32 v14, a251
 v_mfma_f32_16x16x32_bf16 v[196:199], a[164:167], a[84:87], v[196:199]
 v_lshlrev_b32 v20, 4, v1
 v_mov_b32 v21, 0
 v_mfma_f32_16x16x32_bf16 v[200:203], a[160:163], a[72:75], v[200:203]
 ds_read_b64_tr_b16 a[188:189], v5 offset:20480
 v_mov_b32 v22, 0x3f803f80
 v_mfma_f32_16x16x32_bf16 v[200:203], a[164:167], a[88:91], v[200:203]
 buffer_load_dwordx4 v17, s[32:35], s85 offen offset:1024 lds
 v_mfma_f32_16x16x32_bf16 v[204:207], a[160:163], a[76:79], v[204:207]
 ds_read_b64_tr_b16 a[190:191], v5 offset:20992
 v_xor_b32 v15, 128, v14
 v_mfma_f32_16x16x32_bf16 v[204:207], a[164:167], a[92:95], v[204:207]
 s_waitcnt vmcnt(2) lgkmcnt(8)
 v_xor_b32 v11, 64, v10
 v_xor_b32 v12, 128, v10
 v_mfma_f32_16x16x32_bf16 v[208:211], a[168:171], a[64:67], v[208:211]
 ds_read_b64_tr_b16 a[160:161], v2 offset:32768
 v_xor_b32 v13, 192, v10
 v_mfma_f32_16x16x32_bf16 v[208:211], a[172:175], a[80:83], v[208:211]
 buffer_load_dwordx4 v18, s[32:35], s85 offen offset:2048 lds
 v_accvgpr_write_b32 a144, v22
 v_mfma_f32_16x16x32_bf16 v[212:215], a[168:171], a[68:71], v[212:215]
 ds_read_b64_tr_b16 a[162:163], v2 offset:33280
 v_accvgpr_write_b32 a145, v22
 v_accvgpr_write_b32 a146, v22
 v_mfma_f32_16x16x32_bf16 v[212:215], a[172:175], a[84:87], v[212:215]
 v_accvgpr_write_b32 a147, v22
 v_cvt_pk_bf16_f32 v64, v128, v129
 v_mfma_f32_16x16x32_bf16 v[216:219], a[168:171], a[72:75], v[216:219]
 ds_read_b64_tr_b16 a[164:165], v2 offset:36864
 v_cvt_pk_bf16_f32 v65, v130, v131
 v_cvt_pk_bf16_f32 v66, v144, v145
 v_mfma_f32_16x16x32_bf16 v[216:219], a[172:175], a[88:91], v[216:219]
 buffer_load_dwordx4 v19, s[32:35], s85 offen offset:3072 lds
 v_cvt_pk_bf16_f32 v67, v146, v147
 v_mfma_f32_16x16x32_bf16 v[220:223], a[168:171], a[76:79], v[220:223]
 s_mov_b32 m0, s87
 ds_read_b64_tr_b16 a[166:167], v2 offset:37376
 v_cvt_pk_bf16_f32 v68, v132, v133
 v_cvt_pk_bf16_f32 v69, v134, v135
 v_mfma_f32_16x16x32_bf16 v[220:223], a[172:175], a[92:95], v[220:223]
 s_waitcnt lgkmcnt(4)
 v_cvt_pk_bf16_f32 v70, v148, v149
 v_cvt_pk_bf16_f32 v71, v150, v151
 v_mfma_f32_16x16x32_bf16 v[224:227], a[176:179], a[64:67], v[224:227]
 ds_read_b64_tr_b16 a[168:169], v3 offset:32768
 v_cvt_pk_bf16_f32 v72, v136, v137
 v_mfma_f32_16x16x32_bf16 v[224:227], a[180:183], a[80:83], v[224:227]
 buffer_load_dwordx4 v16, s[32:35], s86 offen offset:0 lds
 v_cvt_pk_bf16_f32 v73, v138, v139
 v_mfma_f32_16x16x32_bf16 v[228:231], a[176:179], a[68:71], v[228:231]
 ds_read_b64_tr_b16 a[170:171], v3 offset:33280
 v_cvt_pk_bf16_f32 v74, v152, v153
 v_cvt_pk_bf16_f32 v75, v154, v155
 v_mfma_f32_16x16x32_bf16 v[228:231], a[180:183], a[84:87], v[228:231]
 v_cvt_pk_bf16_f32 v76, v140, v141
 v_cvt_pk_bf16_f32 v77, v142, v143
 v_cvt_pk_bf16_f32 v78, v156, v157
 v_mfma_f32_16x16x32_bf16 v[232:235], a[176:179], a[72:75], v[232:235]
 ds_read_b64_tr_b16 a[172:173], v3 offset:36864
 v_cvt_pk_bf16_f32 v79, v158, v159
 v_mfma_f32_16x16x32_bf16 v[232:235], a[180:183], a[88:91], v[232:235]
 buffer_load_dwordx4 v17, s[32:35], s86 offen offset:1024 lds
 v_permlane32_swap_b32 v64, v66
 v_mfma_f32_16x16x32_bf16 v[236:239], a[176:179], a[76:79], v[236:239]
 ds_read_b64_tr_b16 a[174:175], v3 offset:37376
 v_permlane32_swap_b32 v65, v67
 v_mfma_f32_16x16x32_bf16 v[236:239], a[180:183], a[92:95], v[236:239]
 s_waitcnt lgkmcnt(8)
 v_permlane32_swap_b32 v68, v70
L_pg6:
 s_cbranch_execz L_site0
 v_mfma_f32_16x16x32_bf16 v[240:243], a[184:187], a[64:67], v[240:243]
 ds_read_b64_tr_b16 a[176:177], v4 offset:32768
 v_mfma_f32_16x16x32_bf16 v[240:243], a[188:191], a[80:83], v[240:243]
 buffer_load_dwordx4 v18, s[32:35], s86 offen offset:2048 lds
 v_permlane32_swap_b32 v69, v71
 v_mfma_f32_16x16x32_bf16 v[244:247], a[184:187], a[68:71], v[244:247]
 ds_read_b64_tr_b16 a[178:179], v4 offset:33280
 v_permlane32_swap_b32 v72, v74
 v_mfma_f32_16x16x32_bf16 v[244:247], a[188:191], a[84:87], v[244:247]
 v_permlane32_swap_b32 v73, v75
 v_mfma_f32_16x16x32_bf16 v[248:251], a[184:187], a[72:75], v[248:251]
 ds_read_b64_tr_b16 a[180:181], v4 offset:36864
 v_permlane32_swap_b32 v76, v78
 v_mfma_f32_16x16x32_bf16 v[248:251], a[188:191], a[88:91], v[248:251]
 buffer_load_dwordx4 v19, s[32:35], s86 offen offset:3072 lds
 v_permlane32_swap_b32 v77, v79
 v_mfma_f32_16x16x32_bf16 v[252:255], a[184:187], a[76:79], v[252:255]
 ds_read_b64_tr_b16 a[182:183], v4 offset:37376
 v_mfma_f32_16x16x32_bf16 v[252:255], a[188:191], a[92:95], v[252:255]
 s_waitcnt lgkmcnt(8)
 v_permlane16_swap_b32 v64, v66
 v_mfma_f32_16x16x32_bf16 v[192:195], a[160:163], a[96:99], v[192:195]
 ds_read_b64_tr_b16 a[184:185], v5 offset:32768
 v_permlane16_swap_b32 v65, v67
 v_mfma_f32_16x16x32_bf16 v[192:195], a[164:167], a[112:115], v[192:195]
 ds_read_b64_tr_b16 a[186:187], v5 offset:33280
 v_permlane16_swap_b32 v68, v70
 v_mfma_f32_16x16x32_bf16 v[196:199], a[160:163], a[100:103], v[196:199]
 v_permlane16_swap_b32 v69, v71
 v_mfma_f32_16x16x32_bf16 v[196:199], a[164:167], a[116:119], v[196:199]
 v_permlane16_swap_b32 v72, v74
 v_mfma_f32_16x16x32_bf16 v[200:203], a[160:163], a[104:107], v[200:203]
 ds_read_b64_tr_b16 a[188:189], v5 offset:36864
 v_permlane16_swap_b32 v73, v75
 v_mfma_f32_16x16x32_bf16 v[200:203], a[164:167], a[120:123], v[200:203]
 ds_read_b64_tr_b16 a[190:191], v5 offset:37376
 v_mfma_f32_16x16x32_bf16 v[204:207], a[160:163], a[108:111], v[204:207]
 v_permlane16_swap_b32 v76, v78
 v_mfma_f32_16x16x32_bf16 v[204:207], a[164:167], a[124:127], v[204:207]
 s_waitcnt lgkmcnt(8)
 v_permlane16_swap_b32 v77, v79
 v_cvt_pk_bf16_f32 v80, v160, v161
 v_mfma_f32_16x16x32_bf16 v[208:211], a[168:171], a[96:99], v[208:211]
 v_cvt_pk_bf16_f32 v81, v162, v163
 v_cvt_pk_bf16_f32 v82, v176, v177
 v_mfma_f32_16x16x32_bf16 v[208:211], a[172:175], a[112:115], v[208:211]
 v_cvt_pk_bf16_f32 v83, v178, v179
 v_cvt_pk_bf16_f32 v84, v164, v165
 v_mfma_f32_16x16x32_bf16 v[212:215], a[168:171], a[100:103], v[212:215]
 v_cvt_pk_bf16_f32 v85, v166, v167
 v_cvt_pk_bf16_f32 v86, v180, v181
 v_mfma_f32_16x16x32_bf16 v[212:215], a[172:175], a[116:119], v[212:215]
 v_cvt_pk_bf16_f32 v87, v182, v183
 v_cvt_pk_bf16_f32 v88, v168, v169
 v_mfma_f32_16x16x32_bf16 v[216:219], a[168:171], a[104:107], v[216:219]
 v_cvt_pk_bf16_f32 v89, v170, v171
 v_cvt_pk_bf16_f32 v90, v184, v185
 v_mfma_f32_16x16x32_bf16 v[216:219], a[172:175], a[120:123], v[216:219]
 v_cvt_pk_bf16_f32 v91, v186, v187
 v_cvt_pk_bf16_f32 v92, v172, v173
 v_mfma_f32_16x16x32_bf16 v[220:223], a[168:171], a[108:111], v[220:223]
 v_cvt_pk_bf16_f32 v93, v174, v175
 v_cvt_pk_bf16_f32 v94, v188, v189
 v_mfma_f32_16x16x32_bf16 v[220:223], a[172:175], a[124:127], v[220:223]
 s_waitcnt lgkmcnt(0)
 v_cvt_pk_bf16_f32 v95, v190, v191
 v_mfma_f32_16x16x32_bf16 v[224:227], a[176:179], a[96:99], v[224:227]
 v_permlane32_swap_b32 v80, v82
 v_mfma_f32_16x16x32_bf16 v[224:227], a[180:183], a[112:115], v[224:227]
 v_permlane32_swap_b32 v81, v83
 v_mfma_f32_16x16x32_bf16 v[228:231], a[176:179], a[100:103], v[228:231]
 v_permlane32_swap_b32 v84, v86
 v_mfma_f32_16x16x32_bf16 v[228:231], a[180:183], a[116:119], v[228:231]
 v_permlane32_swap_b32 v85, v87
 v_mfma_f32_16x16x32_bf16 v[232:235], a[176:179], a[104:107], v[232:235]
 v_permlane32_swap_b32 v88, v90
 v_mfma_f32_16x16x32_bf16 v[232:235], a[180:183], a[120:123], v[232:235]
 v_permlane32_swap_b32 v89, v91
 v_mfma_f32_16x16x32_bf16 v[236:239], a[176:179], a[108:111], v[236:239]
 v_permlane32_swap_b32 v92, v94
 v_mfma_f32_16x16x32_bf16 v[236:239], a[180:183], a[124:127], v[236:239]
 s_waitcnt lgkmcnt(0)
 v_permlane32_swap_b32 v93, v95
 v_mfma_f32_16x16x32_bf16 v[240:243], a[184:187], a[96:99], v[240:243]
 v_permlane16_swap_b32 v80, v82
 v_mfma_f32_16x16x32_bf16 v[240:243], a[188:191], a[112:115], v[240:243]
 v_permlane16_swap_b32 v81, v83
 v_mfma_f32_16x16x32_bf16 v[244:247], a[184:187], a[100:103], v[244:247]
 v_permlane16_swap_b32 v84, v86
 v_mfma_f32_16x16x32_bf16 v[244:247], a[188:191], a[116:119], v[244:247]
 v_permlane16_swap_b32 v85, v87
 v_mfma_f32_16x16x32_bf16 v[248:251], a[184:187], a[104:107], v[248:251]
 v_permlane16_swap_b32 v88, v90
 v_mfma_f32_16x16x32_bf16 v[248:251], a[188:191], a[120:123], v[248:251]
 v_permlane16_swap_b32 v89, v91
 v_mfma_f32_16x16x32_bf16 v[252:255], a[184:187], a[108:111], v[252:255]
 v_permlane16_swap_b32 v92, v94
 v_mfma_f32_16x16x32_bf16 v[252:255], a[188:191], a[124:127], v[252:255]
 v_permlane16_swap_b32 v93, v95
 s_add_u32 m0, s87, 65536
 s_mov_b64 exec, 0
 s_cmp_eq_u32 s76, 0
 s_cbranch_scc1 L_pg9
 s_cmp_eq_u32 s76, 1
 s_cbranch_scc1 L_pg10
 s_cmp_eq_u32 s76, 2
 s_cbranch_scc1 L_pg11
 s_branch L_pg12
L_site1:
 s_mov_b64 exec, -1
 s_nop 0
 s_waitcnt vmcnt(0)
 s_barrier
 ds_read_b128 a[228:231], v10 offset:49152
 ds_read_b128 a[232:235], v11 offset:49152
 ds_read_b128 a[236:239], v10 offset:53248
 v_accvgpr_read_b32 v2, a249
 v_xor_b32 v3, 32, v2
 v_xor_b32 v4, 64, v2
 v_xor_b32 v5, 96, v2
 v_xor_b32 v6, 128, v2
 v_xor_b32 v7, 160, v2
 v_xor_b32 v8, 192, v2
 v_xor_b32 v9, 224, v2
 s_waitcnt lgkmcnt(2)
 v_mfma_f32_16x16x32_bf16 v[128:131], a[228:231], v[64:67], 0
 ds_read_b128 a[240:243], v11 offset:53248
 v_cvt_pk_bf16_f32 v96, v192, v193
 v_mfma_f32_16x16x32_bf16 v[132:135], a[228:231], v[68:71], 0
 buffer_load_dwordx4 v14, s[36:39], s85 offen offset:0 lds
 v_cvt_pk_bf16_f32 v97, v194, v195
 v_mfma_f32_16x16x32_bf16 v[136:139], a[228:231], v[72:75], 0
 v_cvt_pk_bf16_f32 v98, v208, v209
 v_cvt_pk_bf16_f32 v99, v210, v211
 v_cvt_pk_bf16_f32 v100, v196, v197
 v_mfma_f32_16x16x32_bf16 v[140:143], a[228:231], v[76:79], 0
 s_waitcnt lgkmcnt(2)
 v_cvt_pk_bf16_f32 v101, v198, v199
 v_cvt_pk_bf16_f32 v102, v212, v213
 v_cvt_pk_bf16_f32 v103, v214, v215
 v_mfma_f32_16x16x32_bf16 v[128:131], a[232:235], v[80:83], v[128:131]
 ds_read_b128 a[228:231], v12 offset:49152
 v_cvt_pk_bf16_f32 v104, v200, v201
 v_cvt_pk_bf16_f32 v105, v202, v203
 v_mfma_f32_16x16x32_bf16 v[132:135], a[232:235], v[84:87], v[132:135]
 buffer_load_dwordx4 v15, s[36:39], s85 offen offset:1024 lds
 v_cvt_pk_bf16_f32 v106, v216, v217
 v_mfma_f32_16x16x32_bf16 v[136:139], a[232:235], v[88:91], v[136:139]
 v_cvt_pk_bf16_f32 v107, v218, v219
 v_cvt_pk_bf16_f32 v108, v204, v205
 v_cvt_pk_bf16_f32 v109, v206, v207
 v_mfma_f32_16x16x32_bf16 v[140:143], a[232:235], v[92:95], v[140:143]
 s_waitcnt lgkmcnt(2)
 v_cvt_pk_bf16_f32 v110, v220, v221
 v_cvt_pk_bf16_f32 v111, v222, v223
 v_permlane32_swap_b32 v96, v98
 v_mfma_f32_16x16x32_bf16 v[144:147], a[236:239], v[64:67], 0
 ds_read_b128 a[232:235], v13 offset:49152
 v_permlane32_swap_b32 v97, v99
 v_mfma_f32_16x16x32_bf16 v[148:151], a[236:239], v[68:71], 0
 buffer_load_dwordx4 v14, s[36:39], s85 offen offset:2048 lds
 v_permlane32_swap_b32 v100, v102
 v_mfma_f32_16x16x32_bf16 v[152:155], a[236:239], v[72:75], 0
 v_permlane32_swap_b32 v101, v103
 v_permlane32_swap_b32 v104, v106
 v_mfma_f32_16x16x32_bf16 v[156:159], a[236:239], v[76:79], 0
 s_waitcnt lgkmcnt(2)
 v_permlane32_swap_b32 v105, v107
 v_permlane32_swap_b32 v108, v110
 v_mfma_f32_16x16x32_bf16 v[144:147], a[240:243], v[80:83], v[144:147]
 ds_read_b128 a[236:239], v12 offset:53248
 v_permlane32_swap_b32 v109, v111
 v_mfma_f32_16x16x32_bf16 v[148:151], a[240:243], v[84:87], v[148:151]
 buffer_load_dwordx4 v15, s[36:39], s85 offen offset:3072 lds
 v_permlane16_swap_b32 v96, v98
 v_mfma_f32_16x16x32_bf16 v[152:155], a[240:243], v[88:91], v[152:155]
 v_permlane16_swap_b32 v97, v99
 v_permlane16_swap_b32 v100, v102
 v_mfma_f32_16x16x32_bf16 v[156:159], a[240:243], v[92:95], v[156:159]
 s_waitcnt lgkmcnt(2)
 v_permlane16_swap_b32 v101, v103
 v_permlane16_swap_b32 v104, v106
 v_permlane16_swap_b32 v105, v107
 v_permlane16_swap_b32 v108, v110
 v_permlane16_swap_b32 v109, v111
 v_cvt_pk_bf16_f32 v112, v224, v225
 v_cvt_pk_bf16_f32 v113, v226, v227
 v_cvt_pk_bf16_f32 v114, v240, v241
 v_cvt_pk_bf16_f32 v115, v242, v243
 v_cvt_pk_bf16_f32 v116, v228, v229
 v_cvt_pk_bf16_f32 v117, v230, v231
 v_cvt_pk_bf16_f32 v118, v244, v245
 v_cvt_pk_bf16_f32 v119, v246, v247
 v_cvt_pk_bf16_f32 v120, v232, v233
 v_cvt_pk_bf16_f32 v121, v234, v235
 v_cvt_pk_bf16_f32 v122, v248, v249
 v_cvt_pk_bf16_f32 v123, v250, v251
 v_cvt_pk_bf16_f32 v124, v236, v237
 v_cvt_pk_bf16_f32 v125, v238, v239
 v_cvt_pk_bf16_f32 v126, v252, v253
 v_cvt_pk_bf16_f32 v127, v254, v255
 v_permlane32_swap_b32 v112, v114
 v_permlane32_swap_b32 v113, v115
 v_permlane32_swap_b32 v116, v118
 v_permlane32_swap_b32 v117, v119
 v_permlane32_swap_b32 v120, v122
 v_permlane32_swap_b32 v121, v123
 v_permlane32_swap_b32 v124, v126
 v_permlane32_swap_b32 v125, v127
 v_permlane16_swap_b32 v112, v114
 v_permlane16_swap_b32 v113, v115
 v_permlane16_swap_b32 v116, v118
 v_permlane16_swap_b32 v117, v119
 v_permlane16_swap_b32 v120, v122
 v_permlane16_swap_b32 v121, v123
 v_permlane16_swap_b32 v124, v126
 v_permlane16_swap_b32 v125, v127
L_attn:
 s_add_u32 s85, s86, 16384
 s_add_u32 m0, s87, 16384
 v_mfma_f32_16x16x32_bf16 v[128:131], a[228:231], v[96:99], v[128:131]
 ds_read_b128 a[240:243], v13 offset:53248
 v_mfma_f32_16x16x32_bf16 v[132:135], a[228:231], v[100:103], v[132:135]
 buffer_load_dwordx4 v16, s[32:35], s85 offen offset:0 lds
 v_mfma_f32_16x16x32_bf16 v[136:139], a[228:231], v[104:107], v[136:139]
 v_mfma_f32_16x16x32_bf16 v[140:143], a[228:231], v[108:111], v[140:143]
 s_waitcnt lgkmcnt(2)
 v_mfma_f32_16x16x32_bf16 v[128:131], a[232:235], v[112:115], v[128:131]
 ds_read_b128 a[148:151], v10 offset:57344
 v_mfma_f32_16x16x32_bf16 v[132:135], a[232:235], v[116:119], v[132:135]
 buffer_load_dwordx4 v17, s[32:35], s85 offen offset:1024 lds
 v_mfma_f32_16x16x32_bf16 v[136:139], a[232:235], v[120:123], v[136:139]
 v_mfma_f32_16x16x32_bf16 v[140:143], a[232:235], v[124:127], v[140:143]
 s_waitcnt lgkmcnt(2)
 v_mfma_f32_16x16x32_bf16 v[144:147], a[236:239], v[96:99], v[144:147]
 ds_read_b128 a[152:155], v11 offset:57344
 v_mfma_f32_16x16x32_bf16 v[148:151], a[236:239], v[100:103], v[148:151]
 buffer_load_dwordx4 v18, s[32:35], s85 offen offset:2048 lds
 v_mfma_f32_16x16x32_bf16 v[152:155], a[236:239], v[104:107], v[152:155]
 v_mfma_f32_16x16x32_bf16 v[156:159], a[236:239], v[108:111], v[156:159]
 s_waitcnt lgkmcnt(2)
 v_max3_f32 v192, v128, v129, v24
 v_max3_f32 v196, v132, v133, v25
 v_mfma_f32_16x16x32_bf16 v[144:147], a[240:243], v[112:115], v[144:147]
 ds_read_b128 a[156:159], v12 offset:57344
 v_max3_f32 v200, v136, v137, v26
 v_mfma_f32_16x16x32_bf16 v[148:151], a[240:243], v[116:119], v[148:151]
 buffer_load_dwordx4 v19, s[32:35], s85 offen offset:3072 lds
 v_mfma_f32_16x16x32_bf16 v[152:155], a[240:243], v[120:123], v[152:155]
 v_max3_f32 v204, v140, v141, v27
 v_max3_f32 v192, v130, v131, v192
 v_mfma_f32_16x16x32_bf16 v[156:159], a[240:243], v[124:127], v[156:159]
 v_max3_f32 v196, v134, v135, v196
 v_max3_f32 v200, v138, v139, v200
 v_max3_f32 v204, v142, v143, v204
 s_add_u32 m0, s87, 81920
 ds_read_b128 a[160:163], v13 offset:57344
 ds_read_b128 a[228:231], v10 offset:61440
 v_mov_b32 v193, v192
 v_mov_b32 v197, v196
 v_mov_b32 v201, v200
 buffer_store_dword v21, off, s[64:67], s74 offset:0 sc1
 v_mov_b32 v205, v204
 v_permlane32_swap_b32 v192, v193
 v_permlane32_swap_b32 v196, v197
 v_permlane32_swap_b32 v200, v201
 v_permlane32_swap_b32 v204, v205
 v_max_f32 v192, v192, v193
 v_max_f32 v196, v196, v197
 v_max_f32 v200, v200, v201
 v_max_f32 v204, v204, v205
 v_mov_b32 v193, v192
 v_mov_b32 v197, v196
 v_mov_b32 v201, v200
 buffer_store_dword v21, off, s[64:67], s74 offset:128 sc1
 v_mov_b32 v205, v204
 v_permlane16_swap_b32 v192, v193
 v_permlane16_swap_b32 v196, v197
 v_permlane16_swap_b32 v200, v201
 v_permlane16_swap_b32 v204, v205
 v_max_f32 v192, v192, v193
 v_max_f32 v196, v196, v197
 v_max_f32 v200, v200, v201
 v_max_f32 v204, v204, v205
 v_sub_f32 v193, 0, v192
 v_sub_f32 v197, 0, v196
 v_sub_f32 v201, 0, v200
 buffer_store_dwordx4 v[32:35], v20, s[64:67], s92 offen offset:0 sc1
 v_sub_f32 v205, 0, v204
 v_sub_f32 v128, v128, v192
 v_sub_f32 v129, v129, v192
 v_sub_f32 v130, v130, v192
 v_sub_f32 v131, v131, v192
 v_sub_f32 v132, v132, v196
 v_sub_f32 v133, v133, v196
 v_sub_f32 v134, v134, v196
 v_sub_f32 v135, v135, v196
 v_sub_f32 v136, v136, v200
 v_sub_f32 v137, v137, v200
 v_sub_f32 v138, v138, v200
 buffer_store_dwordx4 v[36:39], v20, s[64:67], s92 offen offset:1024 sc1
 v_sub_f32 v139, v139, v200
 v_sub_f32 v140, v140, v204
 v_sub_f32 v141, v141, v204
 v_sub_f32 v142, v142, v204
 v_sub_f32 v143, v143, v204
 v_sub_f32 v144, v144, v192
 v_sub_f32 v145, v145, v192
 v_sub_f32 v146, v146, v192
 v_sub_f32 v147, v147, v192
 v_sub_f32 v148, v148, v196
 v_sub_f32 v149, v149, v196
 v_sub_f32 v150, v150, v196
 buffer_store_dwordx4 v[40:43], v20, s[64:67], s92 offen offset:2048 sc1
 v_sub_f32 v151, v151, v196
 v_sub_f32 v152, v152, v200
 v_sub_f32 v153, v153, v200
 v_sub_f32 v154, v154, v200
 v_sub_f32 v155, v155, v200
 v_sub_f32 v156, v156, v204
 v_sub_f32 v157, v157, v204
 v_sub_f32 v158, v158, v204
 v_sub_f32 v159, v159, v204
 v_mov_b32 v192, v193
 v_mov_b32 v194, v193
 v_mov_b32 v195, v193
 buffer_store_dwordx4 v[44:47], v20, s[64:67], s92 offen offset:3072 sc1
 v_mov_b32 v196, v197
 v_mov_b32 v198, v197
 v_mov_b32 v199, v197
 v_mov_b32 v200, v201
 v_mov_b32 v202, v201
 v_mov_b32 v203, v201
 v_mov_b32 v204, v205
 v_mov_b32 v206, v205
 v_mov_b32 v207, v205
 v_exp_f32 v128, v128
 v_exp_f32 v129, v129
 v_exp_f32 v130, v130
 v_exp_f32 v131, v131
 v_add_f32 v0, v128, v129
 v_cvt_pk_bf16_f32 v160, v128, v129
 v_add_f32 v0, v0, v130
 v_cvt_pk_bf16_f32 v161, v130, v131
 v_add_f32 v0, v0, v131
 s_waitcnt lgkmcnt(1)
 v_mfma_f32_16x16x32_bf16 v[128:131], a[148:151], v[64:67], v[192:195]
 ds_read_b128 a[232:235], v11 offset:61440
 v_exp_f32 v132, v132
 v_exp_f32 v133, v133
 v_mfma_f32_16x16x32_bf16 v[128:131], a[152:155], v[80:83], v[128:131]
 v_exp_f32 v134, v134
 v_exp_f32 v135, v135
 v_mfma_f32_16x16x32_bf16 v[128:131], a[156:159], v[96:99], v[128:131]
 buffer_load_dwordx4 v14, s[36:39], s86 offen offset:0 lds
 v_cvt_pk_bf16_f32 v164, v132, v133
 v_cvt_pk_bf16_f32 v165, v134, v135
 v_mfma_f32_16x16x32_bf16 v[128:131], a[160:163], v[112:115], v[128:131]
 v_add_f32 v24, v132, v133
 v_add_f32 v24, v24, v134
 v_add_f32 v24, v24, v135
 v_mfma_f32_16x16x32_bf16 v[132:135], a[148:151], v[68:71], v[196:199]
 ds_read_b128 a[236:239], v12 offset:61440
 v_exp_f32 v136, v136
 v_exp_f32 v137, v137
 v_mfma_f32_16x16x32_bf16 v[132:135], a[152:155], v[84:87], v[132:135]
 v_exp_f32 v138, v138
 v_exp_f32 v139, v139
 v_mfma_f32_16x16x32_bf16 v[132:135], a[156:159], v[100:103], v[132:135]
 buffer_load_dwordx4 v15, s[36:39], s86 offen offset:1024 lds
 v_exp_f32 v128, v128
 v_exp_f32 v129, v129
 v_cvt_pk_bf16_f32 v168, v136, v137
 v_cvt_pk_bf16_f32 v169, v138, v139
 v_mfma_f32_16x16x32_bf16 v[132:135], a[160:163], v[116:119], v[132:135]
 v_exp_f32 v130, v130
 v_exp_f32 v131, v131
 v_cvt_pk_bf16_f32 v176, v128, v129
 v_cvt_pk_bf16_f32 v177, v130, v131
 v_add_f32 v0, v0, v128
 v_add_f32 v0, v0, v129
 v_add_f32 v0, v0, v130
 v_add_f32 v0, v0, v131
 v_mfma_f32_16x16x32_bf16 v[136:139], a[148:151], v[72:75], v[200:203]
 ds_read_b128 a[240:243], v13 offset:61440
 v_exp_f32 v140, v140
 v_exp_f32 v141, v141
 v_mfma_f32_16x16x32_bf16 v[136:139], a[152:155], v[88:91], v[136:139]
 v_exp_f32 v142, v142
 v_exp_f32 v143, v143
 v_mfma_f32_16x16x32_bf16 v[136:139], a[156:159], v[104:107], v[136:139]
 buffer_load_dwordx4 v14, s[36:39], s86 offen offset:2048 lds
 v_exp_f32 v132, v132
 v_exp_f32 v133, v133
 v_cvt_pk_bf16_f32 v172, v140, v141
 v_cvt_pk_bf16_f32 v173, v142, v143
 v_mfma_f32_16x16x32_bf16 v[136:139], a[160:163], v[120:123], v[136:139]
 v_exp_f32 v134, v134
 v_exp_f32 v135, v135
 v_cvt_pk_bf16_f32 v180, v132, v133
 v_cvt_pk_bf16_f32 v181, v134, v135
 v_add_f32 v24, v24, v132
 v_add_f32 v24, v24, v133
 v_add_f32 v24, v24, v134
 v_add_f32 v24, v24, v135
 s_waitcnt vmcnt(13)
 s_barrier
 v_mfma_f32_16x16x32_bf16 v[140:143], a[148:151], v[76:79], v[204:207]
 ds_read_b128 a[148:151], v10 offset:0
 v_exp_f32 v144, v144
 v_exp_f32 v145, v145
 v_mfma_f32_16x16x32_bf16 v[140:143], a[152:155], v[92:95], v[140:143]
 v_exp_f32 v146, v146
 v_exp_f32 v147, v147
 v_mfma_f32_16x16x32_bf16 v[140:143], a[156:159], v[108:111], v[140:143]
 buffer_load_dwordx4 v15, s[36:39], s86 offen offset:3072 lds
 v_exp_f32 v136, v136
 v_exp_f32 v137, v137
 v_cvt_pk_bf16_f32 v162, v144, v145
 v_cvt_pk_bf16_f32 v163, v146, v147
 v_mfma_f32_16x16x32_bf16 v[140:143], a[160:163], v[124:127], v[140:143]
 v_exp_f32 v138, v138
 v_exp_f32 v139, v139
 v_cvt_pk_bf16_f32 v184, v136, v137
 v_cvt_pk_bf16_f32 v185, v138, v139
 v_add_f32 v0, v0, v144
 v_add_f32 v0, v0, v145
 v_add_f32 v0, v0, v146
 v_add_f32 v0, v0, v147
 s_waitcnt lgkmcnt(1)
 v_mfma_f32_16x16x32_bf16 v[144:147], a[228:231], v[64:67], v[192:195]
 ds_read_b128 a[152:155], v11 offset:0
 v_exp_f32 v148, v148
 v_exp_f32 v149, v149
 v_mfma_f32_16x16x32_bf16 v[144:147], a[232:235], v[80:83], v[144:147]
 v_exp_f32 v150, v150
 v_exp_f32 v151, v151
 v_mfma_f32_16x16x32_bf16 v[144:147], a[236:239], v[96:99], v[144:147]
 buffer_store_dwordx4 v[48:51], v20, s[64:67], s93 offen offset:0 sc1
 v_exp_f32 v140, v140
 v_exp_f32 v141, v141
 v_cvt_pk_bf16_f32 v166, v148, v149
 v_cvt_pk_bf16_f32 v167, v150, v151
 v_mfma_f32_16x16x32_bf16 v[144:147], a[240:243], v[112:115], v[144:147]
 v_exp_f32 v142, v142
 v_exp_f32 v143, v143
 v_cvt_pk_bf16_f32 v188, v140, v141
 v_cvt_pk_bf16_f32 v189, v142, v143
 v_add_f32 v24, v24, v148
 v_add_f32 v24, v24, v149
 v_add_f32 v24, v24, v150
 v_add_f32 v24, v24, v151
 v_mfma_f32_16x16x32_bf16 v[148:151], a[228:231], v[68:71], v[196:199]
 ds_read_b128 a[156:159], v12 offset:0
 v_exp_f32 v152, v152
 v_exp_f32 v153, v153
 v_mfma_f32_16x16x32_bf16 v[148:151], a[232:235], v[84:87], v[148:151]
 ds_read_b64_tr_b16 a[164:165], v2 offset:0
 ds_read_b64_tr_b16 a[166:167], v2 offset:4096
 v_exp_f32 v154, v154
 v_exp_f32 v155, v155
 v_mfma_f32_16x16x32_bf16 v[148:151], a[236:239], v[100:103], v[148:151]
 buffer_store_dwordx4 v[52:55], v20, s[64:67], s93 offen offset:1024 sc1
 v_exp_f32 v144, v144
 v_exp_f32 v145, v145
 v_cvt_pk_bf16_f32 v170, v152, v153
 v_cvt_pk_bf16_f32 v171, v154, v155
 v_mfma_f32_16x16x32_bf16 v[148:151], a[240:243], v[116:119], v[148:151]
 v_exp_f32 v146, v146
 v_exp_f32 v147, v147
 v_cvt_pk_bf16_f32 v178, v144, v145
 v_cvt_pk_bf16_f32 v179, v146, v147
 v_add_f32 v0, v0, v144
 v_add_f32 v0, v0, v145
 v_add_f32 v0, v0, v146
 v_add_f32 v0, v0, v147
 v_mfma_f32_16x16x32_bf16 v[152:155], a[228:231], v[72:75], v[200:203]
 ds_read_b128 a[160:163], v13 offset:0
 v_exp_f32 v156, v156
 v_exp_f32 v157, v157
 v_mfma_f32_16x16x32_bf16 v[152:155], a[232:235], v[88:91], v[152:155]
 ds_read_b64_tr_b16 a[168:169], v2 offset:8192
 ds_read_b64_tr_b16 a[170:171], v2 offset:12288
 v_exp_f32 v158, v158
 v_exp_f32 v159, v159
 v_mfma_f32_16x16x32_bf16 v[152:155], a[236:239], v[104:107], v[152:155]
 buffer_store_dwordx4 v[56:59], v20, s[64:67], s93 offen offset:2048 sc1
 v_exp_f32 v148, v148
 v_exp_f32 v149, v149
 v_cvt_pk_bf16_f32 v174, v156, v157
 v_cvt_pk_bf16_f32 v175, v158, v159
 v_mfma_f32_16x16x32_bf16 v[152:155], a[240:243], v[120:123], v[152:155]
 v_exp_f32 v150, v150
 v_exp_f32 v151, v151
 v_cvt_pk_bf16_f32 v182, v148, v149
 v_cvt_pk_bf16_f32 v183, v150, v151
 v_add_f32 v24, v24, v148
 v_add_f32 v24, v24, v149
 v_add_f32 v24, v24, v150
 v_add_f32 v24, v24, v151
 v_mfma_f32_16x16x32_bf16 v[156:159], a[228:231], v[76:79], v[204:207]
 ds_read_b128 a[228:231], v10 offset:4096
 v_mfma_f32_16x16x32_bf16 v[156:159], a[232:235], v[92:95], v[156:159]
 ds_read_b64_tr_b16 a[172:173], v3 offset:0
 ds_read_b64_tr_b16 a[174:175], v3 offset:4096
 v_mfma_f32_16x16x32_bf16 v[156:159], a[236:239], v[108:111], v[156:159]
 s_add_u32 s86, s85, 16384
 s_add_u32 m0, s87, 32768
 buffer_store_dwordx4 v[60:63], v20, s[64:67], s93 offen offset:3072 sc1
 v_exp_f32 v152, v152
 v_exp_f32 v153, v153
 v_mfma_f32_16x16x32_bf16 v[156:159], a[240:243], v[124:127], v[156:159]
 v_exp_f32 v154, v154
 v_exp_f32 v155, v155
 v_cvt_pk_bf16_f32 v186, v152, v153
 s_nop 0
 v_cvt_pk_bf16_f32 v187, v154, v155
 s_waitcnt lgkmcnt(3)
 s_nop 1
 v_mfma_f32_16x16x32_bf16 v[128:131], a[148:151], v[64:67], v[192:195]
 v_exp_f32 v156, v156
 v_mfma_f32_16x16x32_bf16 v[128:131], a[152:155], v[80:83], v[128:131]
 ds_read_b128 a[232:235], v11 offset:4096
 ds_read_b64_tr_b16 a[176:177], v3 offset:8192
 v_mfma_f32_16x16x32_bf16 v[128:131], a[156:159], v[96:99], v[128:131]
 v_exp_f32 v157, v157
 v_mfma_f32_16x16x32_bf16 v[128:131], a[160:163], v[112:115], v[128:131]
 ds_read_b64_tr_b16 a[178:179], v3 offset:12288
 v_cvt_pk_bf16_f32 v190, v156, v157
 v_mfma_f32_16x16x32_bf16 v[132:135], a[160:163], v[116:119], v[196:199]
 v_exp_f32 v158, v158
 v_mfma_f32_16x16x32_bf16 v[132:135], a[156:159], v[100:103], v[132:135]
 buffer_load_dwordx4 v16, s[32:35], s86 offen offset:0 lds
 v_mfma_f32_16x16x32_bf16 v[132:135], a[152:155], v[84:87], v[132:135]
 v_exp_f32 v159, v159
 v_mfma_f32_16x16x32_bf16 v[132:135], a[148:151], v[68:71], v[132:135]
 v_cvt_pk_bf16_f32 v191, v158, v159
 v_mfma_f32_16x16x32_bf16 v[136:139], a[148:151], v[72:75], v[200:203]
 v_exp_f32 v128, v128
 v_mfma_f32_16x16x32_bf16 v[136:139], a[152:155], v[88:91], v[136:139]
 ds_read_b128 a[236:239], v12 offset:4096
 ds_read_b64_tr_b16 a[212:213], v4 offset:0
 v_mfma_f32_16x16x32_bf16 v[136:139], a[156:159], v[104:107], v[136:139]
 v_exp_f32 v129, v129
 v_mfma_f32_16x16x32_bf16 v[136:139], a[160:163], v[120:123], v[136:139]
 ds_read_b64_tr_b16 a[214:215], v4 offset:4096
 v_cvt_pk_bf16_f32 v32, v128, v129
 v_mfma_f32_16x16x32_bf16 v[140:143], a[160:163], v[124:127], v[204:207]
 v_exp_f32 v130, v130
 v_mfma_f32_16x16x32_bf16 v[140:143], a[156:159], v[108:111], v[140:143]
 buffer_load_dwordx4 v17, s[32:35], s86 offen offset:1024 lds
 v_mfma_f32_16x16x32_bf16 v[140:143], a[152:155], v[92:95], v[140:143]
 v_exp_f32 v131, v131
 v_mfma_f32_16x16x32_bf16 v[140:143], a[148:151], v[76:79], v[140:143]
 s_waitcnt lgkmcnt(3)
 v_cvt_pk_bf16_f32 v33, v130, v131
 v_add_f32 v0, v0, v128
 v_mfma_f32_16x16x32_bf16 a[0:3], a[164:167], v[160:163], 0
 v_exp_f32 v132, v132
 v_mfma_f32_16x16x32_bf16 a[0:3], a[168:171], v[176:179], a[0:3]
 ds_read_b128 a[240:243], v13 offset:4096
 ds_read_b64_tr_b16 a[216:217], v4 offset:8192
 v_mfma_f32_16x16x32_bf16 a[4:7], a[168:171], v[180:183], 0
 v_exp_f32 v133, v133
 v_mfma_f32_16x16x32_bf16 a[4:7], a[164:167], v[164:167], a[4:7]
 ds_read_b64_tr_b16 a[218:219], v4 offset:12288
 v_cvt_pk_bf16_f32 v36, v132, v133
 v_mfma_f32_16x16x32_bf16 a[8:11], a[164:167], v[168:171], 0
 v_exp_f32 v134, v134
 v_mfma_f32_16x16x32_bf16 a[8:11], a[168:171], v[184:187], a[8:11]
 buffer_load_dwordx4 v18, s[32:35], s86 offen offset:2048 lds
 v_mfma_f32_16x16x32_bf16 a[12:15], a[168:171], v[188:191], 0
 v_exp_f32 v135, v135
 v_mfma_f32_16x16x32_bf16 a[12:15], a[164:167], v[172:175], a[12:15]
 v_cvt_pk_bf16_f32 v37, v134, v135
 v_add_f32 v0, v0, v129
 v_mfma_f32_16x16x32_bf16 a[16:19], a[172:175], v[160:163], 0
 v_exp_f32 v136, v136
 v_mfma_f32_16x16x32_bf16 a[16:19], a[176:179], v[176:179], a[16:19]
 ds_read_b128 a[148:151], v10 offset:8192
 ds_read_b64_tr_b16 a[220:221], v5 offset:0
 v_mfma_f32_16x16x32_bf16 a[20:23], a[176:179], v[180:183], 0
 v_exp_f32 v137, v137
 v_mfma_f32_16x16x32_bf16 a[20:23], a[172:175], v[164:167], a[20:23]
 ds_read_b64_tr_b16 a[222:223], v5 offset:4096
 v_cvt_pk_bf16_f32 v40, v136, v137
 v_mfma_f32_16x16x32_bf16 a[24:27], a[172:175], v[168:171], 0
 v_exp_f32 v138, v138
 v_mfma_f32_16x16x32_bf16 a[24:27], a[176:179], v[184:187], a[24:27]
 buffer_load_dwordx4 v19, s[32:35], s86 offen offset:3072 lds
 v_mfma_f32_16x16x32_bf16 a[28:31], a[176:179], v[188:191], 0
 v_exp_f32 v139, v139
 v_mfma_f32_16x16x32_bf16 a[28:31], a[172:175], v[172:175], a[28:31]
 s_waitcnt lgkmcnt(3)
 v_cvt_pk_bf16_f32 v41, v138, v139
 v_add_f32 v0, v0, v130
 v_mfma_f32_16x16x32_bf16 v[144:147], a[228:231], v[64:67], v[192:195]
 v_exp_f32 v140, v140
 v_mfma_f32_16x16x32_bf16 v[144:147], a[232:235], v[80:83], v[144:147]
 ds_read_b128 a[152:155], v11 offset:8192
 ds_read_b64_tr_b16 a[224:225], v5 offset:8192
 v_mfma_f32_16x16x32_bf16 v[144:147], a[236:239], v[96:99], v[144:147]
 v_exp_f32 v141, v141
 v_mfma_f32_16x16x32_bf16 v[144:147], a[240:243], v[112:115], v[144:147]
 ds_read_b64_tr_b16 a[226:227], v5 offset:12288
 v_cvt_pk_bf16_f32 v44, v140, v141
 v_mfma_f32_16x16x32_bf16 v[148:151], a[240:243], v[116:119], v[196:199]
 v_exp_f32 v142, v142
 v_mfma_f32_16x16x32_bf16 v[148:151], a[236:239], v[100:103], v[148:151]
 v_add_f32 v0, v0, v131
 v_add_f32 v24, v24, v132
 v_mfma_f32_16x16x32_bf16 v[148:151], a[232:235], v[84:87], v[148:151]
 v_exp_f32 v143, v143
 v_mfma_f32_16x16x32_bf16 v[148:151], a[228:231], v[68:71], v[148:151]
 v_cvt_pk_bf16_f32 v45, v142, v143
 v_add_f32 v24, v24, v133
 v_mfma_f32_16x16x32_bf16 v[152:155], a[228:231], v[72:75], v[200:203]
 v_exp_f32 v144, v144
 v_mfma_f32_16x16x32_bf16 v[152:155], a[232:235], v[88:91], v[152:155]
 ds_read_b128 a[156:159], v12 offset:8192
 ds_read_b64_tr_b16 a[164:165], v6 offset:0
 v_mfma_f32_16x16x32_bf16 v[152:155], a[236:239], v[104:107], v[152:155]
 v_exp_f32 v145, v145
 v_mfma_f32_16x16x32_bf16 v[152:155], a[240:243], v[120:123], v[152:155]
 ds_read_b64_tr_b16 a[166:167], v6 offset:4096
 v_cvt_pk_bf16_f32 v34, v144, v145
 v_mfma_f32_16x16x32_bf16 v[156:159], a[240:243], v[124:127], v[204:207]
 v_exp_f32 v146, v146
 v_mfma_f32_16x16x32_bf16 v[156:159], a[236:239], v[108:111], v[156:159]
 v_add_f32 v24, v24, v134
 v_add_f32 v24, v24, v135
 v_mfma_f32_16x16x32_bf16 v[156:159], a[232:235], v[92:95], v[156:159]
 v_exp_f32 v147, v147
 v_mfma_f32_16x16x32_bf16 v[156:159], a[228:231], v[76:79], v[156:159]
 s_waitcnt lgkmcnt(3)
 v_cvt_pk_bf16_f32 v35, v146, v147
 v_add_f32 v0, v0, v144
 v_mfma_f32_16x16x32_bf16 a[32:35], a[212:215], v[160:163], 0
 v_exp_f32 v148, v148
 v_mfma_f32_16x16x32_bf16 a[32:35], a[216:219], v[176:179], a[32:35]
 ds_read_b128 a[160:163], v13 offset:8192
 ds_read_b64_tr_b16 a[168:169], v6 offset:8192
 v_mfma_f32_16x16x32_bf16 a[36:39], a[216:219], v[180:183], 0
 v_exp_f32 v149, v149
 v_mfma_f32_16x16x32_bf16 a[36:39], a[212:215], v[164:167], a[36:39]
 ds_read_b64_tr_b16 a[170:171], v6 offset:12288
 v_cvt_pk_bf16_f32 v38, v148, v149
 v_mfma_f32_16x16x32_bf16 a[40:43], a[212:215], v[168:171], 0
 v_exp_f32 v150, v150
 v_mfma_f32_16x16x32_bf16 a[40:43], a[216:219], v[184:187], a[40:43]
 v_add_f32 v0, v0, v145
 v_add_f32 v0, v0, v146
 v_mfma_f32_16x16x32_bf16 a[44:47], a[216:219], v[188:191], 0
 v_exp_f32 v151, v151
 v_mfma_f32_16x16x32_bf16 a[44:47], a[212:215], v[172:175], a[44:47]
 v_cvt_pk_bf16_f32 v39, v150, v151
 v_add_f32 v0, v0, v147
 v_mfma_f32_16x16x32_bf16 a[48:51], a[220:223], v[160:163], 0
 v_exp_f32 v152, v152
 v_mfma_f32_16x16x32_bf16 a[48:51], a[224:227], v[176:179], a[48:51]
 ds_read_b128 a[228:231], v10 offset:12288
 ds_read_b64_tr_b16 a[172:173], v7 offset:0
 v_mfma_f32_16x16x32_bf16 a[52:55], a[224:227], v[180:183], 0
 v_exp_f32 v153, v153
L_pg7:
 s_cbranch_execz L_site0
 v_mfma_f32_16x16x32_bf16 a[52:55], a[220:223], v[164:167], a[52:55]
 ds_read_b64_tr_b16 a[174:175], v7 offset:4096
 v_cvt_pk_bf16_f32 v42, v152, v153
 v_mfma_f32_16x16x32_bf16 a[56:59], a[220:223], v[168:171], 0
 s_add_u32 m0, s87, 98304
 v_exp_f32 v154, v154
 v_mfma_f32_16x16x32_bf16 a[56:59], a[224:227], v[184:187], a[56:59]
 v_add_f32 v24, v24, v148
 v_add_f32 v24, v24, v149
 v_mfma_f32_16x16x32_bf16 a[60:63], a[224:227], v[188:191], 0
 v_exp_f32 v155, v155
 v_mfma_f32_16x16x32_bf16 a[60:63], a[220:223], v[172:175], a[60:63]
 s_waitcnt lgkmcnt(3)
 v_cvt_pk_bf16_f32 v43, v154, v155
 v_add_f32 v24, v24, v150
 v_mfma_f32_16x16x32_bf16 v[128:131], a[148:151], v[64:67], v[192:195]
 v_exp_f32 v156, v156
 v_mfma_f32_16x16x32_bf16 v[128:131], a[152:155], v[80:83], v[128:131]
 ds_read_b128 a[232:235], v11 offset:12288
 ds_read_b64_tr_b16 a[176:177], v7 offset:8192
 v_mfma_f32_16x16x32_bf16 v[128:131], a[156:159], v[96:99], v[128:131]
 v_exp_f32 v157, v157
 v_mfma_f32_16x16x32_bf16 v[128:131], a[160:163], v[112:115], v[128:131]
 ds_read_b64_tr_b16 a[178:179], v7 offset:12288
 v_cvt_pk_bf16_f32 v46, v156, v157
 v_mfma_f32_16x16x32_bf16 v[132:135], a[160:163], v[116:119], v[196:199]
 v_exp_f32 v158, v158
 v_mfma_f32_16x16x32_bf16 v[132:135], a[156:159], v[100:103], v[132:135]
 buffer_load_dwordx4 v14, s[36:39], s85 offen offset:0 lds
 v_mfma_f32_16x16x32_bf16 v[132:135], a[152:155], v[84:87], v[132:135]
 v_exp_f32 v159, v159
 v_mfma_f32_16x16x32_bf16 v[132:135], a[148:151], v[68:71], v[132:135]
 v_cvt_pk_bf16_f32 v47, v158, v159
 v_add_f32 v24, v24, v151
 v_mfma_f32_16x16x32_bf16 v[136:139], a[148:151], v[72:75], v[200:203]
 v_exp_f32 v128, v128
 v_mfma_f32_16x16x32_bf16 v[136:139], a[152:155], v[88:91], v[136:139]
 ds_read_b128 a[236:239], v12 offset:12288
 ds_read_b64_tr_b16 a[212:213], v8 offset:0
 v_mfma_f32_16x16x32_bf16 v[136:139], a[156:159], v[104:107], v[136:139]
 v_exp_f32 v129, v129
 v_mfma_f32_16x16x32_bf16 v[136:139], a[160:163], v[120:123], v[136:139]
 ds_read_b64_tr_b16 a[214:215], v8 offset:4096
 v_cvt_pk_bf16_f32 v48, v128, v129
 v_mfma_f32_16x16x32_bf16 v[140:143], a[160:163], v[124:127], v[204:207]
 v_exp_f32 v130, v130
 v_mfma_f32_16x16x32_bf16 v[140:143], a[156:159], v[108:111], v[140:143]
 buffer_load_dwordx4 v15, s[36:39], s85 offen offset:1024 lds
 v_mfma_f32_16x16x32_bf16 v[140:143], a[152:155], v[92:95], v[140:143]
 v_exp_f32 v131, v131
 v_mfma_f32_16x16x32_bf16 v[140:143], a[148:151], v[76:79], v[140:143]
 s_waitcnt lgkmcnt(3)
 v_cvt_pk_bf16_f32 v49, v130, v131
 v_add_f32 v0, v0, v128
 v_mfma_f32_16x16x32_bf16 a[64:67], a[164:167], v[160:163], 0
 v_exp_f32 v132, v132
 v_mfma_f32_16x16x32_bf16 a[64:67], a[168:171], v[176:179], a[64:67]
 ds_read_b128 a[240:243], v13 offset:12288
 ds_read_b64_tr_b16 a[216:217], v8 offset:8192
 v_mfma_f32_16x16x32_bf16 a[68:71], a[168:171], v[180:183], 0
 v_exp_f32 v133, v133
 v_mfma_f32_16x16x32_bf16 a[68:71], a[164:167], v[164:167], a[68:71]
 ds_read_b64_tr_b16 a[218:219], v8 offset:12288
 v_cvt_pk_bf16_f32 v52, v132, v133
 v_mfma_f32_16x16x32_bf16 a[72:75], a[164:167], v[168:171], 0
 v_exp_f32 v134, v134
 v_mfma_f32_16x16x32_bf16 a[72:75], a[168:171], v[184:187], a[72:75]
 buffer_load_dwordx4 v14, s[36:39], s85 offen offset:2048 lds
 v_mfma_f32_16x16x32_bf16 a[76:79], a[168:171], v[188:191], 0
 v_exp_f32 v135, v135
 v_mfma_f32_16x16x32_bf16 a[76:79], a[164:167], v[172:175], a[76:79]
 v_cvt_pk_bf16_f32 v53, v134, v135
 v_add_f32 v0, v0, v129
 v_mfma_f32_16x16x32_bf16 a[140:143], a[144:147], v[172:175], 0
 s_waitcnt vmcnt(11)
 v_add_f32 v0, v0, v130
 v_add_f32 v0, v0, v131
 v_mfma_f32_16x16x32_bf16 a[140:143], a[144:147], v[188:191], a[140:143]
 s_barrier
 v_add_f32 v24, v24, v132
 v_add_f32 v24, v24, v133
 v_mfma_f32_16x16x32_bf16 v[208:211], a[172:175], v[160:163], 0
 v_exp_f32 v136, v136
 v_mfma_f32_16x16x32_bf16 v[208:211], a[176:179], v[176:179], v[208:211]
 ds_read_b128 a[148:151], v10 offset:16384
 ds_read_b64_tr_b16 a[220:221], v9 offset:0
 v_mfma_f32_16x16x32_bf16 v[212:215], a[176:179], v[180:183], 0
 v_exp_f32 v137, v137
 v_mfma_f32_16x16x32_bf16 v[212:215], a[172:175], v[164:167], v[212:215]
 ds_read_b64_tr_b16 a[222:223], v9 offset:4096
 v_cvt_pk_bf16_f32 v56, v136, v137
 v_mfma_f32_16x16x32_bf16 v[216:219], a[172:175], v[168:171], 0
 v_exp_f32 v138, v138
 v_mfma_f32_16x16x32_bf16 v[216:219], a[176:179], v[184:187], v[216:219]
 buffer_load_dwordx4 v15, s[36:39], s85 offen offset:3072 lds
 v_mfma_f32_16x16x32_bf16 v[220:223], a[176:179], v[188:191], 0
 v_exp_f32 v139, v139
 v_mfma_f32_16x16x32_bf16 v[220:223], a[172:175], v[172:175], v[220:223]
 s_waitcnt lgkmcnt(3)
 v_cvt_pk_bf16_f32 v57, v138, v139
 v_add_f32 v24, v24, v134
 v_mfma_f32_16x16x32_bf16 v[144:147], a[228:231], v[64:67], v[192:195]
 v_exp_f32 v140, v140
 v_mfma_f32_16x16x32_bf16 v[144:147], a[232:235], v[80:83], v[144:147]
 ds_read_b128 a[152:155], v11 offset:16384
 ds_read_b64_tr_b16 a[224:225], v9 offset:8192
 v_mfma_f32_16x16x32_bf16 v[144:147], a[236:239], v[96:99], v[144:147]
 v_exp_f32 v141, v141
 v_mfma_f32_16x16x32_bf16 v[144:147], a[240:243], v[112:115], v[144:147]
 ds_read_b64_tr_b16 a[226:227], v9 offset:12288
 v_cvt_pk_bf16_f32 v60, v140, v141
 v_mfma_f32_16x16x32_bf16 v[148:151], a[240:243], v[116:119], v[196:199]
 v_exp_f32 v142, v142
 v_mfma_f32_16x16x32_bf16 v[148:151], a[236:239], v[100:103], v[148:151]
 v_add_f32 v24, v24, v135
 v_mfma_f32_16x16x32_bf16 v[148:151], a[232:235], v[84:87], v[148:151]
 v_exp_f32 v143, v143
 v_mfma_f32_16x16x32_bf16 v[148:151], a[228:231], v[68:71], v[148:151]
 v_cvt_pk_bf16_f32 v61, v142, v143
 v_mfma_f32_16x16x32_bf16 v[152:155], a[228:231], v[72:75], v[200:203]
 v_exp_f32 v144, v144
 v_mfma_f32_16x16x32_bf16 v[152:155], a[232:235], v[88:91], v[152:155]
 ds_read_b128 a[156:159], v12 offset:16384
 ds_read_b64_tr_b16 a[164:165], v2 offset:16384
 v_mfma_f32_16x16x32_bf16 v[152:155], a[236:239], v[104:107], v[152:155]
 v_exp_f32 v145, v145
 v_mfma_f32_16x16x32_bf16 v[152:155], a[240:243], v[120:123], v[152:155]
 ds_read_b64_tr_b16 a[166:167], v2 offset:20480
 v_cvt_pk_bf16_f32 v50, v144, v145
 v_mfma_f32_16x16x32_bf16 v[156:159], a[240:243], v[124:127], v[204:207]
 v_exp_f32 v146, v146
 v_mfma_f32_16x16x32_bf16 v[156:159], a[236:239], v[108:111], v[156:159]
 v_add_f32 v0, v0, v144
 v_add_f32 v0, v0, v145
 v_mfma_f32_16x16x32_bf16 v[156:159], a[232:235], v[92:95], v[156:159]
 v_exp_f32 v147, v147
 v_mfma_f32_16x16x32_bf16 v[156:159], a[228:231], v[76:79], v[156:159]
 s_waitcnt lgkmcnt(3)
 v_cvt_pk_bf16_f32 v51, v146, v147
 v_add_f32 v0, v0, v146
 v_mfma_f32_16x16x32_bf16 v[224:227], a[212:215], v[160:163], 0
 v_exp_f32 v148, v148
 v_mfma_f32_16x16x32_bf16 v[224:227], a[216:219], v[176:179], v[224:227]
 ds_read_b128 a[160:163], v13 offset:16384
 ds_read_b64_tr_b16 a[168:169], v2 offset:24576
 v_mfma_f32_16x16x32_bf16 v[228:231], a[216:219], v[180:183], 0
 v_exp_f32 v149, v149
 v_mfma_f32_16x16x32_bf16 v[228:231], a[212:215], v[164:167], v[228:231]
 ds_read_b64_tr_b16 a[170:171], v2 offset:28672
 v_cvt_pk_bf16_f32 v54, v148, v149
 v_mfma_f32_16x16x32_bf16 v[232:235], a[212:215], v[168:171], 0
 v_exp_f32 v150, v150
 v_mfma_f32_16x16x32_bf16 v[232:235], a[216:219], v[184:187], v[232:235]
 v_add_f32 v0, v0, v147
 v_add_f32 v24, v24, v148
 v_mfma_f32_16x16x32_bf16 v[236:239], a[216:219], v[188:191], 0
 v_exp_f32 v151, v151
 v_mfma_f32_16x16x32_bf16 v[236:239], a[212:215], v[172:175], v[236:239]
 v_cvt_pk_bf16_f32 v55, v150, v151
 v_add_f32 v24, v24, v149
 v_mfma_f32_16x16x32_bf16 v[240:243], a[220:223], v[160:163], 0
 v_exp_f32 v152, v152
 v_mfma_f32_16x16x32_bf16 v[240:243], a[224:227], v[176:179], v[240:243]
 ds_read_b128 a[228:231], v10 offset:20480
 ds_read_b64_tr_b16 a[172:173], v3 offset:16384
 v_mfma_f32_16x16x32_bf16 v[244:247], a[224:227], v[180:183], 0
 v_exp_f32 v153, v153
 v_mfma_f32_16x16x32_bf16 v[244:247], a[220:223], v[164:167], v[244:247]
 ds_read_b64_tr_b16 a[174:175], v3 offset:20480
 v_cvt_pk_bf16_f32 v58, v152, v153
 v_mfma_f32_16x16x32_bf16 v[248:251], a[220:223], v[168:171], 0
 s_add_u32 s85, s86, 16384
 v_exp_f32 v154, v154
 v_mfma_f32_16x16x32_bf16 v[248:251], a[224:227], v[184:187], v[248:251]
 v_add_f32 v24, v24, v150
 v_add_f32 v24, v24, v151
 v_mfma_f32_16x16x32_bf16 v[252:255], a[224:227], v[188:191], 0
 s_add_u32 m0, s87, 49152
 v_exp_f32 v155, v155
 v_mfma_f32_16x16x32_bf16 v[252:255], a[220:223], v[172:175], v[252:255]
 s_waitcnt lgkmcnt(3)
 v_cvt_pk_bf16_f32 v59, v154, v155
 v_mfma_f32_16x16x32_bf16 a[136:139], a[144:147], v[168:171], 0
 v_mfma_f32_16x16x32_bf16 a[136:139], a[144:147], v[184:187], a[136:139]
 s_or_b32 s88, s76, s81
 s_cmp_lg_u32 s88, 0
 s_cbranch_scc1 L_hflag
 s_lshl_b32 s88, s78, 2
 v_mov_b32 v21, 1
 s_mov_b64 exec, 1
 buffer_atomic_add v21, off, s[68:71], s88 offset:128
 s_mov_b64 exec, -1
L_hflag:
 v_mfma_f32_16x16x32_bf16 v[128:131], a[148:151], v[64:67], v[192:195]
 v_exp_f32 v156, v156
 v_mfma_f32_16x16x32_bf16 v[128:131], a[152:155], v[80:83], v[128:131]
 ds_read_b128 a[232:235], v11 offset:20480
 ds_read_b64_tr_b16 a[176:177], v3 offset:24576
 v_mfma_f32_16x16x32_bf16 v[128:131], a[156:159], v[96:99], v[128:131]
 v_exp_f32 v157, v157
 v_mfma_f32_16x16x32_bf16 v[128:131], a[160:163], v[112:115], v[128:131]
 ds_read_b64_tr_b16 a[178:179], v3 offset:28672
 v_cvt_pk_bf16_f32 v62, v156, v157
 v_mfma_f32_16x16x32_bf16 v[132:135], a[160:163], v[116:119], v[196:199]
 v_exp_f32 v158, v158
 v_mfma_f32_16x16x32_bf16 v[132:135], a[156:159], v[100:103], v[132:135]
 buffer_load_dwordx4 v16, s[32:35], s85 offen offset:0 lds
 v_mfma_f32_16x16x32_bf16 v[132:135], a[152:155], v[84:87], v[132:135]
 v_exp_f32 v159, v159
 v_mfma_f32_16x16x32_bf16 v[132:135], a[148:151], v[68:71], v[132:135]
 v_cvt_pk_bf16_f32 v63, v158, v159
 v_mfma_f32_16x16x32_bf16 v[136:139], a[148:151], v[72:75], v[200:203]
 v_exp_f32 v128, v128
 v_mfma_f32_16x16x32_bf16 v[136:139], a[152:155], v[88:91], v[136:139]
 ds_read_b128 a[236:239], v12 offset:20480
 ds_read_b64_tr_b16 a[212:213], v4 offset:16384
 v_mfma_f32_16x16x32_bf16 v[136:139], a[156:159], v[104:107], v[136:139]
 v_exp_f32 v129, v129
 v_mfma_f32_16x16x32_bf16 v[136:139], a[160:163], v[120:123], v[136:139]
 ds_read_b64_tr_b16 a[214:215], v4 offset:20480
 v_cvt_pk_bf16_f32 v160, v128, v129
 v_mfma_f32_16x16x32_bf16 v[140:143], a[160:163], v[124:127], v[204:207]
 v_exp_f32 v130, v130
 v_mfma_f32_16x16x32_bf16 v[140:143], a[156:159], v[108:111], v[140:143]
 buffer_load_dwordx4 v17, s[32:35], s85 offen offset:1024 lds
 v_mfma_f32_16x16x32_bf16 v[140:143], a[152:155], v[92:95], v[140:143]
 v_exp_f32 v131, v131
 v_mfma_f32_16x16x32_bf16 v[140:143], a[148:151], v[76:79], v[140:143]
 s_waitcnt lgkmcnt(3)
 v_cvt_pk_bf16_f32 v161, v130, v131
 v_add_f32 v0, v0, v128
 v_mfma_f32_16x16x32_bf16 a[0:3], a[164:167], v[32:35], a[0:3]
 v_exp_f32 v132, v132
 v_mfma_f32_16x16x32_bf16 a[0:3], a[168:171], v[48:51], a[0:3]
 ds_read_b128 a[240:243], v13 offset:20480
 ds_read_b64_tr_b16 a[216:217], v4 offset:24576
 v_mfma_f32_16x16x32_bf16 a[4:7], a[168:171], v[52:55], a[4:7]
 v_exp_f32 v133, v133
 v_mfma_f32_16x16x32_bf16 a[4:7], a[164:167], v[36:39], a[4:7]
 ds_read_b64_tr_b16 a[218:219], v4 offset:28672
 v_cvt_pk_bf16_f32 v164, v132, v133
 v_mfma_f32_16x16x32_bf16 a[8:11], a[164:167], v[40:43], a[8:11]
 v_exp_f32 v134, v134
 v_mfma_f32_16x16x32_bf16 a[8:11], a[168:171], v[56:59], a[8:11]
 buffer_load_dwordx4 v18, s[32:35], s85 offen offset:2048 lds
 v_mfma_f32_16x16x32_bf16 a[12:15], a[168:171], v[60:63], a[12:15]
 v_exp_f32 v135, v135
 v_mfma_f32_16x16x32_bf16 a[12:15], a[164:167], v[44:47], a[12:15]
 v_cvt_pk_bf16_f32 v165, v134, v135
 v_add_f32 v0, v0, v129
 v_mfma_f32_16x16x32_bf16 a[16:19], a[172:175], v[32:35], a[16:19]
 v_exp_f32 v136, v136
 v_mfma_f32_16x16x32_bf16 a[16:19], a[176:179], v[48:51], a[16:19]
 ds_read_b128 a[148:151], v10 offset:24576
 ds_read_b64_tr_b16 a[220:221], v5 offset:16384
 v_mfma_f32_16x16x32_bf16 a[20:23], a[176:179], v[52:55], a[20:23]
 v_exp_f32 v137, v137
 v_mfma_f32_16x16x32_bf16 a[20:23], a[172:175], v[36:39], a[20:23]
 ds_read_b64_tr_b16 a[222:223], v5 offset:20480
 v_cvt_pk_bf16_f32 v168, v136, v137
 v_mfma_f32_16x16x32_bf16 a[24:27], a[172:175], v[40:43], a[24:27]
 v_exp_f32 v138, v138
 v_mfma_f32_16x16x32_bf16 a[24:27], a[176:179], v[56:59], a[24:27]
 buffer_load_dwordx4 v19, s[32:35], s85 offen offset:3072 lds
 v_mfma_f32_16x16x32_bf16 a[28:31], a[176:179], v[60:63], a[28:31]
 v_exp_f32 v139, v139
 v_mfma_f32_16x16x32_bf16 a[28:31], a[172:175], v[44:47], a[28:31]
 s_waitcnt lgkmcnt(3)
 v_cvt_pk_bf16_f32 v169, v138, v139
 v_add_f32 v0, v0, v130
 v_mfma_f32_16x16x32_bf16 v[144:147], a[228:231], v[64:67], v[192:195]
 v_exp_f32 v140, v140
 v_mfma_f32_16x16x32_bf16 v[144:147], a[232:235], v[80:83], v[144:147]
 ds_read_b128 a[152:155], v11 offset:24576
 ds_read_b64_tr_b16 a[224:225], v5 offset:24576
 v_mfma_f32_16x16x32_bf16 v[144:147], a[236:239], v[96:99], v[144:147]
 v_exp_f32 v141, v141
 v_mfma_f32_16x16x32_bf16 v[144:147], a[240:243], v[112:115], v[144:147]
 ds_read_b64_tr_b16 a[226:227], v5 offset:28672
 v_cvt_pk_bf16_f32 v172, v140, v141
 v_mfma_f32_16x16x32_bf16 v[148:151], a[240:243], v[116:119], v[196:199]
 v_exp_f32 v142, v142
 v_mfma_f32_16x16x32_bf16 v[148:151], a[236:239], v[100:103], v[148:151]
 v_add_f32 v0, v0, v131
 v_add_f32 v24, v24, v132
 v_mfma_f32_16x16x32_bf16 v[148:151], a[232:235], v[84:87], v[148:151]
 v_exp_f32 v143, v143
 v_mfma_f32_16x16x32_bf16 v[148:151], a[228:231], v[68:71], v[148:151]
 v_cvt_pk_bf16_f32 v173, v142, v143
 v_add_f32 v24, v24, v133
 v_mfma_f32_16x16x32_bf16 v[152:155], a[228:231], v[72:75], v[200:203]
 v_exp_f32 v144, v144
 v_mfma_f32_16x16x32_bf16 v[152:155], a[232:235], v[88:91], v[152:155]
 ds_read_b128 a[156:159], v12 offset:24576
 ds_read_b64_tr_b16 a[164:165], v6 offset:16384
 v_mfma_f32_16x16x32_bf16 v[152:155], a[236:239], v[104:107], v[152:155]
 v_exp_f32 v145, v145
 v_mfma_f32_16x16x32_bf16 v[152:155], a[240:243], v[120:123], v[152:155]
 ds_read_b64_tr_b16 a[166:167], v6 offset:20480
 v_cvt_pk_bf16_f32 v162, v144, v145
 v_mfma_f32_16x16x32_bf16 v[156:159], a[240:243], v[124:127], v[204:207]
 v_exp_f32 v146, v146
 v_mfma_f32_16x16x32_bf16 v[156:159], a[236:239], v[108:111], v[156:159]
 v_add_f32 v24, v24, v134
 v_add_f32 v24, v24, v135
 v_mfma_f32_16x16x32_bf16 v[156:159], a[232:235], v[92:95], v[156:159]
 v_exp_f32 v147, v147
 v_mfma_f32_16x16x32_bf16 v[156:159], a[228:231], v[76:79], v[156:159]
 s_waitcnt lgkmcnt(3)
 v_cvt_pk_bf16_f32 v163, v146, v147
 v_add_f32 v0, v0, v144
 v_mfma_f32_16x16x32_bf16 a[32:35], a[212:215], v[32:35], a[32:35]
 v_exp_f32 v148, v148
 v_mfma_f32_16x16x32_bf16 a[32:35], a[216:219], v[48:51], a[32:35]
 ds_read_b128 a[160:163], v13 offset:24576
 ds_read_b64_tr_b16 a[168:169], v6 offset:24576
 v_mfma_f32_16x16x32_bf16 a[36:39], a[216:219], v[52:55], a[36:39]
 v_exp_f32 v149, v149
 v_mfma_f32_16x16x32_bf16 a[36:39], a[212:215], v[36:39], a[36:39]
 ds_read_b64_tr_b16 a[170:171], v6 offset:28672
 v_cvt_pk_bf16_f32 v166, v148, v149
 v_mfma_f32_16x16x32_bf16 a[40:43], a[212:215], v[40:43], a[40:43]
 v_exp_f32 v150, v150
 v_mfma_f32_16x16x32_bf16 a[40:43], a[216:219], v[56:59], a[40:43]
 v_add_f32 v0, v0, v145
 v_add_f32 v0, v0, v146
 v_mfma_f32_16x16x32_bf16 a[44:47], a[216:219], v[60:63], a[44:47]
 v_exp_f32 v151, v151
 v_mfma_f32_16x16x32_bf16 a[44:47], a[212:215], v[44:47], a[44:47]
 v_cvt_pk_bf16_f32 v167, v150, v151
 v_add_f32 v0, v0, v147
 v_mfma_f32_16x16x32_bf16 a[48:51], a[220:223], v[32:35], a[48:51]
 v_exp_f32 v152, v152
 v_mfma_f32_16x16x32_bf16 a[48:51], a[224:227], v[48:51], a[48:51]
 ds_read_b128 a[228:231], v10 offset:28672
 ds_read_b64_tr_b16 a[172:173], v7 offset:16384
 v_mfma_f32_16x16x32_bf16 a[52:55], a[224:227], v[52:55], a[52:55]
 v_exp_f32 v153, v153
 v_mfma_f32_16x16x32_bf16 a[52:55], a[220:223], v[36:39], a[52:55]
 ds_read_b64_tr_b16 a[174:175], v7 offset:20480
 v_cvt_pk_bf16_f32 v170, v152, v153
 v_mfma_f32_16x16x32_bf16 a[56:59], a[220:223], v[40:43], a[56:59]
 s_add_u32 m0, s87, 114688
 v_exp_f32 v154, v154
 v_mfma_f32_16x16x32_bf16 a[56:59], a[224:227], v[56:59], a[56:59]
 v_add_f32 v24, v24, v148
 v_add_f32 v24, v24, v149
 v_mfma_f32_16x16x32_bf16 a[60:63], a[224:227], v[60:63], a[60:63]
 v_exp_f32 v155, v155
 v_mfma_f32_16x16x32_bf16 a[60:63], a[220:223], v[44:47], a[60:63]
 s_waitcnt lgkmcnt(3)
 v_cvt_pk_bf16_f32 v171, v154, v155
 v_add_f32 v24, v24, v150
 v_mfma_f32_16x16x32_bf16 v[128:131], a[148:151], v[64:67], v[192:195]
 v_exp_f32 v156, v156
 v_mfma_f32_16x16x32_bf16 v[128:131], a[152:155], v[80:83], v[128:131]
 ds_read_b128 a[232:235], v11 offset:28672
 ds_read_b64_tr_b16 a[176:177], v7 offset:24576
 v_mfma_f32_16x16x32_bf16 v[128:131], a[156:159], v[96:99], v[128:131]
 v_exp_f32 v157, v157
 v_mfma_f32_16x16x32_bf16 v[128:131], a[160:163], v[112:115], v[128:131]
 ds_read_b64_tr_b16 a[178:179], v7 offset:28672
 v_cvt_pk_bf16_f32 v174, v156, v157
 v_mfma_f32_16x16x32_bf16 v[132:135], a[160:163], v[116:119], v[196:199]
 v_exp_f32 v158, v158
 v_mfma_f32_16x16x32_bf16 v[132:135], a[156:159], v[100:103], v[132:135]
 buffer_load_dwordx4 v14, s[36:39], s86 offen offset:0 lds
 v_mfma_f32_16x16x32_bf16 v[132:135], a[152:155], v[84:87], v[132:135]
 v_exp_f32 v159, v159
 v_mfma_f32_16x16x32_bf16 v[132:135], a[148:151], v[68:71], v[132:135]
 v_cvt_pk_bf16_f32 v175, v158, v159
 v_add_f32 v24, v24, v151
 v_mfma_f32_16x16x32_bf16 v[136:139], a[148:151], v[72:75], v[200:203]
 v_exp_f32 v128, v128
 v_mfma_f32_16x16x32_bf16 v[136:139], a[152:155], v[88:91], v[136:139]
 ds_read_b128 a[236:239], v12 offset:28672
 ds_read_b64_tr_b16 a[212:213], v8 offset:16384
 v_mfma_f32_16x16x32_bf16 v[136:139], a[156:159], v[104:107], v[136:139]
 v_exp_f32 v129, v129
 v_mfma_f32_16x16x32_bf16 v[136:139], a[160:163], v[120:123], v[136:139]
 ds_read_b64_tr_b16 a[214:215], v8 offset:20480
 v_cvt_pk_bf16_f32 v176, v128, v129
 v_mfma_f32_16x16x32_bf16 v[140:143], a[160:163], v[124:127], v[204:207]
 v_exp_f32 v130, v130
 v_mfma_f32_16x16x32_bf16 v[140:143], a[156:159], v[108:111], v[140:143]
 buffer_load_dwordx4 v15, s[36:39], s86 offen offset:1024 lds
 v_mfma_f32_16x16x32_bf16 v[140:143], a[152:155], v[92:95], v[140:143]
 v_exp_f32 v131, v131
 v_mfma_f32_16x16x32_bf16 v[140:143], a[148:151], v[76:79], v[140:143]
 s_waitcnt lgkmcnt(3)
 v_cvt_pk_bf16_f32 v177, v130, v131
 v_add_f32 v0, v0, v128
 v_mfma_f32_16x16x32_bf16 a[64:67], a[164:167], v[32:35], a[64:67]
 v_exp_f32 v132, v132
 v_mfma_f32_16x16x32_bf16 a[64:67], a[168:171], v[48:51], a[64:67]
 ds_read_b128 a[240:243], v13 offset:28672
 ds_read_b64_tr_b16 a[216:217], v8 offset:24576
 v_mfma_f32_16x16x32_bf16 a[68:71], a[168:171], v[52:55], a[68:71]
 v_exp_f32 v133, v133
 v_mfma_f32_16x16x32_bf16 a[68:71], a[164:167], v[36:39], a[68:71]
 ds_read_b64_tr_b16 a[218:219], v8 offset:28672
 v_cvt_pk_bf16_f32 v180, v132, v133
 v_mfma_f32_16x16x32_bf16 a[72:75], a[164:167], v[40:43], a[72:75]
 v_exp_f32 v134, v134
 v_mfma_f32_16x16x32_bf16 a[72:75], a[168:171], v[56:59], a[72:75]
 buffer_load_dwordx4 v14, s[36:39], s86 offen offset:2048 lds
 v_mfma_f32_16x16x32_bf16 a[76:79], a[168:171], v[60:63], a[76:79]
 v_exp_f32 v135, v135
 v_mfma_f32_16x16x32_bf16 a[76:79], a[164:167], v[44:47], a[76:79]
 v_cvt_pk_bf16_f32 v181, v134, v135
 v_add_f32 v0, v0, v129
 v_mfma_f32_16x16x32_bf16 a[140:143], a[144:147], v[44:47], a[140:143]
 s_waitcnt vmcnt(7)
 v_add_f32 v0, v0, v130
 v_add_f32 v0, v0, v131
 v_mfma_f32_16x16x32_bf16 a[140:143], a[144:147], v[60:63], a[140:143]
 s_barrier
 v_add_f32 v24, v24, v132
 v_add_f32 v24, v24, v133
 v_mfma_f32_16x16x32_bf16 v[208:211], a[172:175], v[32:35], v[208:211]
 v_exp_f32 v136, v136
 v_mfma_f32_16x16x32_bf16 v[208:211], a[176:179], v[48:51], v[208:211]
 ds_read_b128 a[148:151], v10 offset:32768
 ds_read_b64_tr_b16 a[220:221], v9 offset:16384
 v_mfma_f32_16x16x32_bf16 v[212:215], a[176:179], v[52:55], v[212:215]
 v_exp_f32 v137, v137
 v_mfma_f32_16x16x32_bf16 v[212:215], a[172:175], v[36:39], v[212:215]
 ds_read_b64_tr_b16 a[222:223], v9 offset:20480
 v_cvt_pk_bf16_f32 v184, v136, v137
 v_mfma_f32_16x16x32_bf16 v[216:219], a[172:175], v[40:43], v[216:219]
 v_exp_f32 v138, v138
 v_mfma_f32_16x16x32_bf16 v[216:219], a[176:179], v[56:59], v[216:219]
 buffer_load_dwordx4 v15, s[36:39], s86 offen offset:3072 lds
 v_mfma_f32_16x16x32_bf16 v[220:223], a[176:179], v[60:63], v[220:223]
 v_exp_f32 v139, v139
 v_mfma_f32_16x16x32_bf16 v[220:223], a[172:175], v[44:47], v[220:223]
 s_waitcnt lgkmcnt(3)
 v_cvt_pk_bf16_f32 v185, v138, v139
 v_add_f32 v24, v24, v134
 v_mfma_f32_16x16x32_bf16 v[144:147], a[228:231], v[64:67], v[192:195]
 v_exp_f32 v140, v140
 v_mfma_f32_16x16x32_bf16 v[144:147], a[232:235], v[80:83], v[144:147]
 ds_read_b128 a[152:155], v11 offset:32768
 ds_read_b64_tr_b16 a[224:225], v9 offset:24576
 v_mfma_f32_16x16x32_bf16 v[144:147], a[236:239], v[96:99], v[144:147]
 v_exp_f32 v141, v141
 v_mfma_f32_16x16x32_bf16 v[144:147], a[240:243], v[112:115], v[144:147]
 ds_read_b64_tr_b16 a[226:227], v9 offset:28672
 v_cvt_pk_bf16_f32 v188, v140, v141
 v_mfma_f32_16x16x32_bf16 v[148:151], a[240:243], v[116:119], v[196:199]
 v_exp_f32 v142, v142
 v_mfma_f32_16x16x32_bf16 v[148:151], a[236:239], v[100:103], v[148:151]
 v_add_f32 v24, v24, v135
 v_mfma_f32_16x16x32_bf16 v[148:151], a[232:235], v[84:87], v[148:151]
 v_exp_f32 v143, v143
 v_mfma_f32_16x16x32_bf16 v[148:151], a[228:231], v[68:71], v[148:151]
 v_cvt_pk_bf16_f32 v189, v142, v143
 v_mfma_f32_16x16x32_bf16 v[152:155], a[228:231], v[72:75], v[200:203]
 v_exp_f32 v144, v144
 v_mfma_f32_16x16x32_bf16 v[152:155], a[232:235], v[88:91], v[152:155]
 ds_read_b128 a[156:159], v12 offset:32768
 ds_read_b64_tr_b16 a[164:165], v2 offset:32768
 v_mfma_f32_16x16x32_bf16 v[152:155], a[236:239], v[104:107], v[152:155]
 v_exp_f32 v145, v145
 v_mfma_f32_16x16x32_bf16 v[152:155], a[240:243], v[120:123], v[152:155]
 ds_read_b64_tr_b16 a[166:167], v2 offset:36864
 v_cvt_pk_bf16_f32 v178, v144, v145
 v_mfma_f32_16x16x32_bf16 v[156:159], a[240:243], v[124:127], v[204:207]
 v_exp_f32 v146, v146
 v_mfma_f32_16x16x32_bf16 v[156:159], a[236:239], v[108:111], v[156:159]
 v_add_f32 v0, v0, v144
 v_add_f32 v0, v0, v145
 v_mfma_f32_16x16x32_bf16 v[156:159], a[232:235], v[92:95], v[156:159]
 v_exp_f32 v147, v147
 v_mfma_f32_16x16x32_bf16 v[156:159], a[228:231], v[76:79], v[156:159]
 s_waitcnt lgkmcnt(3)
 v_cvt_pk_bf16_f32 v179, v146, v147
 v_add_f32 v0, v0, v146
 v_mfma_f32_16x16x32_bf16 v[224:227], a[212:215], v[32:35], v[224:227]
 v_exp_f32 v148, v148
 v_mfma_f32_16x16x32_bf16 v[224:227], a[216:219], v[48:51], v[224:227]
 ds_read_b128 a[160:163], v13 offset:32768
 ds_read_b64_tr_b16 a[168:169], v2 offset:40960
 v_mfma_f32_16x16x32_bf16 v[228:231], a[216:219], v[52:55], v[228:231]
 v_exp_f32 v149, v149
 v_mfma_f32_16x16x32_bf16 v[228:231], a[212:215], v[36:39], v[228:231]
 ds_read_b64_tr_b16 a[170:171], v2 offset:45056
 v_cvt_pk_bf16_f32 v182, v148, v149
 v_mfma_f32_16x16x32_bf16 v[232:235], a[212:215], v[40:43], v[232:235]
 v_exp_f32 v150, v150
 v_mfma_f32_16x16x32_bf16 v[232:235], a[216:219], v[56:59], v[232:235]
 v_add_f32 v0, v0, v147
 v_add_f32 v24, v24, v148
 v_mfma_f32_16x16x32_bf16 v[236:239], a[216:219], v[60:63], v[236:239]
 v_exp_f32 v151, v151
 v_mfma_f32_16x16x32_bf16 v[236:239], a[212:215], v[44:47], v[236:239]
 v_cvt_pk_bf16_f32 v183, v150, v151
 v_add_f32 v24, v24, v149
 v_mfma_f32_16x16x32_bf16 v[240:243], a[220:223], v[32:35], v[240:243]
 v_exp_f32 v152, v152
 v_mfma_f32_16x16x32_bf16 v[240:243], a[224:227], v[48:51], v[240:243]
 ds_read_b128 a[228:231], v10 offset:36864
 ds_read_b64_tr_b16 a[172:173], v3 offset:32768
 v_mfma_f32_16x16x32_bf16 v[244:247], a[224:227], v[52:55], v[244:247]
 v_exp_f32 v153, v153
 v_mfma_f32_16x16x32_bf16 v[244:247], a[220:223], v[36:39], v[244:247]
 ds_read_b64_tr_b16 a[174:175], v3 offset:36864
 v_cvt_pk_bf16_f32 v186, v152, v153
 v_mfma_f32_16x16x32_bf16 v[248:251], a[220:223], v[40:43], v[248:251]
 s_add_u32 s86, s85, 16384
 v_exp_f32 v154, v154
 v_mfma_f32_16x16x32_bf16 v[248:251], a[224:227], v[56:59], v[248:251]
 v_add_f32 v24, v24, v150
 v_add_f32 v24, v24, v151
 v_mfma_f32_16x16x32_bf16 v[252:255], a[224:227], v[60:63], v[252:255]
 s_add_u32 m0, s87, 0
 v_exp_f32 v155, v155
 v_mfma_f32_16x16x32_bf16 v[252:255], a[220:223], v[44:47], v[252:255]
 s_waitcnt lgkmcnt(3)
 v_cvt_pk_bf16_f32 v187, v154, v155
 v_mfma_f32_16x16x32_bf16 a[136:139], a[144:147], v[40:43], a[136:139]
 v_mfma_f32_16x16x32_bf16 a[136:139], a[144:147], v[56:59], a[136:139]
 v_mfma_f32_16x16x32_bf16 v[128:131], a[148:151], v[64:67], v[192:195]
 v_exp_f32 v156, v156
 v_mfma_f32_16x16x32_bf16 v[128:131], a[152:155], v[80:83], v[128:131]
 ds_read_b128 a[232:235], v11 offset:36864
 ds_read_b64_tr_b16 a[176:177], v3 offset:40960
 v_mfma_f32_16x16x32_bf16 v[128:131], a[156:159], v[96:99], v[128:131]
 v_exp_f32 v157, v157
 v_mfma_f32_16x16x32_bf16 v[128:131], a[160:163], v[112:115], v[128:131]
 ds_read_b64_tr_b16 a[178:179], v3 offset:45056
 v_cvt_pk_bf16_f32 v190, v156, v157
 v_mfma_f32_16x16x32_bf16 v[132:135], a[160:163], v[116:119], v[196:199]
 v_exp_f32 v158, v158
 v_mfma_f32_16x16x32_bf16 v[132:135], a[156:159], v[100:103], v[132:135]
 buffer_load_dwordx4 v16, s[32:35], s86 offen offset:0 lds
 v_mfma_f32_16x16x32_bf16 v[132:135], a[152:155], v[84:87], v[132:135]
 v_exp_f32 v159, v159
 v_mfma_f32_16x16x32_bf16 v[132:135], a[148:151], v[68:71], v[132:135]
 v_cvt_pk_bf16_f32 v191, v158, v159
 v_mfma_f32_16x16x32_bf16 v[136:139], a[148:151], v[72:75], v[200:203]
 v_exp_f32 v128, v128
 v_mfma_f32_16x16x32_bf16 v[136:139], a[152:155], v[88:91], v[136:139]
 ds_read_b128 a[236:239], v12 offset:36864
 ds_read_b64_tr_b16 a[212:213], v4 offset:32768
 v_mfma_f32_16x16x32_bf16 v[136:139], a[156:159], v[104:107], v[136:139]
 v_exp_f32 v129, v129
 v_mfma_f32_16x16x32_bf16 v[136:139], a[160:163], v[120:123], v[136:139]
 ds_read_b64_tr_b16 a[214:215], v4 offset:36864
 v_cvt_pk_bf16_f32 v32, v128, v129
 v_mfma_f32_16x16x32_bf16 v[140:143], a[160:163], v[124:127], v[204:207]
 v_exp_f32 v130, v130
 v_mfma_f32_16x16x32_bf16 v[140:143], a[156:159], v[108:111], v[140:143]
 buffer_load_dwordx4 v17, s[32:35], s86 offen offset:1024 lds
 v_mfma_f32_16x16x32_bf16 v[140:143], a[152:155], v[92:95], v[140:143]
 v_exp_f32 v131, v131
 v_mfma_f32_16x16x32_bf16 v[140:143], a[148:151], v[76:79], v[140:143]
 s_waitcnt lgkmcnt(3)
 v_cvt_pk_bf16_f32 v33, v130, v131
 v_add_f32 v0, v0, v128
 v_mfma_f32_16x16x32_bf16 a[0:3], a[164:167], v[160:163], a[0:3]
 v_exp_f32 v132, v132
 v_mfma_f32_16x16x32_bf16 a[0:3], a[168:171], v[176:179], a[0:3]
 ds_read_b128 a[240:243], v13 offset:36864
 ds_read_b64_tr_b16 a[216:217], v4 offset:40960
 v_mfma_f32_16x16x32_bf16 a[4:7], a[168:171], v[180:183], a[4:7]
 v_exp_f32 v133, v133
 v_mfma_f32_16x16x32_bf16 a[4:7], a[164:167], v[164:167], a[4:7]
 ds_read_b64_tr_b16 a[218:219], v4 offset:45056
 v_cvt_pk_bf16_f32 v36, v132, v133
 v_mfma_f32_16x16x32_bf16 a[8:11], a[164:167], v[168:171], a[8:11]
 v_exp_f32 v134, v134
 v_mfma_f32_16x16x32_bf16 a[8:11], a[168:171], v[184:187], a[8:11]
 buffer_load_dwordx4 v18, s[32:35], s86 offen offset:2048 lds
 v_mfma_f32_16x16x32_bf16 a[12:15], a[168:171], v[188:191], a[12:15]
 v_exp_f32 v135, v135
 v_mfma_f32_16x16x32_bf16 a[12:15], a[164:167], v[172:175], a[12:15]
 v_cvt_pk_bf16_f32 v37, v134, v135
 v_add_f32 v0, v0, v129
 v_mfma_f32_16x16x32_bf16 a[16:19], a[172:175], v[160:163], a[16:19]
 v_exp_f32 v136, v136
 v_mfma_f32_16x16x32_bf16 a[16:19], a[176:179], v[176:179], a[16:19]
 ds_read_b128 a[148:151], v10 offset:40960
 ds_read_b64_tr_b16 a[220:221], v5 offset:32768
 v_mfma_f32_16x16x32_bf16 a[20:23], a[176:179], v[180:183], a[20:23]
 v_exp_f32 v137, v137
 v_mfma_f32_16x16x32_bf16 a[20:23], a[172:175], v[164:167], a[20:23]
 ds_read_b64_tr_b16 a[222:223], v5 offset:36864
 v_cvt_pk_bf16_f32 v40, v136, v137
 v_mfma_f32_16x16x32_bf16 a[24:27], a[172:175], v[168:171], a[24:27]
 v_exp_f32 v138, v138
 v_mfma_f32_16x16x32_bf16 a[24:27], a[176:179], v[184:187], a[24:27]
 buffer_load_dwordx4 v19, s[32:35], s86 offen offset:3072 lds
 v_mfma_f32_16x16x32_bf16 a[28:31], a[176:179], v[188:191], a[28:31]
 v_exp_f32 v139, v139
 v_mfma_f32_16x16x32_bf16 a[28:31], a[172:175], v[172:175], a[28:31]
 s_waitcnt lgkmcnt(3)
 v_cvt_pk_bf16_f32 v41, v138, v139
 v_add_f32 v0, v0, v130
 v_mfma_f32_16x16x32_bf16 v[144:147], a[228:231], v[64:67], v[192:195]
 v_exp_f32 v140, v140
 v_mfma_f32_16x16x32_bf16 v[144:147], a[232:235], v[80:83], v[144:147]
 ds_read_b128 a[152:155], v11 offset:40960
 ds_read_b64_tr_b16 a[224:225], v5 offset:40960
 v_mfma_f32_16x16x32_bf16 v[144:147], a[236:239], v[96:99], v[144:147]
 v_exp_f32 v141, v141
 v_mfma_f32_16x16x32_bf16 v[144:147], a[240:243], v[112:115], v[144:147]
 ds_read_b64_tr_b16 a[226:227], v5 offset:45056
 v_cvt_pk_bf16_f32 v44, v140, v141
 v_mfma_f32_16x16x32_bf16 v[148:151], a[240:243], v[116:119], v[196:199]
 v_exp_f32 v142, v142
 v_mfma_f32_16x16x32_bf16 v[148:151], a[236:239], v[100:103], v[148:151]
L_pg8:
 s_cbranch_execz L_site0
 v_add_f32 v0, v0, v131
 v_add_f32 v24, v24, v132
 v_mfma_f32_16x16x32_bf16 v[148:151], a[232:235], v[84:87], v[148:151]
 v_exp_f32 v143, v143
 v_mfma_f32_16x16x32_bf16 v[148:151], a[228:231], v[68:71], v[148:151]
 v_cvt_pk_bf16_f32 v45, v142, v143
 v_add_f32 v24, v24, v133
 v_mfma_f32_16x16x32_bf16 v[152:155], a[228:231], v[72:75], v[200:203]
 v_exp_f32 v144, v144
 v_mfma_f32_16x16x32_bf16 v[152:155], a[232:235], v[88:91], v[152:155]
 ds_read_b128 a[156:159], v12 offset:40960
 ds_read_b64_tr_b16 a[164:165], v6 offset:32768
 v_mfma_f32_16x16x32_bf16 v[152:155], a[236:239], v[104:107], v[152:155]
 v_exp_f32 v145, v145
 v_mfma_f32_16x16x32_bf16 v[152:155], a[240:243], v[120:123], v[152:155]
 ds_read_b64_tr_b16 a[166:167], v6 offset:36864
 v_cvt_pk_bf16_f32 v34, v144, v145
 v_mfma_f32_16x16x32_bf16 v[156:159], a[240:243], v[124:127], v[204:207]
 v_exp_f32 v146, v146
 v_mfma_f32_16x16x32_bf16 v[156:159], a[236:239], v[108:111], v[156:159]
 v_add_f32 v24, v24, v134
 v_add_f32 v24, v24, v135
 v_mfma_f32_16x16x32_bf16 v[156:159], a[232:235], v[92:95], v[156:159]
 v_exp_f32 v147, v147
 v_mfma_f32_16x16x32_bf16 v[156:159], a[228:231], v[76:79], v[156:159]
 s_waitcnt lgkmcnt(3)
 v_cvt_pk_bf16_f32 v35, v146, v147
 v_add_f32 v0, v0, v144
 v_mfma_f32_16x16x32_bf16 a[32:35], a[212:215], v[160:163], a[32:35]
 v_exp_f32 v148, v148
 v_mfma_f32_16x16x32_bf16 a[32:35], a[216:219], v[176:179], a[32:35]
 ds_read_b128 a[160:163], v13 offset:40960
 ds_read_b64_tr_b16 a[168:169], v6 offset:40960
 v_mfma_f32_16x16x32_bf16 a[36:39], a[216:219], v[180:183], a[36:39]
 v_exp_f32 v149, v149
 v_mfma_f32_16x16x32_bf16 a[36:39], a[212:215], v[164:167], a[36:39]
 ds_read_b64_tr_b16 a[170:171], v6 offset:45056
 v_cvt_pk_bf16_f32 v38, v148, v149
 v_mfma_f32_16x16x32_bf16 a[40:43], a[212:215], v[168:171], a[40:43]
 v_exp_f32 v150, v150
 v_mfma_f32_16x16x32_bf16 a[40:43], a[216:219], v[184:187], a[40:43]
 v_add_f32 v0, v0, v145
 v_add_f32 v0, v0, v146
 v_mfma_f32_16x16x32_bf16 a[44:47], a[216:219], v[188:191], a[44:47]
 v_exp_f32 v151, v151
 v_mfma_f32_16x16x32_bf16 a[44:47], a[212:215], v[172:175], a[44:47]
 v_cvt_pk_bf16_f32 v39, v150, v151
 v_add_f32 v0, v0, v147
 v_mfma_f32_16x16x32_bf16 a[48:51], a[220:223], v[160:163], a[48:51]
 v_exp_f32 v152, v152
 v_mfma_f32_16x16x32_bf16 a[48:51], a[224:227], v[176:179], a[48:51]
 ds_read_b128 a[228:231], v10 offset:45056
 ds_read_b64_tr_b16 a[172:173], v7 offset:32768
 v_mfma_f32_16x16x32_bf16 a[52:55], a[224:227], v[180:183], a[52:55]
 v_exp_f32 v153, v153
 v_mfma_f32_16x16x32_bf16 a[52:55], a[220:223], v[164:167], a[52:55]
 ds_read_b64_tr_b16 a[174:175], v7 offset:36864
 v_cvt_pk_bf16_f32 v42, v152, v153
 v_mfma_f32_16x16x32_bf16 a[56:59], a[220:223], v[168:171], a[56:59]
 s_add_u32 m0, s87, 65536
 v_exp_f32 v154, v154
 v_mfma_f32_16x16x32_bf16 a[56:59], a[224:227], v[184:187], a[56:59]
 v_add_f32 v24, v24, v148
 v_add_f32 v24, v24, v149
 v_mfma_f32_16x16x32_bf16 a[60:63], a[224:227], v[188:191], a[60:63]
 v_exp_f32 v155, v155
 v_mfma_f32_16x16x32_bf16 a[60:63], a[220:223], v[172:175], a[60:63]
 s_waitcnt lgkmcnt(3)
 v_cvt_pk_bf16_f32 v43, v154, v155
 v_add_f32 v24, v24, v150
 v_mfma_f32_16x16x32_bf16 v[128:131], a[148:151], v[64:67], v[192:195]
 v_exp_f32 v156, v156
 v_mfma_f32_16x16x32_bf16 v[128:131], a[152:155], v[80:83], v[128:131]
 ds_read_b128 a[232:235], v11 offset:45056
 ds_read_b64_tr_b16 a[176:177], v7 offset:40960
 v_mfma_f32_16x16x32_bf16 v[128:131], a[156:159], v[96:99], v[128:131]
 v_exp_f32 v157, v157
 v_mfma_f32_16x16x32_bf16 v[128:131], a[160:163], v[112:115], v[128:131]
 ds_read_b64_tr_b16 a[178:179], v7 offset:45056
 v_cvt_pk_bf16_f32 v46, v156, v157
 v_mfma_f32_16x16x32_bf16 v[132:135], a[160:163], v[116:119], v[196:199]
 v_exp_f32 v158, v158
 v_mfma_f32_16x16x32_bf16 v[132:135], a[156:159], v[100:103], v[132:135]
 buffer_load_dwordx4 v14, s[36:39], s85 offen offset:0 lds
 v_mfma_f32_16x16x32_bf16 v[132:135], a[152:155], v[84:87], v[132:135]
 v_exp_f32 v159, v159
 v_mfma_f32_16x16x32_bf16 v[132:135], a[148:151], v[68:71], v[132:135]
 v_cvt_pk_bf16_f32 v47, v158, v159
 v_add_f32 v24, v24, v151
 v_mfma_f32_16x16x32_bf16 v[136:139], a[148:151], v[72:75], v[200:203]
 v_exp_f32 v128, v128
 v_mfma_f32_16x16x32_bf16 v[136:139], a[152:155], v[88:91], v[136:139]
 ds_read_b128 a[236:239], v12 offset:45056
 ds_read_b64_tr_b16 a[212:213], v8 offset:32768
 v_mfma_f32_16x16x32_bf16 v[136:139], a[156:159], v[104:107], v[136:139]
 v_exp_f32 v129, v129
 v_mfma_f32_16x16x32_bf16 v[136:139], a[160:163], v[120:123], v[136:139]
 ds_read_b64_tr_b16 a[214:215], v8 offset:36864
 v_cvt_pk_bf16_f32 v48, v128, v129
 v_mfma_f32_16x16x32_bf16 v[140:143], a[160:163], v[124:127], v[204:207]
 v_exp_f32 v130, v130
 v_mfma_f32_16x16x32_bf16 v[140:143], a[156:159], v[108:111], v[140:143]
 buffer_load_dwordx4 v15, s[36:39], s85 offen offset:1024 lds
 v_mfma_f32_16x16x32_bf16 v[140:143], a[152:155], v[92:95], v[140:143]
 v_exp_f32 v131, v131
 v_mfma_f32_16x16x32_bf16 v[140:143], a[148:151], v[76:79], v[140:143]
 s_waitcnt lgkmcnt(3)
 v_cvt_pk_bf16_f32 v49, v130, v131
 v_add_f32 v0, v0, v128
 v_mfma_f32_16x16x32_bf16 a[64:67], a[164:167], v[160:163], a[64:67]
 v_exp_f32 v132, v132
 v_mfma_f32_16x16x32_bf16 a[64:67], a[168:171], v[176:179], a[64:67]
 ds_read_b128 a[240:243], v13 offset:45056
 ds_read_b64_tr_b16 a[216:217], v8 offset:40960
 v_mfma_f32_16x16x32_bf16 a[68:71], a[168:171], v[180:183], a[68:71]
 v_exp_f32 v133, v133
 v_mfma_f32_16x16x32_bf16 a[68:71], a[164:167], v[164:167], a[68:71]
 ds_read_b64_tr_b16 a[218:219], v8 offset:45056
 v_cvt_pk_bf16_f32 v52, v132, v133
 v_mfma_f32_16x16x32_bf16 a[72:75], a[164:167], v[168:171], a[72:75]
 v_exp_f32 v134, v134
 v_mfma_f32_16x16x32_bf16 a[72:75], a[168:171], v[184:187], a[72:75]
 buffer_load_dwordx4 v14, s[36:39], s85 offen offset:2048 lds
 v_mfma_f32_16x16x32_bf16 a[76:79], a[168:171], v[188:191], a[76:79]
 v_exp_f32 v135, v135
 v_mfma_f32_16x16x32_bf16 a[76:79], a[164:167], v[172:175], a[76:79]
 v_cvt_pk_bf16_f32 v53, v134, v135
 v_add_f32 v0, v0, v129
 v_mfma_f32_16x16x32_bf16 a[140:143], a[144:147], v[172:175], a[140:143]
 s_waitcnt vmcnt(7)
 v_add_f32 v0, v0, v130
 v_add_f32 v0, v0, v131
 v_mfma_f32_16x16x32_bf16 a[140:143], a[144:147], v[188:191], a[140:143]
 s_barrier
 v_add_f32 v24, v24, v132
 v_add_f32 v24, v24, v133
 v_mfma_f32_16x16x32_bf16 v[208:211], a[172:175], v[160:163], v[208:211]
 v_exp_f32 v136, v136
 v_mfma_f32_16x16x32_bf16 v[208:211], a[176:179], v[176:179], v[208:211]
 ds_read_b128 a[148:151], v10 offset:49152
 ds_read_b64_tr_b16 a[220:221], v9 offset:32768
 v_mfma_f32_16x16x32_bf16 v[212:215], a[176:179], v[180:183], v[212:215]
 v_exp_f32 v137, v137
 v_mfma_f32_16x16x32_bf16 v[212:215], a[172:175], v[164:167], v[212:215]
 ds_read_b64_tr_b16 a[222:223], v9 offset:36864
 v_cvt_pk_bf16_f32 v56, v136, v137
 v_mfma_f32_16x16x32_bf16 v[216:219], a[172:175], v[168:171], v[216:219]
 v_exp_f32 v138, v138
 v_mfma_f32_16x16x32_bf16 v[216:219], a[176:179], v[184:187], v[216:219]
 buffer_load_dwordx4 v15, s[36:39], s85 offen offset:3072 lds
 v_mfma_f32_16x16x32_bf16 v[220:223], a[176:179], v[188:191], v[220:223]
 v_exp_f32 v139, v139
 v_mfma_f32_16x16x32_bf16 v[220:223], a[172:175], v[172:175], v[220:223]
 s_waitcnt lgkmcnt(3)
 v_cvt_pk_bf16_f32 v57, v138, v139
 v_add_f32 v24, v24, v134
 v_mfma_f32_16x16x32_bf16 v[144:147], a[228:231], v[64:67], v[192:195]
 v_exp_f32 v140, v140
 v_mfma_f32_16x16x32_bf16 v[144:147], a[232:235], v[80:83], v[144:147]
 ds_read_b128 a[152:155], v11 offset:49152
 ds_read_b64_tr_b16 a[224:225], v9 offset:40960
 v_mfma_f32_16x16x32_bf16 v[144:147], a[236:239], v[96:99], v[144:147]
 v_exp_f32 v141, v141
 v_mfma_f32_16x16x32_bf16 v[144:147], a[240:243], v[112:115], v[144:147]
 ds_read_b64_tr_b16 a[226:227], v9 offset:45056
 v_cvt_pk_bf16_f32 v60, v140, v141
 v_mfma_f32_16x16x32_bf16 v[148:151], a[240:243], v[116:119], v[196:199]
 v_exp_f32 v142, v142
 v_mfma_f32_16x16x32_bf16 v[148:151], a[236:239], v[100:103], v[148:151]
 v_add_f32 v24, v24, v135
 v_mfma_f32_16x16x32_bf16 v[148:151], a[232:235], v[84:87], v[148:151]
 v_exp_f32 v143, v143
 v_mfma_f32_16x16x32_bf16 v[148:151], a[228:231], v[68:71], v[148:151]
 v_cvt_pk_bf16_f32 v61, v142, v143
 v_mfma_f32_16x16x32_bf16 v[152:155], a[228:231], v[72:75], v[200:203]
 v_exp_f32 v144, v144
 v_mfma_f32_16x16x32_bf16 v[152:155], a[232:235], v[88:91], v[152:155]
 ds_read_b128 a[156:159], v12 offset:49152
 ds_read_b64_tr_b16 a[164:165], v2 offset:49152
 v_mfma_f32_16x16x32_bf16 v[152:155], a[236:239], v[104:107], v[152:155]
 v_exp_f32 v145, v145
 v_mfma_f32_16x16x32_bf16 v[152:155], a[240:243], v[120:123], v[152:155]
 ds_read_b64_tr_b16 a[166:167], v2 offset:53248
 v_cvt_pk_bf16_f32 v50, v144, v145
 v_mfma_f32_16x16x32_bf16 v[156:159], a[240:243], v[124:127], v[204:207]
 v_exp_f32 v146, v146
 v_mfma_f32_16x16x32_bf16 v[156:159], a[236:239], v[108:111], v[156:159]
 v_add_f32 v0, v0, v144
 v_add_f32 v0, v0, v145
 v_mfma_f32_16x16x32_bf16 v[156:159], a[232:235], v[92:95], v[156:159]
 v_exp_f32 v147, v147
 v_mfma_f32_16x16x32_bf16 v[156:159], a[228:231], v[76:79], v[156:159]
 s_waitcnt lgkmcnt(3)
 v_cvt_pk_bf16_f32 v51, v146, v147
 v_add_f32 v0, v0, v146
 v_mfma_f32_16x16x32_bf16 v[224:227], a[212:215], v[160:163], v[224:227]
 v_exp_f32 v148, v148
 v_mfma_f32_16x16x32_bf16 v[224:227], a[216:219], v[176:179], v[224:227]
 ds_read_b128 a[160:163], v13 offset:49152
 ds_read_b64_tr_b16 a[168:169], v2 offset:57344
 v_mfma_f32_16x16x32_bf16 v[228:231], a[216:219], v[180:183], v[228:231]
 v_exp_f32 v149, v149
 v_mfma_f32_16x16x32_bf16 v[228:231], a[212:215], v[164:167], v[228:231]
 ds_read_b64_tr_b16 a[170:171], v2 offset:61440
 v_cvt_pk_bf16_f32 v54, v148, v149
 v_mfma_f32_16x16x32_bf16 v[232:235], a[212:215], v[168:171], v[232:235]
 v_exp_f32 v150, v150
 v_mfma_f32_16x16x32_bf16 v[232:235], a[216:219], v[184:187], v[232:235]
 s_mov_b32 s75, 0x40000000
 buffer_load_dword a255, off, s[44:47], s75
 v_mfma_f32_16x16x32_bf16 v[236:239], a[216:219], v[188:191], v[236:239]
 v_exp_f32 v151, v151
 v_mfma_f32_16x16x32_bf16 v[236:239], a[212:215], v[172:175], v[236:239]
 v_cvt_pk_bf16_f32 v55, v150, v151
 v_add_f32 v0, v0, v147
 v_mfma_f32_16x16x32_bf16 v[240:243], a[220:223], v[160:163], v[240:243]
 v_exp_f32 v152, v152
 v_mfma_f32_16x16x32_bf16 v[240:243], a[224:227], v[176:179], v[240:243]
 ds_read_b128 a[228:231], v10 offset:53248
 ds_read_b64_tr_b16 a[172:173], v3 offset:49152
 v_mfma_f32_16x16x32_bf16 v[244:247], a[224:227], v[180:183], v[244:247]
 v_exp_f32 v153, v153
 v_mfma_f32_16x16x32_bf16 v[244:247], a[220:223], v[164:167], v[244:247]
 ds_read_b64_tr_b16 a[174:175], v3 offset:53248
 v_cvt_pk_bf16_f32 v58, v152, v153
 v_mfma_f32_16x16x32_bf16 v[248:251], a[220:223], v[168:171], v[248:251]
 s_add_u32 s85, s86, 16384
 v_exp_f32 v154, v154
 v_mfma_f32_16x16x32_bf16 v[248:251], a[224:227], v[184:187], v[248:251]
 v_add_f32 v24, v24, v148
 v_add_f32 v24, v24, v149
 v_mfma_f32_16x16x32_bf16 v[252:255], a[224:227], v[188:191], v[252:255]
 s_add_u32 m0, s87, 16384
 v_exp_f32 v155, v155
 v_mfma_f32_16x16x32_bf16 v[252:255], a[220:223], v[172:175], v[252:255]
 s_waitcnt lgkmcnt(3)
 v_cvt_pk_bf16_f32 v59, v154, v155
 v_add_f32 v24, v24, v150
 v_mfma_f32_16x16x32_bf16 a[136:139], a[144:147], v[168:171], a[136:139]
 v_add_f32 v24, v24, v151
 v_mfma_f32_16x16x32_bf16 a[136:139], a[144:147], v[184:187], a[136:139]
 s_mul_i32 s92, s72, 8192
 s_lshl_b32 s88, s77, 19
 s_add_u32 s92, s92, s88
 s_lshr_b32 s88, s2, 3
 s_lshl_b32 s88, s88, 2
 s_add_u32 s88, s88, s76
 s_mul_i32 s93, s88, 14336
 v_and_b32 v21, 31, v1
 v_lshlrev_b32 v21, 7, v21
 v_min_u32 v23, 27, v1
 v_lshlrev_b32 v23, 7, v23
 s_lshl_b32 s90, s79, 2
 s_mov_b32 s82, 5
.p2align 3
L_loop:
 v_mfma_f32_16x16x32_bf16 v[128:131], a[148:151], v[64:67], v[192:195]
 v_exp_f32 v156, v156
 v_mfma_f32_16x16x32_bf16 v[128:131], a[152:155], v[80:83], v[128:131]
 ds_read_b128 a[232:235], v11 offset:53248
 ds_read_b64_tr_b16 a[176:177], v3 offset:57344
 v_mfma_f32_16x16x32_bf16 v[128:131], a[156:159], v[96:99], v[128:131]
 v_exp_f32 v157, v157
 v_mfma_f32_16x16x32_bf16 v[128:131], a[160:163], v[112:115], v[128:131]
 ds_read_b64_tr_b16 a[178:179], v3 offset:61440
 v_cvt_pk_bf16_f32 v62, v156, v157
 v_mfma_f32_16x16x32_bf16 v[132:135], a[160:163], v[116:119], v[196:199]
 v_exp_f32 v158, v158
 v_mfma_f32_16x16x32_bf16 v[132:135], a[156:159], v[100:103], v[132:135]
 buffer_load_dwordx4 v16, s[32:35], s85 offen offset:0 lds
 v_mfma_f32_16x16x32_bf16 v[132:135], a[152:155], v[84:87], v[132:135]
 v_exp_f32 v159, v159
 v_mfma_f32_16x16x32_bf16 v[132:135], a[148:151], v[68:71], v[132:135]
 v_cvt_pk_bf16_f32 v63, v158, v159
 v_mfma_f32_16x16x32_bf16 v[136:139], a[148:151], v[72:75], v[200:203]
 v_exp_f32 v128, v128
 v_mfma_f32_16x16x32_bf16 v[136:139], a[152:155], v[88:91], v[136:139]
 ds_read_b128 a[236:239], v12 offset:53248
 ds_read_b64_tr_b16 a[212:213], v4 offset:49152
 v_mfma_f32_16x16x32_bf16 v[136:139], a[156:159], v[104:107], v[136:139]
 v_exp_f32 v129, v129
 v_mfma_f32_16x16x32_bf16 v[136:139], a[160:163], v[120:123], v[136:139]
 ds_read_b64_tr_b16 a[214:215], v4 offset:53248
 v_cvt_pk_bf16_f32 v160, v128, v129
 v_mfma_f32_16x16x32_bf16 v[140:143], a[160:163], v[124:127], v[204:207]
 v_exp_f32 v130, v130
 v_mfma_f32_16x16x32_bf16 v[140:143], a[156:159], v[108:111], v[140:143]
 buffer_load_dwordx4 v17, s[32:35], s85 offen offset:1024 lds
 v_mfma_f32_16x16x32_bf16 v[140:143], a[152:155], v[92:95], v[140:143]
 v_exp_f32 v131, v131
 v_mfma_f32_16x16x32_bf16 v[140:143], a[148:151], v[76:79], v[140:143]
 s_waitcnt lgkmcnt(3)
 v_cvt_pk_bf16_f32 v161, v130, v131
 v_add_f32 v0, v0, v128
 v_mfma_f32_16x16x32_bf16 a[0:3], a[164:167], v[32:35], a[0:3]
 v_exp_f32 v132, v132
 v_mfma_f32_16x16x32_bf16 a[0:3], a[168:171], v[48:51], a[0:3]
 ds_read_b128 a[240:243], v13 offset:53248
 ds_read_b64_tr_b16 a[216:217], v4 offset:57344
 v_mfma_f32_16x16x32_bf16 a[4:7], a[168:171], v[52:55], a[4:7]
 v_exp_f32 v133, v133
 v_mfma_f32_16x16x32_bf16 a[4:7], a[164:167], v[36:39], a[4:7]
 ds_read_b64_tr_b16 a[218:219], v4 offset:61440
 v_cvt_pk_bf16_f32 v164, v132, v133
 v_mfma_f32_16x16x32_bf16 a[8:11], a[164:167], v[40:43], a[8:11]
 v_exp_f32 v134, v134
 v_mfma_f32_16x16x32_bf16 a[8:11], a[168:171], v[56:59], a[8:11]
 buffer_load_dwordx4 v18, s[32:35], s85 offen offset:2048 lds
 v_mfma_f32_16x16x32_bf16 a[12:15], a[168:171], v[60:63], a[12:15]
 v_exp_f32 v135, v135
 v_mfma_f32_16x16x32_bf16 a[12:15], a[164:167], v[44:47], a[12:15]
 s_cmp_eq_u32 s82, 0
 v_cvt_pk_bf16_f32 v165, v134, v135
 s_cselect_b32 s75, s92, 0x40000000
 s_cselect_b32 s73, s93, 0x40000000
 s_cselect_b32 s91, s90, 0x40000000
 v_mfma_f32_16x16x32_bf16 a[16:19], a[172:175], v[32:35], a[16:19]
 v_exp_f32 v136, v136
 v_mfma_f32_16x16x32_bf16 a[16:19], a[176:179], v[48:51], a[16:19]
 ds_read_b128 a[148:151], v10 offset:57344
 ds_read_b64_tr_b16 a[220:221], v5 offset:49152
 v_mfma_f32_16x16x32_bf16 a[20:23], a[176:179], v[52:55], a[20:23]
 v_exp_f32 v137, v137
 v_mfma_f32_16x16x32_bf16 a[20:23], a[172:175], v[36:39], a[20:23]
 ds_read_b64_tr_b16 a[222:223], v5 offset:53248
 v_cvt_pk_bf16_f32 v168, v136, v137
 v_mfma_f32_16x16x32_bf16 a[24:27], a[172:175], v[40:43], a[24:27]
 v_exp_f32 v138, v138
 v_mfma_f32_16x16x32_bf16 a[24:27], a[176:179], v[56:59], a[24:27]
 buffer_load_dwordx4 v19, s[32:35], s85 offen offset:3072 lds
 v_mfma_f32_16x16x32_bf16 a[28:31], a[176:179], v[60:63], a[28:31]
 v_exp_f32 v139, v139
 v_mfma_f32_16x16x32_bf16 a[28:31], a[172:175], v[44:47], a[28:31]
 s_waitcnt lgkmcnt(3)
 v_cvt_pk_bf16_f32 v169, v138, v139
 v_add_f32 v0, v0, v129
 v_mfma_f32_16x16x32_bf16 v[144:147], a[228:231], v[64:67], v[192:195]
 v_exp_f32 v140, v140
 v_mfma_f32_16x16x32_bf16 v[144:147], a[232:235], v[80:83], v[144:147]
 ds_read_b128 a[152:155], v11 offset:57344
 ds_read_b64_tr_b16 a[224:225], v5 offset:57344
 v_mfma_f32_16x16x32_bf16 v[144:147], a[236:239], v[96:99], v[144:147]
 v_exp_f32 v141, v141
 v_mfma_f32_16x16x32_bf16 v[144:147], a[240:243], v[112:115], v[144:147]
 ds_read_b64_tr_b16 a[226:227], v5 offset:61440
 v_cvt_pk_bf16_f32 v172, v140, v141
 v_mfma_f32_16x16x32_bf16 v[148:151], a[240:243], v[116:119], v[196:199]
 v_exp_f32 v142, v142
 v_mfma_f32_16x16x32_bf16 v[148:151], a[236:239], v[100:103], v[148:151]
 v_add_f32 v0, v0, v130
 v_add_f32 v0, v0, v131
 v_mfma_f32_16x16x32_bf16 v[148:151], a[232:235], v[84:87], v[148:151]
 v_exp_f32 v143, v143
 v_mfma_f32_16x16x32_bf16 v[148:151], a[228:231], v[68:71], v[148:151]
 v_cvt_pk_bf16_f32 v173, v142, v143
 v_add_f32 v24, v24, v132
 v_mfma_f32_16x16x32_bf16 v[152:155], a[228:231], v[72:75], v[200:203]
 v_exp_f32 v144, v144
 v_mfma_f32_16x16x32_bf16 v[152:155], a[232:235], v[88:91], v[152:155]
 ds_read_b128 a[156:159], v12 offset:57344
 ds_read_b64_tr_b16 a[164:165], v6 offset:49152
 v_mfma_f32_16x16x32_bf16 v[152:155], a[236:239], v[104:107], v[152:155]
 v_exp_f32 v145, v145
 v_mfma_f32_16x16x32_bf16 v[152:155], a[240:243], v[120:123], v[152:155]
 ds_read_b64_tr_b16 a[166:167], v6 offset:53248
 v_cvt_pk_bf16_f32 v162, v144, v145
 v_mfma_f32_16x16x32_bf16 v[156:159], a[240:243], v[124:127], v[204:207]
 v_exp_f32 v146, v146
 v_mfma_f32_16x16x32_bf16 v[156:159], a[236:239], v[108:111], v[156:159]
 v_add_f32 v24, v24, v133
 v_add_f32 v24, v24, v134
 v_mfma_f32_16x16x32_bf16 v[156:159], a[232:235], v[92:95], v[156:159]
 v_exp_f32 v147, v147
 v_mfma_f32_16x16x32_bf16 v[156:159], a[228:231], v[76:79], v[156:159]
 s_waitcnt lgkmcnt(3)
 v_cvt_pk_bf16_f32 v163, v146, v147
 v_add_f32 v24, v24, v135
 v_mfma_f32_16x16x32_bf16 a[32:35], a[212:215], v[32:35], a[32:35]
 v_exp_f32 v148, v148
 v_mfma_f32_16x16x32_bf16 a[32:35], a[216:219], v[48:51], a[32:35]
 ds_read_b128 a[160:163], v13 offset:57344
 ds_read_b64_tr_b16 a[168:169], v6 offset:57344
 v_mfma_f32_16x16x32_bf16 a[36:39], a[216:219], v[52:55], a[36:39]
 v_exp_f32 v149, v149
 v_mfma_f32_16x16x32_bf16 a[36:39], a[212:215], v[36:39], a[36:39]
 ds_read_b64_tr_b16 a[170:171], v6 offset:61440
 v_cvt_pk_bf16_f32 v166, v148, v149
 v_mfma_f32_16x16x32_bf16 a[40:43], a[212:215], v[40:43], a[40:43]
 v_exp_f32 v150, v150
 v_mfma_f32_16x16x32_bf16 a[40:43], a[216:219], v[56:59], a[40:43]
 v_add_f32 v0, v0, v144
 v_add_f32 v0, v0, v145
 v_mfma_f32_16x16x32_bf16 a[44:47], a[216:219], v[60:63], a[44:47]
 v_exp_f32 v151, v151
 v_mfma_f32_16x16x32_bf16 a[44:47], a[212:215], v[44:47], a[44:47]
 v_cvt_pk_bf16_f32 v167, v150, v151
 v_add_f32 v0, v0, v146
 v_mfma_f32_16x16x32_bf16 a[48:51], a[220:223], v[32:35], a[48:51]
 v_exp_f32 v152, v152
 v_mfma_f32_16x16x32_bf16 a[48:51], a[224:227], v[48:51], a[48:51]
 ds_read_b128 a[228:231], v10 offset:61440
 ds_read_b64_tr_b16 a[172:173], v7 offset:49152
 v_mfma_f32_16x16x32_bf16 a[52:55], a[224:227], v[52:55], a[52:55]
 v_exp_f32 v153, v153
 v_mfma_f32_16x16x32_bf16 a[52:55], a[220:223], v[36:39], a[52:55]
 ds_read_b64_tr_b16 a[174:175], v7 offset:53248
 v_cvt_pk_bf16_f32 v170, v152, v153
 v_mfma_f32_16x16x32_bf16 a[56:59], a[220:223], v[40:43], a[56:59]
 s_add_u32 m0, s87, 81920
 v_exp_f32 v154, v154
 v_mfma_f32_16x16x32_bf16 a[56:59], a[224:227], v[56:59], a[56:59]
 v_add_f32 v0, v0, v147
 v_add_f32 v24, v24, v148
 v_mfma_f32_16x16x32_bf16 a[60:63], a[224:227], v[60:63], a[60:63]
 v_exp_f32 v155, v155
 v_mfma_f32_16x16x32_bf16 a[60:63], a[220:223], v[44:47], a[60:63]
 s_waitcnt lgkmcnt(3)
 v_cvt_pk_bf16_f32 v171, v154, v155
 v_add_f32 v24, v24, v149
 v_mfma_f32_16x16x32_bf16 v[128:131], a[148:151], v[64:67], v[192:195]
 v_exp_f32 v156, v156
 v_mfma_f32_16x16x32_bf16 v[128:131], a[152:155], v[80:83], v[128:131]
 ds_read_b128 a[232:235], v11 offset:61440
 ds_read_b64_tr_b16 a[176:177], v7 offset:57344
 v_mfma_f32_16x16x32_bf16 v[128:131], a[156:159], v[96:99], v[128:131]
 v_exp_f32 v157, v157
 v_mfma_f32_16x16x32_bf16 v[128:131], a[160:163], v[112:115], v[128:131]
 ds_read_b64_tr_b16 a[178:179], v7 offset:61440
 v_cvt_pk_bf16_f32 v174, v156, v157
 v_mfma_f32_16x16x32_bf16 v[132:135], a[160:163], v[116:119], v[196:199]
 v_exp_f32 v158, v158
 v_mfma_f32_16x16x32_bf16 v[132:135], a[156:159], v[100:103], v[132:135]
 buffer_load_dwordx4 v14, s[36:39], s86 offen offset:0 lds
 v_mfma_f32_16x16x32_bf16 v[132:135], a[152:155], v[84:87], v[132:135]
 v_exp_f32 v159, v159
 v_mfma_f32_16x16x32_bf16 v[132:135], a[148:151], v[68:71], v[132:135]
 v_cvt_pk_bf16_f32 v175, v158, v159
 v_add_f32 v24, v24, v150
 v_mfma_f32_16x16x32_bf16 v[136:139], a[148:151], v[72:75], v[200:203]
 v_exp_f32 v128, v128
 v_mfma_f32_16x16x32_bf16 v[136:139], a[152:155], v[88:91], v[136:139]
 ds_read_b128 a[236:239], v12 offset:61440
 ds_read_b64_tr_b16 a[212:213], v8 offset:49152
 v_mfma_f32_16x16x32_bf16 v[136:139], a[156:159], v[104:107], v[136:139]
 v_exp_f32 v129, v129
 v_mfma_f32_16x16x32_bf16 v[136:139], a[160:163], v[120:123], v[136:139]
 ds_read_b64_tr_b16 a[214:215], v8 offset:53248
 v_cvt_pk_bf16_f32 v176, v128, v129
 v_mfma_f32_16x16x32_bf16 v[140:143], a[160:163], v[124:127], v[204:207]
 v_exp_f32 v130, v130
 v_mfma_f32_16x16x32_bf16 v[140:143], a[156:159], v[108:111], v[140:143]
 buffer_load_dwordx4 v15, s[36:39], s86 offen offset:1024 lds
 v_mfma_f32_16x16x32_bf16 v[140:143], a[152:155], v[92:95], v[140:143]
 v_exp_f32 v131, v131
 v_mfma_f32_16x16x32_bf16 v[140:143], a[148:151], v[76:79], v[140:143]
 s_waitcnt lgkmcnt(3)
 v_cvt_pk_bf16_f32 v177, v130, v131
 v_add_f32 v24, v24, v151
 v_mfma_f32_16x16x32_bf16 a[64:67], a[164:167], v[32:35], a[64:67]
 v_exp_f32 v132, v132
 v_mfma_f32_16x16x32_bf16 a[64:67], a[168:171], v[48:51], a[64:67]
 ds_read_b128 a[240:243], v13 offset:61440
 ds_read_b64_tr_b16 a[216:217], v8 offset:57344
 v_mfma_f32_16x16x32_bf16 a[68:71], a[168:171], v[52:55], a[68:71]
 v_exp_f32 v133, v133
 v_mfma_f32_16x16x32_bf16 a[68:71], a[164:167], v[36:39], a[68:71]
 ds_read_b64_tr_b16 a[218:219], v8 offset:61440
 v_cvt_pk_bf16_f32 v180, v132, v133
 v_mfma_f32_16x16x32_bf16 a[72:75], a[164:167], v[40:43], a[72:75]
 v_exp_f32 v134, v134
 v_mfma_f32_16x16x32_bf16 a[72:75], a[168:171], v[56:59], a[72:75]
 buffer_load_dwordx4 v14, s[36:39], s86 offen offset:2048 lds
 v_mfma_f32_16x16x32_bf16 a[76:79], a[168:171], v[60:63], a[76:79]
 v_exp_f32 v135, v135
 v_mfma_f32_16x16x32_bf16 a[76:79], a[164:167], v[44:47], a[76:79]
 v_cvt_pk_bf16_f32 v181, v134, v135
 v_add_f32 v0, v0, v128
 v_mfma_f32_16x16x32_bf16 a[140:143], a[144:147], v[44:47], a[140:143]
 s_waitcnt vmcnt(8)
 v_add_f32 v0, v0, v129
 v_add_f32 v0, v0, v130
 v_mfma_f32_16x16x32_bf16 a[140:143], a[144:147], v[60:63], a[140:143]
 s_barrier
 v_add_f32 v0, v0, v131
 v_add_f32 v24, v24, v132
 v_mfma_f32_16x16x32_bf16 v[208:211], a[172:175], v[32:35], v[208:211]
 v_exp_f32 v136, v136
 v_mfma_f32_16x16x32_bf16 v[208:211], a[176:179], v[48:51], v[208:211]
 ds_read_b128 a[148:151], v10 offset:0
 ds_read_b64_tr_b16 a[220:221], v9 offset:49152
 v_mfma_f32_16x16x32_bf16 v[212:215], a[176:179], v[52:55], v[212:215]
 v_exp_f32 v137, v137
 v_mfma_f32_16x16x32_bf16 v[212:215], a[172:175], v[36:39], v[212:215]
 ds_read_b64_tr_b16 a[222:223], v9 offset:53248
 v_cvt_pk_bf16_f32 v184, v136, v137
 v_mfma_f32_16x16x32_bf16 v[216:219], a[172:175], v[40:43], v[216:219]
 v_exp_f32 v138, v138
 v_mfma_f32_16x16x32_bf16 v[216:219], a[176:179], v[56:59], v[216:219]
 buffer_load_dwordx4 v15, s[36:39], s86 offen offset:3072 lds
 v_mfma_f32_16x16x32_bf16 v[220:223], a[176:179], v[60:63], v[220:223]
 v_exp_f32 v139, v139
 v_mfma_f32_16x16x32_bf16 v[220:223], a[172:175], v[44:47], v[220:223]
 s_waitcnt lgkmcnt(3)
 v_cvt_pk_bf16_f32 v185, v138, v139
 v_add_f32 v24, v24, v133
 v_mfma_f32_16x16x32_bf16 v[144:147], a[228:231], v[64:67], v[192:195]
 v_exp_f32 v140, v140
 v_mfma_f32_16x16x32_bf16 v[144:147], a[232:235], v[80:83], v[144:147]
 ds_read_b128 a[152:155], v11 offset:0
 ds_read_b64_tr_b16 a[224:225], v9 offset:57344
 v_mfma_f32_16x16x32_bf16 v[144:147], a[236:239], v[96:99], v[144:147]
 v_exp_f32 v141, v141
 v_mfma_f32_16x16x32_bf16 v[144:147], a[240:243], v[112:115], v[144:147]
 ds_read_b64_tr_b16 a[226:227], v9 offset:61440
 v_cvt_pk_bf16_f32 v188, v140, v141
 v_mfma_f32_16x16x32_bf16 v[148:151], a[240:243], v[116:119], v[196:199]
 v_exp_f32 v142, v142
 v_mfma_f32_16x16x32_bf16 v[148:151], a[236:239], v[100:103], v[148:151]
 v_add_f32 v24, v24, v134
 v_add_f32 v24, v24, v135
 v_mfma_f32_16x16x32_bf16 v[148:151], a[232:235], v[84:87], v[148:151]
 v_exp_f32 v143, v143
 v_mfma_f32_16x16x32_bf16 v[148:151], a[228:231], v[68:71], v[148:151]
 v_cvt_pk_bf16_f32 v189, v142, v143
 v_mfma_f32_16x16x32_bf16 v[152:155], a[228:231], v[72:75], v[200:203]
 v_exp_f32 v144, v144
 v_mfma_f32_16x16x32_bf16 v[152:155], a[232:235], v[88:91], v[152:155]
 ds_read_b128 a[156:159], v12 offset:0
 ds_read_b64_tr_b16 a[164:165], v2 offset:0
 v_mfma_f32_16x16x32_bf16 v[152:155], a[236:239], v[104:107], v[152:155]
 v_exp_f32 v145, v145
 v_mfma_f32_16x16x32_bf16 v[152:155], a[240:243], v[120:123], v[152:155]
 ds_read_b64_tr_b16 a[166:167], v2 offset:4096
 v_cvt_pk_bf16_f32 v178, v144, v145
 v_mfma_f32_16x16x32_bf16 v[156:159], a[240:243], v[124:127], v[204:207]
 v_exp_f32 v146, v146
 v_mfma_f32_16x16x32_bf16 v[156:159], a[236:239], v[108:111], v[156:159]
 v_add_f32 v0, v0, v144
 v_add_f32 v0, v0, v145
 v_mfma_f32_16x16x32_bf16 v[156:159], a[232:235], v[92:95], v[156:159]
 v_exp_f32 v147, v147
 v_mfma_f32_16x16x32_bf16 v[156:159], a[228:231], v[76:79], v[156:159]
 s_waitcnt lgkmcnt(3)
 v_cvt_pk_bf16_f32 v179, v146, v147
 v_add_f32 v0, v0, v146
 v_mfma_f32_16x16x32_bf16 v[224:227], a[212:215], v[32:35], v[224:227]
 v_exp_f32 v148, v148
 v_mfma_f32_16x16x32_bf16 v[224:227], a[216:219], v[48:51], v[224:227]
 ds_read_b128 a[160:163], v13 offset:0
 ds_read_b64_tr_b16 a[168:169], v2 offset:8192
 v_mfma_f32_16x16x32_bf16 v[228:231], a[216:219], v[52:55], v[228:231]
 v_exp_f32 v149, v149
 v_mfma_f32_16x16x32_bf16 v[228:231], a[212:215], v[36:39], v[228:231]
 ds_read_b64_tr_b16 a[170:171], v2 offset:12288
 v_cvt_pk_bf16_f32 v182, v148, v149
 v_mfma_f32_16x16x32_bf16 v[232:235], a[212:215], v[40:43], v[232:235]
 v_exp_f32 v150, v150
 v_mfma_f32_16x16x32_bf16 v[232:235], a[216:219], v[56:59], v[232:235]
 buffer_load_dword a252, v21, s[44:47], s75 offen offset:0
 v_mfma_f32_16x16x32_bf16 v[236:239], a[216:219], v[60:63], v[236:239]
 v_exp_f32 v151, v151
 v_mfma_f32_16x16x32_bf16 v[236:239], a[212:215], v[44:47], v[236:239]
 v_cvt_pk_bf16_f32 v183, v150, v151
 v_add_f32 v0, v0, v147
 v_mfma_f32_16x16x32_bf16 v[240:243], a[220:223], v[32:35], v[240:243]
 v_exp_f32 v152, v152
 v_mfma_f32_16x16x32_bf16 v[240:243], a[224:227], v[48:51], v[240:243]
 ds_read_b128 a[228:231], v10 offset:4096
 ds_read_b64_tr_b16 a[172:173], v3 offset:0
 v_mfma_f32_16x16x32_bf16 v[244:247], a[224:227], v[52:55], v[244:247]
 v_exp_f32 v153, v153
 v_mfma_f32_16x16x32_bf16 v[244:247], a[220:223], v[36:39], v[244:247]
 ds_read_b64_tr_b16 a[174:175], v3 offset:4096
 v_cvt_pk_bf16_f32 v186, v152, v153
 v_mfma_f32_16x16x32_bf16 v[248:251], a[220:223], v[40:43], v[248:251]
 s_add_u32 s86, s85, 16384
 v_exp_f32 v154, v154
 v_mfma_f32_16x16x32_bf16 v[248:251], a[224:227], v[56:59], v[248:251]
 v_add_f32 v24, v24, v148
 v_add_f32 v24, v24, v149
 v_mfma_f32_16x16x32_bf16 v[252:255], a[224:227], v[60:63], v[252:255]
 s_add_u32 m0, s87, 32768
 v_exp_f32 v155, v155
 v_mfma_f32_16x16x32_bf16 v[252:255], a[220:223], v[44:47], v[252:255]
 s_waitcnt lgkmcnt(3)
 v_cvt_pk_bf16_f32 v187, v154, v155
 v_add_f32 v24, v24, v150
 v_mfma_f32_16x16x32_bf16 a[136:139], a[144:147], v[40:43], a[136:139]
 v_add_f32 v24, v24, v151
 v_mfma_f32_16x16x32_bf16 a[136:139], a[144:147], v[56:59], a[136:139]
 v_mfma_f32_16x16x32_bf16 v[128:131], a[148:151], v[64:67], v[192:195]
 v_exp_f32 v156, v156
 v_mfma_f32_16x16x32_bf16 v[128:131], a[152:155], v[80:83], v[128:131]
 ds_read_b128 a[232:235], v11 offset:4096
 ds_read_b64_tr_b16 a[176:177], v3 offset:8192
 v_mfma_f32_16x16x32_bf16 v[128:131], a[156:159], v[96:99], v[128:131]
 v_exp_f32 v157, v157
 v_mfma_f32_16x16x32_bf16 v[128:131], a[160:163], v[112:115], v[128:131]
 ds_read_b64_tr_b16 a[178:179], v3 offset:12288
 v_cvt_pk_bf16_f32 v190, v156, v157
 v_mfma_f32_16x16x32_bf16 v[132:135], a[160:163], v[116:119], v[196:199]
 v_exp_f32 v158, v158
 v_mfma_f32_16x16x32_bf16 v[132:135], a[156:159], v[100:103], v[132:135]
 buffer_load_dwordx4 v16, s[32:35], s86 offen offset:0 lds
 v_mfma_f32_16x16x32_bf16 v[132:135], a[152:155], v[84:87], v[132:135]
 v_exp_f32 v159, v159
 v_mfma_f32_16x16x32_bf16 v[132:135], a[148:151], v[68:71], v[132:135]
 v_cvt_pk_bf16_f32 v191, v158, v159
 v_mfma_f32_16x16x32_bf16 v[136:139], a[148:151], v[72:75], v[200:203]
 v_exp_f32 v128, v128
 v_mfma_f32_16x16x32_bf16 v[136:139], a[152:155], v[88:91], v[136:139]
 ds_read_b128 a[236:239], v12 offset:4096
 ds_read_b64_tr_b16 a[212:213], v4 offset:0
 v_mfma_f32_16x16x32_bf16 v[136:139], a[156:159], v[104:107], v[136:139]
 v_exp_f32 v129, v129
 v_mfma_f32_16x16x32_bf16 v[136:139], a[160:163], v[120:123], v[136:139]
 ds_read_b64_tr_b16 a[214:215], v4 offset:4096
 v_cvt_pk_bf16_f32 v32, v128, v129
L_pg9:
 s_cbranch_execz L_pg13
 v_mfma_f32_16x16x32_bf16 v[140:143], a[160:163], v[124:127], v[204:207]
 v_exp_f32 v130, v130
 v_mfma_f32_16x16x32_bf16 v[140:143], a[156:159], v[108:111], v[140:143]
 buffer_load_dwordx4 v17, s[32:35], s86 offen offset:1024 lds
 v_mfma_f32_16x16x32_bf16 v[140:143], a[152:155], v[92:95], v[140:143]
 v_exp_f32 v131, v131
 v_mfma_f32_16x16x32_bf16 v[140:143], a[148:151], v[76:79], v[140:143]
 s_waitcnt lgkmcnt(3)
 v_cvt_pk_bf16_f32 v33, v130, v131
 v_add_f32 v0, v0, v128
 v_mfma_f32_16x16x32_bf16 a[0:3], a[164:167], v[160:163], a[0:3]
 v_exp_f32 v132, v132
 v_mfma_f32_16x16x32_bf16 a[0:3], a[168:171], v[176:179], a[0:3]
 ds_read_b128 a[240:243], v13 offset:4096
 ds_read_b64_tr_b16 a[216:217], v4 offset:8192
 v_mfma_f32_16x16x32_bf16 a[4:7], a[168:171], v[180:183], a[4:7]
 v_exp_f32 v133, v133
 v_mfma_f32_16x16x32_bf16 a[4:7], a[164:167], v[164:167], a[4:7]
 ds_read_b64_tr_b16 a[218:219], v4 offset:12288
 v_cvt_pk_bf16_f32 v36, v132, v133
 v_mfma_f32_16x16x32_bf16 a[8:11], a[164:167], v[168:171], a[8:11]
 v_exp_f32 v134, v134
 v_mfma_f32_16x16x32_bf16 a[8:11], a[168:171], v[184:187], a[8:11]
 buffer_load_dwordx4 v18, s[32:35], s86 offen offset:2048 lds
 v_mfma_f32_16x16x32_bf16 a[12:15], a[168:171], v[188:191], a[12:15]
 v_exp_f32 v135, v135
 v_mfma_f32_16x16x32_bf16 a[12:15], a[164:167], v[172:175], a[12:15]
 s_add_u32 s75, s75, 4096
 v_cvt_pk_bf16_f32 v37, v134, v135
 buffer_load_dword v22, off, s[68:71], s91 offset:128 sc1
 v_mfma_f32_16x16x32_bf16 a[16:19], a[172:175], v[160:163], a[16:19]
 v_exp_f32 v136, v136
 v_mfma_f32_16x16x32_bf16 a[16:19], a[176:179], v[176:179], a[16:19]
 ds_read_b128 a[148:151], v10 offset:8192
 ds_read_b64_tr_b16 a[220:221], v5 offset:0
 v_mfma_f32_16x16x32_bf16 a[20:23], a[176:179], v[180:183], a[20:23]
 v_exp_f32 v137, v137
 v_mfma_f32_16x16x32_bf16 a[20:23], a[172:175], v[164:167], a[20:23]
 ds_read_b64_tr_b16 a[222:223], v5 offset:4096
 v_cvt_pk_bf16_f32 v40, v136, v137
 v_mfma_f32_16x16x32_bf16 a[24:27], a[172:175], v[168:171], a[24:27]
 v_exp_f32 v138, v138
 v_mfma_f32_16x16x32_bf16 a[24:27], a[176:179], v[184:187], a[24:27]
 buffer_load_dwordx4 v19, s[32:35], s86 offen offset:3072 lds
 v_mfma_f32_16x16x32_bf16 a[28:31], a[176:179], v[188:191], a[28:31]
 v_exp_f32 v139, v139
 v_mfma_f32_16x16x32_bf16 a[28:31], a[172:175], v[172:175], a[28:31]
 s_waitcnt lgkmcnt(3)
 v_cvt_pk_bf16_f32 v41, v138, v139
 v_add_f32 v0, v0, v129
 v_mfma_f32_16x16x32_bf16 v[144:147], a[228:231], v[64:67], v[192:195]
 v_exp_f32 v140, v140
 v_mfma_f32_16x16x32_bf16 v[144:147], a[232:235], v[80:83], v[144:147]
 ds_read_b128 a[152:155], v11 offset:8192
 ds_read_b64_tr_b16 a[224:225], v5 offset:8192
 v_mfma_f32_16x16x32_bf16 v[144:147], a[236:239], v[96:99], v[144:147]
 v_exp_f32 v141, v141
 v_mfma_f32_16x16x32_bf16 v[144:147], a[240:243], v[112:115], v[144:147]
 ds_read_b64_tr_b16 a[226:227], v5 offset:12288
 v_cvt_pk_bf16_f32 v44, v140, v141
 v_mfma_f32_16x16x32_bf16 v[148:151], a[240:243], v[116:119], v[196:199]
 v_exp_f32 v142, v142
 v_mfma_f32_16x16x32_bf16 v[148:151], a[236:239], v[100:103], v[148:151]
 v_add_f32 v0, v0, v130
 v_add_f32 v0, v0, v131
 v_mfma_f32_16x16x32_bf16 v[148:151], a[232:235], v[84:87], v[148:151]
 v_exp_f32 v143, v143
 v_mfma_f32_16x16x32_bf16 v[148:151], a[228:231], v[68:71], v[148:151]
 v_cvt_pk_bf16_f32 v45, v142, v143
 v_add_f32 v24, v24, v132
 v_mfma_f32_16x16x32_bf16 v[152:155], a[228:231], v[72:75], v[200:203]
 v_exp_f32 v144, v144
 v_mfma_f32_16x16x32_bf16 v[152:155], a[232:235], v[88:91], v[152:155]
 ds_read_b128 a[156:159], v12 offset:8192
 ds_read_b64_tr_b16 a[164:165], v6 offset:0
 v_mfma_f32_16x16x32_bf16 v[152:155], a[236:239], v[104:107], v[152:155]
 v_exp_f32 v145, v145
 v_mfma_f32_16x16x32_bf16 v[152:155], a[240:243], v[120:123], v[152:155]
 ds_read_b64_tr_b16 a[166:167], v6 offset:4096
 v_cvt_pk_bf16_f32 v34, v144, v145
 v_mfma_f32_16x16x32_bf16 v[156:159], a[240:243], v[124:127], v[204:207]
 v_exp_f32 v146, v146
 v_mfma_f32_16x16x32_bf16 v[156:159], a[236:239], v[108:111], v[156:159]
 v_add_f32 v24, v24, v133
 v_add_f32 v24, v24, v134
 v_mfma_f32_16x16x32_bf16 v[156:159], a[232:235], v[92:95], v[156:159]
 v_exp_f32 v147, v147
 v_mfma_f32_16x16x32_bf16 v[156:159], a[228:231], v[76:79], v[156:159]
 s_waitcnt lgkmcnt(3)
 v_cvt_pk_bf16_f32 v35, v146, v147
 v_add_f32 v24, v24, v135
 v_mfma_f32_16x16x32_bf16 a[32:35], a[212:215], v[160:163], a[32:35]
 v_exp_f32 v148, v148
 v_mfma_f32_16x16x32_bf16 a[32:35], a[216:219], v[176:179], a[32:35]
 ds_read_b128 a[160:163], v13 offset:8192
 ds_read_b64_tr_b16 a[168:169], v6 offset:8192
 v_mfma_f32_16x16x32_bf16 a[36:39], a[216:219], v[180:183], a[36:39]
 v_exp_f32 v149, v149
 v_mfma_f32_16x16x32_bf16 a[36:39], a[212:215], v[164:167], a[36:39]
 ds_read_b64_tr_b16 a[170:171], v6 offset:12288
 v_cvt_pk_bf16_f32 v38, v148, v149
 v_mfma_f32_16x16x32_bf16 a[40:43], a[212:215], v[168:171], a[40:43]
 v_exp_f32 v150, v150
 v_mfma_f32_16x16x32_bf16 a[40:43], a[216:219], v[184:187], a[40:43]
 v_add_f32 v0, v0, v144
 v_add_f32 v0, v0, v145
 v_mfma_f32_16x16x32_bf16 a[44:47], a[216:219], v[188:191], a[44:47]
 v_exp_f32 v151, v151
 v_mfma_f32_16x16x32_bf16 a[44:47], a[212:215], v[172:175], a[44:47]
 v_cvt_pk_bf16_f32 v39, v150, v151
 v_add_f32 v0, v0, v146
 v_mfma_f32_16x16x32_bf16 a[48:51], a[220:223], v[160:163], a[48:51]
 v_exp_f32 v152, v152
 v_mfma_f32_16x16x32_bf16 a[48:51], a[224:227], v[176:179], a[48:51]
 ds_read_b128 a[228:231], v10 offset:12288
 ds_read_b64_tr_b16 a[172:173], v7 offset:0
 v_mfma_f32_16x16x32_bf16 a[52:55], a[224:227], v[180:183], a[52:55]
 v_exp_f32 v153, v153
 v_mfma_f32_16x16x32_bf16 a[52:55], a[220:223], v[164:167], a[52:55]
 ds_read_b64_tr_b16 a[174:175], v7 offset:4096
 v_cvt_pk_bf16_f32 v42, v152, v153
 v_mfma_f32_16x16x32_bf16 a[56:59], a[220:223], v[168:171], a[56:59]
 s_add_u32 m0, s87, 98304
 v_exp_f32 v154, v154
 v_mfma_f32_16x16x32_bf16 a[56:59], a[224:227], v[184:187], a[56:59]
 v_add_f32 v0, v0, v147
 v_add_f32 v24, v24, v148
 v_mfma_f32_16x16x32_bf16 a[60:63], a[224:227], v[188:191], a[60:63]
 v_exp_f32 v155, v155
 v_mfma_f32_16x16x32_bf16 a[60:63], a[220:223], v[172:175], a[60:63]
 s_waitcnt lgkmcnt(3)
 v_cvt_pk_bf16_f32 v43, v154, v155
 v_add_f32 v24, v24, v149
 v_mfma_f32_16x16x32_bf16 v[128:131], a[148:151], v[64:67], v[192:195]
 v_exp_f32 v156, v156
 v_mfma_f32_16x16x32_bf16 v[128:131], a[152:155], v[80:83], v[128:131]
 ds_read_b128 a[232:235], v11 offset:12288
 ds_read_b64_tr_b16 a[176:177], v7 offset:8192
 v_mfma_f32_16x16x32_bf16 v[128:131], a[156:159], v[96:99], v[128:131]
 v_exp_f32 v157, v157
 v_mfma_f32_16x16x32_bf16 v[128:131], a[160:163], v[112:115], v[128:131]
 ds_read_b64_tr_b16 a[178:179], v7 offset:12288
 v_cvt_pk_bf16_f32 v46, v156, v157
 v_mfma_f32_16x16x32_bf16 v[132:135], a[160:163], v[116:119], v[196:199]
 v_exp_f32 v158, v158
 v_mfma_f32_16x16x32_bf16 v[132:135], a[156:159], v[100:103], v[132:135]
 buffer_load_dwordx4 v14, s[36:39], s85 offen offset:0 lds
 v_mfma_f32_16x16x32_bf16 v[132:135], a[152:155], v[84:87], v[132:135]
 v_exp_f32 v159, v159
 v_mfma_f32_16x16x32_bf16 v[132:135], a[148:151], v[68:71], v[132:135]
 v_cvt_pk_bf16_f32 v47, v158, v159
 v_add_f32 v24, v24, v150
 v_mfma_f32_16x16x32_bf16 v[136:139], a[148:151], v[72:75], v[200:203]
 v_exp_f32 v128, v128
 v_mfma_f32_16x16x32_bf16 v[136:139], a[152:155], v[88:91], v[136:139]
 ds_read_b128 a[236:239], v12 offset:12288
 ds_read_b64_tr_b16 a[212:213], v8 offset:0
 v_mfma_f32_16x16x32_bf16 v[136:139], a[156:159], v[104:107], v[136:139]
 v_exp_f32 v129, v129
 v_mfma_f32_16x16x32_bf16 v[136:139], a[160:163], v[120:123], v[136:139]
 ds_read_b64_tr_b16 a[214:215], v8 offset:4096
 v_cvt_pk_bf16_f32 v48, v128, v129
 v_mfma_f32_16x16x32_bf16 v[140:143], a[160:163], v[124:127], v[204:207]
 v_exp_f32 v130, v130
 v_mfma_f32_16x16x32_bf16 v[140:143], a[156:159], v[108:111], v[140:143]
 buffer_load_dwordx4 v15, s[36:39], s85 offen offset:1024 lds
 v_mfma_f32_16x16x32_bf16 v[140:143], a[152:155], v[92:95], v[140:143]
 v_exp_f32 v131, v131
 v_mfma_f32_16x16x32_bf16 v[140:143], a[148:151], v[76:79], v[140:143]
 s_waitcnt lgkmcnt(3)
 v_cvt_pk_bf16_f32 v49, v130, v131
 v_add_f32 v24, v24, v151
 v_mfma_f32_16x16x32_bf16 a[64:67], a[164:167], v[160:163], a[64:67]
 v_exp_f32 v132, v132
 v_mfma_f32_16x16x32_bf16 a[64:67], a[168:171], v[176:179], a[64:67]
 ds_read_b128 a[240:243], v13 offset:12288
 ds_read_b64_tr_b16 a[216:217], v8 offset:8192
 v_mfma_f32_16x16x32_bf16 a[68:71], a[168:171], v[180:183], a[68:71]
 v_exp_f32 v133, v133
 v_mfma_f32_16x16x32_bf16 a[68:71], a[164:167], v[164:167], a[68:71]
 ds_read_b64_tr_b16 a[218:219], v8 offset:12288
 v_cvt_pk_bf16_f32 v52, v132, v133
 v_mfma_f32_16x16x32_bf16 a[72:75], a[164:167], v[168:171], a[72:75]
 v_exp_f32 v134, v134
 v_mfma_f32_16x16x32_bf16 a[72:75], a[168:171], v[184:187], a[72:75]
 buffer_load_dwordx4 v14, s[36:39], s85 offen offset:2048 lds
 v_mfma_f32_16x16x32_bf16 a[76:79], a[168:171], v[188:191], a[76:79]
 v_exp_f32 v135, v135
 v_mfma_f32_16x16x32_bf16 a[76:79], a[164:167], v[172:175], a[76:79]
 v_cvt_pk_bf16_f32 v53, v134, v135
 v_add_f32 v0, v0, v128
 v_mfma_f32_16x16x32_bf16 a[140:143], a[144:147], v[172:175], a[140:143]
 s_waitcnt vmcnt(9)
 v_add_f32 v0, v0, v129
 v_add_f32 v0, v0, v130
 v_mfma_f32_16x16x32_bf16 a[140:143], a[144:147], v[188:191], a[140:143]
 s_barrier
 v_add_f32 v0, v0, v131
 v_add_f32 v24, v24, v132
 v_mfma_f32_16x16x32_bf16 v[208:211], a[172:175], v[160:163], v[208:211]
 v_exp_f32 v136, v136
 v_mfma_f32_16x16x32_bf16 v[208:211], a[176:179], v[176:179], v[208:211]
 ds_read_b128 a[148:151], v10 offset:16384
 ds_read_b64_tr_b16 a[220:221], v9 offset:0
 v_mfma_f32_16x16x32_bf16 v[212:215], a[176:179], v[180:183], v[212:215]
 v_exp_f32 v137, v137
 v_mfma_f32_16x16x32_bf16 v[212:215], a[172:175], v[164:167], v[212:215]
 ds_read_b64_tr_b16 a[222:223], v9 offset:4096
 v_cvt_pk_bf16_f32 v56, v136, v137
 v_mfma_f32_16x16x32_bf16 v[216:219], a[172:175], v[168:171], v[216:219]
 v_exp_f32 v138, v138
 v_mfma_f32_16x16x32_bf16 v[216:219], a[176:179], v[184:187], v[216:219]
 buffer_load_dwordx4 v15, s[36:39], s85 offen offset:3072 lds
 v_mfma_f32_16x16x32_bf16 v[220:223], a[176:179], v[188:191], v[220:223]
 v_exp_f32 v139, v139
 v_mfma_f32_16x16x32_bf16 v[220:223], a[172:175], v[172:175], v[220:223]
 s_waitcnt lgkmcnt(3)
 v_cvt_pk_bf16_f32 v57, v138, v139
 v_add_f32 v24, v24, v133
 v_mfma_f32_16x16x32_bf16 v[144:147], a[228:231], v[64:67], v[192:195]
 v_exp_f32 v140, v140
 v_mfma_f32_16x16x32_bf16 v[144:147], a[232:235], v[80:83], v[144:147]
 ds_read_b128 a[152:155], v11 offset:16384
 ds_read_b64_tr_b16 a[224:225], v9 offset:8192
 v_mfma_f32_16x16x32_bf16 v[144:147], a[236:239], v[96:99], v[144:147]
 v_exp_f32 v141, v141
 v_mfma_f32_16x16x32_bf16 v[144:147], a[240:243], v[112:115], v[144:147]
 ds_read_b64_tr_b16 a[226:227], v9 offset:12288
 v_cvt_pk_bf16_f32 v60, v140, v141
 v_mfma_f32_16x16x32_bf16 v[148:151], a[240:243], v[116:119], v[196:199]
 v_exp_f32 v142, v142
 v_mfma_f32_16x16x32_bf16 v[148:151], a[236:239], v[100:103], v[148:151]
 v_add_f32 v24, v24, v134
 v_add_f32 v24, v24, v135
 v_mfma_f32_16x16x32_bf16 v[148:151], a[232:235], v[84:87], v[148:151]
 v_exp_f32 v143, v143
 v_mfma_f32_16x16x32_bf16 v[148:151], a[228:231], v[68:71], v[148:151]
 v_cvt_pk_bf16_f32 v61, v142, v143
 v_mfma_f32_16x16x32_bf16 v[152:155], a[228:231], v[72:75], v[200:203]
 v_exp_f32 v144, v144
 v_mfma_f32_16x16x32_bf16 v[152:155], a[232:235], v[88:91], v[152:155]
 ds_read_b128 a[156:159], v12 offset:16384
 ds_read_b64_tr_b16 a[164:165], v2 offset:16384
 v_mfma_f32_16x16x32_bf16 v[152:155], a[236:239], v[104:107], v[152:155]
 v_exp_f32 v145, v145
 v_mfma_f32_16x16x32_bf16 v[152:155], a[240:243], v[120:123], v[152:155]
 ds_read_b64_tr_b16 a[166:167], v2 offset:20480
 v_cvt_pk_bf16_f32 v50, v144, v145
 v_mfma_f32_16x16x32_bf16 v[156:159], a[240:243], v[124:127], v[204:207]
 v_exp_f32 v146, v146
 v_mfma_f32_16x16x32_bf16 v[156:159], a[236:239], v[108:111], v[156:159]
 v_add_f32 v0, v0, v144
 v_add_f32 v0, v0, v145
 v_mfma_f32_16x16x32_bf16 v[156:159], a[232:235], v[92:95], v[156:159]
 v_exp_f32 v147, v147
 v_mfma_f32_16x16x32_bf16 v[156:159], a[228:231], v[76:79], v[156:159]
 s_waitcnt lgkmcnt(3)
 v_cvt_pk_bf16_f32 v51, v146, v147
 v_add_f32 v0, v0, v146
 v_mfma_f32_16x16x32_bf16 v[224:227], a[212:215], v[160:163], v[224:227]
 v_exp_f32 v148, v148
 v_mfma_f32_16x16x32_bf16 v[224:227], a[216:219], v[176:179], v[224:227]
 ds_read_b128 a[160:163], v13 offset:16384
 ds_read_b64_tr_b16 a[168:169], v2 offset:24576
 v_mfma_f32_16x16x32_bf16 v[228:231], a[216:219], v[180:183], v[228:231]
 v_exp_f32 v149, v149
 v_mfma_f32_16x16x32_bf16 v[228:231], a[212:215], v[164:167], v[228:231]
 ds_read_b64_tr_b16 a[170:171], v2 offset:28672
 v_cvt_pk_bf16_f32 v54, v148, v149
 v_mfma_f32_16x16x32_bf16 v[232:235], a[212:215], v[168:171], v[232:235]
 v_exp_f32 v150, v150
 v_mfma_f32_16x16x32_bf16 v[232:235], a[216:219], v[184:187], v[232:235]
 buffer_load_dword a253, v21, s[44:47], s75 offen offset:0
 v_mfma_f32_16x16x32_bf16 v[236:239], a[216:219], v[188:191], v[236:239]
 v_exp_f32 v151, v151
 v_mfma_f32_16x16x32_bf16 v[236:239], a[212:215], v[172:175], v[236:239]
 v_cvt_pk_bf16_f32 v55, v150, v151
 v_add_f32 v0, v0, v147
 v_mfma_f32_16x16x32_bf16 v[240:243], a[220:223], v[160:163], v[240:243]
 v_exp_f32 v152, v152
 v_mfma_f32_16x16x32_bf16 v[240:243], a[224:227], v[176:179], v[240:243]
 ds_read_b128 a[228:231], v10 offset:20480
 ds_read_b64_tr_b16 a[172:173], v3 offset:16384
 v_mfma_f32_16x16x32_bf16 v[244:247], a[224:227], v[180:183], v[244:247]
 v_exp_f32 v153, v153
 v_mfma_f32_16x16x32_bf16 v[244:247], a[220:223], v[164:167], v[244:247]
 ds_read_b64_tr_b16 a[174:175], v3 offset:20480
 v_cvt_pk_bf16_f32 v58, v152, v153
 v_mfma_f32_16x16x32_bf16 v[248:251], a[220:223], v[168:171], v[248:251]
 s_add_u32 s85, s86, 16384
 v_exp_f32 v154, v154
 v_mfma_f32_16x16x32_bf16 v[248:251], a[224:227], v[184:187], v[248:251]
 v_add_f32 v24, v24, v148
 v_add_f32 v24, v24, v149
 v_mfma_f32_16x16x32_bf16 v[252:255], a[224:227], v[188:191], v[252:255]
 s_add_u32 m0, s87, 49152
 v_exp_f32 v155, v155
 v_mfma_f32_16x16x32_bf16 v[252:255], a[220:223], v[172:175], v[252:255]
 s_waitcnt lgkmcnt(3)
 v_cvt_pk_bf16_f32 v59, v154, v155
 v_add_f32 v24, v24, v150
 v_mfma_f32_16x16x32_bf16 a[136:139], a[144:147], v[168:171], a[136:139]
 v_add_f32 v24, v24, v151
 v_mfma_f32_16x16x32_bf16 a[136:139], a[144:147], v[184:187], a[136:139]
 v_mfma_f32_16x16x32_bf16 v[128:131], a[148:151], v[64:67], v[192:195]
 v_exp_f32 v156, v156
 v_mfma_f32_16x16x32_bf16 v[128:131], a[152:155], v[80:83], v[128:131]
 ds_read_b128 a[232:235], v11 offset:20480
 ds_read_b64_tr_b16 a[176:177], v3 offset:24576
 v_mfma_f32_16x16x32_bf16 v[128:131], a[156:159], v[96:99], v[128:131]
 v_exp_f32 v157, v157
 v_mfma_f32_16x16x32_bf16 v[128:131], a[160:163], v[112:115], v[128:131]
 ds_read_b64_tr_b16 a[178:179], v3 offset:28672
 v_cvt_pk_bf16_f32 v62, v156, v157
 v_mfma_f32_16x16x32_bf16 v[132:135], a[160:163], v[116:119], v[196:199]
 v_exp_f32 v158, v158
 v_mfma_f32_16x16x32_bf16 v[132:135], a[156:159], v[100:103], v[132:135]
 buffer_load_dwordx4 v16, s[32:35], s85 offen offset:0 lds
 v_mfma_f32_16x16x32_bf16 v[132:135], a[152:155], v[84:87], v[132:135]
 v_exp_f32 v159, v159
 v_mfma_f32_16x16x32_bf16 v[132:135], a[148:151], v[68:71], v[132:135]
 v_cvt_pk_bf16_f32 v63, v158, v159
 v_mfma_f32_16x16x32_bf16 v[136:139], a[148:151], v[72:75], v[200:203]
 v_exp_f32 v128, v128
 v_mfma_f32_16x16x32_bf16 v[136:139], a[152:155], v[88:91], v[136:139]
 ds_read_b128 a[236:239], v12 offset:20480
 ds_read_b64_tr_b16 a[212:213], v4 offset:16384
 v_mfma_f32_16x16x32_bf16 v[136:139], a[156:159], v[104:107], v[136:139]
 v_exp_f32 v129, v129
 v_mfma_f32_16x16x32_bf16 v[136:139], a[160:163], v[120:123], v[136:139]
 ds_read_b64_tr_b16 a[214:215], v4 offset:20480
 v_cvt_pk_bf16_f32 v160, v128, v129
 v_mfma_f32_16x16x32_bf16 v[140:143], a[160:163], v[124:127], v[204:207]
 v_exp_f32 v130, v130
 v_mfma_f32_16x16x32_bf16 v[140:143], a[156:159], v[108:111], v[140:143]
 buffer_load_dwordx4 v17, s[32:35], s85 offen offset:1024 lds
 v_mfma_f32_16x16x32_bf16 v[140:143], a[152:155], v[92:95], v[140:143]
 v_exp_f32 v131, v131
 v_mfma_f32_16x16x32_bf16 v[140:143], a[148:151], v[76:79], v[140:143]
 s_waitcnt lgkmcnt(3)
 v_cvt_pk_bf16_f32 v161, v130, v131
 v_add_f32 v0, v0, v128
 v_mfma_f32_16x16x32_bf16 a[0:3], a[164:167], v[32:35], a[0:3]
 v_exp_f32 v132, v132
 v_mfma_f32_16x16x32_bf16 a[0:3], a[168:171], v[48:51], a[0:3]
 ds_read_b128 a[240:243], v13 offset:20480
 ds_read_b64_tr_b16 a[216:217], v4 offset:24576
 v_mfma_f32_16x16x32_bf16 a[4:7], a[168:171], v[52:55], a[4:7]
 v_exp_f32 v133, v133
 v_mfma_f32_16x16x32_bf16 a[4:7], a[164:167], v[36:39], a[4:7]
 ds_read_b64_tr_b16 a[218:219], v4 offset:28672
 v_cvt_pk_bf16_f32 v164, v132, v133
 v_mfma_f32_16x16x32_bf16 a[8:11], a[164:167], v[40:43], a[8:11]
 v_exp_f32 v134, v134
 v_mfma_f32_16x16x32_bf16 a[8:11], a[168:171], v[56:59], a[8:11]
 buffer_load_dwordx4 v18, s[32:35], s85 offen offset:2048 lds
 v_mfma_f32_16x16x32_bf16 a[12:15], a[168:171], v[60:63], a[12:15]
 v_exp_f32 v135, v135
 v_mfma_f32_16x16x32_bf16 a[12:15], a[164:167], v[44:47], a[12:15]
 v_cvt_pk_bf16_f32 v165, v134, v135
 v_add_f32 v0, v0, v129
 v_mfma_f32_16x16x32_bf16 a[16:19], a[172:175], v[32:35], a[16:19]
 v_exp_f32 v136, v136
 v_mfma_f32_16x16x32_bf16 a[16:19], a[176:179], v[48:51], a[16:19]
 ds_read_b128 a[148:151], v10 offset:24576
 ds_read_b64_tr_b16 a[220:221], v5 offset:16384
 v_mfma_f32_16x16x32_bf16 a[20:23], a[176:179], v[52:55], a[20:23]
 v_exp_f32 v137, v137
 v_mfma_f32_16x16x32_bf16 a[20:23], a[172:175], v[36:39], a[20:23]
 ds_read_b64_tr_b16 a[222:223], v5 offset:20480
 v_cvt_pk_bf16_f32 v168, v136, v137
 v_mfma_f32_16x16x32_bf16 a[24:27], a[172:175], v[40:43], a[24:27]
 v_exp_f32 v138, v138
 v_mfma_f32_16x16x32_bf16 a[24:27], a[176:179], v[56:59], a[24:27]
 buffer_load_dwordx4 v19, s[32:35], s85 offen offset:3072 lds
 v_mfma_f32_16x16x32_bf16 a[28:31], a[176:179], v[60:63], a[28:31]
 v_exp_f32 v139, v139
 v_mfma_f32_16x16x32_bf16 a[28:31], a[172:175], v[44:47], a[28:31]
 s_waitcnt lgkmcnt(3)
 v_cvt_pk_bf16_f32 v169, v138, v139
 v_add_f32 v0, v0, v130
 v_mfma_f32_16x16x32_bf16 v[144:147], a[228:231], v[64:67], v[192:195]
 v_exp_f32 v140, v140
 v_mfma_f32_16x16x32_bf16 v[144:147], a[232:235], v[80:83], v[144:147]
 ds_read_b128 a[152:155], v11 offset:24576
 ds_read_b64_tr_b16 a[224:225], v5 offset:24576
 v_mfma_f32_16x16x32_bf16 v[144:147], a[236:239], v[96:99], v[144:147]
 v_exp_f32 v141, v141
 v_mfma_f32_16x16x32_bf16 v[144:147], a[240:243], v[112:115], v[144:147]
 ds_read_b64_tr_b16 a[226:227], v5 offset:28672
 v_cvt_pk_bf16_f32 v172, v140, v141
 v_mfma_f32_16x16x32_bf16 v[148:151], a[240:243], v[116:119], v[196:199]
 v_exp_f32 v142, v142
 v_mfma_f32_16x16x32_bf16 v[148:151], a[236:239], v[100:103], v[148:151]
 v_add_f32 v0, v0, v131
 v_add_f32 v24, v24, v132
 v_mfma_f32_16x16x32_bf16 v[148:151], a[232:235], v[84:87], v[148:151]
 v_exp_f32 v143, v143
 v_mfma_f32_16x16x32_bf16 v[148:151], a[228:231], v[68:71], v[148:151]
 v_cvt_pk_bf16_f32 v173, v142, v143
 v_add_f32 v24, v24, v133
 v_mfma_f32_16x16x32_bf16 v[152:155], a[228:231], v[72:75], v[200:203]
 v_exp_f32 v144, v144
 v_mfma_f32_16x16x32_bf16 v[152:155], a[232:235], v[88:91], v[152:155]
 ds_read_b128 a[156:159], v12 offset:24576
 ds_read_b64_tr_b16 a[164:165], v6 offset:16384
 v_mfma_f32_16x16x32_bf16 v[152:155], a[236:239], v[104:107], v[152:155]
 v_exp_f32 v145, v145
 v_mfma_f32_16x16x32_bf16 v[152:155], a[240:243], v[120:123], v[152:155]
 ds_read_b64_tr_b16 a[166:167], v6 offset:20480
 v_cvt_pk_bf16_f32 v162, v144, v145
 v_mfma_f32_16x16x32_bf16 v[156:159], a[240:243], v[124:127], v[204:207]
 v_exp_f32 v146, v146
 v_mfma_f32_16x16x32_bf16 v[156:159], a[236:239], v[108:111], v[156:159]
 v_add_f32 v24, v24, v134
 v_add_f32 v24, v24, v135
 v_mfma_f32_16x16x32_bf16 v[156:159], a[232:235], v[92:95], v[156:159]
 v_exp_f32 v147, v147
 v_mfma_f32_16x16x32_bf16 v[156:159], a[228:231], v[76:79], v[156:159]
 s_waitcnt lgkmcnt(3)
 v_cvt_pk_bf16_f32 v163, v146, v147
 v_add_f32 v0, v0, v144
 v_mfma_f32_16x16x32_bf16 a[32:35], a[212:215], v[32:35], a[32:35]
 v_exp_f32 v148, v148
 v_mfma_f32_16x16x32_bf16 a[32:35], a[216:219], v[48:51], a[32:35]
 ds_read_b128 a[160:163], v13 offset:24576
 ds_read_b64_tr_b16 a[168:169], v6 offset:24576
 v_mfma_f32_16x16x32_bf16 a[36:39], a[216:219], v[52:55], a[36:39]
 v_exp_f32 v149, v149
 v_mfma_f32_16x16x32_bf16 a[36:39], a[212:215], v[36:39], a[36:39]
 ds_read_b64_tr_b16 a[170:171], v6 offset:28672
 v_cvt_pk_bf16_f32 v166, v148, v149
 v_mfma_f32_16x16x32_bf16 a[40:43], a[212:215], v[40:43], a[40:43]
 v_exp_f32 v150, v150
 v_mfma_f32_16x16x32_bf16 a[40:43], a[216:219], v[56:59], a[40:43]
 v_add_f32 v0, v0, v145
 v_add_f32 v0, v0, v146
 v_mfma_f32_16x16x32_bf16 a[44:47], a[216:219], v[60:63], a[44:47]
 v_exp_f32 v151, v151
 v_mfma_f32_16x16x32_bf16 a[44:47], a[212:215], v[44:47], a[44:47]
 v_cvt_pk_bf16_f32 v167, v150, v151
 v_add_f32 v0, v0, v147
 v_mfma_f32_16x16x32_bf16 a[48:51], a[220:223], v[32:35], a[48:51]
 v_exp_f32 v152, v152
 v_mfma_f32_16x16x32_bf16 a[48:51], a[224:227], v[48:51], a[48:51]
 ds_read_b128 a[228:231], v10 offset:28672
 ds_read_b64_tr_b16 a[172:173], v7 offset:16384
 v_mfma_f32_16x16x32_bf16 a[52:55], a[224:227], v[52:55], a[52:55]
 v_exp_f32 v153, v153
 v_mfma_f32_16x16x32_bf16 a[52:55], a[220:223], v[36:39], a[52:55]
 ds_read_b64_tr_b16 a[174:175], v7 offset:20480
 v_cvt_pk_bf16_f32 v170, v152, v153
 v_mfma_f32_16x16x32_bf16 a[56:59], a[220:223], v[40:43], a[56:59]
 s_add_u32 m0, s87, 114688
 v_exp_f32 v154, v154
 v_mfma_f32_16x16x32_bf16 a[56:59], a[224:227], v[56:59], a[56:59]
 v_add_f32 v24, v24, v148
 v_add_f32 v24, v24, v149
 v_mfma_f32_16x16x32_bf16 a[60:63], a[224:227], v[60:63], a[60:63]
 v_exp_f32 v155, v155
 v_mfma_f32_16x16x32_bf16 a[60:63], a[220:223], v[44:47], a[60:63]
 s_waitcnt lgkmcnt(3)
 v_cvt_pk_bf16_f32 v171, v154, v155
 v_add_f32 v24, v24, v150
 v_mfma_f32_16x16x32_bf16 v[128:131], a[148:151], v[64:67], v[192:195]
 v_exp_f32 v156, v156
 v_mfma_f32_16x16x32_bf16 v[128:131], a[152:155], v[80:83], v[128:131]
 ds_read_b128 a[232:235], v11 offset:28672
 ds_read_b64_tr_b16 a[176:177], v7 offset:24576
 v_mfma_f32_16x16x32_bf16 v[128:131], a[156:159], v[96:99], v[128:131]
 v_exp_f32 v157, v157
 v_mfma_f32_16x16x32_bf16 v[128:131], a[160:163], v[112:115], v[128:131]
 ds_read_b64_tr_b16 a[178:179], v7 offset:28672
 v_cvt_pk_bf16_f32 v174, v156, v157
 v_mfma_f32_16x16x32_bf16 v[132:135], a[160:163], v[116:119], v[196:199]
 v_exp_f32 v158, v158
 v_mfma_f32_16x16x32_bf16 v[132:135], a[156:159], v[100:103], v[132:135]
 buffer_load_dwordx4 v14, s[36:39], s86 offen offset:0 lds
 v_mfma_f32_16x16x32_bf16 v[132:135], a[152:155], v[84:87], v[132:135]
 v_exp_f32 v159, v159
 v_mfma_f32_16x16x32_bf16 v[132:135], a[148:151], v[68:71], v[132:135]
 v_cvt_pk_bf16_f32 v175, v158, v159
 v_add_f32 v24, v24, v151
 v_mfma_f32_16x16x32_bf16 v[136:139], a[148:151], v[72:75], v[200:203]
 v_exp_f32 v128, v128
 v_mfma_f32_16x16x32_bf16 v[136:139], a[152:155], v[88:91], v[136:139]
 ds_read_b128 a[236:239], v12 offset:28672
 ds_read_b64_tr_b16 a[212:213], v8 offset:16384
 v_mfma_f32_16x16x32_bf16 v[136:139], a[156:159], v[104:107], v[136:139]
 v_exp_f32 v129, v129
 v_mfma_f32_16x16x32_bf16 v[136:139], a[160:163], v[120:123], v[136:139]
 ds_read_b64_tr_b16 a[214:215], v8 offset:20480
 v_cvt_pk_bf16_f32 v176, v128, v129
 v_mfma_f32_16x16x32_bf16 v[140:143], a[160:163], v[124:127], v[204:207]
 v_exp_f32 v130, v130
 v_mfma_f32_16x16x32_bf16 v[140:143], a[156:159], v[108:111], v[140:143]
 buffer_load_dwordx4 v15, s[36:39], s86 offen offset:1024 lds
 v_mfma_f32_16x16x32_bf16 v[140:143], a[152:155], v[92:95], v[140:143]
 v_exp_f32 v131, v131
 v_mfma_f32_16x16x32_bf16 v[140:143], a[148:151], v[76:79], v[140:143]
 s_waitcnt lgkmcnt(3)
 v_cvt_pk_bf16_f32 v177, v130, v131
 v_add_f32 v0, v0, v128
 v_mfma_f32_16x16x32_bf16 a[64:67], a[164:167], v[32:35], a[64:67]
 v_exp_f32 v132, v132
 v_mfma_f32_16x16x32_bf16 a[64:67], a[168:171], v[48:51], a[64:67]
 ds_read_b128 a[240:243], v13 offset:28672
 ds_read_b64_tr_b16 a[216:217], v8 offset:24576
 v_mfma_f32_16x16x32_bf16 a[68:71], a[168:171], v[52:55], a[68:71]
 v_exp_f32 v133, v133
 v_mfma_f32_16x16x32_bf16 a[68:71], a[164:167], v[36:39], a[68:71]
 ds_read_b64_tr_b16 a[218:219], v8 offset:28672
 v_cvt_pk_bf16_f32 v180, v132, v133
 v_mfma_f32_16x16x32_bf16 a[72:75], a[164:167], v[40:43], a[72:75]
 v_exp_f32 v134, v134
 v_mfma_f32_16x16x32_bf16 a[72:75], a[168:171], v[56:59], a[72:75]
 buffer_load_dwordx4 v14, s[36:39], s86 offen offset:2048 lds
 v_mfma_f32_16x16x32_bf16 a[76:79], a[168:171], v[60:63], a[76:79]
 v_exp_f32 v135, v135
 v_mfma_f32_16x16x32_bf16 a[76:79], a[164:167], v[44:47], a[76:79]
 v_cvt_pk_bf16_f32 v181, v134, v135
 v_add_f32 v0, v0, v129
 v_mfma_f32_16x16x32_bf16 a[140:143], a[144:147], v[44:47], a[140:143]
 s_waitcnt vmcnt(8)
 v_add_f32 v0, v0, v130
 v_add_f32 v0, v0, v131
 v_mfma_f32_16x16x32_bf16 a[140:143], a[144:147], v[60:63], a[140:143]
 s_barrier
 v_add_f32 v24, v24, v132
 v_add_f32 v24, v24, v133
 v_mfma_f32_16x16x32_bf16 v[208:211], a[172:175], v[32:35], v[208:211]
 v_exp_f32 v136, v136
 v_mfma_f32_16x16x32_bf16 v[208:211], a[176:179], v[48:51], v[208:211]
 ds_read_b128 a[148:151], v10 offset:32768
 ds_read_b64_tr_b16 a[220:221], v9 offset:16384
 v_mfma_f32_16x16x32_bf16 v[212:215], a[176:179], v[52:55], v[212:215]
 v_exp_f32 v137, v137
 v_mfma_f32_16x16x32_bf16 v[212:215], a[172:175], v[36:39], v[212:215]
 ds_read_b64_tr_b16 a[222:223], v9 offset:20480
 v_cvt_pk_bf16_f32 v184, v136, v137
 v_mfma_f32_16x16x32_bf16 v[216:219], a[172:175], v[40:43], v[216:219]
 v_exp_f32 v138, v138
 v_mfma_f32_16x16x32_bf16 v[216:219], a[176:179], v[56:59], v[216:219]
 buffer_load_dwordx4 v15, s[36:39], s86 offen offset:3072 lds
 v_mfma_f32_16x16x32_bf16 v[220:223], a[176:179], v[60:63], v[220:223]
 v_exp_f32 v139, v139
 v_mfma_f32_16x16x32_bf16 v[220:223], a[172:175], v[44:47], v[220:223]
 s_waitcnt lgkmcnt(3)
 v_cvt_pk_bf16_f32 v185, v138, v139
 v_add_f32 v24, v24, v134
 v_mfma_f32_16x16x32_bf16 v[144:147], a[228:231], v[64:67], v[192:195]
 v_exp_f32 v140, v140
 v_mfma_f32_16x16x32_bf16 v[144:147], a[232:235], v[80:83], v[144:147]
 ds_read_b128 a[152:155], v11 offset:32768
 ds_read_b64_tr_b16 a[224:225], v9 offset:24576
 v_mfma_f32_16x16x32_bf16 v[144:147], a[236:239], v[96:99], v[144:147]
 v_exp_f32 v141, v141
 v_mfma_f32_16x16x32_bf16 v[144:147], a[240:243], v[112:115], v[144:147]
 ds_read_b64_tr_b16 a[226:227], v9 offset:28672
 v_cvt_pk_bf16_f32 v188, v140, v141
 v_mfma_f32_16x16x32_bf16 v[148:151], a[240:243], v[116:119], v[196:199]
 v_exp_f32 v142, v142
 v_mfma_f32_16x16x32_bf16 v[148:151], a[236:239], v[100:103], v[148:151]
 v_add_f32 v24, v24, v135
 v_mfma_f32_16x16x32_bf16 v[148:151], a[232:235], v[84:87], v[148:151]
 v_exp_f32 v143, v143
 v_mfma_f32_16x16x32_bf16 v[148:151], a[228:231], v[68:71], v[148:151]
 v_cvt_pk_bf16_f32 v189, v142, v143
 v_mfma_f32_16x16x32_bf16 v[152:155], a[228:231], v[72:75], v[200:203]
 v_exp_f32 v144, v144
 v_mfma_f32_16x16x32_bf16 v[152:155], a[232:235], v[88:91], v[152:155]
 ds_read_b128 a[156:159], v12 offset:32768
 ds_read_b64_tr_b16 a[164:165], v2 offset:32768
 v_mfma_f32_16x16x32_bf16 v[152:155], a[236:239], v[104:107], v[152:155]
 v_exp_f32 v145, v145
 v_mfma_f32_16x16x32_bf16 v[152:155], a[240:243], v[120:123], v[152:155]
 ds_read_b64_tr_b16 a[166:167], v2 offset:36864
 v_cvt_pk_bf16_f32 v178, v144, v145
 v_mfma_f32_16x16x32_bf16 v[156:159], a[240:243], v[124:127], v[204:207]
 v_exp_f32 v146, v146
 v_mfma_f32_16x16x32_bf16 v[156:159], a[236:239], v[108:111], v[156:159]
 v_add_f32 v0, v0, v144
 v_add_f32 v0, v0, v145
 v_mfma_f32_16x16x32_bf16 v[156:159], a[232:235], v[92:95], v[156:159]
 v_exp_f32 v147, v147
 v_mfma_f32_16x16x32_bf16 v[156:159], a[228:231], v[76:79], v[156:159]
 s_waitcnt lgkmcnt(3)
 v_cvt_pk_bf16_f32 v179, v146, v147
 v_add_f32 v0, v0, v146
 v_mfma_f32_16x16x32_bf16 v[224:227], a[212:215], v[32:35], v[224:227]
 v_exp_f32 v148, v148
 v_mfma_f32_16x16x32_bf16 v[224:227], a[216:219], v[48:51], v[224:227]
 ds_read_b128 a[160:163], v13 offset:32768
 ds_read_b64_tr_b16 a[168:169], v2 offset:40960
 v_mfma_f32_16x16x32_bf16 v[228:231], a[216:219], v[52:55], v[228:231]
 v_exp_f32 v149, v149
 v_mfma_f32_16x16x32_bf16 v[228:231], a[212:215], v[36:39], v[228:231]
 ds_read_b64_tr_b16 a[170:171], v2 offset:45056
 v_cvt_pk_bf16_f32 v182, v148, v149
 v_mfma_f32_16x16x32_bf16 v[232:235], a[212:215], v[40:43], v[232:235]
 v_exp_f32 v150, v150
 v_mfma_f32_16x16x32_bf16 v[232:235], a[216:219], v[56:59], v[232:235]
 buffer_load_dword a254, v23, s[56:59], s73 offen offset:0
 v_mfma_f32_16x16x32_bf16 v[236:239], a[216:219], v[60:63], v[236:239]
 v_exp_f32 v151, v151
 v_mfma_f32_16x16x32_bf16 v[236:239], a[212:215], v[44:47], v[236:239]
 v_cvt_pk_bf16_f32 v183, v150, v151
 v_add_f32 v0, v0, v147
 v_mfma_f32_16x16x32_bf16 v[240:243], a[220:223], v[32:35], v[240:243]
 v_exp_f32 v152, v152
 v_mfma_f32_16x16x32_bf16 v[240:243], a[224:227], v[48:51], v[240:243]
L_pg10:
 s_cbranch_execz L_site1
 ds_read_b128 a[228:231], v10 offset:36864
 ds_read_b64_tr_b16 a[172:173], v3 offset:32768
 v_mfma_f32_16x16x32_bf16 v[244:247], a[224:227], v[52:55], v[244:247]
 v_exp_f32 v153, v153
 v_mfma_f32_16x16x32_bf16 v[244:247], a[220:223], v[36:39], v[244:247]
 ds_read_b64_tr_b16 a[174:175], v3 offset:36864
 v_cvt_pk_bf16_f32 v186, v152, v153
 v_mfma_f32_16x16x32_bf16 v[248:251], a[220:223], v[40:43], v[248:251]
 s_add_u32 s86, s85, 16384
 v_exp_f32 v154, v154
 v_mfma_f32_16x16x32_bf16 v[248:251], a[224:227], v[56:59], v[248:251]
 v_add_f32 v24, v24, v148
 v_add_f32 v24, v24, v149
 v_mfma_f32_16x16x32_bf16 v[252:255], a[224:227], v[60:63], v[252:255]
 s_add_u32 m0, s87, 0
 v_exp_f32 v155, v155
 v_mfma_f32_16x16x32_bf16 v[252:255], a[220:223], v[44:47], v[252:255]
 s_waitcnt lgkmcnt(3)
 v_cvt_pk_bf16_f32 v187, v154, v155
 v_add_f32 v24, v24, v150
 v_mfma_f32_16x16x32_bf16 a[136:139], a[144:147], v[40:43], a[136:139]
 v_add_f32 v24, v24, v151
 v_mfma_f32_16x16x32_bf16 a[136:139], a[144:147], v[56:59], a[136:139]
 v_mfma_f32_16x16x32_bf16 v[128:131], a[148:151], v[64:67], v[192:195]
 v_exp_f32 v156, v156
 v_mfma_f32_16x16x32_bf16 v[128:131], a[152:155], v[80:83], v[128:131]
 ds_read_b128 a[232:235], v11 offset:36864
 ds_read_b64_tr_b16 a[176:177], v3 offset:40960
 v_mfma_f32_16x16x32_bf16 v[128:131], a[156:159], v[96:99], v[128:131]
 v_exp_f32 v157, v157
 v_mfma_f32_16x16x32_bf16 v[128:131], a[160:163], v[112:115], v[128:131]
 ds_read_b64_tr_b16 a[178:179], v3 offset:45056
 v_cvt_pk_bf16_f32 v190, v156, v157
 v_mfma_f32_16x16x32_bf16 v[132:135], a[160:163], v[116:119], v[196:199]
 v_exp_f32 v158, v158
 v_mfma_f32_16x16x32_bf16 v[132:135], a[156:159], v[100:103], v[132:135]
 buffer_load_dwordx4 v16, s[32:35], s86 offen offset:0 lds
 v_mfma_f32_16x16x32_bf16 v[132:135], a[152:155], v[84:87], v[132:135]
 v_exp_f32 v159, v159
 v_mfma_f32_16x16x32_bf16 v[132:135], a[148:151], v[68:71], v[132:135]
 v_cvt_pk_bf16_f32 v191, v158, v159
 v_mfma_f32_16x16x32_bf16 v[136:139], a[148:151], v[72:75], v[200:203]
 v_exp_f32 v128, v128
 v_mfma_f32_16x16x32_bf16 v[136:139], a[152:155], v[88:91], v[136:139]
 ds_read_b128 a[236:239], v12 offset:36864
 ds_read_b64_tr_b16 a[212:213], v4 offset:32768
 v_mfma_f32_16x16x32_bf16 v[136:139], a[156:159], v[104:107], v[136:139]
 v_exp_f32 v129, v129
 v_mfma_f32_16x16x32_bf16 v[136:139], a[160:163], v[120:123], v[136:139]
 ds_read_b64_tr_b16 a[214:215], v4 offset:36864
 v_cvt_pk_bf16_f32 v32, v128, v129
 v_mfma_f32_16x16x32_bf16 v[140:143], a[160:163], v[124:127], v[204:207]
 v_exp_f32 v130, v130
 v_mfma_f32_16x16x32_bf16 v[140:143], a[156:159], v[108:111], v[140:143]
 buffer_load_dwordx4 v17, s[32:35], s86 offen offset:1024 lds
 v_mfma_f32_16x16x32_bf16 v[140:143], a[152:155], v[92:95], v[140:143]
 v_exp_f32 v131, v131
 v_mfma_f32_16x16x32_bf16 v[140:143], a[148:151], v[76:79], v[140:143]
 s_waitcnt lgkmcnt(3)
 v_cvt_pk_bf16_f32 v33, v130, v131
 v_add_f32 v0, v0, v128
 v_mfma_f32_16x16x32_bf16 a[0:3], a[164:167], v[160:163], a[0:3]
 v_exp_f32 v132, v132
 v_mfma_f32_16x16x32_bf16 a[0:3], a[168:171], v[176:179], a[0:3]
 ds_read_b128 a[240:243], v13 offset:36864
 ds_read_b64_tr_b16 a[216:217], v4 offset:40960
 v_mfma_f32_16x16x32_bf16 a[4:7], a[168:171], v[180:183], a[4:7]
 v_exp_f32 v133, v133
 v_mfma_f32_16x16x32_bf16 a[4:7], a[164:167], v[164:167], a[4:7]
 ds_read_b64_tr_b16 a[218:219], v4 offset:45056
 v_cvt_pk_bf16_f32 v36, v132, v133
 v_mfma_f32_16x16x32_bf16 a[8:11], a[164:167], v[168:171], a[8:11]
 v_exp_f32 v134, v134
 v_mfma_f32_16x16x32_bf16 a[8:11], a[168:171], v[184:187], a[8:11]
 buffer_load_dwordx4 v18, s[32:35], s86 offen offset:2048 lds
 v_mfma_f32_16x16x32_bf16 a[12:15], a[168:171], v[188:191], a[12:15]
 v_exp_f32 v135, v135
 v_mfma_f32_16x16x32_bf16 a[12:15], a[164:167], v[172:175], a[12:15]
 v_cvt_pk_bf16_f32 v37, v134, v135
 v_add_f32 v0, v0, v129
 v_mfma_f32_16x16x32_bf16 a[16:19], a[172:175], v[160:163], a[16:19]
 v_exp_f32 v136, v136
 v_mfma_f32_16x16x32_bf16 a[16:19], a[176:179], v[176:179], a[16:19]
 ds_read_b128 a[148:151], v10 offset:40960
 ds_read_b64_tr_b16 a[220:221], v5 offset:32768
 v_mfma_f32_16x16x32_bf16 a[20:23], a[176:179], v[180:183], a[20:23]
 v_exp_f32 v137, v137
 v_mfma_f32_16x16x32_bf16 a[20:23], a[172:175], v[164:167], a[20:23]
 ds_read_b64_tr_b16 a[222:223], v5 offset:36864
 v_cvt_pk_bf16_f32 v40, v136, v137
 v_mfma_f32_16x16x32_bf16 a[24:27], a[172:175], v[168:171], a[24:27]
 v_exp_f32 v138, v138
 v_mfma_f32_16x16x32_bf16 a[24:27], a[176:179], v[184:187], a[24:27]
 buffer_load_dwordx4 v19, s[32:35], s86 offen offset:3072 lds
 v_mfma_f32_16x16x32_bf16 a[28:31], a[176:179], v[188:191], a[28:31]
 v_exp_f32 v139, v139
 v_mfma_f32_16x16x32_bf16 a[28:31], a[172:175], v[172:175], a[28:31]
 s_waitcnt lgkmcnt(3)
 v_cvt_pk_bf16_f32 v41, v138, v139
 v_add_f32 v0, v0, v130
 v_mfma_f32_16x16x32_bf16 v[144:147], a[228:231], v[64:67], v[192:195]
 v_exp_f32 v140, v140
 v_mfma_f32_16x16x32_bf16 v[144:147], a[232:235], v[80:83], v[144:147]
 ds_read_b128 a[152:155], v11 offset:40960
 ds_read_b64_tr_b16 a[224:225], v5 offset:40960
 v_mfma_f32_16x16x32_bf16 v[144:147], a[236:239], v[96:99], v[144:147]
 v_exp_f32 v141, v141
 v_mfma_f32_16x16x32_bf16 v[144:147], a[240:243], v[112:115], v[144:147]
 ds_read_b64_tr_b16 a[226:227], v5 offset:45056
 v_cvt_pk_bf16_f32 v44, v140, v141
 v_mfma_f32_16x16x32_bf16 v[148:151], a[240:243], v[116:119], v[196:199]
 v_exp_f32 v142, v142
 v_mfma_f32_16x16x32_bf16 v[148:151], a[236:239], v[100:103], v[148:151]
 v_add_f32 v0, v0, v131
 v_add_f32 v24, v24, v132
 v_mfma_f32_16x16x32_bf16 v[148:151], a[232:235], v[84:87], v[148:151]
 v_exp_f32 v143, v143
 v_mfma_f32_16x16x32_bf16 v[148:151], a[228:231], v[68:71], v[148:151]
 v_cvt_pk_bf16_f32 v45, v142, v143
 v_add_f32 v24, v24, v133
 v_mfma_f32_16x16x32_bf16 v[152:155], a[228:231], v[72:75], v[200:203]
 v_exp_f32 v144, v144
 v_mfma_f32_16x16x32_bf16 v[152:155], a[232:235], v[88:91], v[152:155]
 ds_read_b128 a[156:159], v12 offset:40960
 ds_read_b64_tr_b16 a[164:165], v6 offset:32768
 v_mfma_f32_16x16x32_bf16 v[152:155], a[236:239], v[104:107], v[152:155]
 v_exp_f32 v145, v145
 v_mfma_f32_16x16x32_bf16 v[152:155], a[240:243], v[120:123], v[152:155]
 ds_read_b64_tr_b16 a[166:167], v6 offset:36864
 v_cvt_pk_bf16_f32 v34, v144, v145
 v_mfma_f32_16x16x32_bf16 v[156:159], a[240:243], v[124:127], v[204:207]
 v_exp_f32 v146, v146
 v_mfma_f32_16x16x32_bf16 v[156:159], a[236:239], v[108:111], v[156:159]
 v_add_f32 v24, v24, v134
 v_add_f32 v24, v24, v135
 v_mfma_f32_16x16x32_bf16 v[156:159], a[232:235], v[92:95], v[156:159]
 v_exp_f32 v147, v147
 v_mfma_f32_16x16x32_bf16 v[156:159], a[228:231], v[76:79], v[156:159]
 s_waitcnt lgkmcnt(3)
 v_cvt_pk_bf16_f32 v35, v146, v147
 v_add_f32 v0, v0, v144
 v_mfma_f32_16x16x32_bf16 a[32:35], a[212:215], v[160:163], a[32:35]
 v_exp_f32 v148, v148
 v_mfma_f32_16x16x32_bf16 a[32:35], a[216:219], v[176:179], a[32:35]
 ds_read_b128 a[160:163], v13 offset:40960
 ds_read_b64_tr_b16 a[168:169], v6 offset:40960
 v_mfma_f32_16x16x32_bf16 a[36:39], a[216:219], v[180:183], a[36:39]
 v_exp_f32 v149, v149
 v_mfma_f32_16x16x32_bf16 a[36:39], a[212:215], v[164:167], a[36:39]
 ds_read_b64_tr_b16 a[170:171], v6 offset:45056
 v_cvt_pk_bf16_f32 v38, v148, v149
 v_mfma_f32_16x16x32_bf16 a[40:43], a[212:215], v[168:171], a[40:43]
 v_exp_f32 v150, v150
 v_mfma_f32_16x16x32_bf16 a[40:43], a[216:219], v[184:187], a[40:43]
 v_add_f32 v0, v0, v145
 v_add_f32 v0, v0, v146
 v_mfma_f32_16x16x32_bf16 a[44:47], a[216:219], v[188:191], a[44:47]
 v_exp_f32 v151, v151
 v_mfma_f32_16x16x32_bf16 a[44:47], a[212:215], v[172:175], a[44:47]
 v_cvt_pk_bf16_f32 v39, v150, v151
 v_add_f32 v0, v0, v147
 v_mfma_f32_16x16x32_bf16 a[48:51], a[220:223], v[160:163], a[48:51]
 v_exp_f32 v152, v152
 v_mfma_f32_16x16x32_bf16 a[48:51], a[224:227], v[176:179], a[48:51]
 ds_read_b128 a[228:231], v10 offset:45056
 ds_read_b64_tr_b16 a[172:173], v7 offset:32768
 v_mfma_f32_16x16x32_bf16 a[52:55], a[224:227], v[180:183], a[52:55]
 v_exp_f32 v153, v153
 v_mfma_f32_16x16x32_bf16 a[52:55], a[220:223], v[164:167], a[52:55]
 ds_read_b64_tr_b16 a[174:175], v7 offset:36864
 v_cvt_pk_bf16_f32 v42, v152, v153
 v_mfma_f32_16x16x32_bf16 a[56:59], a[220:223], v[168:171], a[56:59]
 s_add_u32 m0, s87, 65536
 v_exp_f32 v154, v154
 v_mfma_f32_16x16x32_bf16 a[56:59], a[224:227], v[184:187], a[56:59]
 v_add_f32 v24, v24, v148
 v_add_f32 v24, v24, v149
 v_mfma_f32_16x16x32_bf16 a[60:63], a[224:227], v[188:191], a[60:63]
 v_exp_f32 v155, v155
 v_mfma_f32_16x16x32_bf16 a[60:63], a[220:223], v[172:175], a[60:63]
 s_waitcnt lgkmcnt(3)
 v_cvt_pk_bf16_f32 v43, v154, v155
 v_add_f32 v24, v24, v150
 v_mfma_f32_16x16x32_bf16 v[128:131], a[148:151], v[64:67], v[192:195]
 v_exp_f32 v156, v156
 v_mfma_f32_16x16x32_bf16 v[128:131], a[152:155], v[80:83], v[128:131]
 ds_read_b128 a[232:235], v11 offset:45056
 ds_read_b64_tr_b16 a[176:177], v7 offset:40960
 v_mfma_f32_16x16x32_bf16 v[128:131], a[156:159], v[96:99], v[128:131]
 v_exp_f32 v157, v157
 v_mfma_f32_16x16x32_bf16 v[128:131], a[160:163], v[112:115], v[128:131]
 ds_read_b64_tr_b16 a[178:179], v7 offset:45056
 v_cvt_pk_bf16_f32 v46, v156, v157
 v_mfma_f32_16x16x32_bf16 v[132:135], a[160:163], v[116:119], v[196:199]
 v_exp_f32 v158, v158
 v_mfma_f32_16x16x32_bf16 v[132:135], a[156:159], v[100:103], v[132:135]
 buffer_load_dwordx4 v14, s[36:39], s85 offen offset:0 lds
 v_mfma_f32_16x16x32_bf16 v[132:135], a[152:155], v[84:87], v[132:135]
 v_exp_f32 v159, v159
 v_mfma_f32_16x16x32_bf16 v[132:135], a[148:151], v[68:71], v[132:135]
 v_cvt_pk_bf16_f32 v47, v158, v159
 v_add_f32 v24, v24, v151
 v_mfma_f32_16x16x32_bf16 v[136:139], a[148:151], v[72:75], v[200:203]
 v_exp_f32 v128, v128
 v_mfma_f32_16x16x32_bf16 v[136:139], a[152:155], v[88:91], v[136:139]
 ds_read_b128 a[236:239], v12 offset:45056
 ds_read_b64_tr_b16 a[212:213], v8 offset:32768
 v_mfma_f32_16x16x32_bf16 v[136:139], a[156:159], v[104:107], v[136:139]
 v_exp_f32 v129, v129
 v_mfma_f32_16x16x32_bf16 v[136:139], a[160:163], v[120:123], v[136:139]
 ds_read_b64_tr_b16 a[214:215], v8 offset:36864
 v_cvt_pk_bf16_f32 v48, v128, v129
 v_mfma_f32_16x16x32_bf16 v[140:143], a[160:163], v[124:127], v[204:207]
 v_exp_f32 v130, v130
 v_mfma_f32_16x16x32_bf16 v[140:143], a[156:159], v[108:111], v[140:143]
 buffer_load_dwordx4 v15, s[36:39], s85 offen offset:1024 lds
 v_mfma_f32_16x16x32_bf16 v[140:143], a[152:155], v[92:95], v[140:143]
 v_exp_f32 v131, v131
 v_mfma_f32_16x16x32_bf16 v[140:143], a[148:151], v[76:79], v[140:143]
 s_waitcnt lgkmcnt(3)
 v_cvt_pk_bf16_f32 v49, v130, v131
 v_add_f32 v0, v0, v128
 v_mfma_f32_16x16x32_bf16 a[64:67], a[164:167], v[160:163], a[64:67]
 v_exp_f32 v132, v132
 v_mfma_f32_16x16x32_bf16 a[64:67], a[168:171], v[176:179], a[64:67]
 ds_read_b128 a[240:243], v13 offset:45056
 ds_read_b64_tr_b16 a[216:217], v8 offset:40960
 v_mfma_f32_16x16x32_bf16 a[68:71], a[168:171], v[180:183], a[68:71]
 v_exp_f32 v133, v133
 v_mfma_f32_16x16x32_bf16 a[68:71], a[164:167], v[164:167], a[68:71]
 ds_read_b64_tr_b16 a[218:219], v8 offset:45056
 v_cvt_pk_bf16_f32 v52, v132, v133
 v_mfma_f32_16x16x32_bf16 a[72:75], a[164:167], v[168:171], a[72:75]
 v_exp_f32 v134, v134
 v_mfma_f32_16x16x32_bf16 a[72:75], a[168:171], v[184:187], a[72:75]
 buffer_load_dwordx4 v14, s[36:39], s85 offen offset:2048 lds
 v_mfma_f32_16x16x32_bf16 a[76:79], a[168:171], v[188:191], a[76:79]
 v_exp_f32 v135, v135
 v_mfma_f32_16x16x32_bf16 a[76:79], a[164:167], v[172:175], a[76:79]
 v_cvt_pk_bf16_f32 v53, v134, v135
 v_add_f32 v0, v0, v129
 v_mfma_f32_16x16x32_bf16 a[140:143], a[144:147], v[172:175], a[140:143]
 s_waitcnt vmcnt(8)
 v_add_f32 v0, v0, v130
 v_add_f32 v0, v0, v131
 v_mfma_f32_16x16x32_bf16 a[140:143], a[144:147], v[188:191], a[140:143]
 s_barrier
 v_add_f32 v24, v24, v132
 v_add_f32 v24, v24, v133
 v_mfma_f32_16x16x32_bf16 v[208:211], a[172:175], v[160:163], v[208:211]
 v_exp_f32 v136, v136
 v_mfma_f32_16x16x32_bf16 v[208:211], a[176:179], v[176:179], v[208:211]
 ds_read_b128 a[148:151], v10 offset:49152
 ds_read_b64_tr_b16 a[220:221], v9 offset:32768
 v_mfma_f32_16x16x32_bf16 v[212:215], a[176:179], v[180:183], v[212:215]
 v_exp_f32 v137, v137
 v_mfma_f32_16x16x32_bf16 v[212:215], a[172:175], v[164:167], v[212:215]
 ds_read_b64_tr_b16 a[222:223], v9 offset:36864
 v_cvt_pk_bf16_f32 v56, v136, v137
 v_mfma_f32_16x16x32_bf16 v[216:219], a[172:175], v[168:171], v[216:219]
 v_exp_f32 v138, v138
 v_mfma_f32_16x16x32_bf16 v[216:219], a[176:179], v[184:187], v[216:219]
 buffer_load_dwordx4 v15, s[36:39], s85 offen offset:3072 lds
 v_mfma_f32_16x16x32_bf16 v[220:223], a[176:179], v[188:191], v[220:223]
 v_exp_f32 v139, v139
 v_mfma_f32_16x16x32_bf16 v[220:223], a[172:175], v[172:175], v[220:223]
 s_waitcnt lgkmcnt(3)
 v_cvt_pk_bf16_f32 v57, v138, v139
 v_add_f32 v24, v24, v134
 v_mfma_f32_16x16x32_bf16 v[144:147], a[228:231], v[64:67], v[192:195]
 v_exp_f32 v140, v140
 v_mfma_f32_16x16x32_bf16 v[144:147], a[232:235], v[80:83], v[144:147]
 ds_read_b128 a[152:155], v11 offset:49152
 ds_read_b64_tr_b16 a[224:225], v9 offset:40960
 v_mfma_f32_16x16x32_bf16 v[144:147], a[236:239], v[96:99], v[144:147]
 v_exp_f32 v141, v141
 v_mfma_f32_16x16x32_bf16 v[144:147], a[240:243], v[112:115], v[144:147]
 ds_read_b64_tr_b16 a[226:227], v9 offset:45056
 v_cvt_pk_bf16_f32 v60, v140, v141
 v_mfma_f32_16x16x32_bf16 v[148:151], a[240:243], v[116:119], v[196:199]
 v_exp_f32 v142, v142
 v_mfma_f32_16x16x32_bf16 v[148:151], a[236:239], v[100:103], v[148:151]
 v_add_f32 v24, v24, v135
 v_mfma_f32_16x16x32_bf16 v[148:151], a[232:235], v[84:87], v[148:151]
 v_exp_f32 v143, v143
 v_mfma_f32_16x16x32_bf16 v[148:151], a[228:231], v[68:71], v[148:151]
 v_cvt_pk_bf16_f32 v61, v142, v143
 v_mfma_f32_16x16x32_bf16 v[152:155], a[228:231], v[72:75], v[200:203]
 v_exp_f32 v144, v144
 v_mfma_f32_16x16x32_bf16 v[152:155], a[232:235], v[88:91], v[152:155]
 ds_read_b128 a[156:159], v12 offset:49152
 ds_read_b64_tr_b16 a[164:165], v2 offset:49152
 v_mfma_f32_16x16x32_bf16 v[152:155], a[236:239], v[104:107], v[152:155]
 v_exp_f32 v145, v145
 v_mfma_f32_16x16x32_bf16 v[152:155], a[240:243], v[120:123], v[152:155]
 ds_read_b64_tr_b16 a[166:167], v2 offset:53248
 v_cvt_pk_bf16_f32 v50, v144, v145
 v_mfma_f32_16x16x32_bf16 v[156:159], a[240:243], v[124:127], v[204:207]
 v_exp_f32 v146, v146
 v_mfma_f32_16x16x32_bf16 v[156:159], a[236:239], v[108:111], v[156:159]
 v_add_f32 v0, v0, v144
 v_add_f32 v0, v0, v145
 v_mfma_f32_16x16x32_bf16 v[156:159], a[232:235], v[92:95], v[156:159]
 v_exp_f32 v147, v147
 v_mfma_f32_16x16x32_bf16 v[156:159], a[228:231], v[76:79], v[156:159]
 s_waitcnt lgkmcnt(3)
 v_cvt_pk_bf16_f32 v51, v146, v147
 v_add_f32 v0, v0, v146
 v_mfma_f32_16x16x32_bf16 v[224:227], a[212:215], v[160:163], v[224:227]
 v_exp_f32 v148, v148
 v_mfma_f32_16x16x32_bf16 v[224:227], a[216:219], v[176:179], v[224:227]
 ds_read_b128 a[160:163], v13 offset:49152
 ds_read_b64_tr_b16 a[168:169], v2 offset:57344
 v_mfma_f32_16x16x32_bf16 v[228:231], a[216:219], v[180:183], v[228:231]
 v_exp_f32 v149, v149
 v_mfma_f32_16x16x32_bf16 v[228:231], a[212:215], v[164:167], v[228:231]
 ds_read_b64_tr_b16 a[170:171], v2 offset:61440
 v_cvt_pk_bf16_f32 v54, v148, v149
 v_mfma_f32_16x16x32_bf16 v[232:235], a[212:215], v[168:171], v[232:235]
 v_exp_f32 v150, v150
 v_mfma_f32_16x16x32_bf16 v[232:235], a[216:219], v[184:187], v[232:235]
 buffer_load_dword a255, v23, s[56:59], s73 offen offset:3584
 v_mfma_f32_16x16x32_bf16 v[236:239], a[216:219], v[188:191], v[236:239]
 v_exp_f32 v151, v151
 v_mfma_f32_16x16x32_bf16 v[236:239], a[212:215], v[172:175], v[236:239]
 v_cvt_pk_bf16_f32 v55, v150, v151
 v_add_f32 v0, v0, v147
 v_mfma_f32_16x16x32_bf16 v[240:243], a[220:223], v[160:163], v[240:243]
 v_exp_f32 v152, v152
 v_mfma_f32_16x16x32_bf16 v[240:243], a[224:227], v[176:179], v[240:243]
 ds_read_b128 a[228:231], v10 offset:53248
 ds_read_b64_tr_b16 a[172:173], v3 offset:49152
 v_mfma_f32_16x16x32_bf16 v[244:247], a[224:227], v[180:183], v[244:247]
 v_exp_f32 v153, v153
 v_mfma_f32_16x16x32_bf16 v[244:247], a[220:223], v[164:167], v[244:247]
 ds_read_b64_tr_b16 a[174:175], v3 offset:53248
 v_cvt_pk_bf16_f32 v58, v152, v153
 v_mfma_f32_16x16x32_bf16 v[248:251], a[220:223], v[168:171], v[248:251]
 s_add_u32 s85, s86, 16384
 v_exp_f32 v154, v154
 v_mfma_f32_16x16x32_bf16 v[248:251], a[224:227], v[184:187], v[248:251]
 v_add_f32 v24, v24, v148
 v_add_f32 v24, v24, v149
 v_mfma_f32_16x16x32_bf16 v[252:255], a[224:227], v[188:191], v[252:255]
 s_add_u32 m0, s87, 16384
 v_exp_f32 v155, v155
 v_mfma_f32_16x16x32_bf16 v[252:255], a[220:223], v[172:175], v[252:255]
 s_waitcnt lgkmcnt(3)
 v_cvt_pk_bf16_f32 v59, v154, v155
 v_add_f32 v24, v24, v150
 v_mfma_f32_16x16x32_bf16 a[136:139], a[144:147], v[168:171], a[136:139]
 v_add_f32 v24, v24, v151
 v_mfma_f32_16x16x32_bf16 a[136:139], a[144:147], v[184:187], a[136:139]
 s_sub_u32 s82, s82, 1
 s_cbranch_scc0 L_loop
L_tail:
 v_mfma_f32_16x16x32_bf16 v[128:131], a[148:151], v[64:67], v[192:195]
 v_exp_f32 v156, v156
 v_mfma_f32_16x16x32_bf16 v[128:131], a[152:155], v[80:83], v[128:131]
 ds_read_b128 a[232:235], v11 offset:53248
 ds_read_b64_tr_b16 a[176:177], v3 offset:57344
 v_mfma_f32_16x16x32_bf16 v[128:131], a[156:159], v[96:99], v[128:131]
 v_exp_f32 v157, v157
 v_mfma_f32_16x16x32_bf16 v[128:131], a[160:163], v[112:115], v[128:131]
 ds_read_b64_tr_b16 a[178:179], v3 offset:61440
 v_cvt_pk_bf16_f32 v62, v156, v157
 v_mfma_f32_16x16x32_bf16 v[132:135], a[160:163], v[116:119], v[196:199]
 v_exp_f32 v158, v158
 v_mfma_f32_16x16x32_bf16 v[132:135], a[156:159], v[100:103], v[132:135]
 buffer_load_dwordx4 v16, s[32:35], s85 offen offset:0 lds
 v_mfma_f32_16x16x32_bf16 v[132:135], a[152:155], v[84:87], v[132:135]
 v_exp_f32 v159, v159
 v_mfma_f32_16x16x32_bf16 v[132:135], a[148:151], v[68:71], v[132:135]
 v_cvt_pk_bf16_f32 v63, v158, v159
 v_mfma_f32_16x16x32_bf16 v[136:139], a[148:151], v[72:75], v[200:203]
 v_exp_f32 v128, v128
 v_mfma_f32_16x16x32_bf16 v[136:139], a[152:155], v[88:91], v[136:139]
 ds_read_b128 a[236:239], v12 offset:53248
 ds_read_b64_tr_b16 a[212:213], v4 offset:49152
 v_mfma_f32_16x16x32_bf16 v[136:139], a[156:159], v[104:107], v[136:139]
 v_exp_f32 v129, v129
 v_mfma_f32_16x16x32_bf16 v[136:139], a[160:163], v[120:123], v[136:139]
 ds_read_b64_tr_b16 a[214:215], v4 offset:53248
 v_cvt_pk_bf16_f32 v160, v128, v129
 v_mfma_f32_16x16x32_bf16 v[140:143], a[160:163], v[124:127], v[204:207]
 v_exp_f32 v130, v130
 v_mfma_f32_16x16x32_bf16 v[140:143], a[156:159], v[108:111], v[140:143]
 buffer_load_dwordx4 v17, s[32:35], s85 offen offset:1024 lds
 v_mfma_f32_16x16x32_bf16 v[140:143], a[152:155], v[92:95], v[140:143]
 v_exp_f32 v131, v131
 v_mfma_f32_16x16x32_bf16 v[140:143], a[148:151], v[76:79], v[140:143]
 s_waitcnt lgkmcnt(3)
 v_cvt_pk_bf16_f32 v161, v130, v131
 v_mfma_f32_16x16x32_bf16 a[0:3], a[164:167], v[32:35], a[0:3]
 v_exp_f32 v132, v132
 v_mfma_f32_16x16x32_bf16 a[0:3], a[168:171], v[48:51], a[0:3]
 ds_read_b128 a[240:243], v13 offset:53248
 ds_read_b64_tr_b16 a[216:217], v4 offset:57344
 v_mfma_f32_16x16x32_bf16 a[4:7], a[168:171], v[52:55], a[4:7]
 v_exp_f32 v133, v133
 v_mfma_f32_16x16x32_bf16 a[4:7], a[164:167], v[36:39], a[4:7]
 ds_read_b64_tr_b16 a[218:219], v4 offset:61440
 v_cvt_pk_bf16_f32 v164, v132, v133
 v_mfma_f32_16x16x32_bf16 a[8:11], a[164:167], v[40:43], a[8:11]
 v_exp_f32 v134, v134
 v_mfma_f32_16x16x32_bf16 a[8:11], a[168:171], v[56:59], a[8:11]
 buffer_load_dwordx4 v18, s[32:35], s85 offen offset:2048 lds
 v_mfma_f32_16x16x32_bf16 a[12:15], a[168:171], v[60:63], a[12:15]
 v_exp_f32 v135, v135
 v_mfma_f32_16x16x32_bf16 a[12:15], a[164:167], v[44:47], a[12:15]
 v_cvt_pk_bf16_f32 v165, v134, v135
 v_readfirstlane_b32 s88, v22
 s_lshl_b32 s89, s79, 2
 s_cmp_ge_u32 s88, 8
 s_cbranch_scc1 L_hp_ok
 s_mov_b32 s90, 0x200000
L_hp_spin:
 s_sub_u32 s90, s90, 1
 s_cbranch_scc1 L_hp_ok
 s_sleep 2
 buffer_load_dword v22, off, s[68:71], s89 offset:128 sc1
 s_waitcnt vmcnt(0)
 v_readfirstlane_b32 s88, v22
 s_nop 0
 s_cmp_ge_u32 s88, 8
 s_cbranch_scc0 L_hp_spin
L_hp_ok:
 s_mul_i32 s94, s79, 229376
 s_mul_i32 s88, s76, 57344
 s_add_u32 s94, s94, s88
 s_mul_i32 s88, s80, 3584
 s_add_u32 s88, s88, s94
 s_add_u32 s88, s88, 20480
 buffer_load_dword a252, v23, s[64:67], s88 offen sc1
 v_and_b32 v22, 15, v1
 v_lshrrev_b32 v21, 4, v1
 v_lshlrev_b32 v21, 3, v21
 v_lshl_or_b32 v22, v22, 10, v21
 s_lshl_b32 s73, s79, 16
 s_lshl_b32 s88, s76, 14
 s_lshl_b32 s89, s80, 7
 s_add_u32 s73, s73, s88
 s_add_u32 s73, s73, s89
 s_add_u32 s75, s93, 7168
 v_mov_b32 v26, v0
 s_nop 1
 v_permlane32_swap_b32 v0, v26
 v_add_f32 v0, v0, v26
 v_mfma_f32_16x16x32_bf16 a[16:19], a[172:175], v[32:35], a[16:19]
 v_exp_f32 v136, v136
 v_mfma_f32_16x16x32_bf16 a[16:19], a[176:179], v[48:51], a[16:19]
 ds_read_b128 a[148:151], v10 offset:57344
 ds_read_b64_tr_b16 a[220:221], v5 offset:49152
 v_mfma_f32_16x16x32_bf16 a[20:23], a[176:179], v[52:55], a[20:23]
 v_exp_f32 v137, v137
 v_mfma_f32_16x16x32_bf16 a[20:23], a[172:175], v[36:39], a[20:23]
 ds_read_b64_tr_b16 a[222:223], v5 offset:53248
 v_cvt_pk_bf16_f32 v168, v136, v137
 v_mfma_f32_16x16x32_bf16 a[24:27], a[172:175], v[40:43], a[24:27]
 v_exp_f32 v138, v138
 v_mfma_f32_16x16x32_bf16 a[24:27], a[176:179], v[56:59], a[24:27]
 buffer_load_dwordx4 v19, s[32:35], s85 offen offset:3072 lds
 v_mfma_f32_16x16x32_bf16 a[28:31], a[176:179], v[60:63], a[28:31]
 v_exp_f32 v139, v139
 v_mfma_f32_16x16x32_bf16 a[28:31], a[172:175], v[44:47], a[28:31]
 s_waitcnt lgkmcnt(3)
 v_cvt_pk_bf16_f32 v169, v138, v139
 v_mfma_f32_16x16x32_bf16 v[144:147], a[228:231], v[64:67], v[192:195]
 v_exp_f32 v140, v140
 v_mfma_f32_16x16x32_bf16 v[144:147], a[232:235], v[80:83], v[144:147]
 ds_read_b128 a[152:155], v11 offset:57344
 ds_read_b64_tr_b16 a[224:225], v5 offset:57344
 v_mfma_f32_16x16x32_bf16 v[144:147], a[236:239], v[96:99], v[144:147]
 v_exp_f32 v141, v141
 v_mfma_f32_16x16x32_bf16 v[144:147], a[240:243], v[112:115], v[144:147]
 ds_read_b64_tr_b16 a[226:227], v5 offset:61440
 v_cvt_pk_bf16_f32 v172, v140, v141
 v_mfma_f32_16x16x32_bf16 v[148:151], a[240:243], v[116:119], v[196:199]
 v_exp_f32 v142, v142
 v_mfma_f32_16x16x32_bf16 v[148:151], a[236:239], v[100:103], v[148:151]
 v_mov_b32 v26, v24
 s_nop 1
 v_permlane32_swap_b32 v24, v26
 v_add_f32 v24, v24, v26
 v_mfma_f32_16x16x32_bf16 v[148:151], a[232:235], v[84:87], v[148:151]
 v_exp_f32 v143, v143
 v_mfma_f32_16x16x32_bf16 v[148:151], a[228:231], v[68:71], v[148:151]
 v_cvt_pk_bf16_f32 v173, v142, v143
 v_mfma_f32_16x16x32_bf16 v[152:155], a[228:231], v[72:75], v[200:203]
 v_exp_f32 v144, v144
 v_mfma_f32_16x16x32_bf16 v[152:155], a[232:235], v[88:91], v[152:155]
 ds_read_b128 a[156:159], v12 offset:57344
 ds_read_b64_tr_b16 a[164:165], v6 offset:49152
 v_mfma_f32_16x16x32_bf16 v[152:155], a[236:239], v[104:107], v[152:155]
 v_exp_f32 v145, v145
 v_mfma_f32_16x16x32_bf16 v[152:155], a[240:243], v[120:123], v[152:155]
 ds_read_b64_tr_b16 a[166:167], v6 offset:53248
 v_cvt_pk_bf16_f32 v162, v144, v145
 v_mfma_f32_16x16x32_bf16 v[156:159], a[240:243], v[124:127], v[204:207]
 v_exp_f32 v146, v146
 v_mfma_f32_16x16x32_bf16 v[156:159], a[236:239], v[108:111], v[156:159]
 v_mov_b32 v26, v0
 s_nop 1
 v_permlane16_swap_b32 v0, v26
 v_add_f32 v0, v0, v26
 v_mfma_f32_16x16x32_bf16 v[156:159], a[232:235], v[92:95], v[156:159]
 v_exp_f32 v147, v147
 v_mfma_f32_16x16x32_bf16 v[156:159], a[228:231], v[76:79], v[156:159]
 s_waitcnt lgkmcnt(3)
 v_cvt_pk_bf16_f32 v163, v146, v147
 v_mfma_f32_16x16x32_bf16 a[32:35], a[212:215], v[32:35], a[32:35]
 v_exp_f32 v148, v148
 v_mfma_f32_16x16x32_bf16 a[32:35], a[216:219], v[48:51], a[32:35]
 ds_read_b128 a[160:163], v13 offset:57344
 ds_read_b64_tr_b16 a[168:169], v6 offset:57344
 v_mfma_f32_16x16x32_bf16 a[36:39], a[216:219], v[52:55], a[36:39]
 v_exp_f32 v149, v149
 v_mfma_f32_16x16x32_bf16 a[36:39], a[212:215], v[36:39], a[36:39]
 ds_read_b64_tr_b16 a[170:171], v6 offset:61440
 v_cvt_pk_bf16_f32 v166, v148, v149
 v_mfma_f32_16x16x32_bf16 a[40:43], a[212:215], v[40:43], a[40:43]
 v_exp_f32 v150, v150
 v_mfma_f32_16x16x32_bf16 a[40:43], a[216:219], v[56:59], a[40:43]
 v_mov_b32 v26, v24
 s_nop 1
 v_permlane16_swap_b32 v24, v26
 v_add_f32 v24, v24, v26
 v_mfma_f32_16x16x32_bf16 a[44:47], a[216:219], v[60:63], a[44:47]
 v_exp_f32 v151, v151
 v_mfma_f32_16x16x32_bf16 a[44:47], a[212:215], v[44:47], a[44:47]
 v_cvt_pk_bf16_f32 v167, v150, v151
 v_mfma_f32_16x16x32_bf16 a[48:51], a[220:223], v[32:35], a[48:51]
 v_exp_f32 v152, v152
 v_mfma_f32_16x16x32_bf16 a[48:51], a[224:227], v[48:51], a[48:51]
 ds_read_b128 a[228:231], v10 offset:61440
 ds_read_b64_tr_b16 a[172:173], v7 offset:49152
 v_mfma_f32_16x16x32_bf16 a[52:55], a[224:227], v[52:55], a[52:55]
 v_exp_f32 v153, v153
 v_mfma_f32_16x16x32_bf16 a[52:55], a[220:223], v[36:39], a[52:55]
 ds_read_b64_tr_b16 a[174:175], v7 offset:53248
 v_cvt_pk_bf16_f32 v170, v152, v153
 v_mfma_f32_16x16x32_bf16 a[56:59], a[220:223], v[40:43], a[56:59]
 s_add_u32 m0, s87, 81920
 v_exp_f32 v154, v154
 v_mfma_f32_16x16x32_bf16 a[56:59], a[224:227], v[56:59], a[56:59]
 v_mfma_f32_16x16x32_bf16 a[60:63], a[224:227], v[60:63], a[60:63]
 v_exp_f32 v155, v155
 v_mfma_f32_16x16x32_bf16 a[60:63], a[220:223], v[44:47], a[60:63]
 s_waitcnt lgkmcnt(3)
 v_cvt_pk_bf16_f32 v171, v154, v155
 v_accvgpr_write_b32 a128, v0
 v_accvgpr_write_b32 a132, v24
 v_mfma_f32_16x16x32_bf16 v[128:131], a[148:151], v[64:67], v[192:195]
 v_exp_f32 v156, v156
 v_mfma_f32_16x16x32_bf16 v[128:131], a[152:155], v[80:83], v[128:131]
 ds_read_b128 a[232:235], v11 offset:61440
 ds_read_b64_tr_b16 a[176:177], v7 offset:57344
 v_mfma_f32_16x16x32_bf16 v[128:131], a[156:159], v[96:99], v[128:131]
 v_exp_f32 v157, v157
 v_mfma_f32_16x16x32_bf16 v[128:131], a[160:163], v[112:115], v[128:131]
 ds_read_b64_tr_b16 a[178:179], v7 offset:61440
 v_cvt_pk_bf16_f32 v174, v156, v157
 v_mfma_f32_16x16x32_bf16 v[132:135], a[160:163], v[116:119], v[196:199]
 v_exp_f32 v158, v158
 v_mfma_f32_16x16x32_bf16 v[132:135], a[156:159], v[100:103], v[132:135]
 buffer_load_dwordx4 v14, s[36:39], s86 offen offset:0 lds
 v_mfma_f32_16x16x32_bf16 v[132:135], a[152:155], v[84:87], v[132:135]
 v_exp_f32 v159, v159
 v_mfma_f32_16x16x32_bf16 v[132:135], a[148:151], v[68:71], v[132:135]
 v_cvt_pk_bf16_f32 v175, v158, v159
 v_mfma_f32_16x16x32_bf16 v[136:139], a[148:151], v[72:75], v[200:203]
 v_exp_f32 v128, v128
 v_mfma_f32_16x16x32_bf16 v[136:139], a[152:155], v[88:91], v[136:139]
 ds_read_b128 a[236:239], v12 offset:61440
 ds_read_b64_tr_b16 a[212:213], v8 offset:49152
 v_mfma_f32_16x16x32_bf16 v[136:139], a[156:159], v[104:107], v[136:139]
 v_exp_f32 v129, v129
 v_mfma_f32_16x16x32_bf16 v[136:139], a[160:163], v[120:123], v[136:139]
 ds_read_b64_tr_b16 a[214:215], v8 offset:53248
 v_cvt_pk_bf16_f32 v176, v128, v129
 v_mfma_f32_16x16x32_bf16 v[140:143], a[160:163], v[124:127], v[204:207]
 v_exp_f32 v130, v130
 v_mfma_f32_16x16x32_bf16 v[140:143], a[156:159], v[108:111], v[140:143]
 buffer_load_dwordx4 v15, s[36:39], s86 offen offset:1024 lds
 v_mfma_f32_16x16x32_bf16 v[140:143], a[152:155], v[92:95], v[140:143]
 v_exp_f32 v131, v131
 v_mfma_f32_16x16x32_bf16 v[140:143], a[148:151], v[76:79], v[140:143]
 s_waitcnt lgkmcnt(3)
 v_cvt_pk_bf16_f32 v177, v130, v131
 v_mfma_f32_16x16x32_bf16 a[64:67], a[164:167], v[32:35], a[64:67]
 v_exp_f32 v132, v132
 v_mfma_f32_16x16x32_bf16 a[64:67], a[168:171], v[48:51], a[64:67]
 ds_read_b128 a[240:243], v13 offset:61440
 ds_read_b64_tr_b16 a[216:217], v8 offset:57344
 v_mfma_f32_16x16x32_bf16 a[68:71], a[168:171], v[52:55], a[68:71]
 v_exp_f32 v133, v133
 v_mfma_f32_16x16x32_bf16 a[68:71], a[164:167], v[36:39], a[68:71]
 ds_read_b64_tr_b16 a[218:219], v8 offset:61440
 v_cvt_pk_bf16_f32 v180, v132, v133
 v_mfma_f32_16x16x32_bf16 a[72:75], a[164:167], v[40:43], a[72:75]
 v_exp_f32 v134, v134
 v_mfma_f32_16x16x32_bf16 a[72:75], a[168:171], v[56:59], a[72:75]
 buffer_load_dwordx4 v14, s[36:39], s86 offen offset:2048 lds
 v_mfma_f32_16x16x32_bf16 a[76:79], a[168:171], v[60:63], a[76:79]
 v_exp_f32 v135, v135
 v_mfma_f32_16x16x32_bf16 a[76:79], a[164:167], v[44:47], a[76:79]
 v_cvt_pk_bf16_f32 v181, v134, v135
 v_mfma_f32_16x16x32_bf16 a[140:143], a[144:147], v[44:47], a[140:143]
 s_waitcnt vmcnt(9)
 v_mfma_f32_16x16x32_bf16 a[140:143], a[144:147], v[60:63], a[140:143]
 s_barrier
L_pg11:
 s_cbranch_execz L_site1
 v_mfma_f32_16x16x32_bf16 v[208:211], a[172:175], v[32:35], v[208:211]
 v_exp_f32 v136, v136
 v_mfma_f32_16x16x32_bf16 v[208:211], a[176:179], v[48:51], v[208:211]
 ds_read_b128 a[148:151], v10 offset:0
 ds_read_b64_tr_b16 a[220:221], v9 offset:49152
 v_mfma_f32_16x16x32_bf16 v[212:215], a[176:179], v[52:55], v[212:215]
 v_exp_f32 v137, v137
 v_mfma_f32_16x16x32_bf16 v[212:215], a[172:175], v[36:39], v[212:215]
 ds_read_b64_tr_b16 a[222:223], v9 offset:53248
 v_cvt_pk_bf16_f32 v184, v136, v137
 v_mfma_f32_16x16x32_bf16 v[216:219], a[172:175], v[40:43], v[216:219]
 v_exp_f32 v138, v138
 v_mfma_f32_16x16x32_bf16 v[216:219], a[176:179], v[56:59], v[216:219]
 buffer_load_dwordx4 v15, s[36:39], s86 offen offset:3072 lds
 v_mfma_f32_16x16x32_bf16 v[220:223], a[176:179], v[60:63], v[220:223]
 v_exp_f32 v139, v139
 v_mfma_f32_16x16x32_bf16 v[220:223], a[172:175], v[44:47], v[220:223]
 s_waitcnt lgkmcnt(3)
 v_cvt_pk_bf16_f32 v185, v138, v139
 v_mfma_f32_16x16x32_bf16 v[144:147], a[228:231], v[64:67], v[192:195]
 v_exp_f32 v140, v140
 v_mfma_f32_16x16x32_bf16 v[144:147], a[232:235], v[80:83], v[144:147]
 ds_read_b128 a[152:155], v11 offset:0
 ds_read_b64_tr_b16 a[224:225], v9 offset:57344
 v_mfma_f32_16x16x32_bf16 v[144:147], a[236:239], v[96:99], v[144:147]
 v_exp_f32 v141, v141
 v_mfma_f32_16x16x32_bf16 v[144:147], a[240:243], v[112:115], v[144:147]
 ds_read_b64_tr_b16 a[226:227], v9 offset:61440
 v_cvt_pk_bf16_f32 v188, v140, v141
 v_mfma_f32_16x16x32_bf16 v[148:151], a[240:243], v[116:119], v[196:199]
 v_exp_f32 v142, v142
 v_mfma_f32_16x16x32_bf16 v[148:151], a[236:239], v[100:103], v[148:151]
 buffer_load_dwordx4 a[80:83], v20, s[64:67], s94 offen offset:0 sc1
 v_mfma_f32_16x16x32_bf16 v[148:151], a[232:235], v[84:87], v[148:151]
 v_exp_f32 v143, v143
 v_mfma_f32_16x16x32_bf16 v[148:151], a[228:231], v[68:71], v[148:151]
 v_cvt_pk_bf16_f32 v189, v142, v143
 v_mfma_f32_16x16x32_bf16 v[152:155], a[228:231], v[72:75], v[200:203]
 v_exp_f32 v144, v144
 v_mfma_f32_16x16x32_bf16 v[152:155], a[232:235], v[88:91], v[152:155]
 ds_read_b128 a[156:159], v12 offset:0
 ds_read_b64_tr_b16 a[164:165], v2 offset:0
 v_mfma_f32_16x16x32_bf16 v[152:155], a[236:239], v[104:107], v[152:155]
 v_exp_f32 v145, v145
 v_mfma_f32_16x16x32_bf16 v[152:155], a[240:243], v[120:123], v[152:155]
 ds_read_b64_tr_b16 a[166:167], v2 offset:4096
 v_cvt_pk_bf16_f32 v178, v144, v145
 v_mfma_f32_16x16x32_bf16 v[156:159], a[240:243], v[124:127], v[204:207]
 v_exp_f32 v146, v146
 v_mfma_f32_16x16x32_bf16 v[156:159], a[236:239], v[108:111], v[156:159]
 buffer_load_dwordx4 a[84:87], v20, s[64:67], s94 offen offset:1024 sc1
 v_mfma_f32_16x16x32_bf16 v[156:159], a[232:235], v[92:95], v[156:159]
 v_exp_f32 v147, v147
 v_mfma_f32_16x16x32_bf16 v[156:159], a[228:231], v[76:79], v[156:159]
 s_waitcnt lgkmcnt(3)
 v_cvt_pk_bf16_f32 v179, v146, v147
 v_mfma_f32_16x16x32_bf16 v[224:227], a[212:215], v[32:35], v[224:227]
 v_exp_f32 v148, v148
 v_mfma_f32_16x16x32_bf16 v[224:227], a[216:219], v[48:51], v[224:227]
 ds_read_b128 a[160:163], v13 offset:0
 ds_read_b64_tr_b16 a[168:169], v2 offset:8192
 v_mfma_f32_16x16x32_bf16 v[228:231], a[216:219], v[52:55], v[228:231]
 v_exp_f32 v149, v149
 v_mfma_f32_16x16x32_bf16 v[228:231], a[212:215], v[36:39], v[228:231]
 ds_read_b64_tr_b16 a[170:171], v2 offset:12288
 v_cvt_pk_bf16_f32 v182, v148, v149
 v_mfma_f32_16x16x32_bf16 v[232:235], a[212:215], v[40:43], v[232:235]
 v_exp_f32 v150, v150
 v_mfma_f32_16x16x32_bf16 v[232:235], a[216:219], v[56:59], v[232:235]
 buffer_load_dword a253, v23, s[56:59], s75 offen offset:0
 v_mfma_f32_16x16x32_bf16 v[236:239], a[216:219], v[60:63], v[236:239]
 v_exp_f32 v151, v151
 v_mfma_f32_16x16x32_bf16 v[236:239], a[212:215], v[44:47], v[236:239]
 v_cvt_pk_bf16_f32 v183, v150, v151
 v_mfma_f32_16x16x32_bf16 v[240:243], a[220:223], v[32:35], v[240:243]
 v_exp_f32 v152, v152
 v_mfma_f32_16x16x32_bf16 v[240:243], a[224:227], v[48:51], v[240:243]
 ds_read_b128 a[228:231], v10 offset:4096
 ds_read_b64_tr_b16 a[172:173], v3 offset:0
 v_mfma_f32_16x16x32_bf16 v[244:247], a[224:227], v[52:55], v[244:247]
 v_exp_f32 v153, v153
 v_mfma_f32_16x16x32_bf16 v[244:247], a[220:223], v[36:39], v[244:247]
 ds_read_b64_tr_b16 a[174:175], v3 offset:4096
 v_cvt_pk_bf16_f32 v186, v152, v153
 v_mfma_f32_16x16x32_bf16 v[248:251], a[220:223], v[40:43], v[248:251]
 s_add_u32 s86, s85, 16384
 v_exp_f32 v154, v154
 v_mfma_f32_16x16x32_bf16 v[248:251], a[224:227], v[56:59], v[248:251]
 v_mfma_f32_16x16x32_bf16 v[252:255], a[224:227], v[60:63], v[252:255]
 s_add_u32 m0, s87, 32768
 v_exp_f32 v155, v155
 v_mfma_f32_16x16x32_bf16 v[252:255], a[220:223], v[44:47], v[252:255]
 s_waitcnt lgkmcnt(3)
 v_cvt_pk_bf16_f32 v187, v154, v155
 v_mfma_f32_16x16x32_bf16 a[136:139], a[144:147], v[40:43], a[136:139]
 buffer_load_dwordx4 a[88:91], v20, s[64:67], s94 offen offset:2048 sc1
 v_mfma_f32_16x16x32_bf16 a[136:139], a[144:147], v[56:59], a[136:139]
 buffer_load_dwordx4 a[92:95], v20, s[64:67], s94 offen offset:3072 sc1
 v_mfma_f32_16x16x32_bf16 v[128:131], a[148:151], v[64:67], v[192:195]
 v_exp_f32 v156, v156
 v_mfma_f32_16x16x32_bf16 v[128:131], a[152:155], v[80:83], v[128:131]
 ds_read_b128 a[232:235], v11 offset:4096
 ds_read_b64_tr_b16 a[176:177], v3 offset:8192
 v_mfma_f32_16x16x32_bf16 v[128:131], a[156:159], v[96:99], v[128:131]
 v_exp_f32 v157, v157
 v_mfma_f32_16x16x32_bf16 v[128:131], a[160:163], v[112:115], v[128:131]
 ds_read_b64_tr_b16 a[178:179], v3 offset:12288
 v_cvt_pk_bf16_f32 v190, v156, v157
 v_mfma_f32_16x16x32_bf16 v[132:135], a[160:163], v[116:119], v[196:199]
 v_exp_f32 v158, v158
 v_mfma_f32_16x16x32_bf16 v[132:135], a[156:159], v[100:103], v[132:135]
 buffer_load_dwordx4 v16, s[32:35], s86 offen offset:0 lds
 v_mfma_f32_16x16x32_bf16 v[132:135], a[152:155], v[84:87], v[132:135]
 v_exp_f32 v159, v159
 v_mfma_f32_16x16x32_bf16 v[132:135], a[148:151], v[68:71], v[132:135]
 v_cvt_pk_bf16_f32 v191, v158, v159
 v_mfma_f32_16x16x32_bf16 v[136:139], a[148:151], v[72:75], v[200:203]
 v_exp_f32 v128, v128
 v_mfma_f32_16x16x32_bf16 v[136:139], a[152:155], v[88:91], v[136:139]
 ds_read_b128 a[236:239], v12 offset:4096
 ds_read_b64_tr_b16 a[212:213], v4 offset:0
 v_mfma_f32_16x16x32_bf16 v[136:139], a[156:159], v[104:107], v[136:139]
 v_exp_f32 v129, v129
 v_mfma_f32_16x16x32_bf16 v[136:139], a[160:163], v[120:123], v[136:139]
 ds_read_b64_tr_b16 a[214:215], v4 offset:4096
 v_cvt_pk_bf16_f32 v32, v128, v129
 v_mfma_f32_16x16x32_bf16 v[140:143], a[160:163], v[124:127], v[204:207]
 v_exp_f32 v130, v130
 v_mfma_f32_16x16x32_bf16 v[140:143], a[156:159], v[108:111], v[140:143]
 buffer_load_dwordx4 v17, s[32:35], s86 offen offset:1024 lds
 v_mfma_f32_16x16x32_bf16 v[140:143], a[152:155], v[92:95], v[140:143]
 v_exp_f32 v131, v131
 v_mfma_f32_16x16x32_bf16 v[140:143], a[148:151], v[76:79], v[140:143]
 s_waitcnt lgkmcnt(3)
 v_cvt_pk_bf16_f32 v33, v130, v131
 v_mfma_f32_16x16x32_bf16 a[0:3], a[164:167], v[160:163], a[0:3]
 v_exp_f32 v132, v132
 v_mfma_f32_16x16x32_bf16 a[0:3], a[168:171], v[176:179], a[0:3]
 ds_read_b128 a[240:243], v13 offset:4096
 ds_read_b64_tr_b16 a[216:217], v4 offset:8192
 v_mfma_f32_16x16x32_bf16 a[4:7], a[168:171], v[180:183], a[4:7]
 v_exp_f32 v133, v133
 v_mfma_f32_16x16x32_bf16 a[4:7], a[164:167], v[164:167], a[4:7]
 ds_read_b64_tr_b16 a[218:219], v4 offset:12288
 v_cvt_pk_bf16_f32 v36, v132, v133
 v_mfma_f32_16x16x32_bf16 a[8:11], a[164:167], v[168:171], a[8:11]
 v_exp_f32 v134, v134
 v_mfma_f32_16x16x32_bf16 a[8:11], a[168:171], v[184:187], a[8:11]
 buffer_load_dwordx4 v18, s[32:35], s86 offen offset:2048 lds
 v_mfma_f32_16x16x32_bf16 a[12:15], a[168:171], v[188:191], a[12:15]
 v_exp_f32 v135, v135
 v_mfma_f32_16x16x32_bf16 a[12:15], a[164:167], v[172:175], a[12:15]
 v_cvt_pk_bf16_f32 v37, v134, v135
 v_mfma_f32_16x16x32_bf16 a[132:135], a[144:147], v[164:167], a[132:135]
 buffer_load_dwordx2 v[24:25], v22, s[28:31], s73 offen offset:0
 v_mfma_f32_16x16x32_bf16 a[132:135], a[144:147], v[180:183], a[132:135]
 buffer_load_dwordx2 v[26:27], v22, s[28:31], s73 offen offset:32
 v_mfma_f32_16x16x32_bf16 a[16:19], a[172:175], v[160:163], a[16:19]
 v_exp_f32 v136, v136
 v_mfma_f32_16x16x32_bf16 a[16:19], a[176:179], v[176:179], a[16:19]
 ds_read_b128 a[148:151], v10 offset:8192
 ds_read_b64_tr_b16 a[220:221], v5 offset:0
 v_mfma_f32_16x16x32_bf16 a[20:23], a[176:179], v[180:183], a[20:23]
 v_exp_f32 v137, v137
 v_mfma_f32_16x16x32_bf16 a[20:23], a[172:175], v[164:167], a[20:23]
 ds_read_b64_tr_b16 a[222:223], v5 offset:4096
 v_cvt_pk_bf16_f32 v40, v136, v137
 v_mfma_f32_16x16x32_bf16 a[24:27], a[172:175], v[168:171], a[24:27]
 v_exp_f32 v138, v138
 v_mfma_f32_16x16x32_bf16 a[24:27], a[176:179], v[184:187], a[24:27]
 buffer_load_dwordx4 v19, s[32:35], s86 offen offset:3072 lds
 v_mfma_f32_16x16x32_bf16 a[28:31], a[176:179], v[188:191], a[28:31]
 v_exp_f32 v139, v139
 v_mfma_f32_16x16x32_bf16 a[28:31], a[172:175], v[172:175], a[28:31]
 s_waitcnt lgkmcnt(3)
 v_cvt_pk_bf16_f32 v41, v138, v139
 v_mfma_f32_16x16x32_bf16 v[144:147], a[228:231], v[64:67], v[192:195]
 v_exp_f32 v140, v140
 v_mfma_f32_16x16x32_bf16 v[144:147], a[232:235], v[80:83], v[144:147]
 ds_read_b128 a[152:155], v11 offset:8192
 ds_read_b64_tr_b16 a[224:225], v5 offset:8192
 v_mfma_f32_16x16x32_bf16 v[144:147], a[236:239], v[96:99], v[144:147]
 v_exp_f32 v141, v141
 v_mfma_f32_16x16x32_bf16 v[144:147], a[240:243], v[112:115], v[144:147]
 ds_read_b64_tr_b16 a[226:227], v5 offset:12288
 v_cvt_pk_bf16_f32 v44, v140, v141
 v_mfma_f32_16x16x32_bf16 v[148:151], a[240:243], v[116:119], v[196:199]
 v_exp_f32 v142, v142
 v_mfma_f32_16x16x32_bf16 v[148:151], a[236:239], v[100:103], v[148:151]
 s_add_u32 s94, s94, 4096
 buffer_load_dwordx4 a[96:99], v20, s[64:67], s94 offen offset:0 sc1
 v_mfma_f32_16x16x32_bf16 v[148:151], a[232:235], v[84:87], v[148:151]
 v_exp_f32 v143, v143
 v_mfma_f32_16x16x32_bf16 v[148:151], a[228:231], v[68:71], v[148:151]
 v_cvt_pk_bf16_f32 v45, v142, v143
 v_mfma_f32_16x16x32_bf16 v[152:155], a[228:231], v[72:75], v[200:203]
 v_exp_f32 v144, v144
 v_mfma_f32_16x16x32_bf16 v[152:155], a[232:235], v[88:91], v[152:155]
 ds_read_b128 a[156:159], v12 offset:8192
 ds_read_b64_tr_b16 a[164:165], v6 offset:0
 v_mfma_f32_16x16x32_bf16 v[152:155], a[236:239], v[104:107], v[152:155]
 v_exp_f32 v145, v145
 v_mfma_f32_16x16x32_bf16 v[152:155], a[240:243], v[120:123], v[152:155]
 ds_read_b64_tr_b16 a[166:167], v6 offset:4096
 v_cvt_pk_bf16_f32 v34, v144, v145
 v_mfma_f32_16x16x32_bf16 v[156:159], a[240:243], v[124:127], v[204:207]
 v_exp_f32 v146, v146
 v_mfma_f32_16x16x32_bf16 v[156:159], a[236:239], v[108:111], v[156:159]
 buffer_load_dwordx4 a[100:103], v20, s[64:67], s94 offen offset:1024 sc1
 v_mfma_f32_16x16x32_bf16 v[156:159], a[232:235], v[92:95], v[156:159]
 v_exp_f32 v147, v147
 v_mfma_f32_16x16x32_bf16 v[156:159], a[228:231], v[76:79], v[156:159]
 s_waitcnt lgkmcnt(3)
 v_cvt_pk_bf16_f32 v35, v146, v147
 v_mfma_f32_16x16x32_bf16 a[32:35], a[212:215], v[160:163], a[32:35]
 v_exp_f32 v148, v148
 v_mfma_f32_16x16x32_bf16 a[32:35], a[216:219], v[176:179], a[32:35]
 ds_read_b128 a[160:163], v13 offset:8192
 ds_read_b64_tr_b16 a[168:169], v6 offset:8192
 v_mfma_f32_16x16x32_bf16 a[36:39], a[216:219], v[180:183], a[36:39]
 v_exp_f32 v149, v149
 v_mfma_f32_16x16x32_bf16 a[36:39], a[212:215], v[164:167], a[36:39]
 ds_read_b64_tr_b16 a[170:171], v6 offset:12288
 v_cvt_pk_bf16_f32 v38, v148, v149
 v_mfma_f32_16x16x32_bf16 a[40:43], a[212:215], v[168:171], a[40:43]
 v_exp_f32 v150, v150
 v_mfma_f32_16x16x32_bf16 a[40:43], a[216:219], v[184:187], a[40:43]
 v_mfma_f32_16x16x32_bf16 a[44:47], a[216:219], v[188:191], a[44:47]
 v_exp_f32 v151, v151
 v_mfma_f32_16x16x32_bf16 a[44:47], a[212:215], v[172:175], a[44:47]
 v_cvt_pk_bf16_f32 v39, v150, v151
 v_mfma_f32_16x16x32_bf16 a[48:51], a[220:223], v[160:163], a[48:51]
 v_exp_f32 v152, v152
 v_mfma_f32_16x16x32_bf16 a[48:51], a[224:227], v[176:179], a[48:51]
 ds_read_b128 a[228:231], v10 offset:12288
 ds_read_b64_tr_b16 a[172:173], v7 offset:0
 v_mfma_f32_16x16x32_bf16 a[52:55], a[224:227], v[180:183], a[52:55]
 v_exp_f32 v153, v153
 v_mfma_f32_16x16x32_bf16 a[52:55], a[220:223], v[164:167], a[52:55]
 ds_read_b64_tr_b16 a[174:175], v7 offset:4096
 v_cvt_pk_bf16_f32 v42, v152, v153
 v_mfma_f32_16x16x32_bf16 a[56:59], a[220:223], v[168:171], a[56:59]
 s_add_u32 m0, s87, 98304
 v_exp_f32 v154, v154
 v_mfma_f32_16x16x32_bf16 a[56:59], a[224:227], v[184:187], a[56:59]
 v_mfma_f32_16x16x32_bf16 a[60:63], a[224:227], v[188:191], a[60:63]
 v_exp_f32 v155, v155
 v_mfma_f32_16x16x32_bf16 a[60:63], a[220:223], v[172:175], a[60:63]
 s_waitcnt lgkmcnt(3)
 v_cvt_pk_bf16_f32 v43, v154, v155
 v_mfma_f32_16x16x32_bf16 a[128:131], a[144:147], v[160:163], a[128:131]
 buffer_load_dwordx4 a[104:107], v20, s[64:67], s94 offen offset:2048 sc1
 v_mfma_f32_16x16x32_bf16 a[128:131], a[144:147], v[176:179], a[128:131]
 buffer_load_dwordx4 a[108:111], v20, s[64:67], s94 offen offset:3072 sc1
 v_mfma_f32_16x16x32_bf16 v[128:131], a[148:151], v[64:67], v[192:195]
 v_exp_f32 v156, v156
 v_mfma_f32_16x16x32_bf16 v[128:131], a[152:155], v[80:83], v[128:131]
 ds_read_b128 a[232:235], v11 offset:12288
 ds_read_b64_tr_b16 a[176:177], v7 offset:8192
 v_mfma_f32_16x16x32_bf16 v[128:131], a[156:159], v[96:99], v[128:131]
 v_exp_f32 v157, v157
 v_mfma_f32_16x16x32_bf16 v[128:131], a[160:163], v[112:115], v[128:131]
 ds_read_b64_tr_b16 a[178:179], v7 offset:12288
 v_cvt_pk_bf16_f32 v46, v156, v157
 v_mfma_f32_16x16x32_bf16 v[132:135], a[160:163], v[116:119], v[196:199]
 v_exp_f32 v158, v158
 v_mfma_f32_16x16x32_bf16 v[132:135], a[156:159], v[100:103], v[132:135]
 buffer_load_dwordx4 v14, s[36:39], s85 offen offset:0 lds
 v_mfma_f32_16x16x32_bf16 v[132:135], a[152:155], v[84:87], v[132:135]
 v_exp_f32 v159, v159
 v_mfma_f32_16x16x32_bf16 v[132:135], a[148:151], v[68:71], v[132:135]
 v_cvt_pk_bf16_f32 v47, v158, v159
 v_mfma_f32_16x16x32_bf16 v[136:139], a[148:151], v[72:75], v[200:203]
 v_exp_f32 v128, v128
 v_mfma_f32_16x16x32_bf16 v[136:139], a[152:155], v[88:91], v[136:139]
 ds_read_b128 a[236:239], v12 offset:12288
 ds_read_b64_tr_b16 a[212:213], v8 offset:0
 v_mfma_f32_16x16x32_bf16 v[136:139], a[156:159], v[104:107], v[136:139]
 v_exp_f32 v129, v129
 v_mfma_f32_16x16x32_bf16 v[136:139], a[160:163], v[120:123], v[136:139]
 ds_read_b64_tr_b16 a[214:215], v8 offset:4096
 v_cvt_pk_bf16_f32 v48, v128, v129
 v_mfma_f32_16x16x32_bf16 v[140:143], a[160:163], v[124:127], v[204:207]
 v_exp_f32 v130, v130
 v_mfma_f32_16x16x32_bf16 v[140:143], a[156:159], v[108:111], v[140:143]
 buffer_load_dwordx4 v15, s[36:39], s85 offen offset:1024 lds
 v_mfma_f32_16x16x32_bf16 v[140:143], a[152:155], v[92:95], v[140:143]
 v_exp_f32 v131, v131
 v_mfma_f32_16x16x32_bf16 v[140:143], a[148:151], v[76:79], v[140:143]
 s_waitcnt lgkmcnt(3)
 v_cvt_pk_bf16_f32 v49, v130, v131
 v_mfma_f32_16x16x32_bf16 a[64:67], a[164:167], v[160:163], a[64:67]
 v_exp_f32 v132, v132
 v_mfma_f32_16x16x32_bf16 a[64:67], a[168:171], v[176:179], a[64:67]
 ds_read_b128 a[240:243], v13 offset:12288
 ds_read_b64_tr_b16 a[216:217], v8 offset:8192
 v_mfma_f32_16x16x32_bf16 a[68:71], a[168:171], v[180:183], a[68:71]
 v_exp_f32 v133, v133
 v_mfma_f32_16x16x32_bf16 a[68:71], a[164:167], v[164:167], a[68:71]
 ds_read_b64_tr_b16 a[218:219], v8 offset:12288
 v_cvt_pk_bf16_f32 v52, v132, v133
 v_mfma_f32_16x16x32_bf16 a[72:75], a[164:167], v[168:171], a[72:75]
 v_exp_f32 v134, v134
 v_mfma_f32_16x16x32_bf16 a[72:75], a[168:171], v[184:187], a[72:75]
 buffer_load_dwordx4 v14, s[36:39], s85 offen offset:2048 lds
 v_mfma_f32_16x16x32_bf16 a[76:79], a[168:171], v[188:191], a[76:79]
 v_exp_f32 v135, v135
 v_mfma_f32_16x16x32_bf16 a[76:79], a[164:167], v[172:175], a[76:79]
 v_cvt_pk_bf16_f32 v53, v134, v135
 v_mfma_f32_16x16x32_bf16 a[136:139], a[144:147], v[168:171], a[136:139]
 s_waitcnt vmcnt(18)
 v_mfma_f32_16x16x32_bf16 a[136:139], a[144:147], v[184:187], a[136:139]
 s_barrier
 v_mfma_f32_16x16x32_bf16 v[208:211], a[172:175], v[160:163], v[208:211]
 v_exp_f32 v136, v136
 v_mfma_f32_16x16x32_bf16 v[208:211], a[176:179], v[176:179], v[208:211]
 ds_read_b128 a[148:151], v10 offset:16384
 ds_read_b64_tr_b16 a[220:221], v9 offset:0
 v_mfma_f32_16x16x32_bf16 v[212:215], a[176:179], v[180:183], v[212:215]
 v_exp_f32 v137, v137
 v_mfma_f32_16x16x32_bf16 v[212:215], a[172:175], v[164:167], v[212:215]
 ds_read_b64_tr_b16 a[222:223], v9 offset:4096
 v_cvt_pk_bf16_f32 v56, v136, v137
 v_mfma_f32_16x16x32_bf16 v[216:219], a[172:175], v[168:171], v[216:219]
 v_exp_f32 v138, v138
 v_mfma_f32_16x16x32_bf16 v[216:219], a[176:179], v[184:187], v[216:219]
 buffer_load_dwordx4 v15, s[36:39], s85 offen offset:3072 lds
 v_mfma_f32_16x16x32_bf16 v[220:223], a[176:179], v[188:191], v[220:223]
 v_exp_f32 v139, v139
 v_mfma_f32_16x16x32_bf16 v[220:223], a[172:175], v[172:175], v[220:223]
 s_waitcnt lgkmcnt(3)
 v_cvt_pk_bf16_f32 v57, v138, v139
 v_mfma_f32_16x16x32_bf16 v[144:147], a[228:231], v[64:67], v[192:195]
 v_exp_f32 v140, v140
 v_mfma_f32_16x16x32_bf16 v[144:147], a[232:235], v[80:83], v[144:147]
 ds_read_b128 a[152:155], v11 offset:16384
 ds_read_b64_tr_b16 a[224:225], v9 offset:8192
 v_mfma_f32_16x16x32_bf16 v[144:147], a[236:239], v[96:99], v[144:147]
 v_exp_f32 v141, v141
 v_mfma_f32_16x16x32_bf16 v[144:147], a[240:243], v[112:115], v[144:147]
 ds_read_b64_tr_b16 a[226:227], v9 offset:12288
 v_cvt_pk_bf16_f32 v60, v140, v141
 v_mfma_f32_16x16x32_bf16 v[148:151], a[240:243], v[116:119], v[196:199]
 v_exp_f32 v142, v142
 v_mfma_f32_16x16x32_bf16 v[148:151], a[236:239], v[100:103], v[148:151]
 s_add_u32 s94, s94, 4096
 buffer_load_dwordx4 a[112:115], v20, s[64:67], s94 offen offset:0 sc1
 v_mfma_f32_16x16x32_bf16 v[148:151], a[232:235], v[84:87], v[148:151]
 v_exp_f32 v143, v143
 v_mfma_f32_16x16x32_bf16 v[148:151], a[228:231], v[68:71], v[148:151]
 v_cvt_pk_bf16_f32 v61, v142, v143
 v_mfma_f32_16x16x32_bf16 v[152:155], a[228:231], v[72:75], v[200:203]
 v_exp_f32 v144, v144
 v_mfma_f32_16x16x32_bf16 v[152:155], a[232:235], v[88:91], v[152:155]
 ds_read_b128 a[156:159], v12 offset:16384
 ds_read_b64_tr_b16 a[164:165], v2 offset:16384
 v_mfma_f32_16x16x32_bf16 v[152:155], a[236:239], v[104:107], v[152:155]
 v_exp_f32 v145, v145
 v_mfma_f32_16x16x32_bf16 v[152:155], a[240:243], v[120:123], v[152:155]
 ds_read_b64_tr_b16 a[166:167], v2 offset:20480
 v_cvt_pk_bf16_f32 v50, v144, v145
 v_mfma_f32_16x16x32_bf16 v[156:159], a[240:243], v[124:127], v[204:207]
 v_exp_f32 v146, v146
 v_mfma_f32_16x16x32_bf16 v[156:159], a[236:239], v[108:111], v[156:159]
 buffer_load_dwordx4 a[116:119], v20, s[64:67], s94 offen offset:1024 sc1
 v_mfma_f32_16x16x32_bf16 v[156:159], a[232:235], v[92:95], v[156:159]
 v_exp_f32 v147, v147
 v_mfma_f32_16x16x32_bf16 v[156:159], a[228:231], v[76:79], v[156:159]
 s_waitcnt lgkmcnt(3)
 v_cvt_pk_bf16_f32 v51, v146, v147
 v_mfma_f32_16x16x32_bf16 v[224:227], a[212:215], v[160:163], v[224:227]
 v_exp_f32 v148, v148
 v_mfma_f32_16x16x32_bf16 v[224:227], a[216:219], v[176:179], v[224:227]
 ds_read_b128 a[160:163], v13 offset:16384
 ds_read_b64_tr_b16 a[168:169], v2 offset:24576
 v_mfma_f32_16x16x32_bf16 v[228:231], a[216:219], v[180:183], v[228:231]
 v_exp_f32 v149, v149
 v_mfma_f32_16x16x32_bf16 v[228:231], a[212:215], v[164:167], v[228:231]
 ds_read_b64_tr_b16 a[170:171], v2 offset:28672
 v_cvt_pk_bf16_f32 v54, v148, v149
 v_mfma_f32_16x16x32_bf16 v[232:235], a[212:215], v[168:171], v[232:235]
 v_exp_f32 v150, v150
 v_mfma_f32_16x16x32_bf16 v[232:235], a[216:219], v[184:187], v[232:235]
 buffer_load_dword a254, v23, s[56:59], s75 offen offset:3584
 v_mfma_f32_16x16x32_bf16 v[236:239], a[216:219], v[188:191], v[236:239]
 v_exp_f32 v151, v151
 v_mfma_f32_16x16x32_bf16 v[236:239], a[212:215], v[172:175], v[236:239]
 v_cvt_pk_bf16_f32 v55, v150, v151
 v_mfma_f32_16x16x32_bf16 v[240:243], a[220:223], v[160:163], v[240:243]
 v_exp_f32 v152, v152
 v_mfma_f32_16x16x32_bf16 v[240:243], a[224:227], v[176:179], v[240:243]
 ds_read_b128 a[228:231], v10 offset:20480
 ds_read_b64_tr_b16 a[172:173], v3 offset:16384
 v_mfma_f32_16x16x32_bf16 v[244:247], a[224:227], v[180:183], v[244:247]
 v_exp_f32 v153, v153
 v_mfma_f32_16x16x32_bf16 v[244:247], a[220:223], v[164:167], v[244:247]
 ds_read_b64_tr_b16 a[174:175], v3 offset:20480
 v_cvt_pk_bf16_f32 v58, v152, v153
 v_mfma_f32_16x16x32_bf16 v[248:251], a[220:223], v[168:171], v[248:251]
 v_exp_f32 v154, v154
 v_mfma_f32_16x16x32_bf16 v[248:251], a[224:227], v[184:187], v[248:251]
 v_mfma_f32_16x16x32_bf16 v[252:255], a[224:227], v[188:191], v[252:255]
 v_exp_f32 v155, v155
 v_mfma_f32_16x16x32_bf16 v[252:255], a[220:223], v[172:175], v[252:255]
 s_waitcnt lgkmcnt(3)
 v_cvt_pk_bf16_f32 v59, v154, v155
 v_mfma_f32_16x16x32_bf16 a[140:143], a[144:147], v[172:175], a[140:143]
 buffer_load_dwordx4 a[120:123], v20, s[64:67], s94 offen offset:2048 sc1
 v_mfma_f32_16x16x32_bf16 a[140:143], a[144:147], v[188:191], a[140:143]
 buffer_load_dwordx4 a[124:127], v20, s[64:67], s94 offen offset:3072 sc1
 v_mfma_f32_16x16x32_bf16 v[128:131], a[148:151], v[64:67], v[192:195]
 v_exp_f32 v156, v156
 v_mfma_f32_16x16x32_bf16 v[128:131], a[152:155], v[80:83], v[128:131]
 ds_read_b128 a[232:235], v11 offset:20480
 ds_read_b64_tr_b16 a[176:177], v3 offset:24576
 v_mfma_f32_16x16x32_bf16 v[128:131], a[156:159], v[96:99], v[128:131]
 v_exp_f32 v157, v157
 v_mfma_f32_16x16x32_bf16 v[128:131], a[160:163], v[112:115], v[128:131]
 ds_read_b64_tr_b16 a[178:179], v3 offset:28672
 v_cvt_pk_bf16_f32 v62, v156, v157
 v_mfma_f32_16x16x32_bf16 v[132:135], a[160:163], v[116:119], v[196:199]
 v_exp_f32 v158, v158
 v_mfma_f32_16x16x32_bf16 v[132:135], a[156:159], v[100:103], v[132:135]
 v_mfma_f32_16x16x32_bf16 v[132:135], a[152:155], v[84:87], v[132:135]
 v_exp_f32 v159, v159
 v_mfma_f32_16x16x32_bf16 v[132:135], a[148:151], v[68:71], v[132:135]
 v_cvt_pk_bf16_f32 v63, v158, v159
 v_mfma_f32_16x16x32_bf16 v[136:139], a[148:151], v[72:75], v[200:203]
 v_exp_f32 v128, v128
 v_mfma_f32_16x16x32_bf16 v[136:139], a[152:155], v[88:91], v[136:139]
 ds_read_b128 a[236:239], v12 offset:20480
 ds_read_b64_tr_b16 a[212:213], v4 offset:16384
 v_mfma_f32_16x16x32_bf16 v[136:139], a[156:159], v[104:107], v[136:139]
 v_exp_f32 v129, v129
 v_mfma_f32_16x16x32_bf16 v[136:139], a[160:163], v[120:123], v[136:139]
 ds_read_b64_tr_b16 a[214:215], v4 offset:20480
 v_cvt_pk_bf16_f32 v160, v128, v129
 v_mfma_f32_16x16x32_bf16 v[140:143], a[160:163], v[124:127], v[204:207]
 v_exp_f32 v130, v130
 v_mfma_f32_16x16x32_bf16 v[140:143], a[156:159], v[108:111], v[140:143]
 v_mfma_f32_16x16x32_bf16 v[140:143], a[152:155], v[92:95], v[140:143]
 v_exp_f32 v131, v131
 v_mfma_f32_16x16x32_bf16 v[140:143], a[148:151], v[76:79], v[140:143]
 s_waitcnt lgkmcnt(3)
 v_cvt_pk_bf16_f32 v161, v130, v131
 v_mfma_f32_16x16x32_bf16 a[0:3], a[164:167], v[32:35], a[0:3]
 v_exp_f32 v132, v132
 v_mfma_f32_16x16x32_bf16 a[0:3], a[168:171], v[48:51], a[0:3]
 ds_read_b128 a[240:243], v13 offset:20480
 ds_read_b64_tr_b16 a[216:217], v4 offset:24576
 v_mfma_f32_16x16x32_bf16 a[4:7], a[168:171], v[52:55], a[4:7]
 v_exp_f32 v133, v133
 v_mfma_f32_16x16x32_bf16 a[4:7], a[164:167], v[36:39], a[4:7]
 ds_read_b64_tr_b16 a[218:219], v4 offset:28672
 v_cvt_pk_bf16_f32 v164, v132, v133
 v_mfma_f32_16x16x32_bf16 a[8:11], a[164:167], v[40:43], a[8:11]
 v_exp_f32 v134, v134
 v_mfma_f32_16x16x32_bf16 a[8:11], a[168:171], v[56:59], a[8:11]
 v_mfma_f32_16x16x32_bf16 a[12:15], a[168:171], v[60:63], a[12:15]
 v_exp_f32 v135, v135
 v_mfma_f32_16x16x32_bf16 a[12:15], a[164:167], v[44:47], a[12:15]
 v_cvt_pk_bf16_f32 v165, v134, v135
 v_mfma_f32_16x16x32_bf16 a[132:135], a[144:147], v[36:39], a[132:135]
 buffer_load_dwordx2 a[244:245], v22, s[28:31], s73 offen offset:64
 v_mfma_f32_16x16x32_bf16 a[132:135], a[144:147], v[52:55], a[132:135]
 buffer_load_dwordx2 a[246:247], v22, s[28:31], s73 offen offset:96
 v_mfma_f32_16x16x32_bf16 a[16:19], a[172:175], v[32:35], a[16:19]
 v_exp_f32 v136, v136
 v_mfma_f32_16x16x32_bf16 a[16:19], a[176:179], v[48:51], a[16:19]
 ds_read_b128 a[148:151], v10 offset:24576
 ds_read_b64_tr_b16 a[220:221], v5 offset:16384
 v_mfma_f32_16x16x32_bf16 a[20:23], a[176:179], v[52:55], a[20:23]
 v_exp_f32 v137, v137
 v_mfma_f32_16x16x32_bf16 a[20:23], a[172:175], v[36:39], a[20:23]
 ds_read_b64_tr_b16 a[222:223], v5 offset:20480
 v_cvt_pk_bf16_f32 v168, v136, v137
 v_mfma_f32_16x16x32_bf16 a[24:27], a[172:175], v[40:43], a[24:27]
 v_exp_f32 v138, v138
 v_mfma_f32_16x16x32_bf16 a[24:27], a[176:179], v[56:59], a[24:27]
 v_mfma_f32_16x16x32_bf16 a[28:31], a[176:179], v[60:63], a[28:31]
 v_exp_f32 v139, v139
 v_mfma_f32_16x16x32_bf16 a[28:31], a[172:175], v[44:47], a[28:31]
 s_waitcnt lgkmcnt(3)
 v_cvt_pk_bf16_f32 v169, v138, v139
 v_mfma_f32_16x16x32_bf16 v[144:147], a[228:231], v[64:67], v[192:195]
 v_exp_f32 v140, v140
 v_mfma_f32_16x16x32_bf16 v[144:147], a[232:235], v[80:83], v[144:147]
 ds_read_b128 a[152:155], v11 offset:24576
 ds_read_b64_tr_b16 a[224:225], v5 offset:24576
 v_mfma_f32_16x16x32_bf16 v[144:147], a[236:239], v[96:99], v[144:147]
 v_exp_f32 v141, v141
 v_mfma_f32_16x16x32_bf16 v[144:147], a[240:243], v[112:115], v[144:147]
 ds_read_b64_tr_b16 a[226:227], v5 offset:28672
 v_cvt_pk_bf16_f32 v172, v140, v141
 v_mfma_f32_16x16x32_bf16 v[148:151], a[240:243], v[116:119], v[196:199]
 v_exp_f32 v142, v142
 v_mfma_f32_16x16x32_bf16 v[148:151], a[236:239], v[100:103], v[148:151]
 s_add_u32 s94, s94, 4096
 buffer_load_dwordx4 a[180:183], v20, s[64:67], s94 offen offset:0 sc1
 v_mfma_f32_16x16x32_bf16 v[148:151], a[232:235], v[84:87], v[148:151]
 v_exp_f32 v143, v143
 v_mfma_f32_16x16x32_bf16 v[148:151], a[228:231], v[68:71], v[148:151]
 v_cvt_pk_bf16_f32 v173, v142, v143
 v_mfma_f32_16x16x32_bf16 v[152:155], a[228:231], v[72:75], v[200:203]
 v_exp_f32 v144, v144
 v_mfma_f32_16x16x32_bf16 v[152:155], a[232:235], v[88:91], v[152:155]
 ds_read_b128 a[156:159], v12 offset:24576
 ds_read_b64_tr_b16 a[164:165], v6 offset:16384
 v_mfma_f32_16x16x32_bf16 v[152:155], a[236:239], v[104:107], v[152:155]
 v_exp_f32 v145, v145
 v_mfma_f32_16x16x32_bf16 v[152:155], a[240:243], v[120:123], v[152:155]
 ds_read_b64_tr_b16 a[166:167], v6 offset:20480
 v_cvt_pk_bf16_f32 v162, v144, v145
 v_mfma_f32_16x16x32_bf16 v[156:159], a[240:243], v[124:127], v[204:207]
 v_exp_f32 v146, v146
 v_mfma_f32_16x16x32_bf16 v[156:159], a[236:239], v[108:111], v[156:159]
 buffer_load_dwordx4 a[184:187], v20, s[64:67], s94 offen offset:1024 sc1
 v_mfma_f32_16x16x32_bf16 v[156:159], a[232:235], v[92:95], v[156:159]
 v_exp_f32 v147, v147
 v_mfma_f32_16x16x32_bf16 v[156:159], a[228:231], v[76:79], v[156:159]
 s_waitcnt lgkmcnt(3)
 v_cvt_pk_bf16_f32 v163, v146, v147
 v_mfma_f32_16x16x32_bf16 a[32:35], a[212:215], v[32:35], a[32:35]
 v_exp_f32 v148, v148
 v_mfma_f32_16x16x32_bf16 a[32:35], a[216:219], v[48:51], a[32:35]
 ds_read_b128 a[160:163], v13 offset:24576
 ds_read_b64_tr_b16 a[168:169], v6 offset:24576
 v_mfma_f32_16x16x32_bf16 a[36:39], a[216:219], v[52:55], a[36:39]
 v_exp_f32 v149, v149
 v_mfma_f32_16x16x32_bf16 a[36:39], a[212:215], v[36:39], a[36:39]
 ds_read_b64_tr_b16 a[170:171], v6 offset:28672
 v_cvt_pk_bf16_f32 v166, v148, v149
 v_mfma_f32_16x16x32_bf16 a[40:43], a[212:215], v[40:43], a[40:43]
 v_exp_f32 v150, v150
 v_mfma_f32_16x16x32_bf16 a[40:43], a[216:219], v[56:59], a[40:43]
 v_mfma_f32_16x16x32_bf16 a[44:47], a[216:219], v[60:63], a[44:47]
 v_exp_f32 v151, v151
 v_mfma_f32_16x16x32_bf16 a[44:47], a[212:215], v[44:47], a[44:47]
 v_cvt_pk_bf16_f32 v167, v150, v151
 v_mfma_f32_16x16x32_bf16 a[48:51], a[220:223], v[32:35], a[48:51]
 v_exp_f32 v152, v152
 v_mfma_f32_16x16x32_bf16 a[48:51], a[224:227], v[48:51], a[48:51]
 ds_read_b128 a[228:231], v10 offset:28672
 ds_read_b64_tr_b16 a[172:173], v7 offset:16384
 v_mfma_f32_16x16x32_bf16 a[52:55], a[224:227], v[52:55], a[52:55]
 v_exp_f32 v153, v153
 v_mfma_f32_16x16x32_bf16 a[52:55], a[220:223], v[36:39], a[52:55]
 ds_read_b64_tr_b16 a[174:175], v7 offset:20480
 v_cvt_pk_bf16_f32 v170, v152, v153
 v_mfma_f32_16x16x32_bf16 a[56:59], a[220:223], v[40:43], a[56:59]
 s_add_u32 m0, s87, 114688
 v_exp_f32 v154, v154
 v_mfma_f32_16x16x32_bf16 a[56:59], a[224:227], v[56:59], a[56:59]
 v_mfma_f32_16x16x32_bf16 a[60:63], a[224:227], v[60:63], a[60:63]
 v_exp_f32 v155, v155
 v_mfma_f32_16x16x32_bf16 a[60:63], a[220:223], v[44:47], a[60:63]
 s_waitcnt lgkmcnt(3)
 v_cvt_pk_bf16_f32 v171, v154, v155
 v_mfma_f32_16x16x32_bf16 a[128:131], a[144:147], v[32:35], a[128:131]
 buffer_load_dwordx4 a[188:191], v20, s[64:67], s94 offen offset:2048 sc1
 v_mfma_f32_16x16x32_bf16 a[128:131], a[144:147], v[48:51], a[128:131]
 buffer_load_dwordx4 a[192:195], v20, s[64:67], s94 offen offset:3072 sc1
 v_mfma_f32_16x16x32_bf16 v[128:131], a[148:151], v[64:67], v[192:195]
 v_exp_f32 v156, v156
 v_mfma_f32_16x16x32_bf16 v[128:131], a[152:155], v[80:83], v[128:131]
 ds_read_b128 a[232:235], v11 offset:28672
 ds_read_b64_tr_b16 a[176:177], v7 offset:24576
 v_mfma_f32_16x16x32_bf16 v[128:131], a[156:159], v[96:99], v[128:131]
 v_exp_f32 v157, v157
 v_mfma_f32_16x16x32_bf16 v[128:131], a[160:163], v[112:115], v[128:131]
 ds_read_b64_tr_b16 a[178:179], v7 offset:28672
 v_cvt_pk_bf16_f32 v174, v156, v157
 v_mfma_f32_16x16x32_bf16 v[132:135], a[160:163], v[116:119], v[196:199]
 v_exp_f32 v158, v158
 v_mfma_f32_16x16x32_bf16 v[132:135], a[156:159], v[100:103], v[132:135]
 buffer_load_dwordx4 v14, s[36:39], s86 offen offset:0 lds
 v_mfma_f32_16x16x32_bf16 v[132:135], a[152:155], v[84:87], v[132:135]
 v_exp_f32 v159, v159
 v_mfma_f32_16x16x32_bf16 v[132:135], a[148:151], v[68:71], v[132:135]
 v_cvt_pk_bf16_f32 v175, v158, v159
L_pg12:
 s_cbranch_execz L_site1
 v_mfma_f32_16x16x32_bf16 v[136:139], a[148:151], v[72:75], v[200:203]
 v_exp_f32 v128, v128
 v_mfma_f32_16x16x32_bf16 v[136:139], a[152:155], v[88:91], v[136:139]
 ds_read_b128 a[236:239], v12 offset:28672
 ds_read_b64_tr_b16 a[212:213], v8 offset:16384
 v_mfma_f32_16x16x32_bf16 v[136:139], a[156:159], v[104:107], v[136:139]
 v_exp_f32 v129, v129
 v_mfma_f32_16x16x32_bf16 v[136:139], a[160:163], v[120:123], v[136:139]
 ds_read_b64_tr_b16 a[214:215], v8 offset:20480
 v_cvt_pk_bf16_f32 v176, v128, v129
 v_mfma_f32_16x16x32_bf16 v[140:143], a[160:163], v[124:127], v[204:207]
 v_exp_f32 v130, v130
 v_mfma_f32_16x16x32_bf16 v[140:143], a[156:159], v[108:111], v[140:143]
 buffer_load_dwordx4 v15, s[36:39], s86 offen offset:1024 lds
 v_mfma_f32_16x16x32_bf16 v[140:143], a[152:155], v[92:95], v[140:143]
 v_exp_f32 v131, v131
 v_mfma_f32_16x16x32_bf16 v[140:143], a[148:151], v[76:79], v[140:143]
 s_waitcnt lgkmcnt(3)
 v_cvt_pk_bf16_f32 v177, v130, v131
 v_mfma_f32_16x16x32_bf16 a[64:67], a[164:167], v[32:35], a[64:67]
 v_exp_f32 v132, v132
 v_mfma_f32_16x16x32_bf16 a[64:67], a[168:171], v[48:51], a[64:67]
 ds_read_b128 a[240:243], v13 offset:28672
 ds_read_b64_tr_b16 a[216:217], v8 offset:24576
 v_mfma_f32_16x16x32_bf16 a[68:71], a[168:171], v[52:55], a[68:71]
 v_exp_f32 v133, v133
 v_mfma_f32_16x16x32_bf16 a[68:71], a[164:167], v[36:39], a[68:71]
 ds_read_b64_tr_b16 a[218:219], v8 offset:28672
 v_cvt_pk_bf16_f32 v180, v132, v133
 v_mfma_f32_16x16x32_bf16 a[72:75], a[164:167], v[40:43], a[72:75]
 v_exp_f32 v134, v134
 v_mfma_f32_16x16x32_bf16 a[72:75], a[168:171], v[56:59], a[72:75]
 buffer_load_dwordx4 v14, s[36:39], s86 offen offset:2048 lds
 v_mfma_f32_16x16x32_bf16 a[76:79], a[168:171], v[60:63], a[76:79]
 v_exp_f32 v135, v135
 v_mfma_f32_16x16x32_bf16 a[76:79], a[164:167], v[44:47], a[76:79]
 v_cvt_pk_bf16_f32 v181, v134, v135
 v_mfma_f32_16x16x32_bf16 a[136:139], a[144:147], v[40:43], a[136:139]
 s_waitcnt vmcnt(14)
 v_mfma_f32_16x16x32_bf16 a[136:139], a[144:147], v[56:59], a[136:139]
 s_barrier
 v_mfma_f32_16x16x32_bf16 v[208:211], a[172:175], v[32:35], v[208:211]
 v_exp_f32 v136, v136
 v_mfma_f32_16x16x32_bf16 v[208:211], a[176:179], v[48:51], v[208:211]
 ds_read_b128 a[148:151], v10 offset:32768
 ds_read_b64_tr_b16 a[220:221], v9 offset:16384
 v_mfma_f32_16x16x32_bf16 v[212:215], a[176:179], v[52:55], v[212:215]
 v_exp_f32 v137, v137
 v_mfma_f32_16x16x32_bf16 v[212:215], a[172:175], v[36:39], v[212:215]
 ds_read_b64_tr_b16 a[222:223], v9 offset:20480
 v_cvt_pk_bf16_f32 v184, v136, v137
 v_mfma_f32_16x16x32_bf16 v[216:219], a[172:175], v[40:43], v[216:219]
 v_exp_f32 v138, v138
 v_mfma_f32_16x16x32_bf16 v[216:219], a[176:179], v[56:59], v[216:219]
 buffer_load_dwordx4 v15, s[36:39], s86 offen offset:3072 lds
 v_mfma_f32_16x16x32_bf16 v[220:223], a[176:179], v[60:63], v[220:223]
 v_exp_f32 v139, v139
 v_mfma_f32_16x16x32_bf16 v[220:223], a[172:175], v[44:47], v[220:223]
 s_waitcnt lgkmcnt(3)
 v_cvt_pk_bf16_f32 v185, v138, v139
 v_mfma_f32_16x16x32_bf16 v[144:147], a[228:231], v[64:67], v[192:195]
 v_exp_f32 v140, v140
 v_mfma_f32_16x16x32_bf16 v[144:147], a[232:235], v[80:83], v[144:147]
 ds_read_b128 a[152:155], v11 offset:32768
 ds_read_b64_tr_b16 a[224:225], v9 offset:24576
 v_mfma_f32_16x16x32_bf16 v[144:147], a[236:239], v[96:99], v[144:147]
 v_exp_f32 v141, v141
 v_mfma_f32_16x16x32_bf16 v[144:147], a[240:243], v[112:115], v[144:147]
 ds_read_b64_tr_b16 a[226:227], v9 offset:28672
 v_cvt_pk_bf16_f32 v188, v140, v141
 v_mfma_f32_16x16x32_bf16 v[148:151], a[240:243], v[116:119], v[196:199]
 v_exp_f32 v142, v142
 v_mfma_f32_16x16x32_bf16 v[148:151], a[236:239], v[100:103], v[148:151]
 s_add_u32 s94, s94, 4096
 buffer_load_dwordx4 a[196:199], v20, s[64:67], s94 offen offset:0 sc1
 v_mfma_f32_16x16x32_bf16 v[148:151], a[232:235], v[84:87], v[148:151]
 v_exp_f32 v143, v143
 v_mfma_f32_16x16x32_bf16 v[148:151], a[228:231], v[68:71], v[148:151]
 v_cvt_pk_bf16_f32 v189, v142, v143
 v_mfma_f32_16x16x32_bf16 v[152:155], a[228:231], v[72:75], v[200:203]
 v_exp_f32 v144, v144
 v_mfma_f32_16x16x32_bf16 v[152:155], a[232:235], v[88:91], v[152:155]
 ds_read_b128 a[156:159], v12 offset:32768
 ds_read_b64_tr_b16 a[164:165], v2 offset:32768
 v_mfma_f32_16x16x32_bf16 v[152:155], a[236:239], v[104:107], v[152:155]
 v_exp_f32 v145, v145
 v_mfma_f32_16x16x32_bf16 v[152:155], a[240:243], v[120:123], v[152:155]
 ds_read_b64_tr_b16 a[166:167], v2 offset:36864
 v_cvt_pk_bf16_f32 v178, v144, v145
 v_mfma_f32_16x16x32_bf16 v[156:159], a[240:243], v[124:127], v[204:207]
 v_exp_f32 v146, v146
 v_mfma_f32_16x16x32_bf16 v[156:159], a[236:239], v[108:111], v[156:159]
 buffer_load_dwordx4 a[200:203], v20, s[64:67], s94 offen offset:1024 sc1
 v_mfma_f32_16x16x32_bf16 v[156:159], a[232:235], v[92:95], v[156:159]
 v_exp_f32 v147, v147
 v_mfma_f32_16x16x32_bf16 v[156:159], a[228:231], v[76:79], v[156:159]
 s_waitcnt lgkmcnt(3)
 v_cvt_pk_bf16_f32 v179, v146, v147
 v_mfma_f32_16x16x32_bf16 v[224:227], a[212:215], v[32:35], v[224:227]
 v_exp_f32 v148, v148
 v_mfma_f32_16x16x32_bf16 v[224:227], a[216:219], v[48:51], v[224:227]
 ds_read_b128 a[160:163], v13 offset:32768
 ds_read_b64_tr_b16 a[168:169], v2 offset:40960
 v_mfma_f32_16x16x32_bf16 v[228:231], a[216:219], v[52:55], v[228:231]
 v_exp_f32 v149, v149
 v_mfma_f32_16x16x32_bf16 v[228:231], a[212:215], v[36:39], v[228:231]
 ds_read_b64_tr_b16 a[170:171], v2 offset:45056
 v_cvt_pk_bf16_f32 v182, v148, v149
 v_mfma_f32_16x16x32_bf16 v[232:235], a[212:215], v[40:43], v[232:235]
 v_exp_f32 v150, v150
 v_mfma_f32_16x16x32_bf16 v[232:235], a[216:219], v[56:59], v[232:235]
 v_mfma_f32_16x16x32_bf16 v[236:239], a[216:219], v[60:63], v[236:239]
 v_exp_f32 v151, v151
 v_mfma_f32_16x16x32_bf16 v[236:239], a[212:215], v[44:47], v[236:239]
 v_cvt_pk_bf16_f32 v183, v150, v151
 v_mfma_f32_16x16x32_bf16 v[240:243], a[220:223], v[32:35], v[240:243]
 v_exp_f32 v152, v152
 v_mfma_f32_16x16x32_bf16 v[240:243], a[224:227], v[48:51], v[240:243]
 ds_read_b128 a[228:231], v10 offset:36864
 ds_read_b64_tr_b16 a[172:173], v3 offset:32768
 v_mfma_f32_16x16x32_bf16 v[244:247], a[224:227], v[52:55], v[244:247]
 v_exp_f32 v153, v153
 v_mfma_f32_16x16x32_bf16 v[244:247], a[220:223], v[36:39], v[244:247]
 ds_read_b64_tr_b16 a[174:175], v3 offset:36864
 v_cvt_pk_bf16_f32 v186, v152, v153
 v_mfma_f32_16x16x32_bf16 v[248:251], a[220:223], v[40:43], v[248:251]
 v_exp_f32 v154, v154
 v_mfma_f32_16x16x32_bf16 v[248:251], a[224:227], v[56:59], v[248:251]
 v_mfma_f32_16x16x32_bf16 v[252:255], a[224:227], v[60:63], v[252:255]
 v_exp_f32 v155, v155
 v_mfma_f32_16x16x32_bf16 v[252:255], a[220:223], v[44:47], v[252:255]
 s_waitcnt lgkmcnt(3)
 v_cvt_pk_bf16_f32 v187, v154, v155
 v_mfma_f32_16x16x32_bf16 a[140:143], a[144:147], v[44:47], a[140:143]
 buffer_load_dwordx4 a[204:207], v20, s[64:67], s94 offen offset:2048 sc1
 v_mfma_f32_16x16x32_bf16 a[140:143], a[144:147], v[60:63], a[140:143]
 buffer_load_dwordx4 a[208:211], v20, s[64:67], s94 offen offset:3072 sc1
 v_mfma_f32_16x16x32_bf16 v[128:131], a[148:151], v[64:67], v[192:195]
 v_exp_f32 v156, v156
 v_mfma_f32_16x16x32_bf16 v[128:131], a[152:155], v[80:83], v[128:131]
 ds_read_b128 a[232:235], v11 offset:36864
 ds_read_b64_tr_b16 a[176:177], v3 offset:40960
 v_mfma_f32_16x16x32_bf16 v[128:131], a[156:159], v[96:99], v[128:131]
 v_exp_f32 v157, v157
 v_mfma_f32_16x16x32_bf16 v[128:131], a[160:163], v[112:115], v[128:131]
 ds_read_b64_tr_b16 a[178:179], v3 offset:45056
 v_cvt_pk_bf16_f32 v190, v156, v157
 v_mfma_f32_16x16x32_bf16 v[132:135], a[160:163], v[116:119], v[196:199]
 v_exp_f32 v158, v158
 v_mfma_f32_16x16x32_bf16 v[132:135], a[156:159], v[100:103], v[132:135]
 s_lshl_b32 s95, s77, 19
 s_lshl_b32 s88, s76, 8
 s_add_u32 s95, s95, s88
 s_add_u32 m0, s96, 65536
 s_add_u32 s84, s95, 0
 v_mfma_f32_16x16x32_bf16 v[132:135], a[152:155], v[84:87], v[132:135]
 v_exp_f32 v159, v159
 v_mfma_f32_16x16x32_bf16 v[132:135], a[148:151], v[68:71], v[132:135]
 v_cvt_pk_bf16_f32 v191, v158, v159
 v_mfma_f32_16x16x32_bf16 v[136:139], a[148:151], v[72:75], v[200:203]
 v_exp_f32 v128, v128
 v_mfma_f32_16x16x32_bf16 v[136:139], a[152:155], v[88:91], v[136:139]
 ds_read_b128 a[236:239], v12 offset:36864
 ds_read_b64_tr_b16 a[212:213], v4 offset:32768
 v_mfma_f32_16x16x32_bf16 v[136:139], a[156:159], v[104:107], v[136:139]
 v_exp_f32 v129, v129
 v_mfma_f32_16x16x32_bf16 v[136:139], a[160:163], v[120:123], v[136:139]
 ds_read_b64_tr_b16 a[214:215], v4 offset:36864
 v_cvt_pk_bf16_f32 v32, v128, v129
 v_mfma_f32_16x16x32_bf16 v[140:143], a[160:163], v[124:127], v[204:207]
 v_exp_f32 v130, v130
 v_mfma_f32_16x16x32_bf16 v[140:143], a[156:159], v[108:111], v[140:143]
 buffer_load_dwordx4 v28, s[44:47], s84 offen offset:0 lds
 v_mfma_f32_16x16x32_bf16 v[140:143], a[152:155], v[92:95], v[140:143]
 v_exp_f32 v131, v131
 v_mfma_f32_16x16x32_bf16 v[140:143], a[148:151], v[76:79], v[140:143]
 s_waitcnt lgkmcnt(3)
 v_cvt_pk_bf16_f32 v33, v130, v131
 v_mfma_f32_16x16x32_bf16 a[0:3], a[164:167], v[160:163], a[0:3]
 v_exp_f32 v132, v132
 v_mfma_f32_16x16x32_bf16 a[0:3], a[168:171], v[176:179], a[0:3]
 ds_read_b128 a[240:243], v13 offset:36864
 ds_read_b64_tr_b16 a[216:217], v4 offset:40960
 v_mfma_f32_16x16x32_bf16 a[4:7], a[168:171], v[180:183], a[4:7]
 v_exp_f32 v133, v133
 v_mfma_f32_16x16x32_bf16 a[4:7], a[164:167], v[164:167], a[4:7]
 ds_read_b64_tr_b16 a[218:219], v4 offset:45056
 v_cvt_pk_bf16_f32 v36, v132, v133
 v_mfma_f32_16x16x32_bf16 a[8:11], a[164:167], v[168:171], a[8:11]
 v_exp_f32 v134, v134
 v_mfma_f32_16x16x32_bf16 a[8:11], a[168:171], v[184:187], a[8:11]
 buffer_load_dwordx4 v29, s[44:47], s84 offen offset:1024 lds
 v_mfma_f32_16x16x32_bf16 a[12:15], a[168:171], v[188:191], a[12:15]
 v_exp_f32 v135, v135
 v_mfma_f32_16x16x32_bf16 a[12:15], a[164:167], v[172:175], a[12:15]
 v_cvt_pk_bf16_f32 v37, v134, v135
 v_mfma_f32_16x16x32_bf16 a[132:135], a[144:147], v[164:167], a[132:135]
 v_mfma_f32_16x16x32_bf16 a[132:135], a[144:147], v[180:183], a[132:135]
 v_mfma_f32_16x16x32_bf16 a[16:19], a[172:175], v[160:163], a[16:19]
 v_exp_f32 v136, v136
 v_mfma_f32_16x16x32_bf16 a[16:19], a[176:179], v[176:179], a[16:19]
 ds_read_b128 a[148:151], v10 offset:40960
 ds_read_b64_tr_b16 a[220:221], v5 offset:32768
 v_mfma_f32_16x16x32_bf16 a[20:23], a[176:179], v[180:183], a[20:23]
 v_exp_f32 v137, v137
 v_mfma_f32_16x16x32_bf16 a[20:23], a[172:175], v[164:167], a[20:23]
 ds_read_b64_tr_b16 a[222:223], v5 offset:36864
 v_cvt_pk_bf16_f32 v40, v136, v137
 v_mfma_f32_16x16x32_bf16 a[24:27], a[172:175], v[168:171], a[24:27]
 v_exp_f32 v138, v138
 v_mfma_f32_16x16x32_bf16 a[24:27], a[176:179], v[184:187], a[24:27]
 buffer_load_dwordx4 v30, s[44:47], s84 offen offset:2048 lds
 v_mfma_f32_16x16x32_bf16 a[28:31], a[176:179], v[188:191], a[28:31]
 v_exp_f32 v139, v139
 v_mfma_f32_16x16x32_bf16 a[28:31], a[172:175], v[172:175], a[28:31]
 s_waitcnt lgkmcnt(3)
 v_cvt_pk_bf16_f32 v41, v138, v139
 v_mfma_f32_16x16x32_bf16 v[144:147], a[228:231], v[64:67], v[192:195]
 v_exp_f32 v140, v140
 v_mfma_f32_16x16x32_bf16 v[144:147], a[232:235], v[80:83], v[144:147]
 ds_read_b128 a[152:155], v11 offset:40960
 ds_read_b64_tr_b16 a[224:225], v5 offset:40960
 v_mfma_f32_16x16x32_bf16 v[144:147], a[236:239], v[96:99], v[144:147]
 v_exp_f32 v141, v141
 v_mfma_f32_16x16x32_bf16 v[144:147], a[240:243], v[112:115], v[144:147]
 ds_read_b64_tr_b16 a[226:227], v5 offset:45056
 v_cvt_pk_bf16_f32 v44, v140, v141
 v_mfma_f32_16x16x32_bf16 v[148:151], a[240:243], v[116:119], v[196:199]
 v_exp_f32 v142, v142
 v_mfma_f32_16x16x32_bf16 v[148:151], a[236:239], v[100:103], v[148:151]
 buffer_load_dwordx4 v31, s[44:47], s84 offen offset:3072 lds
 v_mfma_f32_16x16x32_bf16 v[148:151], a[232:235], v[84:87], v[148:151]
 v_exp_f32 v143, v143
 v_mfma_f32_16x16x32_bf16 v[148:151], a[228:231], v[68:71], v[148:151]
 v_cvt_pk_bf16_f32 v45, v142, v143
 v_mfma_f32_16x16x32_bf16 v[152:155], a[228:231], v[72:75], v[200:203]
 v_exp_f32 v144, v144
 v_mfma_f32_16x16x32_bf16 v[152:155], a[232:235], v[88:91], v[152:155]
 ds_read_b128 a[156:159], v12 offset:40960
 ds_read_b64_tr_b16 a[164:165], v6 offset:32768
 v_mfma_f32_16x16x32_bf16 v[152:155], a[236:239], v[104:107], v[152:155]
 v_exp_f32 v145, v145
 v_mfma_f32_16x16x32_bf16 v[152:155], a[240:243], v[120:123], v[152:155]
 ds_read_b64_tr_b16 a[166:167], v6 offset:36864
 v_cvt_pk_bf16_f32 v34, v144, v145
 v_mfma_f32_16x16x32_bf16 v[156:159], a[240:243], v[124:127], v[204:207]
 v_exp_f32 v146, v146
 v_mfma_f32_16x16x32_bf16 v[156:159], a[236:239], v[108:111], v[156:159]
 s_add_u32 m0, s96, 69632
 s_add_u32 s84, s95, 32768
 v_mfma_f32_16x16x32_bf16 v[156:159], a[232:235], v[92:95], v[156:159]
 v_exp_f32 v147, v147
 v_mfma_f32_16x16x32_bf16 v[156:159], a[228:231], v[76:79], v[156:159]
 s_waitcnt lgkmcnt(3)
 v_cvt_pk_bf16_f32 v35, v146, v147
 v_mfma_f32_16x16x32_bf16 a[32:35], a[212:215], v[160:163], a[32:35]
 v_exp_f32 v148, v148
 v_mfma_f32_16x16x32_bf16 a[32:35], a[216:219], v[176:179], a[32:35]
 ds_read_b128 a[160:163], v13 offset:40960
 ds_read_b64_tr_b16 a[168:169], v6 offset:40960
 v_mfma_f32_16x16x32_bf16 a[36:39], a[216:219], v[180:183], a[36:39]
 v_exp_f32 v149, v149
 v_mfma_f32_16x16x32_bf16 a[36:39], a[212:215], v[164:167], a[36:39]
 ds_read_b64_tr_b16 a[170:171], v6 offset:45056
 v_cvt_pk_bf16_f32 v38, v148, v149
 v_mfma_f32_16x16x32_bf16 a[40:43], a[212:215], v[168:171], a[40:43]
 v_exp_f32 v150, v150
 v_mfma_f32_16x16x32_bf16 a[40:43], a[216:219], v[184:187], a[40:43]
 buffer_load_dwordx4 v28, s[44:47], s84 offen offset:0 lds
 v_mfma_f32_16x16x32_bf16 a[44:47], a[216:219], v[188:191], a[44:47]
 v_exp_f32 v151, v151
 v_mfma_f32_16x16x32_bf16 a[44:47], a[212:215], v[172:175], a[44:47]
 v_cvt_pk_bf16_f32 v39, v150, v151
 v_mfma_f32_16x16x32_bf16 a[48:51], a[220:223], v[160:163], a[48:51]
 v_exp_f32 v152, v152
 v_mfma_f32_16x16x32_bf16 a[48:51], a[224:227], v[176:179], a[48:51]
 ds_read_b128 a[228:231], v10 offset:45056
 ds_read_b64_tr_b16 a[172:173], v7 offset:32768
 v_mfma_f32_16x16x32_bf16 a[52:55], a[224:227], v[180:183], a[52:55]
 v_exp_f32 v153, v153
 v_mfma_f32_16x16x32_bf16 a[52:55], a[220:223], v[164:167], a[52:55]
 ds_read_b64_tr_b16 a[174:175], v7 offset:36864
 v_cvt_pk_bf16_f32 v42, v152, v153
 v_mfma_f32_16x16x32_bf16 a[56:59], a[220:223], v[168:171], a[56:59]
 v_exp_f32 v154, v154
 v_mfma_f32_16x16x32_bf16 a[56:59], a[224:227], v[184:187], a[56:59]
 buffer_load_dwordx4 v29, s[44:47], s84 offen offset:1024 lds
 v_mfma_f32_16x16x32_bf16 a[60:63], a[224:227], v[188:191], a[60:63]
 v_exp_f32 v155, v155
 v_mfma_f32_16x16x32_bf16 a[60:63], a[220:223], v[172:175], a[60:63]
 s_waitcnt lgkmcnt(3)
 v_cvt_pk_bf16_f32 v43, v154, v155
 v_mfma_f32_16x16x32_bf16 a[128:131], a[144:147], v[160:163], a[128:131]
 v_mfma_f32_16x16x32_bf16 a[128:131], a[144:147], v[176:179], a[128:131]
 v_mfma_f32_16x16x32_bf16 v[128:131], a[148:151], v[64:67], v[192:195]
 v_exp_f32 v156, v156
 v_mfma_f32_16x16x32_bf16 v[128:131], a[152:155], v[80:83], v[128:131]
 ds_read_b128 a[232:235], v11 offset:45056
 ds_read_b64_tr_b16 a[176:177], v7 offset:40960
 v_mfma_f32_16x16x32_bf16 v[128:131], a[156:159], v[96:99], v[128:131]
 v_exp_f32 v157, v157
 v_mfma_f32_16x16x32_bf16 v[128:131], a[160:163], v[112:115], v[128:131]
 ds_read_b64_tr_b16 a[178:179], v7 offset:45056
 v_cvt_pk_bf16_f32 v46, v156, v157
 v_mfma_f32_16x16x32_bf16 v[132:135], a[160:163], v[116:119], v[196:199]
 v_exp_f32 v158, v158
 v_mfma_f32_16x16x32_bf16 v[132:135], a[156:159], v[100:103], v[132:135]
 buffer_load_dwordx4 v30, s[44:47], s84 offen offset:2048 lds
 v_mfma_f32_16x16x32_bf16 v[132:135], a[152:155], v[84:87], v[132:135]
 v_exp_f32 v159, v159
 v_mfma_f32_16x16x32_bf16 v[132:135], a[148:151], v[68:71], v[132:135]
 v_cvt_pk_bf16_f32 v47, v158, v159
 v_mfma_f32_16x16x32_bf16 v[136:139], a[148:151], v[72:75], v[200:203]
 v_exp_f32 v128, v128
 v_mfma_f32_16x16x32_bf16 v[136:139], a[152:155], v[88:91], v[136:139]
 ds_read_b128 a[236:239], v12 offset:45056
 ds_read_b64_tr_b16 a[212:213], v8 offset:32768
 v_mfma_f32_16x16x32_bf16 v[136:139], a[156:159], v[104:107], v[136:139]
 v_exp_f32 v129, v129
 v_mfma_f32_16x16x32_bf16 v[136:139], a[160:163], v[120:123], v[136:139]
 ds_read_b64_tr_b16 a[214:215], v8 offset:36864
 v_cvt_pk_bf16_f32 v48, v128, v129
 v_mfma_f32_16x16x32_bf16 v[140:143], a[160:163], v[124:127], v[204:207]
 v_exp_f32 v130, v130
 v_mfma_f32_16x16x32_bf16 v[140:143], a[156:159], v[108:111], v[140:143]
 buffer_load_dwordx4 v31, s[44:47], s84 offen offset:3072 lds
 v_mfma_f32_16x16x32_bf16 v[140:143], a[152:155], v[92:95], v[140:143]
 v_exp_f32 v131, v131
 v_mfma_f32_16x16x32_bf16 v[140:143], a[148:151], v[76:79], v[140:143]
 s_waitcnt lgkmcnt(3)
 v_cvt_pk_bf16_f32 v49, v130, v131
 v_mfma_f32_16x16x32_bf16 a[64:67], a[164:167], v[160:163], a[64:67]
 v_exp_f32 v132, v132
 v_mfma_f32_16x16x32_bf16 a[64:67], a[168:171], v[176:179], a[64:67]
 ds_read_b128 a[240:243], v13 offset:45056
 ds_read_b64_tr_b16 a[216:217], v8 offset:40960
 v_mfma_f32_16x16x32_bf16 a[68:71], a[168:171], v[180:183], a[68:71]
 v_exp_f32 v133, v133
 v_mfma_f32_16x16x32_bf16 a[68:71], a[164:167], v[164:167], a[68:71]
 ds_read_b64_tr_b16 a[218:219], v8 offset:45056
 v_cvt_pk_bf16_f32 v52, v132, v133
 v_mfma_f32_16x16x32_bf16 a[72:75], a[164:167], v[168:171], a[72:75]
 v_exp_f32 v134, v134
 v_mfma_f32_16x16x32_bf16 a[72:75], a[168:171], v[184:187], a[72:75]
 s_add_u32 m0, s96, 0
 s_add_u32 s84, s95, 65536
 v_mfma_f32_16x16x32_bf16 a[76:79], a[168:171], v[188:191], a[76:79]
 v_exp_f32 v135, v135
 v_mfma_f32_16x16x32_bf16 a[76:79], a[164:167], v[172:175], a[76:79]
 v_cvt_pk_bf16_f32 v53, v134, v135
 v_mfma_f32_16x16x32_bf16 a[136:139], a[144:147], v[168:171], a[136:139]
 s_waitcnt vmcnt(12)
 v_mfma_f32_16x16x32_bf16 a[136:139], a[144:147], v[184:187], a[136:139]
 s_barrier
 v_mfma_f32_16x16x32_bf16 v[208:211], a[172:175], v[160:163], v[208:211]
 v_exp_f32 v136, v136
 v_mfma_f32_16x16x32_bf16 v[208:211], a[176:179], v[176:179], v[208:211]
 ds_read_b64_tr_b16 a[220:221], v9 offset:32768
 ds_read_b64_tr_b16 a[222:223], v9 offset:36864
 v_mfma_f32_16x16x32_bf16 v[212:215], a[176:179], v[180:183], v[212:215]
 v_exp_f32 v137, v137
 v_mfma_f32_16x16x32_bf16 v[212:215], a[172:175], v[164:167], v[212:215]
 v_cvt_pk_bf16_f32 v56, v136, v137
 v_mfma_f32_16x16x32_bf16 v[216:219], a[172:175], v[168:171], v[216:219]
 v_exp_f32 v138, v138
 v_mfma_f32_16x16x32_bf16 v[216:219], a[176:179], v[184:187], v[216:219]
 buffer_load_dwordx4 v28, s[44:47], s84 offen offset:0 lds
 v_mfma_f32_16x16x32_bf16 v[220:223], a[176:179], v[188:191], v[220:223]
 v_exp_f32 v139, v139
 v_mfma_f32_16x16x32_bf16 v[220:223], a[172:175], v[172:175], v[220:223]
 s_waitcnt lgkmcnt(2)
 v_cvt_pk_bf16_f32 v57, v138, v139
 v_mfma_f32_16x16x32_bf16 v[144:147], a[228:231], v[64:67], v[192:195]
 v_exp_f32 v140, v140
 v_mfma_f32_16x16x32_bf16 v[144:147], a[232:235], v[80:83], v[144:147]
 ds_read_b64_tr_b16 a[224:225], v9 offset:40960
 ds_read_b64_tr_b16 a[226:227], v9 offset:45056
 v_mfma_f32_16x16x32_bf16 v[144:147], a[236:239], v[96:99], v[144:147]
 v_exp_f32 v141, v141
 v_mfma_f32_16x16x32_bf16 v[144:147], a[240:243], v[112:115], v[144:147]
 v_cvt_pk_bf16_f32 v60, v140, v141
 v_mfma_f32_16x16x32_bf16 v[148:151], a[240:243], v[116:119], v[196:199]
 v_exp_f32 v142, v142
 v_mfma_f32_16x16x32_bf16 v[148:151], a[236:239], v[100:103], v[148:151]
 buffer_load_dwordx4 v29, s[44:47], s84 offen offset:1024 lds
 v_mfma_f32_16x16x32_bf16 v[148:151], a[232:235], v[84:87], v[148:151]
 v_exp_f32 v143, v143
 v_mfma_f32_16x16x32_bf16 v[148:151], a[228:231], v[68:71], v[148:151]
 v_cvt_pk_bf16_f32 v61, v142, v143
 v_mfma_f32_16x16x32_bf16 v[152:155], a[228:231], v[72:75], v[200:203]
 v_exp_f32 v144, v144
 v_mfma_f32_16x16x32_bf16 v[152:155], a[232:235], v[88:91], v[152:155]
 ds_read_b64_tr_b16 a[164:165], v2 offset:49152
 ds_read_b64_tr_b16 a[166:167], v2 offset:53248
 v_mfma_f32_16x16x32_bf16 v[152:155], a[236:239], v[104:107], v[152:155]
 v_exp_f32 v145, v145
 v_mfma_f32_16x16x32_bf16 v[152:155], a[240:243], v[120:123], v[152:155]
 v_cvt_pk_bf16_f32 v50, v144, v145
 v_mfma_f32_16x16x32_bf16 v[156:159], a[240:243], v[124:127], v[204:207]
 v_exp_f32 v146, v146
 v_mfma_f32_16x16x32_bf16 v[156:159], a[236:239], v[108:111], v[156:159]
 buffer_load_dwordx4 v30, s[44:47], s84 offen offset:2048 lds
 v_mfma_f32_16x16x32_bf16 v[156:159], a[232:235], v[92:95], v[156:159]
 v_exp_f32 v147, v147
 v_mfma_f32_16x16x32_bf16 v[156:159], a[228:231], v[76:79], v[156:159]
 s_waitcnt lgkmcnt(2)
 v_cvt_pk_bf16_f32 v51, v146, v147
 v_mfma_f32_16x16x32_bf16 v[224:227], a[212:215], v[160:163], v[224:227]
 v_exp_f32 v148, v148
 v_mfma_f32_16x16x32_bf16 v[224:227], a[216:219], v[176:179], v[224:227]
 ds_read_b64_tr_b16 a[168:169], v2 offset:57344
 ds_read_b64_tr_b16 a[170:171], v2 offset:61440
 v_mfma_f32_16x16x32_bf16 v[228:231], a[216:219], v[180:183], v[228:231]
 v_exp_f32 v149, v149
 v_mfma_f32_16x16x32_bf16 v[228:231], a[212:215], v[164:167], v[228:231]
 v_cvt_pk_bf16_f32 v54, v148, v149
 v_mfma_f32_16x16x32_bf16 v[232:235], a[212:215], v[168:171], v[232:235]
 v_exp_f32 v150, v150
 v_mfma_f32_16x16x32_bf16 v[232:235], a[216:219], v[184:187], v[232:235]
 buffer_load_dwordx4 v31, s[44:47], s84 offen offset:3072 lds
 v_mfma_f32_16x16x32_bf16 v[236:239], a[216:219], v[188:191], v[236:239]
 v_exp_f32 v151, v151
 v_mfma_f32_16x16x32_bf16 v[236:239], a[212:215], v[172:175], v[236:239]
 v_cvt_pk_bf16_f32 v55, v150, v151
 v_mfma_f32_16x16x32_bf16 v[240:243], a[220:223], v[160:163], v[240:243]
 v_exp_f32 v152, v152
 v_mfma_f32_16x16x32_bf16 v[240:243], a[224:227], v[176:179], v[240:243]
 ds_read_b64_tr_b16 a[172:173], v3 offset:49152
 ds_read_b64_tr_b16 a[174:175], v3 offset:53248
 v_mfma_f32_16x16x32_bf16 v[244:247], a[224:227], v[180:183], v[244:247]
 v_exp_f32 v153, v153
 v_mfma_f32_16x16x32_bf16 v[244:247], a[220:223], v[164:167], v[244:247]
 v_cvt_pk_bf16_f32 v58, v152, v153
 v_mfma_f32_16x16x32_bf16 v[248:251], a[220:223], v[168:171], v[248:251]
 v_exp_f32 v154, v154
 v_mfma_f32_16x16x32_bf16 v[248:251], a[224:227], v[184:187], v[248:251]
 s_add_u32 m0, s96, 4096
 s_add_u32 s84, s95, 98304
 v_mfma_f32_16x16x32_bf16 v[252:255], a[224:227], v[188:191], v[252:255]
 v_exp_f32 v155, v155
 v_mfma_f32_16x16x32_bf16 v[252:255], a[220:223], v[172:175], v[252:255]
 s_waitcnt lgkmcnt(2)
 v_cvt_pk_bf16_f32 v59, v154, v155
 v_mfma_f32_16x16x32_bf16 a[140:143], a[144:147], v[172:175], a[140:143]
 v_mfma_f32_16x16x32_bf16 a[140:143], a[144:147], v[188:191], a[140:143]
 v_mfma_f32_16x16x32_bf16 a[0:3], a[164:167], v[32:35], a[0:3]
 v_exp_f32 v156, v156
 ds_read_b64_tr_b16 a[176:177], v3 offset:57344
 ds_read_b64_tr_b16 a[178:179], v3 offset:61440
 v_mfma_f32_16x16x32_bf16 a[0:3], a[168:171], v[48:51], a[0:3]
 v_exp_f32 v157, v157
 v_exp_f32 v158, v158
 v_mfma_f32_16x16x32_bf16 a[4:7], a[168:171], v[52:55], a[4:7]
 v_exp_f32 v159, v159
 v_cvt_pk_bf16_f32 v62, v156, v157
 v_mfma_f32_16x16x32_bf16 a[4:7], a[164:167], v[36:39], a[4:7]
 s_nop 0
 v_cvt_pk_bf16_f32 v63, v158, v159
 v_mfma_f32_16x16x32_bf16 a[8:11], a[164:167], v[40:43], a[8:11]
 ds_read_b64_tr_b16 a[212:213], v4 offset:49152
 ds_read_b64_tr_b16 a[214:215], v4 offset:53248
 v_mfma_f32_16x16x32_bf16 a[8:11], a[168:171], v[56:59], a[8:11]
 buffer_load_dwordx4 v28, s[44:47], s84 offen offset:0 lds
 v_mfma_f32_16x16x32_bf16 a[12:15], a[168:171], v[60:63], a[12:15]
 v_mfma_f32_16x16x32_bf16 a[12:15], a[164:167], v[44:47], a[12:15]
 s_waitcnt lgkmcnt(2)
 v_mfma_f32_16x16x32_bf16 a[128:131], a[144:147], v[32:35], a[128:131]
 v_and_b32 v201, 3, v1
 v_lshlrev_b32 v201, 13, v201
 v_mfma_f32_16x16x32_bf16 a[128:131], a[144:147], v[48:51], a[128:131]
 s_lshl_b32 s89, s76, 2
 s_add_u32 s89, s89, 73712
 v_mfma_f32_16x16x32_bf16 a[132:135], a[144:147], v[36:39], a[132:135]
 v_add_u32 v201, s89, v201
 v_mov_b32 v203, s96
 v_mfma_f32_16x16x32_bf16 a[132:135], a[144:147], v[52:55], a[132:135]
 s_lshl_b32 s88, s76, 12
 v_add_u32 v202, s88, v20
 v_mfma_f32_16x16x32_bf16 a[136:139], a[144:147], v[40:43], a[136:139]
 v_mfma_f32_16x16x32_bf16 a[136:139], a[144:147], v[56:59], a[136:139]
 v_mfma_f32_16x16x32_bf16 a[140:143], a[144:147], v[44:47], a[140:143]
 v_mfma_f32_16x16x32_bf16 a[140:143], a[144:147], v[60:63], a[140:143]
 v_mfma_f32_16x16x32_bf16 a[16:19], a[172:175], v[32:35], a[16:19]
 ds_read_b64_tr_b16 a[216:217], v4 offset:57344
 ds_read_b64_tr_b16 a[218:219], v4 offset:61440
 v_mfma_f32_16x16x32_bf16 a[16:19], a[176:179], v[48:51], a[16:19]
 buffer_load_dwordx4 v29, s[44:47], s84 offen offset:1024 lds
 v_mfma_f32_16x16x32_bf16 a[20:23], a[176:179], v[52:55], a[20:23]
 v_mfma_f32_16x16x32_bf16 a[20:23], a[172:175], v[36:39], a[20:23]
 v_mfma_f32_16x16x32_bf16 a[24:27], a[172:175], v[40:43], a[24:27]
 ds_read_b64_tr_b16 a[220:221], v5 offset:49152
 ds_read_b64_tr_b16 a[222:223], v5 offset:53248
 v_mfma_f32_16x16x32_bf16 a[24:27], a[176:179], v[56:59], a[24:27]
 buffer_load_dwordx4 v30, s[44:47], s84 offen offset:2048 lds
 v_mfma_f32_16x16x32_bf16 a[28:31], a[176:179], v[60:63], a[28:31]
 v_accvgpr_read_b32 v193, a128
 v_accvgpr_read_b32 v195, a132
 v_mfma_f32_16x16x32_bf16 a[28:31], a[172:175], v[44:47], a[28:31]
 s_waitcnt lgkmcnt(2)
 v_mfma_f32_16x16x32_bf16 a[32:35], a[212:215], v[32:35], a[32:35]
 ds_read_b64_tr_b16 a[224:225], v5 offset:57344
 ds_read_b64_tr_b16 a[226:227], v5 offset:61440
 v_mfma_f32_16x16x32_bf16 a[32:35], a[216:219], v[48:51], a[32:35]
 v_accvgpr_read_b32 v197, a136
 v_accvgpr_read_b32 v199, a140
 v_mfma_f32_16x16x32_bf16 a[36:39], a[216:219], v[52:55], a[36:39]
 v_add_f32 v204, v197, v199
 v_mfma_f32_16x16x32_bf16 a[36:39], a[212:215], v[36:39], a[36:39]
 v_add_f32 v200, v193, v195
 v_add_f32 v200, v200, v204
 v_mfma_f32_16x16x32_bf16 a[40:43], a[212:215], v[40:43], a[40:43]
 ds_read_b64_tr_b16 a[164:165], v6 offset:49152
 ds_read_b64_tr_b16 a[166:167], v6 offset:53248
 v_mfma_f32_16x16x32_bf16 a[40:43], a[216:219], v[56:59], a[40:43]
 v_cmp_nge_f32 vcc, 0x5f800000, v200
 v_mfma_f32_16x16x32_bf16 a[44:47], a[216:219], v[60:63], a[44:47]
 s_cmp_lg_u64 vcc, 0
 s_cselect_b32 s88, 1, 0
 v_mfma_f32_16x16x32_bf16 a[44:47], a[212:215], v[44:47], a[44:47]
 s_waitcnt lgkmcnt(2)
 v_mfma_f32_16x16x32_bf16 a[48:51], a[220:223], v[32:35], a[48:51]
 ds_read_b64_tr_b16 a[168:169], v6 offset:57344
 ds_read_b64_tr_b16 a[170:171], v6 offset:61440
 v_mfma_f32_16x16x32_bf16 a[48:51], a[224:227], v[48:51], a[48:51]
 v_rcp_f32 v192, v193
 v_mfma_f32_16x16x32_bf16 a[52:55], a[224:227], v[52:55], a[52:55]
 v_rcp_f32 v194, v195
 v_mfma_f32_16x16x32_bf16 a[52:55], a[220:223], v[36:39], a[52:55]
 v_rcp_f32 v196, v197
 v_mfma_f32_16x16x32_bf16 a[56:59], a[220:223], v[40:43], a[56:59]
 ds_read_b64_tr_b16 a[172:173], v7 offset:49152
 ds_read_b64_tr_b16 a[174:175], v7 offset:53248
 v_mfma_f32_16x16x32_bf16 a[56:59], a[224:227], v[56:59], a[56:59]
 v_rcp_f32 v198, v199
 v_mfma_f32_16x16x32_bf16 a[60:63], a[224:227], v[60:63], a[60:63]
 v_mfma_f32_16x16x32_bf16 a[60:63], a[220:223], v[44:47], a[60:63]
 s_waitcnt lgkmcnt(2)
 v_mfma_f32_16x16x32_bf16 a[64:67], a[164:167], v[32:35], a[64:67]
 ds_read_b64_tr_b16 a[176:177], v7 offset:57344
 ds_read_b64_tr_b16 a[178:179], v7 offset:61440
 v_mfma_f32_16x16x32_bf16 a[64:67], a[168:171], v[48:51], a[64:67]
 v_mfma_f32_16x16x32_bf16 a[68:71], a[168:171], v[52:55], a[68:71]
 v_mfma_f32_16x16x32_bf16 a[68:71], a[164:167], v[36:39], a[68:71]
 v_mfma_f32_16x16x32_bf16 a[72:75], a[164:167], v[40:43], a[72:75]
 ds_read_b64_tr_b16 a[212:213], v8 offset:49152
 ds_read_b64_tr_b16 a[214:215], v8 offset:53248
 v_mfma_f32_16x16x32_bf16 a[72:75], a[168:171], v[56:59], a[72:75]
 v_mfma_f32_16x16x32_bf16 a[76:79], a[168:171], v[60:63], a[76:79]
 v_mfma_f32_16x16x32_bf16 a[76:79], a[164:167], v[44:47], a[76:79]
 s_waitcnt lgkmcnt(2)
 v_mfma_f32_16x16x32_bf16 v[208:211], a[172:175], v[32:35], v[208:211]
 ds_read_b64_tr_b16 a[216:217], v8 offset:57344
 ds_read_b64_tr_b16 a[218:219], v8 offset:61440
 v_mfma_f32_16x16x32_bf16 v[208:211], a[176:179], v[48:51], v[208:211]
 v_mfma_f32_16x16x32_bf16 v[212:215], a[176:179], v[52:55], v[212:215]
 v_mfma_f32_16x16x32_bf16 v[212:215], a[172:175], v[36:39], v[212:215]
 v_mfma_f32_16x16x32_bf16 v[216:219], a[172:175], v[40:43], v[216:219]
 ds_read_b64_tr_b16 a[220:221], v9 offset:49152
 ds_read_b64_tr_b16 a[222:223], v9 offset:53248
 v_mfma_f32_16x16x32_bf16 v[216:219], a[176:179], v[56:59], v[216:219]
 v_mfma_f32_16x16x32_bf16 v[220:223], a[176:179], v[60:63], v[220:223]
 v_mfma_f32_16x16x32_bf16 v[220:223], a[172:175], v[44:47], v[220:223]
 s_waitcnt lgkmcnt(2)
 v_mfma_f32_16x16x32_bf16 v[224:227], a[212:215], v[32:35], v[224:227]
 ds_read_b64_tr_b16 a[224:225], v9 offset:57344
 ds_read_b64_tr_b16 a[226:227], v9 offset:61440
 v_mfma_f32_16x16x32_bf16 v[224:227], a[216:219], v[48:51], v[224:227]
 v_mfma_f32_16x16x32_bf16 v[228:231], a[216:219], v[52:55], v[228:231]
 v_mfma_f32_16x16x32_bf16 v[228:231], a[212:215], v[36:39], v[228:231]
 v_mfma_f32_16x16x32_bf16 v[232:235], a[212:215], v[40:43], v[232:235]
 v_mfma_f32_16x16x32_bf16 v[232:235], a[216:219], v[56:59], v[232:235]
 v_mov_b32 v200, s88
 ds_write_b32 v201, v200
 v_mfma_f32_16x16x32_bf16 v[236:239], a[216:219], v[60:63], v[236:239]
 v_mfma_f32_16x16x32_bf16 v[236:239], a[212:215], v[44:47], v[236:239]
 s_waitcnt lgkmcnt(0)
 v_mfma_f32_16x16x32_bf16 v[240:243], a[220:223], v[32:35], v[240:243]
 v_mfma_f32_16x16x32_bf16 v[240:243], a[224:227], v[48:51], v[240:243]
 v_mfma_f32_16x16x32_bf16 v[244:247], a[224:227], v[52:55], v[244:247]
 s_waitcnt lgkmcnt(0)
 s_barrier
 v_mfma_f32_16x16x32_bf16 v[244:247], a[220:223], v[36:39], v[244:247]
 v_mfma_f32_16x16x32_bf16 v[248:251], a[220:223], v[40:43], v[248:251]
 ds_read_b128 v[204:207], v203 offset:8176
 v_accvgpr_read_b32 v2, a248
 v_mfma_f32_16x16x32_bf16 v[248:251], a[224:227], v[56:59], v[248:251]
L_pg13:
 s_cbranch_execz L_site1
 v_mfma_f32_16x16x32_bf16 v[252:255], a[224:227], v[60:63], v[252:255]
 v_mfma_f32_16x16x32_bf16 v[252:255], a[220:223], v[44:47], v[252:255]
 v_xor_b32 v3, 32, v2
 v_xor_b32 v4, 64, v2
 v_xor_b32 v5, 96, v2
 v_add_u32 v6, 65536, v2
 v_add_u32 v7, 65536, v3
 v_add_u32 v8, 65536, v4
 v_add_u32 v9, 65536, v5
 s_waitcnt lgkmcnt(0)
 v_or3_b32 v204, v204, v205, v206
 v_or_b32 v204, v204, v207
 s_nop 0
 v_readfirstlane_b32 s88, v204
 s_nop 0
 s_andn2_b32 s88, s88, s81
 s_cbranch_scc1 L_fallback
 buffer_load_dwordx4 v31, s[44:47], s84 offen offset:3072 lds
 s_add_u32 m0, s96, 32768
 s_add_u32 s84, s95, 131072
 v_accvgpr_read_b32 v128, a0
 v_accvgpr_read_b32 v129, a1
 v_accvgpr_read_b32 v130, a2
 v_accvgpr_read_b32 v131, a3
 v_accvgpr_read_b32 v132, a16
 v_accvgpr_read_b32 v133, a17
 v_accvgpr_read_b32 v134, a18
 v_accvgpr_read_b32 v135, a19
 v_pk_mul_f32 v[128:129], v[128:129], v[192:193] op_sel_hi:[1,0]
 v_pk_mul_f32 v[130:131], v[130:131], v[192:193] op_sel_hi:[1,0]
 v_pk_mul_f32 v[132:133], v[132:133], v[192:193] op_sel_hi:[1,0]
 v_pk_mul_f32 v[134:135], v[134:135], v[192:193] op_sel_hi:[1,0]
 v_cvt_pk_bf16_f32 v136, v128, v129
 v_cvt_pk_bf16_f32 v137, v130, v131
 v_cvt_pk_bf16_f32 v138, v132, v133
 v_cvt_pk_bf16_f32 v139, v134, v135
 v_accvgpr_read_b32 v144, a4
 v_accvgpr_read_b32 v145, a5
 v_accvgpr_read_b32 v146, a6
 v_accvgpr_read_b32 v147, a7
 ds_write_b128 v202, v[136:139] offset:0
 s_add_u32 s94, s94, 4096
 buffer_load_dwordx4 a[128:131], v20, s[64:67], s94 offen offset:0 sc1
 buffer_load_dwordx4 a[132:135], v20, s[64:67], s94 offen offset:1024 sc1
 v_accvgpr_read_b32 v148, a20
 v_accvgpr_read_b32 v149, a21
 v_accvgpr_read_b32 v150, a22
 v_accvgpr_read_b32 v151, a23
 v_pk_mul_f32 v[144:145], v[144:145], v[194:195] op_sel_hi:[1,0]
 v_pk_mul_f32 v[146:147], v[146:147], v[194:195] op_sel_hi:[1,0]
 v_pk_mul_f32 v[148:149], v[148:149], v[194:195] op_sel_hi:[1,0]
 v_pk_mul_f32 v[150:151], v[150:151], v[194:195] op_sel_hi:[1,0]
 v_cvt_pk_bf16_f32 v152, v144, v145
 v_cvt_pk_bf16_f32 v153, v146, v147
 v_cvt_pk_bf16_f32 v154, v148, v149
 v_cvt_pk_bf16_f32 v155, v150, v151
 v_accvgpr_read_b32 v160, a8
 v_accvgpr_read_b32 v161, a9
 v_accvgpr_read_b32 v162, a10
 v_accvgpr_read_b32 v163, a11
 ds_write_b128 v202, v[152:155] offset:16384
 buffer_load_dwordx4 a[136:139], v20, s[64:67], s94 offen offset:2048 sc1
 buffer_load_dwordx4 a[140:143], v20, s[64:67], s94 offen offset:3072 sc1
 v_accvgpr_read_b32 v164, a24
 v_accvgpr_read_b32 v165, a25
 v_accvgpr_read_b32 v166, a26
 v_accvgpr_read_b32 v167, a27
 v_pk_mul_f32 v[160:161], v[160:161], v[196:197] op_sel_hi:[1,0]
 v_pk_mul_f32 v[162:163], v[162:163], v[196:197] op_sel_hi:[1,0]
 v_pk_mul_f32 v[164:165], v[164:165], v[196:197] op_sel_hi:[1,0]
 v_pk_mul_f32 v[166:167], v[166:167], v[196:197] op_sel_hi:[1,0]
 v_cvt_pk_bf16_f32 v168, v160, v161
 v_cvt_pk_bf16_f32 v169, v162, v163
 v_cvt_pk_bf16_f32 v170, v164, v165
 v_cvt_pk_bf16_f32 v171, v166, v167
 v_accvgpr_read_b32 v176, a12
 v_accvgpr_read_b32 v177, a13
 v_accvgpr_read_b32 v178, a14
 v_accvgpr_read_b32 v179, a15
 ds_write_b128 v202, v[168:171] offset:32768
 s_add_u32 s94, s94, 4096
 buffer_load_dwordx4 a[148:151], v20, s[64:67], s94 offen offset:0 sc1
 buffer_load_dwordx4 a[152:155], v20, s[64:67], s94 offen offset:1024 sc1
 v_accvgpr_read_b32 v180, a28
 v_accvgpr_read_b32 v181, a29
 v_accvgpr_read_b32 v182, a30
 v_accvgpr_read_b32 v183, a31
 v_pk_mul_f32 v[176:177], v[176:177], v[198:199] op_sel_hi:[1,0]
 v_pk_mul_f32 v[178:179], v[178:179], v[198:199] op_sel_hi:[1,0]
 v_pk_mul_f32 v[180:181], v[180:181], v[198:199] op_sel_hi:[1,0]
 v_pk_mul_f32 v[182:183], v[182:183], v[198:199] op_sel_hi:[1,0]
 v_cvt_pk_bf16_f32 v184, v176, v177
 v_cvt_pk_bf16_f32 v185, v178, v179
 v_cvt_pk_bf16_f32 v186, v180, v181
 v_cvt_pk_bf16_f32 v187, v182, v183
 v_accvgpr_read_b32 v128, a32
 v_accvgpr_read_b32 v129, a33
 v_accvgpr_read_b32 v130, a34
 v_accvgpr_read_b32 v131, a35
 ds_write_b128 v202, v[184:187] offset:49152
 buffer_load_dwordx4 a[156:159], v20, s[64:67], s94 offen offset:2048 sc1
 buffer_load_dwordx4 a[160:163], v20, s[64:67], s94 offen offset:3072 sc1
 v_accvgpr_read_b32 v132, a48
 v_accvgpr_read_b32 v133, a49
 v_accvgpr_read_b32 v134, a50
 v_accvgpr_read_b32 v135, a51
 v_pk_mul_f32 v[128:129], v[128:129], v[192:193] op_sel_hi:[1,0]
 v_pk_mul_f32 v[130:131], v[130:131], v[192:193] op_sel_hi:[1,0]
 v_pk_mul_f32 v[132:133], v[132:133], v[192:193] op_sel_hi:[1,0]
 v_pk_mul_f32 v[134:135], v[134:135], v[192:193] op_sel_hi:[1,0]
 v_cvt_pk_bf16_f32 v136, v128, v129
 v_cvt_pk_bf16_f32 v137, v130, v131
 v_cvt_pk_bf16_f32 v138, v132, v133
 v_cvt_pk_bf16_f32 v139, v134, v135
 v_accvgpr_read_b32 v144, a36
 v_accvgpr_read_b32 v145, a37
 v_accvgpr_read_b32 v146, a38
 v_accvgpr_read_b32 v147, a39
 ds_write_b128 v202, v[136:139] offset:1024
 s_add_u32 s94, s94, 4096
 buffer_load_dwordx4 a[164:167], v20, s[64:67], s94 offen offset:0 sc1
 buffer_load_dwordx4 a[168:171], v20, s[64:67], s94 offen offset:1024 sc1
 v_accvgpr_read_b32 v148, a52
 v_accvgpr_read_b32 v149, a53
 v_accvgpr_read_b32 v150, a54
 v_accvgpr_read_b32 v151, a55
 v_pk_mul_f32 v[144:145], v[144:145], v[194:195] op_sel_hi:[1,0]
 v_pk_mul_f32 v[146:147], v[146:147], v[194:195] op_sel_hi:[1,0]
 v_pk_mul_f32 v[148:149], v[148:149], v[194:195] op_sel_hi:[1,0]
 v_pk_mul_f32 v[150:151], v[150:151], v[194:195] op_sel_hi:[1,0]
 v_cvt_pk_bf16_f32 v152, v144, v145
 v_cvt_pk_bf16_f32 v153, v146, v147
 v_cvt_pk_bf16_f32 v154, v148, v149
 v_cvt_pk_bf16_f32 v155, v150, v151
 v_accvgpr_read_b32 v160, a40
 v_accvgpr_read_b32 v161, a41
 v_accvgpr_read_b32 v162, a42
 v_accvgpr_read_b32 v163, a43
 ds_write_b128 v202, v[152:155] offset:17408
 buffer_load_dwordx4 a[172:175], v20, s[64:67], s94 offen offset:2048 sc1
 buffer_load_dwordx4 a[176:179], v20, s[64:67], s94 offen offset:3072 sc1
 v_accvgpr_read_b32 v164, a56
 v_accvgpr_read_b32 v165, a57
 v_accvgpr_read_b32 v166, a58
 v_accvgpr_read_b32 v167, a59
 v_pk_mul_f32 v[160:161], v[160:161], v[196:197] op_sel_hi:[1,0]
 v_pk_mul_f32 v[162:163], v[162:163], v[196:197] op_sel_hi:[1,0]
 v_pk_mul_f32 v[164:165], v[164:165], v[196:197] op_sel_hi:[1,0]
 v_pk_mul_f32 v[166:167], v[166:167], v[196:197] op_sel_hi:[1,0]
 v_cvt_pk_bf16_f32 v168, v160, v161
 v_cvt_pk_bf16_f32 v169, v162, v163
 v_cvt_pk_bf16_f32 v170, v164, v165
 v_cvt_pk_bf16_f32 v171, v166, v167
 v_accvgpr_read_b32 v176, a44
 v_accvgpr_read_b32 v177, a45
 v_accvgpr_read_b32 v178, a46
 v_accvgpr_read_b32 v179, a47
 ds_write_b128 v202, v[168:171] offset:33792
 s_add_u32 s94, s94, 4096
 buffer_load_dwordx4 a[212:215], v20, s[64:67], s94 offen offset:0 sc1
 buffer_load_dwordx4 a[216:219], v20, s[64:67], s94 offen offset:1024 sc1
 v_accvgpr_read_b32 v180, a60
 v_accvgpr_read_b32 v181, a61
 v_accvgpr_read_b32 v182, a62
 v_accvgpr_read_b32 v183, a63
 v_pk_mul_f32 v[176:177], v[176:177], v[198:199] op_sel_hi:[1,0]
 v_pk_mul_f32 v[178:179], v[178:179], v[198:199] op_sel_hi:[1,0]
 v_pk_mul_f32 v[180:181], v[180:181], v[198:199] op_sel_hi:[1,0]
 v_pk_mul_f32 v[182:183], v[182:183], v[198:199] op_sel_hi:[1,0]
 v_cvt_pk_bf16_f32 v184, v176, v177
 v_cvt_pk_bf16_f32 v185, v178, v179
 v_cvt_pk_bf16_f32 v186, v180, v181
 v_cvt_pk_bf16_f32 v187, v182, v183
 v_accvgpr_read_b32 v128, a64
 v_accvgpr_read_b32 v129, a65
 v_accvgpr_read_b32 v130, a66
 v_accvgpr_read_b32 v131, a67
 ds_write_b128 v202, v[184:187] offset:50176
 buffer_load_dwordx4 a[220:223], v20, s[64:67], s94 offen offset:2048 sc1
 buffer_load_dwordx4 a[224:227], v20, s[64:67], s94 offen offset:3072 sc1
 v_pk_mul_f32 v[128:129], v[128:129], v[192:193] op_sel_hi:[1,0]
 v_pk_mul_f32 v[130:131], v[130:131], v[192:193] op_sel_hi:[1,0]
 v_pk_mul_f32 v[132:133], v[208:209], v[192:193] op_sel_hi:[1,0]
 v_pk_mul_f32 v[134:135], v[210:211], v[192:193] op_sel_hi:[1,0]
 v_cvt_pk_bf16_f32 v136, v128, v129
 v_cvt_pk_bf16_f32 v137, v130, v131
 v_cvt_pk_bf16_f32 v138, v132, v133
 v_cvt_pk_bf16_f32 v139, v134, v135
 v_accvgpr_read_b32 v144, a68
 v_accvgpr_read_b32 v145, a69
 v_accvgpr_read_b32 v146, a70
 v_accvgpr_read_b32 v147, a71
 ds_write_b128 v202, v[136:139] offset:2048
 s_add_u32 s94, s94, 4096
 buffer_load_dwordx4 a[228:231], v20, s[64:67], s94 offen offset:0 sc1
 buffer_load_dwordx4 a[232:235], v20, s[64:67], s94 offen offset:1024 sc1
 v_pk_mul_f32 v[144:145], v[144:145], v[194:195] op_sel_hi:[1,0]
 v_pk_mul_f32 v[146:147], v[146:147], v[194:195] op_sel_hi:[1,0]
 v_pk_mul_f32 v[148:149], v[212:213], v[194:195] op_sel_hi:[1,0]
 v_pk_mul_f32 v[150:151], v[214:215], v[194:195] op_sel_hi:[1,0]
 v_cvt_pk_bf16_f32 v152, v144, v145
 v_cvt_pk_bf16_f32 v153, v146, v147
 v_cvt_pk_bf16_f32 v154, v148, v149
 v_cvt_pk_bf16_f32 v155, v150, v151
 v_accvgpr_read_b32 v160, a72
 v_accvgpr_read_b32 v161, a73
 v_accvgpr_read_b32 v162, a74
 v_accvgpr_read_b32 v163, a75
 ds_write_b128 v202, v[152:155] offset:18432
 buffer_load_dwordx4 a[236:239], v20, s[64:67], s94 offen offset:2048 sc1
 buffer_load_dwordx4 a[240:243], v20, s[64:67], s94 offen offset:3072 sc1
 v_pk_mul_f32 v[160:161], v[160:161], v[196:197] op_sel_hi:[1,0]
 v_pk_mul_f32 v[162:163], v[162:163], v[196:197] op_sel_hi:[1,0]
 v_pk_mul_f32 v[164:165], v[216:217], v[196:197] op_sel_hi:[1,0]
 v_pk_mul_f32 v[166:167], v[218:219], v[196:197] op_sel_hi:[1,0]
 v_cvt_pk_bf16_f32 v168, v160, v161
 v_cvt_pk_bf16_f32 v169, v162, v163
 v_cvt_pk_bf16_f32 v170, v164, v165
 v_cvt_pk_bf16_f32 v171, v166, v167
 v_accvgpr_read_b32 v176, a76
 v_accvgpr_read_b32 v177, a77
 v_accvgpr_read_b32 v178, a78
 v_accvgpr_read_b32 v179, a79
 ds_write_b128 v202, v[168:171] offset:34816
 s_add_u32 s94, s94, 4096
 buffer_load_dwordx4 a[0:3], v20, s[64:67], s94 offen offset:0 sc1
 buffer_load_dwordx4 a[4:7], v20, s[64:67], s94 offen offset:1024 sc1
 v_pk_mul_f32 v[176:177], v[176:177], v[198:199] op_sel_hi:[1,0]
 v_pk_mul_f32 v[178:179], v[178:179], v[198:199] op_sel_hi:[1,0]
 v_pk_mul_f32 v[180:181], v[220:221], v[198:199] op_sel_hi:[1,0]
 v_pk_mul_f32 v[182:183], v[222:223], v[198:199] op_sel_hi:[1,0]
 v_cvt_pk_bf16_f32 v184, v176, v177
 v_cvt_pk_bf16_f32 v185, v178, v179
 v_cvt_pk_bf16_f32 v186, v180, v181
 v_cvt_pk_bf16_f32 v187, v182, v183
 v_pk_mul_f32 v[128:129], v[224:225], v[192:193] op_sel_hi:[1,0]
 v_pk_mul_f32 v[130:131], v[226:227], v[192:193] op_sel_hi:[1,0]
 v_pk_mul_f32 v[132:133], v[240:241], v[192:193] op_sel_hi:[1,0]
 v_pk_mul_f32 v[134:135], v[242:243], v[192:193] op_sel_hi:[1,0]
 ds_write_b128 v202, v[184:187] offset:51200
 buffer_load_dwordx4 a[8:11], v20, s[64:67], s94 offen offset:2048 sc1
 buffer_load_dwordx4 a[12:15], v20, s[64:67], s94 offen offset:3072 sc1
 v_cvt_pk_bf16_f32 v136, v128, v129
 v_cvt_pk_bf16_f32 v137, v130, v131
 v_cvt_pk_bf16_f32 v138, v132, v133
 v_cvt_pk_bf16_f32 v139, v134, v135
 v_pk_mul_f32 v[144:145], v[228:229], v[194:195] op_sel_hi:[1,0]
 v_pk_mul_f32 v[146:147], v[230:231], v[194:195] op_sel_hi:[1,0]
 v_pk_mul_f32 v[148:149], v[244:245], v[194:195] op_sel_hi:[1,0]
 v_pk_mul_f32 v[150:151], v[246:247], v[194:195] op_sel_hi:[1,0]
 ds_write_b128 v202, v[136:139] offset:3072
 v_cvt_pk_bf16_f32 v152, v144, v145
 v_cvt_pk_bf16_f32 v153, v146, v147
 v_cvt_pk_bf16_f32 v154, v148, v149
 v_cvt_pk_bf16_f32 v155, v150, v151
 v_pk_mul_f32 v[160:161], v[232:233], v[196:197] op_sel_hi:[1,0]
 v_pk_mul_f32 v[162:163], v[234:235], v[196:197] op_sel_hi:[1,0]
 v_pk_mul_f32 v[164:165], v[248:249], v[196:197] op_sel_hi:[1,0]
 v_pk_mul_f32 v[166:167], v[250:251], v[196:197] op_sel_hi:[1,0]
 ds_write_b128 v202, v[152:155] offset:19456
 v_cvt_pk_bf16_f32 v168, v160, v161
 v_cvt_pk_bf16_f32 v169, v162, v163
 v_cvt_pk_bf16_f32 v170, v164, v165
 v_cvt_pk_bf16_f32 v171, v166, v167
 v_pk_mul_f32 v[176:177], v[236:237], v[198:199] op_sel_hi:[1,0]
 v_pk_mul_f32 v[178:179], v[238:239], v[198:199] op_sel_hi:[1,0]
 v_pk_mul_f32 v[180:181], v[252:253], v[198:199] op_sel_hi:[1,0]
 v_pk_mul_f32 v[182:183], v[254:255], v[198:199] op_sel_hi:[1,0]
 ds_write_b128 v202, v[168:171] offset:35840
 v_cvt_pk_bf16_f32 v184, v176, v177
 v_cvt_pk_bf16_f32 v185, v178, v179
 v_cvt_pk_bf16_f32 v186, v180, v181
 v_cvt_pk_bf16_f32 v187, v182, v183
 ds_write_b128 v202, v[184:187] offset:52224
 s_waitcnt vmcnt(32)
 ds_read_b64_tr_b16 v[96:97], v6 offset:0
 ds_read_b64_tr_b16 v[98:99], v6 offset:2048
 ds_read_b64_tr_b16 v[100:101], v6 offset:4096
 ds_read_b64_tr_b16 v[102:103], v6 offset:6144
 ds_read_b64_tr_b16 v[104:105], v7 offset:0
 ds_read_b64_tr_b16 v[106:107], v7 offset:2048
 ds_read_b64_tr_b16 v[108:109], v7 offset:4096
 ds_read_b64_tr_b16 v[110:111], v7 offset:6144
 s_mov_b64 exec, 0
 s_cmp_eq_u32 s76, 0
 s_cbranch_scc1 L_pg14
 s_cmp_eq_u32 s76, 1
 s_cbranch_scc1 L_pg15
 s_cmp_eq_u32 s76, 2
 s_cbranch_scc1 L_pg16
 s_branch L_pg17
L_site2:
 s_mov_b64 exec, -1
 s_nop 0
 s_waitcnt lgkmcnt(8)
 s_barrier
 ds_read_b128 v[32:35], v20 offset:0
 ds_read_b128 v[36:39], v20 offset:16384
 ds_read_b128 v[40:43], v20 offset:32768
 ds_read_b128 v[44:47], v20 offset:49152
 ds_read_b128 v[48:51], v20 offset:1024
 ds_read_b128 v[52:55], v20 offset:17408
 ds_read_b128 v[56:59], v20 offset:33792
 ds_read_b128 v[60:63], v20 offset:50176
 buffer_load_dwordx4 v28, s[44:47], s84 offen offset:0 lds
 buffer_load_dwordx4 v29, s[44:47], s84 offen offset:1024 lds
 buffer_load_dwordx4 v30, s[44:47], s84 offen offset:2048 lds
 buffer_load_dwordx4 v31, s[44:47], s84 offen offset:3072 lds
 s_add_u32 m0, s96, 36864
 s_add_u32 s84, s95, 163840
 s_waitcnt vmcnt(36) lgkmcnt(0)
 v_mfma_f32_16x16x32_bf16 v[128:131], v[96:99], v[32:35], 0
 ds_read_b64_tr_b16 v[112:113], v8 offset:0
 ds_read_b64_tr_b16 v[114:115], v8 offset:2048
 v_mfma_f32_16x16x32_bf16 v[128:131], v[100:103], v[48:51], v[128:131]
 buffer_load_dwordx4 v28, s[44:47], s84 offen offset:0 lds
 v_mfma_f32_16x16x32_bf16 v[132:135], v[96:99], v[36:39], 0
 buffer_load_dwordx4 v29, s[44:47], s84 offen offset:1024 lds
 v_mfma_f32_16x16x32_bf16 v[132:135], v[100:103], v[52:55], v[132:135]
 v_mfma_f32_16x16x32_bf16 v[136:139], v[96:99], v[40:43], 0
 ds_read_b64_tr_b16 v[116:117], v8 offset:4096
 ds_read_b64_tr_b16 v[118:119], v8 offset:6144
 v_mfma_f32_16x16x32_bf16 v[136:139], v[100:103], v[56:59], v[136:139]
 buffer_load_dwordx4 v30, s[44:47], s84 offen offset:2048 lds
 v_mfma_f32_16x16x32_bf16 v[140:143], v[96:99], v[44:47], 0
 buffer_load_dwordx4 v31, s[44:47], s84 offen offset:3072 lds
 v_mfma_f32_16x16x32_bf16 v[140:143], v[100:103], v[60:63], v[140:143]
 s_waitcnt lgkmcnt(12)
 v_mfma_f32_16x16x32_bf16 v[144:147], v[104:107], v[32:35], 0
 ds_read_b64_tr_b16 v[96:97], v9 offset:0
 ds_read_b64_tr_b16 v[98:99], v9 offset:2048
 v_mfma_f32_16x16x32_bf16 v[144:147], v[108:111], v[48:51], v[144:147]
 ds_read_b128 v[64:67], v20 offset:2048
 ds_read_b128 v[68:71], v20 offset:18432
 v_mfma_f32_16x16x32_bf16 v[148:151], v[104:107], v[36:39], 0
 ds_read_b128 v[72:75], v20 offset:34816
 ds_read_b128 v[76:79], v20 offset:51200
 v_mfma_f32_16x16x32_bf16 v[148:151], v[108:111], v[52:55], v[148:151]
 v_mfma_f32_16x16x32_bf16 v[152:155], v[104:107], v[40:43], 0
 ds_read_b64_tr_b16 v[100:101], v9 offset:4096
 ds_read_b64_tr_b16 v[102:103], v9 offset:6144
 v_mfma_f32_16x16x32_bf16 v[152:155], v[108:111], v[56:59], v[152:155]
 ds_read_b128 v[80:83], v20 offset:3072
 ds_read_b128 v[84:87], v20 offset:19456
 v_mfma_f32_16x16x32_bf16 v[156:159], v[104:107], v[44:47], 0
 ds_read_b128 v[88:91], v20 offset:35840
 ds_read_b128 v[92:95], v20 offset:52224
 v_mfma_f32_16x16x32_bf16 v[156:159], v[108:111], v[60:63], v[156:159]
 s_waitcnt vmcnt(32) lgkmcnt(12)
 v_mfma_f32_16x16x32_bf16 v[160:163], v[112:115], v[32:35], 0
 ds_read_b64_tr_b16 v[104:105], v2 offset:0
 ds_read_b64_tr_b16 v[106:107], v2 offset:2048
 v_mfma_f32_16x16x32_bf16 v[160:163], v[116:119], v[48:51], v[160:163]
 v_mfma_f32_16x16x32_bf16 v[164:167], v[112:115], v[36:39], 0
 v_mfma_f32_16x16x32_bf16 v[164:167], v[116:119], v[52:55], v[164:167]
 v_mfma_f32_16x16x32_bf16 v[168:171], v[112:115], v[40:43], 0
 ds_read_b64_tr_b16 v[108:109], v2 offset:4096
 ds_read_b64_tr_b16 v[110:111], v2 offset:6144
 v_mfma_f32_16x16x32_bf16 v[168:171], v[116:119], v[56:59], v[168:171]
 v_mfma_f32_16x16x32_bf16 v[172:175], v[112:115], v[44:47], 0
 v_mfma_f32_16x16x32_bf16 v[172:175], v[116:119], v[60:63], v[172:175]
 s_add_u32 m0, s96, 65536
 s_add_u32 s84, s95, 196608
 s_waitcnt lgkmcnt(8)
 v_mfma_f32_16x16x32_bf16 v[176:179], v[96:99], v[32:35], 0
 ds_read_b64_tr_b16 v[112:113], v3 offset:0
 ds_read_b64_tr_b16 v[114:115], v3 offset:2048
 v_mfma_f32_16x16x32_bf16 v[176:179], v[100:103], v[48:51], v[176:179]
 buffer_load_dwordx4 v28, s[44:47], s84 offen offset:0 lds
 v_mfma_f32_16x16x32_bf16 v[180:183], v[96:99], v[36:39], 0
 buffer_load_dwordx4 v29, s[44:47], s84 offen offset:1024 lds
 v_mfma_f32_16x16x32_bf16 v[180:183], v[100:103], v[52:55], v[180:183]
 v_mfma_f32_16x16x32_bf16 v[184:187], v[96:99], v[40:43], 0
 ds_read_b64_tr_b16 v[116:117], v3 offset:4096
 ds_read_b64_tr_b16 v[118:119], v3 offset:6144
 v_mfma_f32_16x16x32_bf16 v[184:187], v[100:103], v[56:59], v[184:187]
 buffer_load_dwordx4 v30, s[44:47], s84 offen offset:2048 lds
 v_mfma_f32_16x16x32_bf16 v[188:191], v[96:99], v[44:47], 0
 buffer_load_dwordx4 v31, s[44:47], s84 offen offset:3072 lds
 v_mfma_f32_16x16x32_bf16 v[188:191], v[100:103], v[60:63], v[188:191]
 s_add_u32 m0, s96, 69632
 s_add_u32 s84, s95, 229376
 s_waitcnt lgkmcnt(4)
 v_mfma_f32_16x16x32_bf16 v[128:131], v[104:107], v[64:67], v[128:131]
 ds_read_b64_tr_b16 v[96:97], v4 offset:0
 ds_read_b64_tr_b16 v[98:99], v4 offset:2048
 v_mfma_f32_16x16x32_bf16 v[128:131], v[108:111], v[80:83], v[128:131]
 buffer_load_dwordx4 v28, s[44:47], s84 offen offset:0 lds
 v_mfma_f32_16x16x32_bf16 v[132:135], v[104:107], v[68:71], v[132:135]
 buffer_load_dwordx4 v29, s[44:47], s84 offen offset:1024 lds
 v_mfma_f32_16x16x32_bf16 v[132:135], v[108:111], v[84:87], v[132:135]
 v_mfma_f32_16x16x32_bf16 v[136:139], v[104:107], v[72:75], v[136:139]
 ds_read_b64_tr_b16 v[100:101], v4 offset:4096
 ds_read_b64_tr_b16 v[102:103], v4 offset:6144
 v_mfma_f32_16x16x32_bf16 v[136:139], v[108:111], v[88:91], v[136:139]
 buffer_load_dwordx4 v30, s[44:47], s84 offen offset:2048 lds
 v_mfma_f32_16x16x32_bf16 v[140:143], v[104:107], v[76:79], v[140:143]
 buffer_load_dwordx4 v31, s[44:47], s84 offen offset:3072 lds
 v_mfma_f32_16x16x32_bf16 v[140:143], v[108:111], v[92:95], v[140:143]
 s_waitcnt lgkmcnt(4)
 v_mfma_f32_16x16x32_bf16 v[144:147], v[112:115], v[64:67], v[144:147]
 ds_read_b64_tr_b16 v[104:105], v5 offset:0
 ds_read_b64_tr_b16 v[106:107], v5 offset:2048
 v_mfma_f32_16x16x32_bf16 v[144:147], v[116:119], v[80:83], v[144:147]
 ds_read_b128 v[32:35], v20 offset:4096
 ds_read_b128 v[36:39], v20 offset:20480
 v_mfma_f32_16x16x32_bf16 v[148:151], v[112:115], v[68:71], v[148:151]
 ds_read_b128 v[40:43], v20 offset:36864
 ds_read_b128 v[44:47], v20 offset:53248
 v_mfma_f32_16x16x32_bf16 v[148:151], v[116:119], v[84:87], v[148:151]
 v_mfma_f32_16x16x32_bf16 v[152:155], v[112:115], v[72:75], v[152:155]
 ds_read_b64_tr_b16 v[108:109], v5 offset:4096
 ds_read_b64_tr_b16 v[110:111], v5 offset:6144
 v_mfma_f32_16x16x32_bf16 v[152:155], v[116:119], v[88:91], v[152:155]
 ds_read_b128 v[48:51], v20 offset:5120
 ds_read_b128 v[52:55], v20 offset:21504
 v_mfma_f32_16x16x32_bf16 v[156:159], v[112:115], v[76:79], v[156:159]
 ds_read_b128 v[56:59], v20 offset:37888
 ds_read_b128 v[60:63], v20 offset:54272
 v_mfma_f32_16x16x32_bf16 v[156:159], v[116:119], v[92:95], v[156:159]
 s_waitcnt vmcnt(8) lgkmcnt(12)
 v_mfma_f32_16x16x32_bf16 v[160:163], v[96:99], v[64:67], v[160:163]
 ds_read_b64_tr_b16 v[112:113], v2 offset:32768
 ds_read_b64_tr_b16 v[114:115], v2 offset:34816
 v_mfma_f32_16x16x32_bf16 v[160:163], v[100:103], v[80:83], v[160:163]
 v_mfma_f32_16x16x32_bf16 v[164:167], v[96:99], v[68:71], v[164:167]
 v_mfma_f32_16x16x32_bf16 v[164:167], v[100:103], v[84:87], v[164:167]
 v_mfma_f32_16x16x32_bf16 v[168:171], v[96:99], v[72:75], v[168:171]
 ds_read_b64_tr_b16 v[116:117], v2 offset:36864
 ds_read_b64_tr_b16 v[118:119], v2 offset:38912
 v_mfma_f32_16x16x32_bf16 v[168:171], v[100:103], v[88:91], v[168:171]
 v_mfma_f32_16x16x32_bf16 v[172:175], v[96:99], v[76:79], v[172:175]
 v_mfma_f32_16x16x32_bf16 v[172:175], v[100:103], v[92:95], v[172:175]
 s_add_u32 m0, s96, 0
 s_add_u32 s84, s95, 262144
 s_waitcnt lgkmcnt(8)
 v_mfma_f32_16x16x32_bf16 v[176:179], v[104:107], v[64:67], v[176:179]
 ds_read_b64_tr_b16 v[96:97], v3 offset:32768
 ds_read_b64_tr_b16 v[98:99], v3 offset:34816
 v_mfma_f32_16x16x32_bf16 v[176:179], v[108:111], v[80:83], v[176:179]
 buffer_load_dwordx4 v28, s[44:47], s84 offen offset:0 lds
 v_mfma_f32_16x16x32_bf16 v[180:183], v[104:107], v[68:71], v[180:183]
 buffer_load_dwordx4 v29, s[44:47], s84 offen offset:1024 lds
 v_mfma_f32_16x16x32_bf16 v[180:183], v[108:111], v[84:87], v[180:183]
 v_mfma_f32_16x16x32_bf16 v[184:187], v[104:107], v[72:75], v[184:187]
 ds_read_b64_tr_b16 v[100:101], v3 offset:36864
 ds_read_b64_tr_b16 v[102:103], v3 offset:38912
 v_mfma_f32_16x16x32_bf16 v[184:187], v[108:111], v[88:91], v[184:187]
 buffer_load_dwordx4 v30, s[44:47], s84 offen offset:2048 lds
 v_mfma_f32_16x16x32_bf16 v[188:191], v[104:107], v[76:79], v[188:191]
 buffer_load_dwordx4 v31, s[44:47], s84 offen offset:3072 lds
 v_mfma_f32_16x16x32_bf16 v[188:191], v[108:111], v[92:95], v[188:191]
 s_add_u32 m0, s96, 4096
 s_add_u32 s84, s95, 294912
 s_waitcnt lgkmcnt(4)
 v_mfma_f32_16x16x32_bf16 v[128:131], v[112:115], v[32:35], v[128:131]
 ds_read_b64_tr_b16 v[104:105], v4 offset:32768
 ds_read_b64_tr_b16 v[106:107], v4 offset:34816
 v_mfma_f32_16x16x32_bf16 v[128:131], v[116:119], v[48:51], v[128:131]
 buffer_load_dwordx4 v28, s[44:47], s84 offen offset:0 lds
 v_mfma_f32_16x16x32_bf16 v[132:135], v[112:115], v[36:39], v[132:135]
 buffer_load_dwordx4 v29, s[44:47], s84 offen offset:1024 lds
 v_mfma_f32_16x16x32_bf16 v[132:135], v[116:119], v[52:55], v[132:135]
 v_mfma_f32_16x16x32_bf16 v[136:139], v[112:115], v[40:43], v[136:139]
 ds_read_b64_tr_b16 v[108:109], v4 offset:36864
 ds_read_b64_tr_b16 v[110:111], v4 offset:38912
 v_mfma_f32_16x16x32_bf16 v[136:139], v[116:119], v[56:59], v[136:139]
 buffer_load_dwordx4 v30, s[44:47], s84 offen offset:2048 lds
 v_mfma_f32_16x16x32_bf16 v[140:143], v[112:115], v[44:47], v[140:143]
 buffer_load_dwordx4 v31, s[44:47], s84 offen offset:3072 lds
 v_mfma_f32_16x16x32_bf16 v[140:143], v[116:119], v[60:63], v[140:143]
 s_waitcnt lgkmcnt(4)
 v_mfma_f32_16x16x32_bf16 v[144:147], v[96:99], v[32:35], v[144:147]
 ds_read_b64_tr_b16 v[112:113], v5 offset:32768
 ds_read_b64_tr_b16 v[114:115], v5 offset:34816
 v_mfma_f32_16x16x32_bf16 v[144:147], v[100:103], v[48:51], v[144:147]
 ds_read_b128 v[64:67], v20 offset:6144
 ds_read_b128 v[68:71], v20 offset:22528
 v_mfma_f32_16x16x32_bf16 v[148:151], v[96:99], v[36:39], v[148:151]
 ds_read_b128 v[72:75], v20 offset:38912
 ds_read_b128 v[76:79], v20 offset:55296
 v_mfma_f32_16x16x32_bf16 v[148:151], v[100:103], v[52:55], v[148:151]
 v_mfma_f32_16x16x32_bf16 v[152:155], v[96:99], v[40:43], v[152:155]
 ds_read_b64_tr_b16 v[116:117], v5 offset:36864
 ds_read_b64_tr_b16 v[118:119], v5 offset:38912
 v_mfma_f32_16x16x32_bf16 v[152:155], v[100:103], v[56:59], v[152:155]
 ds_read_b128 v[80:83], v20 offset:7168
 ds_read_b128 v[84:87], v20 offset:23552
 v_mfma_f32_16x16x32_bf16 v[156:159], v[96:99], v[44:47], v[156:159]
 ds_read_b128 v[88:91], v20 offset:39936
 ds_read_b128 v[92:95], v20 offset:56320
 v_mfma_f32_16x16x32_bf16 v[156:159], v[100:103], v[60:63], v[156:159]
 s_waitcnt vmcnt(8) lgkmcnt(12)
 v_mfma_f32_16x16x32_bf16 v[160:163], v[104:107], v[32:35], v[160:163]
 ds_read_b64_tr_b16 v[96:97], v6 offset:0
 ds_read_b64_tr_b16 v[98:99], v6 offset:2048
 v_mfma_f32_16x16x32_bf16 v[160:163], v[108:111], v[48:51], v[160:163]
 v_mfma_f32_16x16x32_bf16 v[164:167], v[104:107], v[36:39], v[164:167]
 v_mfma_f32_16x16x32_bf16 v[164:167], v[108:111], v[52:55], v[164:167]
 v_mfma_f32_16x16x32_bf16 v[168:171], v[104:107], v[40:43], v[168:171]
 ds_read_b64_tr_b16 v[100:101], v6 offset:4096
 ds_read_b64_tr_b16 v[102:103], v6 offset:6144
 v_mfma_f32_16x16x32_bf16 v[168:171], v[108:111], v[56:59], v[168:171]
 v_mfma_f32_16x16x32_bf16 v[172:175], v[104:107], v[44:47], v[172:175]
 v_mfma_f32_16x16x32_bf16 v[172:175], v[108:111], v[60:63], v[172:175]
 s_add_u32 m0, s96, 32768
 s_add_u32 s84, s95, 327680
 s_waitcnt lgkmcnt(8)
 v_mfma_f32_16x16x32_bf16 v[176:179], v[112:115], v[32:35], v[176:179]
 ds_read_b64_tr_b16 v[104:105], v7 offset:0
 ds_read_b64_tr_b16 v[106:107], v7 offset:2048
 v_mfma_f32_16x16x32_bf16 v[176:179], v[116:119], v[48:51], v[176:179]
 buffer_load_dwordx4 v28, s[44:47], s84 offen offset:0 lds
 v_mfma_f32_16x16x32_bf16 v[180:183], v[112:115], v[36:39], v[180:183]
 buffer_load_dwordx4 v29, s[44:47], s84 offen offset:1024 lds
 v_mfma_f32_16x16x32_bf16 v[180:183], v[116:119], v[52:55], v[180:183]
 v_mfma_f32_16x16x32_bf16 v[184:187], v[112:115], v[40:43], v[184:187]
 ds_read_b64_tr_b16 v[108:109], v7 offset:4096
 ds_read_b64_tr_b16 v[110:111], v7 offset:6144
 v_mfma_f32_16x16x32_bf16 v[184:187], v[116:119], v[56:59], v[184:187]
 buffer_load_dwordx4 v30, s[44:47], s84 offen offset:2048 lds
 v_mfma_f32_16x16x32_bf16 v[188:191], v[112:115], v[44:47], v[188:191]
 buffer_load_dwordx4 v31, s[44:47], s84 offen offset:3072 lds
 v_mfma_f32_16x16x32_bf16 v[188:191], v[116:119], v[60:63], v[188:191]
 s_add_u32 m0, s96, 36864
 s_add_u32 s84, s95, 360448
 s_waitcnt lgkmcnt(4)
 v_mfma_f32_16x16x32_bf16 v[128:131], v[96:99], v[64:67], v[128:131]
 ds_read_b64_tr_b16 v[112:113], v8 offset:0
 ds_read_b64_tr_b16 v[114:115], v8 offset:2048
 v_mfma_f32_16x16x32_bf16 v[128:131], v[100:103], v[80:83], v[128:131]
 buffer_load_dwordx4 v28, s[44:47], s84 offen offset:0 lds
 v_mfma_f32_16x16x32_bf16 v[132:135], v[96:99], v[68:71], v[132:135]
 buffer_load_dwordx4 v29, s[44:47], s84 offen offset:1024 lds
L_pg14:
 s_cbranch_execz L_site2
 v_mfma_f32_16x16x32_bf16 v[132:135], v[100:103], v[84:87], v[132:135]
 v_mfma_f32_16x16x32_bf16 v[136:139], v[96:99], v[72:75], v[136:139]
 ds_read_b64_tr_b16 v[116:117], v8 offset:4096
 ds_read_b64_tr_b16 v[118:119], v8 offset:6144
 v_mfma_f32_16x16x32_bf16 v[136:139], v[100:103], v[88:91], v[136:139]
 buffer_load_dwordx4 v30, s[44:47], s84 offen offset:2048 lds
 v_mfma_f32_16x16x32_bf16 v[140:143], v[96:99], v[76:79], v[140:143]
 buffer_load_dwordx4 v31, s[44:47], s84 offen offset:3072 lds
 v_mfma_f32_16x16x32_bf16 v[140:143], v[100:103], v[92:95], v[140:143]
 s_waitcnt lgkmcnt(4)
 v_mfma_f32_16x16x32_bf16 v[144:147], v[104:107], v[64:67], v[144:147]
 ds_read_b64_tr_b16 v[96:97], v9 offset:0
 ds_read_b64_tr_b16 v[98:99], v9 offset:2048
 v_mfma_f32_16x16x32_bf16 v[144:147], v[108:111], v[80:83], v[144:147]
 ds_read_b128 v[32:35], v20 offset:8192
 ds_read_b128 v[36:39], v20 offset:24576
 v_mfma_f32_16x16x32_bf16 v[148:151], v[104:107], v[68:71], v[148:151]
 ds_read_b128 v[40:43], v20 offset:40960
 ds_read_b128 v[44:47], v20 offset:57344
 v_mfma_f32_16x16x32_bf16 v[148:151], v[108:111], v[84:87], v[148:151]
 v_mfma_f32_16x16x32_bf16 v[152:155], v[104:107], v[72:75], v[152:155]
 ds_read_b64_tr_b16 v[100:101], v9 offset:4096
 ds_read_b64_tr_b16 v[102:103], v9 offset:6144
 v_mfma_f32_16x16x32_bf16 v[152:155], v[108:111], v[88:91], v[152:155]
 ds_read_b128 v[48:51], v20 offset:9216
 ds_read_b128 v[52:55], v20 offset:25600
 v_mfma_f32_16x16x32_bf16 v[156:159], v[104:107], v[76:79], v[156:159]
 ds_read_b128 v[56:59], v20 offset:41984
 ds_read_b128 v[60:63], v20 offset:58368
 v_mfma_f32_16x16x32_bf16 v[156:159], v[108:111], v[92:95], v[156:159]
 s_waitcnt vmcnt(8) lgkmcnt(12)
 v_mfma_f32_16x16x32_bf16 v[160:163], v[112:115], v[64:67], v[160:163]
 ds_read_b64_tr_b16 v[104:105], v2 offset:0
 ds_read_b64_tr_b16 v[106:107], v2 offset:2048
 v_mfma_f32_16x16x32_bf16 v[160:163], v[116:119], v[80:83], v[160:163]
 v_mfma_f32_16x16x32_bf16 v[164:167], v[112:115], v[68:71], v[164:167]
 v_mfma_f32_16x16x32_bf16 v[164:167], v[116:119], v[84:87], v[164:167]
 v_mfma_f32_16x16x32_bf16 v[168:171], v[112:115], v[72:75], v[168:171]
 ds_read_b64_tr_b16 v[108:109], v2 offset:4096
 ds_read_b64_tr_b16 v[110:111], v2 offset:6144
 v_mfma_f32_16x16x32_bf16 v[168:171], v[116:119], v[88:91], v[168:171]
 v_mfma_f32_16x16x32_bf16 v[172:175], v[112:115], v[76:79], v[172:175]
 v_mfma_f32_16x16x32_bf16 v[172:175], v[116:119], v[92:95], v[172:175]
 s_add_u32 m0, s96, 65536
 s_add_u32 s84, s95, 393216
 s_waitcnt lgkmcnt(8)
 v_mfma_f32_16x16x32_bf16 v[176:179], v[96:99], v[64:67], v[176:179]
 ds_read_b64_tr_b16 v[112:113], v3 offset:0
 ds_read_b64_tr_b16 v[114:115], v3 offset:2048
 v_mfma_f32_16x16x32_bf16 v[176:179], v[100:103], v[80:83], v[176:179]
 buffer_load_dwordx4 v28, s[44:47], s84 offen offset:0 lds
 v_mfma_f32_16x16x32_bf16 v[180:183], v[96:99], v[68:71], v[180:183]
 buffer_load_dwordx4 v29, s[44:47], s84 offen offset:1024 lds
 v_mfma_f32_16x16x32_bf16 v[180:183], v[100:103], v[84:87], v[180:183]
 v_mfma_f32_16x16x32_bf16 v[184:187], v[96:99], v[72:75], v[184:187]
 ds_read_b64_tr_b16 v[116:117], v3 offset:4096
 ds_read_b64_tr_b16 v[118:119], v3 offset:6144
 v_mfma_f32_16x16x32_bf16 v[184:187], v[100:103], v[88:91], v[184:187]
 buffer_load_dwordx4 v30, s[44:47], s84 offen offset:2048 lds
 v_mfma_f32_16x16x32_bf16 v[188:191], v[96:99], v[76:79], v[188:191]
 buffer_load_dwordx4 v31, s[44:47], s84 offen offset:3072 lds
 v_mfma_f32_16x16x32_bf16 v[188:191], v[100:103], v[92:95], v[188:191]
 s_add_u32 m0, s96, 69632
 s_add_u32 s84, s95, 425984
 s_waitcnt lgkmcnt(4)
 v_mfma_f32_16x16x32_bf16 v[128:131], v[104:107], v[32:35], v[128:131]
 ds_read_b64_tr_b16 v[96:97], v4 offset:0
 ds_read_b64_tr_b16 v[98:99], v4 offset:2048
 v_mfma_f32_16x16x32_bf16 v[128:131], v[108:111], v[48:51], v[128:131]
 buffer_load_dwordx4 v28, s[44:47], s84 offen offset:0 lds
 v_mfma_f32_16x16x32_bf16 v[132:135], v[104:107], v[36:39], v[132:135]
 buffer_load_dwordx4 v29, s[44:47], s84 offen offset:1024 lds
 v_mfma_f32_16x16x32_bf16 v[132:135], v[108:111], v[52:55], v[132:135]
 v_mfma_f32_16x16x32_bf16 v[136:139], v[104:107], v[40:43], v[136:139]
 ds_read_b64_tr_b16 v[100:101], v4 offset:4096
 ds_read_b64_tr_b16 v[102:103], v4 offset:6144
 v_mfma_f32_16x16x32_bf16 v[136:139], v[108:111], v[56:59], v[136:139]
 buffer_load_dwordx4 v30, s[44:47], s84 offen offset:2048 lds
 v_mfma_f32_16x16x32_bf16 v[140:143], v[104:107], v[44:47], v[140:143]
 buffer_load_dwordx4 v31, s[44:47], s84 offen offset:3072 lds
 v_mfma_f32_16x16x32_bf16 v[140:143], v[108:111], v[60:63], v[140:143]
 s_waitcnt lgkmcnt(4)
 v_mfma_f32_16x16x32_bf16 v[144:147], v[112:115], v[32:35], v[144:147]
 ds_read_b64_tr_b16 v[104:105], v5 offset:0
 ds_read_b64_tr_b16 v[106:107], v5 offset:2048
 v_mfma_f32_16x16x32_bf16 v[144:147], v[116:119], v[48:51], v[144:147]
 ds_read_b128 v[64:67], v20 offset:10240
 ds_read_b128 v[68:71], v20 offset:26624
 v_mfma_f32_16x16x32_bf16 v[148:151], v[112:115], v[36:39], v[148:151]
 ds_read_b128 v[72:75], v20 offset:43008
 ds_read_b128 v[76:79], v20 offset:59392
 v_mfma_f32_16x16x32_bf16 v[148:151], v[116:119], v[52:55], v[148:151]
 v_mfma_f32_16x16x32_bf16 v[152:155], v[112:115], v[40:43], v[152:155]
 ds_read_b64_tr_b16 v[108:109], v5 offset:4096
 ds_read_b64_tr_b16 v[110:111], v5 offset:6144
 v_mfma_f32_16x16x32_bf16 v[152:155], v[116:119], v[56:59], v[152:155]
 ds_read_b128 v[80:83], v20 offset:11264
 ds_read_b128 v[84:87], v20 offset:27648
 v_mfma_f32_16x16x32_bf16 v[156:159], v[112:115], v[44:47], v[156:159]
 ds_read_b128 v[88:91], v20 offset:44032
 ds_read_b128 v[92:95], v20 offset:60416
 v_mfma_f32_16x16x32_bf16 v[156:159], v[116:119], v[60:63], v[156:159]
 s_waitcnt vmcnt(8) lgkmcnt(12)
 v_mfma_f32_16x16x32_bf16 v[160:163], v[96:99], v[32:35], v[160:163]
 ds_read_b64_tr_b16 v[112:113], v2 offset:32768
 ds_read_b64_tr_b16 v[114:115], v2 offset:34816
 v_mfma_f32_16x16x32_bf16 v[160:163], v[100:103], v[48:51], v[160:163]
 v_mfma_f32_16x16x32_bf16 v[164:167], v[96:99], v[36:39], v[164:167]
 v_mfma_f32_16x16x32_bf16 v[164:167], v[100:103], v[52:55], v[164:167]
 v_mfma_f32_16x16x32_bf16 v[168:171], v[96:99], v[40:43], v[168:171]
 ds_read_b64_tr_b16 v[116:117], v2 offset:36864
 ds_read_b64_tr_b16 v[118:119], v2 offset:38912
 v_mfma_f32_16x16x32_bf16 v[168:171], v[100:103], v[56:59], v[168:171]
 v_mfma_f32_16x16x32_bf16 v[172:175], v[96:99], v[44:47], v[172:175]
 v_mfma_f32_16x16x32_bf16 v[172:175], v[100:103], v[60:63], v[172:175]
 s_add_u32 m0, s96, 0
 s_add_u32 s84, s95, 458752
 s_waitcnt lgkmcnt(8)
 v_mfma_f32_16x16x32_bf16 v[176:179], v[104:107], v[32:35], v[176:179]
 ds_read_b64_tr_b16 v[96:97], v3 offset:32768
 ds_read_b64_tr_b16 v[98:99], v3 offset:34816
 v_mfma_f32_16x16x32_bf16 v[176:179], v[108:111], v[48:51], v[176:179]
 buffer_load_dwordx4 v28, s[44:47], s84 offen offset:0 lds
 v_mfma_f32_16x16x32_bf16 v[180:183], v[104:107], v[36:39], v[180:183]
 buffer_load_dwordx4 v29, s[44:47], s84 offen offset:1024 lds
 v_mfma_f32_16x16x32_bf16 v[180:183], v[108:111], v[52:55], v[180:183]
 v_mfma_f32_16x16x32_bf16 v[184:187], v[104:107], v[40:43], v[184:187]
 ds_read_b64_tr_b16 v[100:101], v3 offset:36864
 ds_read_b64_tr_b16 v[102:103], v3 offset:38912
 v_mfma_f32_16x16x32_bf16 v[184:187], v[108:111], v[56:59], v[184:187]
 buffer_load_dwordx4 v30, s[44:47], s84 offen offset:2048 lds
 v_mfma_f32_16x16x32_bf16 v[188:191], v[104:107], v[44:47], v[188:191]
 buffer_load_dwordx4 v31, s[44:47], s84 offen offset:3072 lds
 v_mfma_f32_16x16x32_bf16 v[188:191], v[108:111], v[60:63], v[188:191]
 s_add_u32 m0, s96, 4096
 s_add_u32 s84, s95, 491520
 s_waitcnt lgkmcnt(4)
 v_mfma_f32_16x16x32_bf16 v[128:131], v[112:115], v[64:67], v[128:131]
 ds_read_b64_tr_b16 v[104:105], v4 offset:32768
 ds_read_b64_tr_b16 v[106:107], v4 offset:34816
 v_mfma_f32_16x16x32_bf16 v[128:131], v[116:119], v[80:83], v[128:131]
 buffer_load_dwordx4 v28, s[44:47], s84 offen offset:0 lds
 v_mfma_f32_16x16x32_bf16 v[132:135], v[112:115], v[68:71], v[132:135]
 buffer_load_dwordx4 v29, s[44:47], s84 offen offset:1024 lds
 v_mfma_f32_16x16x32_bf16 v[132:135], v[116:119], v[84:87], v[132:135]
 v_mfma_f32_16x16x32_bf16 v[136:139], v[112:115], v[72:75], v[136:139]
 ds_read_b64_tr_b16 v[108:109], v4 offset:36864
 ds_read_b64_tr_b16 v[110:111], v4 offset:38912
 v_mfma_f32_16x16x32_bf16 v[136:139], v[116:119], v[88:91], v[136:139]
 buffer_load_dwordx4 v30, s[44:47], s84 offen offset:2048 lds
 v_mfma_f32_16x16x32_bf16 v[140:143], v[112:115], v[76:79], v[140:143]
 buffer_load_dwordx4 v31, s[44:47], s84 offen offset:3072 lds
 v_mfma_f32_16x16x32_bf16 v[140:143], v[116:119], v[92:95], v[140:143]
 s_waitcnt lgkmcnt(4)
 v_mfma_f32_16x16x32_bf16 v[144:147], v[96:99], v[64:67], v[144:147]
 ds_read_b64_tr_b16 v[112:113], v5 offset:32768
 ds_read_b64_tr_b16 v[114:115], v5 offset:34816
 v_mfma_f32_16x16x32_bf16 v[144:147], v[100:103], v[80:83], v[144:147]
 ds_read_b128 v[32:35], v20 offset:12288
 ds_read_b128 v[36:39], v20 offset:28672
 v_mfma_f32_16x16x32_bf16 v[148:151], v[96:99], v[68:71], v[148:151]
 ds_read_b128 v[40:43], v20 offset:45056
 ds_read_b128 v[44:47], v20 offset:61440
 v_mfma_f32_16x16x32_bf16 v[148:151], v[100:103], v[84:87], v[148:151]
 v_mfma_f32_16x16x32_bf16 v[152:155], v[96:99], v[72:75], v[152:155]
 ds_read_b64_tr_b16 v[116:117], v5 offset:36864
 ds_read_b64_tr_b16 v[118:119], v5 offset:38912
 v_mfma_f32_16x16x32_bf16 v[152:155], v[100:103], v[88:91], v[152:155]
 ds_read_b128 v[48:51], v20 offset:13312
 ds_read_b128 v[52:55], v20 offset:29696
 v_mfma_f32_16x16x32_bf16 v[156:159], v[96:99], v[76:79], v[156:159]
 ds_read_b128 v[56:59], v20 offset:46080
 ds_read_b128 v[60:63], v20 offset:62464
 v_mfma_f32_16x16x32_bf16 v[156:159], v[100:103], v[92:95], v[156:159]
 s_waitcnt vmcnt(8) lgkmcnt(12)
 v_mfma_f32_16x16x32_bf16 v[160:163], v[104:107], v[64:67], v[160:163]
 ds_read_b64_tr_b16 v[96:97], v6 offset:0
 ds_read_b64_tr_b16 v[98:99], v6 offset:2048
 v_mfma_f32_16x16x32_bf16 v[160:163], v[108:111], v[80:83], v[160:163]
 v_mfma_f32_16x16x32_bf16 v[164:167], v[104:107], v[68:71], v[164:167]
 v_mfma_f32_16x16x32_bf16 v[164:167], v[108:111], v[84:87], v[164:167]
 v_mfma_f32_16x16x32_bf16 v[168:171], v[104:107], v[72:75], v[168:171]
 ds_read_b64_tr_b16 v[100:101], v6 offset:4096
 ds_read_b64_tr_b16 v[102:103], v6 offset:6144
 v_mfma_f32_16x16x32_bf16 v[168:171], v[108:111], v[88:91], v[168:171]
 v_mfma_f32_16x16x32_bf16 v[172:175], v[104:107], v[76:79], v[172:175]
 v_mfma_f32_16x16x32_bf16 v[172:175], v[108:111], v[92:95], v[172:175]
 s_add_u32 m0, s96, 32768
 s_add_u32 s84, s95, 128
 s_waitcnt lgkmcnt(8)
 v_mfma_f32_16x16x32_bf16 v[176:179], v[112:115], v[64:67], v[176:179]
 ds_read_b64_tr_b16 v[104:105], v7 offset:0
 ds_read_b64_tr_b16 v[106:107], v7 offset:2048
 v_mfma_f32_16x16x32_bf16 v[176:179], v[116:119], v[80:83], v[176:179]
 buffer_load_dwordx4 v28, s[44:47], s84 offen offset:0 lds
 v_mfma_f32_16x16x32_bf16 v[180:183], v[112:115], v[68:71], v[180:183]
 buffer_load_dwordx4 v29, s[44:47], s84 offen offset:1024 lds
 v_mfma_f32_16x16x32_bf16 v[180:183], v[116:119], v[84:87], v[180:183]
 v_mfma_f32_16x16x32_bf16 v[184:187], v[112:115], v[72:75], v[184:187]
 ds_read_b64_tr_b16 v[108:109], v7 offset:4096
 ds_read_b64_tr_b16 v[110:111], v7 offset:6144
 v_mfma_f32_16x16x32_bf16 v[184:187], v[116:119], v[88:91], v[184:187]
 buffer_load_dwordx4 v30, s[44:47], s84 offen offset:2048 lds
 v_mfma_f32_16x16x32_bf16 v[188:191], v[112:115], v[76:79], v[188:191]
 buffer_load_dwordx4 v31, s[44:47], s84 offen offset:3072 lds
 v_mfma_f32_16x16x32_bf16 v[188:191], v[116:119], v[92:95], v[188:191]
 s_add_u32 m0, s96, 36864
 s_add_u32 s84, s95, 32896
 s_waitcnt lgkmcnt(4)
 v_mfma_f32_16x16x32_bf16 v[128:131], v[96:99], v[32:35], v[128:131]
 ds_read_b64_tr_b16 v[112:113], v8 offset:0
 ds_read_b64_tr_b16 v[114:115], v8 offset:2048
 v_mfma_f32_16x16x32_bf16 v[128:131], v[100:103], v[48:51], v[128:131]
 buffer_load_dwordx4 v28, s[44:47], s84 offen offset:0 lds
 v_mfma_f32_16x16x32_bf16 v[132:135], v[96:99], v[36:39], v[132:135]
 buffer_load_dwordx4 v29, s[44:47], s84 offen offset:1024 lds
 v_mfma_f32_16x16x32_bf16 v[132:135], v[100:103], v[52:55], v[132:135]
 v_mfma_f32_16x16x32_bf16 v[136:139], v[96:99], v[40:43], v[136:139]
 ds_read_b64_tr_b16 v[116:117], v8 offset:4096
 ds_read_b64_tr_b16 v[118:119], v8 offset:6144
 v_mfma_f32_16x16x32_bf16 v[136:139], v[100:103], v[56:59], v[136:139]
 buffer_load_dwordx4 v30, s[44:47], s84 offen offset:2048 lds
 v_mfma_f32_16x16x32_bf16 v[140:143], v[96:99], v[44:47], v[140:143]
 buffer_load_dwordx4 v31, s[44:47], s84 offen offset:3072 lds
 v_mfma_f32_16x16x32_bf16 v[140:143], v[100:103], v[60:63], v[140:143]
 s_waitcnt lgkmcnt(4)
 v_mfma_f32_16x16x32_bf16 v[144:147], v[104:107], v[32:35], v[144:147]
 ds_read_b64_tr_b16 v[96:97], v9 offset:0
 ds_read_b64_tr_b16 v[98:99], v9 offset:2048
 v_mfma_f32_16x16x32_bf16 v[144:147], v[108:111], v[48:51], v[144:147]
 ds_read_b128 v[64:67], v20 offset:14336
 ds_read_b128 v[68:71], v20 offset:30720
 v_mfma_f32_16x16x32_bf16 v[148:151], v[104:107], v[36:39], v[148:151]
 ds_read_b128 v[72:75], v20 offset:47104
 ds_read_b128 v[76:79], v20 offset:63488
 v_mfma_f32_16x16x32_bf16 v[148:151], v[108:111], v[52:55], v[148:151]
 v_mfma_f32_16x16x32_bf16 v[152:155], v[104:107], v[40:43], v[152:155]
 ds_read_b64_tr_b16 v[100:101], v9 offset:4096
 ds_read_b64_tr_b16 v[102:103], v9 offset:6144
 v_mfma_f32_16x16x32_bf16 v[152:155], v[108:111], v[56:59], v[152:155]
 ds_read_b128 v[80:83], v20 offset:15360
 ds_read_b128 v[84:87], v20 offset:31744
 v_mfma_f32_16x16x32_bf16 v[156:159], v[104:107], v[44:47], v[156:159]
 ds_read_b128 v[88:91], v20 offset:48128
 ds_read_b128 v[92:95], v20 offset:64512
 v_mfma_f32_16x16x32_bf16 v[156:159], v[108:111], v[60:63], v[156:159]
 s_waitcnt vmcnt(8) lgkmcnt(12)
 v_mfma_f32_16x16x32_bf16 v[160:163], v[112:115], v[32:35], v[160:163]
 ds_read_b64_tr_b16 v[104:105], v2 offset:0
 ds_read_b64_tr_b16 v[106:107], v2 offset:2048
 v_mfma_f32_16x16x32_bf16 v[160:163], v[116:119], v[48:51], v[160:163]
 v_mfma_f32_16x16x32_bf16 v[164:167], v[112:115], v[36:39], v[164:167]
 v_mfma_f32_16x16x32_bf16 v[164:167], v[116:119], v[52:55], v[164:167]
 v_mfma_f32_16x16x32_bf16 v[168:171], v[112:115], v[40:43], v[168:171]
 ds_read_b64_tr_b16 v[108:109], v2 offset:4096
 ds_read_b64_tr_b16 v[110:111], v2 offset:6144
 v_mfma_f32_16x16x32_bf16 v[168:171], v[116:119], v[56:59], v[168:171]
 v_mfma_f32_16x16x32_bf16 v[172:175], v[112:115], v[44:47], v[172:175]
 v_mfma_f32_16x16x32_bf16 v[172:175], v[116:119], v[60:63], v[172:175]
 s_add_u32 m0, s96, 65536
 s_add_u32 s84, s95, 65664
 s_waitcnt lgkmcnt(8)
 v_mfma_f32_16x16x32_bf16 v[176:179], v[96:99], v[32:35], v[176:179]
 ds_read_b64_tr_b16 v[112:113], v3 offset:0
 ds_read_b64_tr_b16 v[114:115], v3 offset:2048
 v_mfma_f32_16x16x32_bf16 v[176:179], v[100:103], v[48:51], v[176:179]
 buffer_load_dwordx4 v28, s[44:47], s84 offen offset:0 lds
 v_mfma_f32_16x16x32_bf16 v[180:183], v[96:99], v[36:39], v[180:183]
 buffer_load_dwordx4 v29, s[44:47], s84 offen offset:1024 lds
 v_mfma_f32_16x16x32_bf16 v[180:183], v[100:103], v[52:55], v[180:183]
 v_mfma_f32_16x16x32_bf16 v[184:187], v[96:99], v[40:43], v[184:187]
 ds_read_b64_tr_b16 v[116:117], v3 offset:4096
 ds_read_b64_tr_b16 v[118:119], v3 offset:6144
 v_mfma_f32_16x16x32_bf16 v[184:187], v[100:103], v[56:59], v[184:187]
 buffer_load_dwordx4 v30, s[44:47], s84 offen offset:2048 lds
 v_mfma_f32_16x16x32_bf16 v[188:191], v[96:99], v[44:47], v[188:191]
 buffer_load_dwordx4 v31, s[44:47], s84 offen offset:3072 lds
 v_mfma_f32_16x16x32_bf16 v[188:191], v[100:103], v[60:63], v[188:191]
 s_add_u32 m0, s96, 69632
 s_add_u32 s84, s95, 98432
 s_waitcnt lgkmcnt(4)
 v_mfma_f32_16x16x32_bf16 v[128:131], v[104:107], v[64:67], v[128:131]
 ds_read_b64_tr_b16 v[96:97], v4 offset:0
 ds_read_b64_tr_b16 v[98:99], v4 offset:2048
 v_mfma_f32_16x16x32_bf16 v[128:131], v[108:111], v[80:83], v[128:131]
 buffer_load_dwordx4 v28, s[44:47], s84 offen offset:0 lds
 v_mfma_f32_16x16x32_bf16 v[132:135], v[104:107], v[68:71], v[132:135]
 buffer_load_dwordx4 v29, s[44:47], s84 offen offset:1024 lds
 v_mfma_f32_16x16x32_bf16 v[132:135], v[108:111], v[84:87], v[132:135]
 v_mfma_f32_16x16x32_bf16 v[136:139], v[104:107], v[72:75], v[136:139]
 ds_read_b64_tr_b16 v[100:101], v4 offset:4096
 ds_read_b64_tr_b16 v[102:103], v4 offset:6144
 v_mfma_f32_16x16x32_bf16 v[136:139], v[108:111], v[88:91], v[136:139]
 buffer_load_dwordx4 v30, s[44:47], s84 offen offset:2048 lds
 v_mfma_f32_16x16x32_bf16 v[140:143], v[104:107], v[76:79], v[140:143]
 buffer_load_dwordx4 v31, s[44:47], s84 offen offset:3072 lds
 v_mfma_f32_16x16x32_bf16 v[140:143], v[108:111], v[92:95], v[140:143]
 s_waitcnt lgkmcnt(4)
 v_mfma_f32_16x16x32_bf16 v[144:147], v[112:115], v[64:67], v[144:147]
 ds_read_b64_tr_b16 v[104:105], v5 offset:0
 ds_read_b64_tr_b16 v[106:107], v5 offset:2048
 v_mfma_f32_16x16x32_bf16 v[144:147], v[116:119], v[80:83], v[144:147]
 ds_read_b128 v[32:35], v20 offset:0
 ds_read_b128 v[36:39], v20 offset:16384
 v_mfma_f32_16x16x32_bf16 v[148:151], v[112:115], v[68:71], v[148:151]
 ds_read_b128 v[40:43], v20 offset:32768
 ds_read_b128 v[44:47], v20 offset:49152
 v_mfma_f32_16x16x32_bf16 v[148:151], v[116:119], v[84:87], v[148:151]
 v_mfma_f32_16x16x32_bf16 v[152:155], v[112:115], v[72:75], v[152:155]
 ds_read_b64_tr_b16 v[108:109], v5 offset:4096
 ds_read_b64_tr_b16 v[110:111], v5 offset:6144
 v_mfma_f32_16x16x32_bf16 v[152:155], v[116:119], v[88:91], v[152:155]
 ds_read_b128 v[48:51], v20 offset:1024
 ds_read_b128 v[52:55], v20 offset:17408
 v_mfma_f32_16x16x32_bf16 v[156:159], v[112:115], v[76:79], v[156:159]
 ds_read_b128 v[56:59], v20 offset:33792
 ds_read_b128 v[60:63], v20 offset:50176
 v_mfma_f32_16x16x32_bf16 v[156:159], v[116:119], v[92:95], v[156:159]
 s_waitcnt vmcnt(8) lgkmcnt(12)
 v_mfma_f32_16x16x32_bf16 v[160:163], v[96:99], v[64:67], v[160:163]
 ds_read_b64_tr_b16 v[112:113], v2 offset:32768
 ds_read_b64_tr_b16 v[114:115], v2 offset:34816
 v_mfma_f32_16x16x32_bf16 v[160:163], v[100:103], v[80:83], v[160:163]
 v_mfma_f32_16x16x32_bf16 v[164:167], v[96:99], v[68:71], v[164:167]
 v_mfma_f32_16x16x32_bf16 v[164:167], v[100:103], v[84:87], v[164:167]
 v_mfma_f32_16x16x32_bf16 v[168:171], v[96:99], v[72:75], v[168:171]
 ds_read_b64_tr_b16 v[116:117], v2 offset:36864
 ds_read_b64_tr_b16 v[118:119], v2 offset:38912
 v_mfma_f32_16x16x32_bf16 v[168:171], v[100:103], v[88:91], v[168:171]
 v_mfma_f32_16x16x32_bf16 v[172:175], v[96:99], v[76:79], v[172:175]
 v_mfma_f32_16x16x32_bf16 v[172:175], v[100:103], v[92:95], v[172:175]
 s_add_u32 m0, s96, 0
 s_add_u32 s84, s95, 131200
 s_waitcnt lgkmcnt(8)
 v_mfma_f32_16x16x32_bf16 v[176:179], v[104:107], v[64:67], v[176:179]
 ds_read_b64_tr_b16 v[96:97], v3 offset:32768
 ds_read_b64_tr_b16 v[98:99], v3 offset:34816
 v_mfma_f32_16x16x32_bf16 v[176:179], v[108:111], v[80:83], v[176:179]
 buffer_load_dwordx4 v28, s[44:47], s84 offen offset:0 lds
 v_mfma_f32_16x16x32_bf16 v[180:183], v[104:107], v[68:71], v[180:183]
 buffer_load_dwordx4 v29, s[44:47], s84 offen offset:1024 lds
 v_mfma_f32_16x16x32_bf16 v[180:183], v[108:111], v[84:87], v[180:183]
 v_mfma_f32_16x16x32_bf16 v[184:187], v[104:107], v[72:75], v[184:187]
 ds_read_b64_tr_b16 v[100:101], v3 offset:36864
 ds_read_b64_tr_b16 v[102:103], v3 offset:38912
 v_mfma_f32_16x16x32_bf16 v[184:187], v[108:111], v[88:91], v[184:187]
 buffer_load_dwordx4 v30, s[44:47], s84 offen offset:2048 lds
 v_mfma_f32_16x16x32_bf16 v[188:191], v[104:107], v[76:79], v[188:191]
 buffer_load_dwordx4 v31, s[44:47], s84 offen offset:3072 lds
 v_mfma_f32_16x16x32_bf16 v[188:191], v[108:111], v[92:95], v[188:191]
 s_add_u32 m0, s96, 4096
 s_add_u32 s84, s95, 163968
 s_waitcnt lgkmcnt(4)
 v_mfma_f32_16x16x32_bf16 v[192:195], v[112:115], v[32:35], 0
 ds_read_b64_tr_b16 v[104:105], v4 offset:32768
 ds_read_b64_tr_b16 v[106:107], v4 offset:34816
 v_mfma_f32_16x16x32_bf16 v[192:195], v[116:119], v[48:51], v[192:195]
 buffer_load_dwordx4 v28, s[44:47], s84 offen offset:0 lds
 v_mfma_f32_16x16x32_bf16 v[196:199], v[112:115], v[36:39], 0
 buffer_load_dwordx4 v29, s[44:47], s84 offen offset:1024 lds
 v_mfma_f32_16x16x32_bf16 v[196:199], v[116:119], v[52:55], v[196:199]
 v_mfma_f32_16x16x32_bf16 v[200:203], v[112:115], v[40:43], 0
 ds_read_b64_tr_b16 v[108:109], v4 offset:36864
 ds_read_b64_tr_b16 v[110:111], v4 offset:38912
 v_mfma_f32_16x16x32_bf16 v[200:203], v[116:119], v[56:59], v[200:203]
 buffer_load_dwordx4 v30, s[44:47], s84 offen offset:2048 lds
 v_mfma_f32_16x16x32_bf16 v[204:207], v[112:115], v[44:47], 0
 buffer_load_dwordx4 v31, s[44:47], s84 offen offset:3072 lds
 v_mfma_f32_16x16x32_bf16 v[204:207], v[116:119], v[60:63], v[204:207]
 s_waitcnt lgkmcnt(4)
 v_mfma_f32_16x16x32_bf16 v[208:211], v[96:99], v[32:35], 0
 ds_read_b64_tr_b16 v[112:113], v5 offset:32768
 ds_read_b64_tr_b16 v[114:115], v5 offset:34816
 v_mfma_f32_16x16x32_bf16 v[208:211], v[100:103], v[48:51], v[208:211]
 ds_read_b128 v[64:67], v20 offset:2048
 ds_read_b128 v[68:71], v20 offset:18432
 v_mfma_f32_16x16x32_bf16 v[212:215], v[96:99], v[36:39], 0
 ds_read_b128 v[72:75], v20 offset:34816
 ds_read_b128 v[76:79], v20 offset:51200
 v_mfma_f32_16x16x32_bf16 v[212:215], v[100:103], v[52:55], v[212:215]
 v_mfma_f32_16x16x32_bf16 v[216:219], v[96:99], v[40:43], 0
 ds_read_b64_tr_b16 v[116:117], v5 offset:36864
 ds_read_b64_tr_b16 v[118:119], v5 offset:38912
 v_mfma_f32_16x16x32_bf16 v[216:219], v[100:103], v[56:59], v[216:219]
 ds_read_b128 v[80:83], v20 offset:3072
 ds_read_b128 v[84:87], v20 offset:19456
 v_mfma_f32_16x16x32_bf16 v[220:223], v[96:99], v[44:47], 0
 ds_read_b128 v[88:91], v20 offset:35840
 ds_read_b128 v[92:95], v20 offset:52224
 v_mfma_f32_16x16x32_bf16 v[220:223], v[100:103], v[60:63], v[220:223]
 s_waitcnt vmcnt(8) lgkmcnt(12)
 v_mfma_f32_16x16x32_bf16 v[224:227], v[104:107], v[32:35], 0
 ds_read_b64_tr_b16 v[96:97], v6 offset:0
 ds_read_b64_tr_b16 v[98:99], v6 offset:2048
 v_mfma_f32_16x16x32_bf16 v[224:227], v[108:111], v[48:51], v[224:227]
 v_cvt_pk_bf16_f32 v120, v128, v129
 v_cvt_pk_bf16_f32 v121, v130, v131
 v_mfma_f32_16x16x32_bf16 v[228:231], v[104:107], v[36:39], 0
 v_cvt_pk_bf16_f32 v122, v144, v145
 v_cvt_pk_bf16_f32 v123, v146, v147
 v_mfma_f32_16x16x32_bf16 v[228:231], v[108:111], v[52:55], v[228:231]
 s_lshl_b32 s93, s78, 19
 s_lshl_b32 s88, s76, 17
 s_lshl_b32 s89, s77, 13
 s_add_u32 s93, s93, s88
 s_add_u32 s93, s93, s89
 s_add_u32 s93, s93, 8388608
 buffer_store_dwordx4 v[120:123], v20, s[64:67], s93 offen offset:0 sc1
 v_mfma_f32_16x16x32_bf16 v[232:235], v[104:107], v[40:43], 0
 ds_read_b64_tr_b16 v[100:101], v6 offset:4096
 ds_read_b64_tr_b16 v[102:103], v6 offset:6144
 v_mfma_f32_16x16x32_bf16 v[232:235], v[108:111], v[56:59], v[232:235]
 v_cvt_pk_bf16_f32 v124, v160, v161
 v_cvt_pk_bf16_f32 v125, v162, v163
 v_mfma_f32_16x16x32_bf16 v[236:239], v[104:107], v[44:47], 0
 v_cvt_pk_bf16_f32 v126, v176, v177
 v_cvt_pk_bf16_f32 v127, v178, v179
 v_mfma_f32_16x16x32_bf16 v[236:239], v[108:111], v[60:63], v[236:239]
 s_add_u32 m0, s96, 32768
 buffer_store_dwordx4 v[124:127], v20, s[64:67], s93 offen offset:1024 sc1
 s_add_u32 s84, s95, 196736
 s_waitcnt lgkmcnt(8)
 v_mfma_f32_16x16x32_bf16 v[240:243], v[112:115], v[32:35], 0
 ds_read_b64_tr_b16 v[104:105], v7 offset:0
 ds_read_b64_tr_b16 v[106:107], v7 offset:2048
 v_mfma_f32_16x16x32_bf16 v[240:243], v[116:119], v[48:51], v[240:243]
 buffer_load_dwordx4 v28, s[44:47], s84 offen offset:0 lds
 v_mfma_f32_16x16x32_bf16 v[244:247], v[112:115], v[36:39], 0
 buffer_load_dwordx4 v29, s[44:47], s84 offen offset:1024 lds
 v_mfma_f32_16x16x32_bf16 v[244:247], v[116:119], v[52:55], v[244:247]
 v_mfma_f32_16x16x32_bf16 v[248:251], v[112:115], v[40:43], 0
 ds_read_b64_tr_b16 v[108:109], v7 offset:4096
 ds_read_b64_tr_b16 v[110:111], v7 offset:6144
 v_mfma_f32_16x16x32_bf16 v[248:251], v[116:119], v[56:59], v[248:251]
 buffer_load_dwordx4 v30, s[44:47], s84 offen offset:2048 lds
 v_mfma_f32_16x16x32_bf16 v[252:255], v[112:115], v[44:47], 0
 buffer_load_dwordx4 v31, s[44:47], s84 offen offset:3072 lds
 v_mfma_f32_16x16x32_bf16 v[252:255], v[116:119], v[60:63], v[252:255]
 s_add_u32 m0, s96, 36864
 s_add_u32 s84, s95, 229504
 s_waitcnt lgkmcnt(4)
 v_mfma_f32_16x16x32_bf16 v[192:195], v[96:99], v[64:67], v[192:195]
 ds_read_b64_tr_b16 v[112:113], v8 offset:0
 ds_read_b64_tr_b16 v[114:115], v8 offset:2048
 v_mfma_f32_16x16x32_bf16 v[192:195], v[100:103], v[80:83], v[192:195]
 buffer_load_dwordx4 v28, s[44:47], s84 offen offset:0 lds
 v_mfma_f32_16x16x32_bf16 v[196:199], v[96:99], v[68:71], v[196:199]
 buffer_load_dwordx4 v29, s[44:47], s84 offen offset:1024 lds
 v_mfma_f32_16x16x32_bf16 v[196:199], v[100:103], v[84:87], v[196:199]
 v_mfma_f32_16x16x32_bf16 v[200:203], v[96:99], v[72:75], v[200:203]
 ds_read_b64_tr_b16 v[116:117], v8 offset:4096
 ds_read_b64_tr_b16 v[118:119], v8 offset:6144
 v_mfma_f32_16x16x32_bf16 v[200:203], v[100:103], v[88:91], v[200:203]
 buffer_load_dwordx4 v30, s[44:47], s84 offen offset:2048 lds
 v_mfma_f32_16x16x32_bf16 v[204:207], v[96:99], v[76:79], v[204:207]
 buffer_load_dwordx4 v31, s[44:47], s84 offen offset:3072 lds
 v_mfma_f32_16x16x32_bf16 v[204:207], v[100:103], v[92:95], v[204:207]
 s_waitcnt lgkmcnt(4)
 v_mfma_f32_16x16x32_bf16 v[208:211], v[104:107], v[64:67], v[208:211]
 ds_read_b64_tr_b16 v[96:97], v9 offset:0
 ds_read_b64_tr_b16 v[98:99], v9 offset:2048
 v_mfma_f32_16x16x32_bf16 v[208:211], v[108:111], v[80:83], v[208:211]
 ds_read_b128 v[32:35], v20 offset:4096
 ds_read_b128 v[36:39], v20 offset:20480
 v_mfma_f32_16x16x32_bf16 v[212:215], v[104:107], v[68:71], v[212:215]
 ds_read_b128 v[40:43], v20 offset:36864
 ds_read_b128 v[44:47], v20 offset:53248
 v_mfma_f32_16x16x32_bf16 v[212:215], v[108:111], v[84:87], v[212:215]
 v_mfma_f32_16x16x32_bf16 v[216:219], v[104:107], v[72:75], v[216:219]
 ds_read_b64_tr_b16 v[100:101], v9 offset:4096
 ds_read_b64_tr_b16 v[102:103], v9 offset:6144
 v_mfma_f32_16x16x32_bf16 v[216:219], v[108:111], v[88:91], v[216:219]
 ds_read_b128 v[48:51], v20 offset:5120
 ds_read_b128 v[52:55], v20 offset:21504
 v_mfma_f32_16x16x32_bf16 v[220:223], v[104:107], v[76:79], v[220:223]
 ds_read_b128 v[56:59], v20 offset:37888
 ds_read_b128 v[60:63], v20 offset:54272
 v_mfma_f32_16x16x32_bf16 v[220:223], v[108:111], v[92:95], v[220:223]
 s_waitcnt vmcnt(10) lgkmcnt(12)
 v_mfma_f32_16x16x32_bf16 v[224:227], v[112:115], v[64:67], v[224:227]
 ds_read_b64_tr_b16 v[104:105], v2 offset:0
 ds_read_b64_tr_b16 v[106:107], v2 offset:2048
 v_mfma_f32_16x16x32_bf16 v[224:227], v[116:119], v[80:83], v[224:227]
 v_cvt_pk_bf16_f32 v120, v132, v133
 v_cvt_pk_bf16_f32 v121, v134, v135
 v_mfma_f32_16x16x32_bf16 v[228:231], v[112:115], v[68:71], v[228:231]
 v_cvt_pk_bf16_f32 v122, v148, v149
 v_cvt_pk_bf16_f32 v123, v150, v151
 v_mfma_f32_16x16x32_bf16 v[228:231], v[116:119], v[84:87], v[228:231]
 buffer_store_dwordx4 v[120:123], v20, s[64:67], s93 offen offset:2048 sc1
 v_mfma_f32_16x16x32_bf16 v[232:235], v[112:115], v[72:75], v[232:235]
 ds_read_b64_tr_b16 v[108:109], v2 offset:4096
 ds_read_b64_tr_b16 v[110:111], v2 offset:6144
 v_mfma_f32_16x16x32_bf16 v[232:235], v[116:119], v[88:91], v[232:235]
 v_cvt_pk_bf16_f32 v124, v164, v165
 v_cvt_pk_bf16_f32 v125, v166, v167
 v_mfma_f32_16x16x32_bf16 v[236:239], v[112:115], v[76:79], v[236:239]
 v_cvt_pk_bf16_f32 v126, v180, v181
 v_cvt_pk_bf16_f32 v127, v182, v183
 v_mfma_f32_16x16x32_bf16 v[236:239], v[116:119], v[92:95], v[236:239]
 s_add_u32 m0, s96, 65536
 buffer_store_dwordx4 v[124:127], v20, s[64:67], s93 offen offset:3072 sc1
 s_add_u32 s84, s95, 262272
 s_waitcnt lgkmcnt(8)
 v_mfma_f32_16x16x32_bf16 v[240:243], v[96:99], v[64:67], v[240:243]
 ds_read_b64_tr_b16 v[112:113], v3 offset:0
 ds_read_b64_tr_b16 v[114:115], v3 offset:2048
 v_mfma_f32_16x16x32_bf16 v[240:243], v[100:103], v[80:83], v[240:243]
 buffer_load_dwordx4 v28, s[44:47], s84 offen offset:0 lds
 v_mfma_f32_16x16x32_bf16 v[244:247], v[96:99], v[68:71], v[244:247]
 buffer_load_dwordx4 v29, s[44:47], s84 offen offset:1024 lds
 v_mfma_f32_16x16x32_bf16 v[244:247], v[100:103], v[84:87], v[244:247]
 v_mfma_f32_16x16x32_bf16 v[248:251], v[96:99], v[72:75], v[248:251]
 ds_read_b64_tr_b16 v[116:117], v3 offset:4096
 ds_read_b64_tr_b16 v[118:119], v3 offset:6144
 v_mfma_f32_16x16x32_bf16 v[248:251], v[100:103], v[88:91], v[248:251]
 buffer_load_dwordx4 v30, s[44:47], s84 offen offset:2048 lds
 v_mfma_f32_16x16x32_bf16 v[252:255], v[96:99], v[76:79], v[252:255]
 buffer_load_dwordx4 v31, s[44:47], s84 offen offset:3072 lds
 v_mfma_f32_16x16x32_bf16 v[252:255], v[100:103], v[92:95], v[252:255]
 s_add_u32 m0, s96, 69632
 s_add_u32 s84, s95, 295040
 s_waitcnt lgkmcnt(4)
 v_mfma_f32_16x16x32_bf16 v[192:195], v[104:107], v[32:35], v[192:195]
 ds_read_b64_tr_b16 v[96:97], v4 offset:0
 ds_read_b64_tr_b16 v[98:99], v4 offset:2048
 v_mfma_f32_16x16x32_bf16 v[192:195], v[108:111], v[48:51], v[192:195]
 buffer_load_dwordx4 v28, s[44:47], s84 offen offset:0 lds
 v_mfma_f32_16x16x32_bf16 v[196:199], v[104:107], v[36:39], v[196:199]
L_pg15:
 s_cbranch_execz L_site2
 buffer_load_dwordx4 v29, s[44:47], s84 offen offset:1024 lds
 v_mfma_f32_16x16x32_bf16 v[196:199], v[108:111], v[52:55], v[196:199]
 v_mfma_f32_16x16x32_bf16 v[200:203], v[104:107], v[40:43], v[200:203]
 ds_read_b64_tr_b16 v[100:101], v4 offset:4096
 ds_read_b64_tr_b16 v[102:103], v4 offset:6144
 v_mfma_f32_16x16x32_bf16 v[200:203], v[108:111], v[56:59], v[200:203]
 buffer_load_dwordx4 v30, s[44:47], s84 offen offset:2048 lds
 v_mfma_f32_16x16x32_bf16 v[204:207], v[104:107], v[44:47], v[204:207]
 buffer_load_dwordx4 v31, s[44:47], s84 offen offset:3072 lds
 v_mfma_f32_16x16x32_bf16 v[204:207], v[108:111], v[60:63], v[204:207]
 s_waitcnt lgkmcnt(4)
 v_mfma_f32_16x16x32_bf16 v[208:211], v[112:115], v[32:35], v[208:211]
 ds_read_b64_tr_b16 v[104:105], v5 offset:0
 ds_read_b64_tr_b16 v[106:107], v5 offset:2048
 v_mfma_f32_16x16x32_bf16 v[208:211], v[116:119], v[48:51], v[208:211]
 ds_read_b128 v[64:67], v20 offset:6144
 ds_read_b128 v[68:71], v20 offset:22528
 v_mfma_f32_16x16x32_bf16 v[212:215], v[112:115], v[36:39], v[212:215]
 ds_read_b128 v[72:75], v20 offset:38912
 ds_read_b128 v[76:79], v20 offset:55296
 v_mfma_f32_16x16x32_bf16 v[212:215], v[116:119], v[52:55], v[212:215]
 v_mfma_f32_16x16x32_bf16 v[216:219], v[112:115], v[40:43], v[216:219]
 ds_read_b64_tr_b16 v[108:109], v5 offset:4096
 ds_read_b64_tr_b16 v[110:111], v5 offset:6144
 v_mfma_f32_16x16x32_bf16 v[216:219], v[116:119], v[56:59], v[216:219]
 ds_read_b128 v[80:83], v20 offset:7168
 ds_read_b128 v[84:87], v20 offset:23552
 v_mfma_f32_16x16x32_bf16 v[220:223], v[112:115], v[44:47], v[220:223]
 ds_read_b128 v[88:91], v20 offset:39936
 ds_read_b128 v[92:95], v20 offset:56320
 v_mfma_f32_16x16x32_bf16 v[220:223], v[116:119], v[60:63], v[220:223]
 s_waitcnt vmcnt(10) lgkmcnt(12)
 v_mfma_f32_16x16x32_bf16 v[224:227], v[96:99], v[32:35], v[224:227]
 ds_read_b64_tr_b16 v[112:113], v2 offset:32768
 ds_read_b64_tr_b16 v[114:115], v2 offset:34816
 v_mfma_f32_16x16x32_bf16 v[224:227], v[100:103], v[48:51], v[224:227]
 v_cvt_pk_bf16_f32 v120, v136, v137
 v_cvt_pk_bf16_f32 v121, v138, v139
 v_mfma_f32_16x16x32_bf16 v[228:231], v[96:99], v[36:39], v[228:231]
 v_cvt_pk_bf16_f32 v122, v152, v153
 v_cvt_pk_bf16_f32 v123, v154, v155
 v_mfma_f32_16x16x32_bf16 v[228:231], v[100:103], v[52:55], v[228:231]
 s_add_u32 s93, s93, 4096
 buffer_store_dwordx4 v[120:123], v20, s[64:67], s93 offen offset:0 sc1
 v_mfma_f32_16x16x32_bf16 v[232:235], v[96:99], v[40:43], v[232:235]
 ds_read_b64_tr_b16 v[116:117], v2 offset:36864
 ds_read_b64_tr_b16 v[118:119], v2 offset:38912
 v_mfma_f32_16x16x32_bf16 v[232:235], v[100:103], v[56:59], v[232:235]
 v_cvt_pk_bf16_f32 v124, v168, v169
 v_cvt_pk_bf16_f32 v125, v170, v171
 v_mfma_f32_16x16x32_bf16 v[236:239], v[96:99], v[44:47], v[236:239]
 v_cvt_pk_bf16_f32 v126, v184, v185
 v_cvt_pk_bf16_f32 v127, v186, v187
 v_mfma_f32_16x16x32_bf16 v[236:239], v[100:103], v[60:63], v[236:239]
 s_add_u32 m0, s96, 0
 buffer_store_dwordx4 v[124:127], v20, s[64:67], s93 offen offset:1024 sc1
 s_add_u32 s84, s95, 327808
 s_waitcnt lgkmcnt(8)
 v_mfma_f32_16x16x32_bf16 v[240:243], v[104:107], v[32:35], v[240:243]
 ds_read_b64_tr_b16 v[96:97], v3 offset:32768
 ds_read_b64_tr_b16 v[98:99], v3 offset:34816
 v_mfma_f32_16x16x32_bf16 v[240:243], v[108:111], v[48:51], v[240:243]
 buffer_load_dwordx4 v28, s[44:47], s84 offen offset:0 lds
 v_mfma_f32_16x16x32_bf16 v[244:247], v[104:107], v[36:39], v[244:247]
 buffer_load_dwordx4 v29, s[44:47], s84 offen offset:1024 lds
 v_mfma_f32_16x16x32_bf16 v[244:247], v[108:111], v[52:55], v[244:247]
 v_mfma_f32_16x16x32_bf16 v[248:251], v[104:107], v[40:43], v[248:251]
 ds_read_b64_tr_b16 v[100:101], v3 offset:36864
 ds_read_b64_tr_b16 v[102:103], v3 offset:38912
 v_mfma_f32_16x16x32_bf16 v[248:251], v[108:111], v[56:59], v[248:251]
 buffer_load_dwordx4 v30, s[44:47], s84 offen offset:2048 lds
 v_mfma_f32_16x16x32_bf16 v[252:255], v[104:107], v[44:47], v[252:255]
 buffer_load_dwordx4 v31, s[44:47], s84 offen offset:3072 lds
 v_mfma_f32_16x16x32_bf16 v[252:255], v[108:111], v[60:63], v[252:255]
 s_add_u32 m0, s96, 4096
 s_add_u32 s84, s95, 360576
 s_waitcnt lgkmcnt(4)
 v_mfma_f32_16x16x32_bf16 v[192:195], v[112:115], v[64:67], v[192:195]
 ds_read_b64_tr_b16 v[104:105], v4 offset:32768
 ds_read_b64_tr_b16 v[106:107], v4 offset:34816
 v_mfma_f32_16x16x32_bf16 v[192:195], v[116:119], v[80:83], v[192:195]
 buffer_load_dwordx4 v28, s[44:47], s84 offen offset:0 lds
 v_mfma_f32_16x16x32_bf16 v[196:199], v[112:115], v[68:71], v[196:199]
 buffer_load_dwordx4 v29, s[44:47], s84 offen offset:1024 lds
 v_mfma_f32_16x16x32_bf16 v[196:199], v[116:119], v[84:87], v[196:199]
 v_mfma_f32_16x16x32_bf16 v[200:203], v[112:115], v[72:75], v[200:203]
 ds_read_b64_tr_b16 v[108:109], v4 offset:36864
 ds_read_b64_tr_b16 v[110:111], v4 offset:38912
 v_mfma_f32_16x16x32_bf16 v[200:203], v[116:119], v[88:91], v[200:203]
 buffer_load_dwordx4 v30, s[44:47], s84 offen offset:2048 lds
 v_mfma_f32_16x16x32_bf16 v[204:207], v[112:115], v[76:79], v[204:207]
 buffer_load_dwordx4 v31, s[44:47], s84 offen offset:3072 lds
 v_mfma_f32_16x16x32_bf16 v[204:207], v[116:119], v[92:95], v[204:207]
 s_waitcnt lgkmcnt(4)
 v_mfma_f32_16x16x32_bf16 v[208:211], v[96:99], v[64:67], v[208:211]
 ds_read_b64_tr_b16 v[112:113], v5 offset:32768
 ds_read_b64_tr_b16 v[114:115], v5 offset:34816
 v_mfma_f32_16x16x32_bf16 v[208:211], v[100:103], v[80:83], v[208:211]
 ds_read_b128 v[32:35], v20 offset:8192
 ds_read_b128 v[36:39], v20 offset:24576
 v_mfma_f32_16x16x32_bf16 v[212:215], v[96:99], v[68:71], v[212:215]
 ds_read_b128 v[40:43], v20 offset:40960
 ds_read_b128 v[44:47], v20 offset:57344
 v_mfma_f32_16x16x32_bf16 v[212:215], v[100:103], v[84:87], v[212:215]
 v_mfma_f32_16x16x32_bf16 v[216:219], v[96:99], v[72:75], v[216:219]
 ds_read_b64_tr_b16 v[116:117], v5 offset:36864
 ds_read_b64_tr_b16 v[118:119], v5 offset:38912
 v_mfma_f32_16x16x32_bf16 v[216:219], v[100:103], v[88:91], v[216:219]
 ds_read_b128 v[48:51], v20 offset:9216
 ds_read_b128 v[52:55], v20 offset:25600
 v_mfma_f32_16x16x32_bf16 v[220:223], v[96:99], v[76:79], v[220:223]
 ds_read_b128 v[56:59], v20 offset:41984
 ds_read_b128 v[60:63], v20 offset:58368
 v_mfma_f32_16x16x32_bf16 v[220:223], v[100:103], v[92:95], v[220:223]
 s_waitcnt vmcnt(10) lgkmcnt(12)
 v_mfma_f32_16x16x32_bf16 v[224:227], v[104:107], v[64:67], v[224:227]
 ds_read_b64_tr_b16 v[96:97], v6 offset:0
 ds_read_b64_tr_b16 v[98:99], v6 offset:2048
 v_mfma_f32_16x16x32_bf16 v[224:227], v[108:111], v[80:83], v[224:227]
 v_cvt_pk_bf16_f32 v120, v140, v141
 v_cvt_pk_bf16_f32 v121, v142, v143
 v_mfma_f32_16x16x32_bf16 v[228:231], v[104:107], v[68:71], v[228:231]
 v_cvt_pk_bf16_f32 v122, v156, v157
 v_cvt_pk_bf16_f32 v123, v158, v159
 v_mfma_f32_16x16x32_bf16 v[228:231], v[108:111], v[84:87], v[228:231]
 buffer_store_dwordx4 v[120:123], v20, s[64:67], s93 offen offset:2048 sc1
 v_mfma_f32_16x16x32_bf16 v[232:235], v[104:107], v[72:75], v[232:235]
 ds_read_b64_tr_b16 v[100:101], v6 offset:4096
 ds_read_b64_tr_b16 v[102:103], v6 offset:6144
 v_mfma_f32_16x16x32_bf16 v[232:235], v[108:111], v[88:91], v[232:235]
 v_cvt_pk_bf16_f32 v124, v172, v173
 v_cvt_pk_bf16_f32 v125, v174, v175
 v_mfma_f32_16x16x32_bf16 v[236:239], v[104:107], v[76:79], v[236:239]
 v_cvt_pk_bf16_f32 v126, v188, v189
 v_cvt_pk_bf16_f32 v127, v190, v191
 v_mfma_f32_16x16x32_bf16 v[236:239], v[108:111], v[92:95], v[236:239]
 s_add_u32 m0, s96, 32768
 buffer_store_dwordx4 v[124:127], v20, s[64:67], s93 offen offset:3072 sc1
 s_add_u32 s84, s95, 393344
 s_waitcnt lgkmcnt(8)
 v_mfma_f32_16x16x32_bf16 v[240:243], v[112:115], v[64:67], v[240:243]
 ds_read_b64_tr_b16 v[104:105], v7 offset:0
 ds_read_b64_tr_b16 v[106:107], v7 offset:2048
 v_mfma_f32_16x16x32_bf16 v[240:243], v[116:119], v[80:83], v[240:243]
 buffer_load_dwordx4 v28, s[44:47], s84 offen offset:0 lds
 v_mfma_f32_16x16x32_bf16 v[244:247], v[112:115], v[68:71], v[244:247]
 buffer_load_dwordx4 v29, s[44:47], s84 offen offset:1024 lds
 v_mfma_f32_16x16x32_bf16 v[244:247], v[116:119], v[84:87], v[244:247]
 v_mfma_f32_16x16x32_bf16 v[248:251], v[112:115], v[72:75], v[248:251]
 ds_read_b64_tr_b16 v[108:109], v7 offset:4096
 ds_read_b64_tr_b16 v[110:111], v7 offset:6144
 v_mfma_f32_16x16x32_bf16 v[248:251], v[116:119], v[88:91], v[248:251]
 buffer_load_dwordx4 v30, s[44:47], s84 offen offset:2048 lds
 v_mfma_f32_16x16x32_bf16 v[252:255], v[112:115], v[76:79], v[252:255]
 buffer_load_dwordx4 v31, s[44:47], s84 offen offset:3072 lds
 v_mfma_f32_16x16x32_bf16 v[252:255], v[116:119], v[92:95], v[252:255]
 s_add_u32 m0, s96, 36864
 s_add_u32 s84, s95, 426112
 s_waitcnt lgkmcnt(4)
 v_mfma_f32_16x16x32_bf16 v[192:195], v[96:99], v[32:35], v[192:195]
 ds_read_b64_tr_b16 v[112:113], v8 offset:0
 ds_read_b64_tr_b16 v[114:115], v8 offset:2048
 v_mfma_f32_16x16x32_bf16 v[192:195], v[100:103], v[48:51], v[192:195]
 buffer_load_dwordx4 v28, s[44:47], s84 offen offset:0 lds
 v_mfma_f32_16x16x32_bf16 v[196:199], v[96:99], v[36:39], v[196:199]
 buffer_load_dwordx4 v29, s[44:47], s84 offen offset:1024 lds
 v_mfma_f32_16x16x32_bf16 v[196:199], v[100:103], v[52:55], v[196:199]
 v_mfma_f32_16x16x32_bf16 v[200:203], v[96:99], v[40:43], v[200:203]
 ds_read_b64_tr_b16 v[116:117], v8 offset:4096
 ds_read_b64_tr_b16 v[118:119], v8 offset:6144
 v_mfma_f32_16x16x32_bf16 v[200:203], v[100:103], v[56:59], v[200:203]
 buffer_load_dwordx4 v30, s[44:47], s84 offen offset:2048 lds
 v_mfma_f32_16x16x32_bf16 v[204:207], v[96:99], v[44:47], v[204:207]
 buffer_load_dwordx4 v31, s[44:47], s84 offen offset:3072 lds
 v_mfma_f32_16x16x32_bf16 v[204:207], v[100:103], v[60:63], v[204:207]
 s_waitcnt lgkmcnt(4)
 v_mfma_f32_16x16x32_bf16 v[208:211], v[104:107], v[32:35], v[208:211]
 ds_read_b64_tr_b16 v[96:97], v9 offset:0
 ds_read_b64_tr_b16 v[98:99], v9 offset:2048
 v_mfma_f32_16x16x32_bf16 v[208:211], v[108:111], v[48:51], v[208:211]
 ds_read_b128 v[64:67], v20 offset:10240
 ds_read_b128 v[68:71], v20 offset:26624
 v_mfma_f32_16x16x32_bf16 v[212:215], v[104:107], v[36:39], v[212:215]
 ds_read_b128 v[72:75], v20 offset:43008
 ds_read_b128 v[76:79], v20 offset:59392
 v_mfma_f32_16x16x32_bf16 v[212:215], v[108:111], v[52:55], v[212:215]
 v_mfma_f32_16x16x32_bf16 v[216:219], v[104:107], v[40:43], v[216:219]
 ds_read_b64_tr_b16 v[100:101], v9 offset:4096
 ds_read_b64_tr_b16 v[102:103], v9 offset:6144
 v_mfma_f32_16x16x32_bf16 v[216:219], v[108:111], v[56:59], v[216:219]
 ds_read_b128 v[80:83], v20 offset:11264
 ds_read_b128 v[84:87], v20 offset:27648
 v_mfma_f32_16x16x32_bf16 v[220:223], v[104:107], v[44:47], v[220:223]
 ds_read_b128 v[88:91], v20 offset:44032
 ds_read_b128 v[92:95], v20 offset:60416
 v_mfma_f32_16x16x32_bf16 v[220:223], v[108:111], v[60:63], v[220:223]
 s_waitcnt vmcnt(10) lgkmcnt(12)
 v_mfma_f32_16x16x32_bf16 v[224:227], v[112:115], v[32:35], v[224:227]
 ds_read_b64_tr_b16 v[104:105], v2 offset:0
 ds_read_b64_tr_b16 v[106:107], v2 offset:2048
 v_mfma_f32_16x16x32_bf16 v[224:227], v[116:119], v[48:51], v[224:227]
 s_add_u32 s94, s94, 4096
 buffer_load_dwordx4 a[16:19], v20, s[64:67], s94 offen offset:0 sc1
 v_mfma_f32_16x16x32_bf16 v[228:231], v[112:115], v[36:39], v[228:231]
 buffer_load_dwordx4 a[20:23], v20, s[64:67], s94 offen offset:1024 sc1
 v_mfma_f32_16x16x32_bf16 v[228:231], v[116:119], v[52:55], v[228:231]
 v_mfma_f32_16x16x32_bf16 v[232:235], v[112:115], v[40:43], v[232:235]
 ds_read_b64_tr_b16 v[108:109], v2 offset:4096
 ds_read_b64_tr_b16 v[110:111], v2 offset:6144
 v_mfma_f32_16x16x32_bf16 v[232:235], v[116:119], v[56:59], v[232:235]
 buffer_load_dwordx4 a[24:27], v20, s[64:67], s94 offen offset:2048 sc1
 v_mfma_f32_16x16x32_bf16 v[236:239], v[112:115], v[44:47], v[236:239]
 buffer_load_dwordx4 a[28:31], v20, s[64:67], s94 offen offset:3072 sc1
 v_mfma_f32_16x16x32_bf16 v[236:239], v[116:119], v[60:63], v[236:239]
 s_add_u32 m0, s96, 65536
 s_add_u32 s84, s95, 458880
 s_waitcnt lgkmcnt(8)
 v_mfma_f32_16x16x32_bf16 v[240:243], v[96:99], v[32:35], v[240:243]
 ds_read_b64_tr_b16 v[112:113], v3 offset:0
 ds_read_b64_tr_b16 v[114:115], v3 offset:2048
 v_mfma_f32_16x16x32_bf16 v[240:243], v[100:103], v[48:51], v[240:243]
 buffer_load_dwordx4 v28, s[44:47], s84 offen offset:0 lds
 v_mfma_f32_16x16x32_bf16 v[244:247], v[96:99], v[36:39], v[244:247]
 buffer_load_dwordx4 v29, s[44:47], s84 offen offset:1024 lds
 v_mfma_f32_16x16x32_bf16 v[244:247], v[100:103], v[52:55], v[244:247]
 v_mfma_f32_16x16x32_bf16 v[248:251], v[96:99], v[40:43], v[248:251]
 ds_read_b64_tr_b16 v[116:117], v3 offset:4096
 ds_read_b64_tr_b16 v[118:119], v3 offset:6144
 v_mfma_f32_16x16x32_bf16 v[248:251], v[100:103], v[56:59], v[248:251]
 buffer_load_dwordx4 v30, s[44:47], s84 offen offset:2048 lds
 v_mfma_f32_16x16x32_bf16 v[252:255], v[96:99], v[44:47], v[252:255]
 buffer_load_dwordx4 v31, s[44:47], s84 offen offset:3072 lds
 v_mfma_f32_16x16x32_bf16 v[252:255], v[100:103], v[60:63], v[252:255]
 s_add_u32 m0, s96, 69632
 s_add_u32 s84, s95, 491648
 s_waitcnt lgkmcnt(4)
 v_mfma_f32_16x16x32_bf16 v[192:195], v[104:107], v[64:67], v[192:195]
 ds_read_b64_tr_b16 v[96:97], v4 offset:0
 ds_read_b64_tr_b16 v[98:99], v4 offset:2048
 v_mfma_f32_16x16x32_bf16 v[192:195], v[108:111], v[80:83], v[192:195]
 buffer_load_dwordx4 v28, s[44:47], s84 offen offset:0 lds
 v_mfma_f32_16x16x32_bf16 v[196:199], v[104:107], v[68:71], v[196:199]
 buffer_load_dwordx4 v29, s[44:47], s84 offen offset:1024 lds
 v_mfma_f32_16x16x32_bf16 v[196:199], v[108:111], v[84:87], v[196:199]
 v_mfma_f32_16x16x32_bf16 v[200:203], v[104:107], v[72:75], v[200:203]
 ds_read_b64_tr_b16 v[100:101], v4 offset:4096
 ds_read_b64_tr_b16 v[102:103], v4 offset:6144
 v_mfma_f32_16x16x32_bf16 v[200:203], v[108:111], v[88:91], v[200:203]
 buffer_load_dwordx4 v30, s[44:47], s84 offen offset:2048 lds
 v_mfma_f32_16x16x32_bf16 v[204:207], v[104:107], v[76:79], v[204:207]
 buffer_load_dwordx4 v31, s[44:47], s84 offen offset:3072 lds
 v_mfma_f32_16x16x32_bf16 v[204:207], v[108:111], v[92:95], v[204:207]
 s_waitcnt lgkmcnt(4)
 v_mfma_f32_16x16x32_bf16 v[208:211], v[112:115], v[64:67], v[208:211]
 ds_read_b64_tr_b16 v[104:105], v5 offset:0
 ds_read_b64_tr_b16 v[106:107], v5 offset:2048
 v_mfma_f32_16x16x32_bf16 v[208:211], v[116:119], v[80:83], v[208:211]
 ds_read_b128 v[32:35], v20 offset:12288
 ds_read_b128 v[36:39], v20 offset:28672
 v_mfma_f32_16x16x32_bf16 v[212:215], v[112:115], v[68:71], v[212:215]
 ds_read_b128 v[40:43], v20 offset:45056
 ds_read_b128 v[44:47], v20 offset:61440
 v_mfma_f32_16x16x32_bf16 v[212:215], v[116:119], v[84:87], v[212:215]
 v_mfma_f32_16x16x32_bf16 v[216:219], v[112:115], v[72:75], v[216:219]
 ds_read_b64_tr_b16 v[108:109], v5 offset:4096
 ds_read_b64_tr_b16 v[110:111], v5 offset:6144
 v_mfma_f32_16x16x32_bf16 v[216:219], v[116:119], v[88:91], v[216:219]
 ds_read_b128 v[48:51], v20 offset:13312
 ds_read_b128 v[52:55], v20 offset:29696
 v_mfma_f32_16x16x32_bf16 v[220:223], v[112:115], v[76:79], v[220:223]
 ds_read_b128 v[56:59], v20 offset:46080
 ds_read_b128 v[60:63], v20 offset:62464
 v_mfma_f32_16x16x32_bf16 v[220:223], v[116:119], v[92:95], v[220:223]
 s_waitcnt vmcnt(12) lgkmcnt(12)
 v_mov_b32 v21, 1
 buffer_store_dword v21, off, s[64:67], s74 offset:0 sc1
 v_mfma_f32_16x16x32_bf16 v[224:227], v[96:99], v[64:67], v[224:227]
 ds_read_b64_tr_b16 v[112:113], v2 offset:32768
 ds_read_b64_tr_b16 v[114:115], v2 offset:34816
 v_mfma_f32_16x16x32_bf16 v[224:227], v[100:103], v[80:83], v[224:227]
 s_add_u32 s94, s94, 4096
 buffer_load_dwordx4 a[32:35], v20, s[64:67], s94 offen offset:0 sc1
 v_mfma_f32_16x16x32_bf16 v[228:231], v[96:99], v[68:71], v[228:231]
 buffer_load_dwordx4 a[36:39], v20, s[64:67], s94 offen offset:1024 sc1
 v_mfma_f32_16x16x32_bf16 v[228:231], v[100:103], v[84:87], v[228:231]
 v_mfma_f32_16x16x32_bf16 v[232:235], v[96:99], v[72:75], v[232:235]
 ds_read_b64_tr_b16 v[116:117], v2 offset:36864
 ds_read_b64_tr_b16 v[118:119], v2 offset:38912
 v_mfma_f32_16x16x32_bf16 v[232:235], v[100:103], v[88:91], v[232:235]
 buffer_load_dwordx4 a[40:43], v20, s[64:67], s94 offen offset:2048 sc1
 v_mfma_f32_16x16x32_bf16 v[236:239], v[96:99], v[76:79], v[236:239]
 buffer_load_dwordx4 a[44:47], v20, s[64:67], s94 offen offset:3072 sc1
 v_mfma_f32_16x16x32_bf16 v[236:239], v[100:103], v[92:95], v[236:239]
 s_lshl_b32 s83, s76, 14
 s_mul_i32 s99, s76, 458752
 s_lshl_b32 s88, s80, 7
 s_add_u32 s99, s99, s88
 s_add_u32 m0, s96, 0
 s_add_u32 s84, s99, 0
 s_waitcnt lgkmcnt(8)
 v_mfma_f32_16x16x32_bf16 v[240:243], v[104:107], v[64:67], v[240:243]
 ds_read_b64_tr_b16 v[96:97], v3 offset:32768
 ds_read_b64_tr_b16 v[98:99], v3 offset:34816
 v_mfma_f32_16x16x32_bf16 v[240:243], v[108:111], v[80:83], v[240:243]
 buffer_load_dwordx4 v28, s[56:59], s84 offen offset:0 lds
 v_mfma_f32_16x16x32_bf16 v[244:247], v[104:107], v[68:71], v[244:247]
 buffer_load_dwordx4 v29, s[56:59], s84 offen offset:1024 lds
 v_mfma_f32_16x16x32_bf16 v[244:247], v[108:111], v[84:87], v[244:247]
 v_mfma_f32_16x16x32_bf16 v[248:251], v[104:107], v[72:75], v[248:251]
 ds_read_b64_tr_b16 v[100:101], v3 offset:36864
 ds_read_b64_tr_b16 v[102:103], v3 offset:38912
 v_mfma_f32_16x16x32_bf16 v[248:251], v[108:111], v[88:91], v[248:251]
 buffer_load_dwordx4 v30, s[56:59], s84 offen offset:2048 lds
 v_mfma_f32_16x16x32_bf16 v[252:255], v[104:107], v[76:79], v[252:255]
 buffer_load_dwordx4 v31, s[56:59], s84 offen offset:3072 lds
 v_mfma_f32_16x16x32_bf16 v[252:255], v[108:111], v[92:95], v[252:255]
 s_add_u32 m0, s96, 4096
 s_add_u32 s84, s99, 32768
 s_waitcnt lgkmcnt(4)
 v_mfma_f32_16x16x32_bf16 v[192:195], v[112:115], v[32:35], v[192:195]
 ds_read_b64_tr_b16 v[104:105], v4 offset:32768
 ds_read_b64_tr_b16 v[106:107], v4 offset:34816
 v_mfma_f32_16x16x32_bf16 v[192:195], v[116:119], v[48:51], v[192:195]
 buffer_load_dwordx4 v28, s[56:59], s84 offen offset:0 lds
 v_mfma_f32_16x16x32_bf16 v[196:199], v[112:115], v[36:39], v[196:199]
 buffer_load_dwordx4 v29, s[56:59], s84 offen offset:1024 lds
 v_mfma_f32_16x16x32_bf16 v[196:199], v[116:119], v[52:55], v[196:199]
 v_mfma_f32_16x16x32_bf16 v[200:203], v[112:115], v[40:43], v[200:203]
 ds_read_b64_tr_b16 v[108:109], v4 offset:36864
 ds_read_b64_tr_b16 v[110:111], v4 offset:38912
 v_mfma_f32_16x16x32_bf16 v[200:203], v[116:119], v[56:59], v[200:203]
 buffer_load_dwordx4 v30, s[56:59], s84 offen offset:2048 lds
 v_mfma_f32_16x16x32_bf16 v[204:207], v[112:115], v[44:47], v[204:207]
 buffer_load_dwordx4 v31, s[56:59], s84 offen offset:3072 lds
 v_mfma_f32_16x16x32_bf16 v[204:207], v[116:119], v[60:63], v[204:207]
 s_waitcnt lgkmcnt(4)
 v_mfma_f32_16x16x32_bf16 v[208:211], v[96:99], v[32:35], v[208:211]
 ds_read_b64_tr_b16 v[112:113], v5 offset:32768
 ds_read_b64_tr_b16 v[114:115], v5 offset:34816
 v_mfma_f32_16x16x32_bf16 v[208:211], v[100:103], v[48:51], v[208:211]
 ds_read_b128 v[64:67], v20 offset:14336
 ds_read_b128 v[68:71], v20 offset:30720
 v_mfma_f32_16x16x32_bf16 v[212:215], v[96:99], v[36:39], v[212:215]
 ds_read_b128 v[72:75], v20 offset:47104
 ds_read_b128 v[76:79], v20 offset:63488
 v_mfma_f32_16x16x32_bf16 v[212:215], v[100:103], v[52:55], v[212:215]
 v_mfma_f32_16x16x32_bf16 v[216:219], v[96:99], v[40:43], v[216:219]
 ds_read_b64_tr_b16 v[116:117], v5 offset:36864
 ds_read_b64_tr_b16 v[118:119], v5 offset:38912
 v_mfma_f32_16x16x32_bf16 v[216:219], v[100:103], v[56:59], v[216:219]
 ds_read_b128 v[80:83], v20 offset:15360
 ds_read_b128 v[84:87], v20 offset:31744
 v_mfma_f32_16x16x32_bf16 v[220:223], v[96:99], v[44:47], v[220:223]
 ds_read_b128 v[88:91], v20 offset:48128
 ds_read_b128 v[92:95], v20 offset:64512
 v_mfma_f32_16x16x32_bf16 v[220:223], v[100:103], v[60:63], v[220:223]
 s_waitcnt vmcnt(13) lgkmcnt(12)
 v_mfma_f32_16x16x32_bf16 v[224:227], v[104:107], v[32:35], v[224:227]
 ds_read_b64_tr_b16 v[96:97], v6 offset:0
 ds_read_b64_tr_b16 v[98:99], v6 offset:2048
 v_mfma_f32_16x16x32_bf16 v[224:227], v[108:111], v[48:51], v[224:227]
 s_add_u32 s94, s94, 4096
 buffer_load_dwordx4 a[48:51], v20, s[64:67], s94 offen offset:0 sc1
 v_mfma_f32_16x16x32_bf16 v[228:231], v[104:107], v[36:39], v[228:231]
 buffer_load_dwordx4 a[52:55], v20, s[64:67], s94 offen offset:1024 sc1
 v_mfma_f32_16x16x32_bf16 v[228:231], v[108:111], v[52:55], v[228:231]
 v_mfma_f32_16x16x32_bf16 v[232:235], v[104:107], v[40:43], v[232:235]
 ds_read_b64_tr_b16 v[100:101], v6 offset:4096
 ds_read_b64_tr_b16 v[102:103], v6 offset:6144
 v_mfma_f32_16x16x32_bf16 v[232:235], v[108:111], v[56:59], v[232:235]
 buffer_load_dwordx4 a[56:59], v20, s[64:67], s94 offen offset:2048 sc1
 v_mfma_f32_16x16x32_bf16 v[236:239], v[104:107], v[44:47], v[236:239]
 buffer_load_dwordx4 a[60:63], v20, s[64:67], s94 offen offset:3072 sc1
 v_mfma_f32_16x16x32_bf16 v[236:239], v[108:111], v[60:63], v[236:239]
 s_add_u32 m0, s96, 32768
 s_add_u32 s84, s99, 65536
 s_waitcnt lgkmcnt(8)
 v_mfma_f32_16x16x32_bf16 v[240:243], v[112:115], v[32:35], v[240:243]
 ds_read_b64_tr_b16 v[104:105], v7 offset:0
 ds_read_b64_tr_b16 v[106:107], v7 offset:2048
 v_mfma_f32_16x16x32_bf16 v[240:243], v[116:119], v[48:51], v[240:243]
 buffer_load_dwordx4 v28, s[56:59], s84 offen offset:0 lds
 v_mfma_f32_16x16x32_bf16 v[244:247], v[112:115], v[36:39], v[244:247]
 buffer_load_dwordx4 v29, s[56:59], s84 offen offset:1024 lds
 v_mfma_f32_16x16x32_bf16 v[244:247], v[116:119], v[52:55], v[244:247]
 v_mfma_f32_16x16x32_bf16 v[248:251], v[112:115], v[40:43], v[248:251]
 ds_read_b64_tr_b16 v[108:109], v7 offset:4096
 ds_read_b64_tr_b16 v[110:111], v7 offset:6144
 v_mfma_f32_16x16x32_bf16 v[248:251], v[116:119], v[56:59], v[248:251]
 buffer_load_dwordx4 v30, s[56:59], s84 offen offset:2048 lds
 v_mfma_f32_16x16x32_bf16 v[252:255], v[112:115], v[44:47], v[252:255]
 buffer_load_dwordx4 v31, s[56:59], s84 offen offset:3072 lds
 v_mfma_f32_16x16x32_bf16 v[252:255], v[116:119], v[60:63], v[252:255]
 s_add_u32 m0, s96, 36864
 s_add_u32 s84, s99, 98304
 s_waitcnt lgkmcnt(4)
 v_mfma_f32_16x16x32_bf16 v[192:195], v[96:99], v[64:67], v[192:195]
 ds_read_b64_tr_b16 v[112:113], v8 offset:0
 ds_read_b64_tr_b16 v[114:115], v8 offset:2048
 v_mfma_f32_16x16x32_bf16 v[192:195], v[100:103], v[80:83], v[192:195]
 buffer_load_dwordx4 v28, s[56:59], s84 offen offset:0 lds
 v_mfma_f32_16x16x32_bf16 v[196:199], v[96:99], v[68:71], v[196:199]
 buffer_load_dwordx4 v29, s[56:59], s84 offen offset:1024 lds
 v_mfma_f32_16x16x32_bf16 v[196:199], v[100:103], v[84:87], v[196:199]
 v_mfma_f32_16x16x32_bf16 v[200:203], v[96:99], v[72:75], v[200:203]
 ds_read_b64_tr_b16 v[116:117], v8 offset:4096
 ds_read_b64_tr_b16 v[118:119], v8 offset:6144
 v_mfma_f32_16x16x32_bf16 v[200:203], v[100:103], v[88:91], v[200:203]
 buffer_load_dwordx4 v30, s[56:59], s84 offen offset:2048 lds
 v_mfma_f32_16x16x32_bf16 v[204:207], v[96:99], v[76:79], v[204:207]
 buffer_load_dwordx4 v31, s[56:59], s84 offen offset:3072 lds
 v_mfma_f32_16x16x32_bf16 v[204:207], v[100:103], v[92:95], v[204:207]
 s_waitcnt lgkmcnt(4)
 v_mfma_f32_16x16x32_bf16 v[208:211], v[104:107], v[64:67], v[208:211]
 ds_read_b64_tr_b16 v[96:97], v9 offset:0
 ds_read_b64_tr_b16 v[98:99], v9 offset:2048
 v_mfma_f32_16x16x32_bf16 v[208:211], v[108:111], v[80:83], v[208:211]
 v_mfma_f32_16x16x32_bf16 v[212:215], v[104:107], v[68:71], v[212:215]
 v_mfma_f32_16x16x32_bf16 v[212:215], v[108:111], v[84:87], v[212:215]
 v_mfma_f32_16x16x32_bf16 v[216:219], v[104:107], v[72:75], v[216:219]
 ds_read_b64_tr_b16 v[100:101], v9 offset:4096
 ds_read_b64_tr_b16 v[102:103], v9 offset:6144
 v_mfma_f32_16x16x32_bf16 v[216:219], v[108:111], v[88:91], v[216:219]
 v_mfma_f32_16x16x32_bf16 v[220:223], v[104:107], v[76:79], v[220:223]
 v_mfma_f32_16x16x32_bf16 v[220:223], v[108:111], v[92:95], v[220:223]
 s_waitcnt vmcnt(12) lgkmcnt(4)
 v_mfma_f32_16x16x32_bf16 v[224:227], v[112:115], v[64:67], v[224:227]
 ds_read_b64_tr_b16 v[104:105], v2 offset:0
 ds_read_b64_tr_b16 v[106:107], v2 offset:2048
 v_mfma_f32_16x16x32_bf16 v[224:227], v[116:119], v[80:83], v[224:227]
 v_mfma_f32_16x16x32_bf16 v[228:231], v[112:115], v[68:71], v[228:231]
 v_mfma_f32_16x16x32_bf16 v[228:231], v[116:119], v[84:87], v[228:231]
 v_mfma_f32_16x16x32_bf16 v[232:235], v[112:115], v[72:75], v[232:235]
 ds_read_b64_tr_b16 v[108:109], v2 offset:4096
 ds_read_b64_tr_b16 v[110:111], v2 offset:6144
 v_mfma_f32_16x16x32_bf16 v[232:235], v[116:119], v[88:91], v[232:235]
 v_mfma_f32_16x16x32_bf16 v[236:239], v[112:115], v[76:79], v[236:239]
 v_mfma_f32_16x16x32_bf16 v[236:239], v[116:119], v[92:95], v[236:239]
 s_add_u32 m0, s96, 65536
 s_add_u32 s84, s99, 131072
 s_waitcnt lgkmcnt(4)
 v_mfma_f32_16x16x32_bf16 v[240:243], v[96:99], v[64:67], v[240:243]
 ds_read_b64_tr_b16 v[112:113], v3 offset:0
 ds_read_b64_tr_b16 v[114:115], v3 offset:2048
 v_mfma_f32_16x16x32_bf16 v[240:243], v[100:103], v[80:83], v[240:243]
 buffer_load_dwordx4 v28, s[56:59], s84 offen offset:0 lds
 v_mfma_f32_16x16x32_bf16 v[244:247], v[96:99], v[68:71], v[244:247]
 buffer_load_dwordx4 v29, s[56:59], s84 offen offset:1024 lds
 v_mfma_f32_16x16x32_bf16 v[244:247], v[100:103], v[84:87], v[244:247]
 v_mfma_f32_16x16x32_bf16 v[248:251], v[96:99], v[72:75], v[248:251]
 ds_read_b64_tr_b16 v[116:117], v3 offset:4096
 ds_read_b64_tr_b16 v[118:119], v3 offset:6144
 v_mfma_f32_16x16x32_bf16 v[248:251], v[100:103], v[88:91], v[248:251]
 buffer_load_dwordx4 v30, s[56:59], s84 offen offset:2048 lds
 v_mfma_f32_16x16x32_bf16 v[252:255], v[96:99], v[76:79], v[252:255]
 buffer_load_dwordx4 v31, s[56:59], s84 offen offset:3072 lds
 v_mfma_f32_16x16x32_bf16 v[252:255], v[100:103], v[92:95], v[252:255]
 s_add_u32 m0, s96, 69632
 s_add_u32 s84, s99, 163840
 s_waitcnt lgkmcnt(4)
 v_mfma_f32_16x16x32_bf16 v[32:35], v[104:107], a[80:83], 0
 ds_read_b64_tr_b16 v[96:97], v4 offset:0
 ds_read_b64_tr_b16 v[98:99], v4 offset:2048
 v_mfma_f32_16x16x32_bf16 v[32:35], v[108:111], a[96:99], v[32:35]
 buffer_load_dwordx4 v28, s[56:59], s84 offen offset:0 lds
 v_mfma_f32_16x16x32_bf16 v[36:39], v[104:107], a[84:87], 0
 buffer_load_dwordx4 v29, s[56:59], s84 offen offset:1024 lds
 v_mfma_f32_16x16x32_bf16 v[36:39], v[108:111], a[100:103], v[36:39]
 v_mfma_f32_16x16x32_bf16 v[40:43], v[104:107], a[88:91], 0
 ds_read_b64_tr_b16 v[100:101], v4 offset:4096
 ds_read_b64_tr_b16 v[102:103], v4 offset:6144
 v_mfma_f32_16x16x32_bf16 v[40:43], v[108:111], a[104:107], v[40:43]
 buffer_load_dwordx4 v30, s[56:59], s84 offen offset:2048 lds
 v_mfma_f32_16x16x32_bf16 v[44:47], v[104:107], a[92:95], 0
 buffer_load_dwordx4 v31, s[56:59], s84 offen offset:3072 lds
 v_mfma_f32_16x16x32_bf16 v[44:47], v[108:111], a[108:111], v[44:47]
 s_waitcnt lgkmcnt(4)
 v_mfma_f32_16x16x32_bf16 v[48:51], v[112:115], a[80:83], 0
 ds_read_b64_tr_b16 v[104:105], v5 offset:0
 ds_read_b64_tr_b16 v[106:107], v5 offset:2048
 v_mfma_f32_16x16x32_bf16 v[48:51], v[116:119], a[96:99], v[48:51]
 s_add_u32 s93, s93, 61440
 v_cvt_pk_bf16_f32 v120, v192, v193
 v_cvt_pk_bf16_f32 v121, v194, v195
 v_cvt_pk_bf16_f32 v122, v208, v209
 v_cvt_pk_bf16_f32 v123, v210, v211
 buffer_store_dwordx4 v[120:123], v20, s[64:67], s93 offen offset:0 sc1
 v_cvt_pk_bf16_f32 v124, v224, v225
 v_cvt_pk_bf16_f32 v125, v226, v227
 v_cvt_pk_bf16_f32 v126, v240, v241
 v_cvt_pk_bf16_f32 v127, v242, v243
 buffer_store_dwordx4 v[124:127], v20, s[64:67], s93 offen offset:1024 sc1
 v_cvt_pk_bf16_f32 v120, v196, v197
 v_cvt_pk_bf16_f32 v121, v198, v199
 v_cvt_pk_bf16_f32 v122, v212, v213
 v_cvt_pk_bf16_f32 v123, v214, v215
 buffer_store_dwordx4 v[120:123], v20, s[64:67], s93 offen offset:2048 sc1
 v_cvt_pk_bf16_f32 v124, v228, v229
 v_cvt_pk_bf16_f32 v125, v230, v231
 v_cvt_pk_bf16_f32 v126, v244, v245
 v_cvt_pk_bf16_f32 v127, v246, v247
 buffer_store_dwordx4 v[124:127], v20, s[64:67], s93 offen offset:3072 sc1
 v_mfma_f32_16x16x32_bf16 v[52:55], v[112:115], a[84:87], 0
 v_mfma_f32_16x16x32_bf16 v[52:55], v[116:119], a[100:103], v[52:55]
 v_mfma_f32_16x16x32_bf16 v[56:59], v[112:115], a[88:91], 0
 ds_read_b64_tr_b16 v[108:109], v5 offset:4096
 ds_read_b64_tr_b16 v[110:111], v5 offset:6144
 v_mfma_f32_16x16x32_bf16 v[56:59], v[116:119], a[104:107], v[56:59]
 s_add_u32 s93, s93, 4096
 v_cvt_pk_bf16_f32 v120, v200, v201
 v_cvt_pk_bf16_f32 v121, v202, v203
 v_cvt_pk_bf16_f32 v122, v216, v217
 v_cvt_pk_bf16_f32 v123, v218, v219
 buffer_store_dwordx4 v[120:123], v20, s[64:67], s93 offen offset:0 sc1
 v_cvt_pk_bf16_f32 v124, v232, v233
 v_cvt_pk_bf16_f32 v125, v234, v235
 v_cvt_pk_bf16_f32 v126, v248, v249
 v_cvt_pk_bf16_f32 v127, v250, v251
 buffer_store_dwordx4 v[124:127], v20, s[64:67], s93 offen offset:1024 sc1
 v_cvt_pk_bf16_f32 v120, v204, v205
 v_cvt_pk_bf16_f32 v121, v206, v207
 v_cvt_pk_bf16_f32 v122, v220, v221
 v_cvt_pk_bf16_f32 v123, v222, v223
 buffer_store_dwordx4 v[120:123], v20, s[64:67], s93 offen offset:2048 sc1
L_pg16:
 s_cbranch_execz L_site2
 v_cvt_pk_bf16_f32 v124, v236, v237
 v_cvt_pk_bf16_f32 v125, v238, v239
 v_cvt_pk_bf16_f32 v126, v252, v253
 v_cvt_pk_bf16_f32 v127, v254, v255
 buffer_store_dwordx4 v[124:127], v20, s[64:67], s93 offen offset:3072 sc1
 v_mfma_f32_16x16x32_bf16 v[60:63], v[112:115], a[92:95], 0
 v_mfma_f32_16x16x32_bf16 v[60:63], v[116:119], a[108:111], v[60:63]
 s_waitcnt vmcnt(16) lgkmcnt(4)
 v_mfma_f32_16x16x32_bf16 v[64:67], v[96:99], a[80:83], 0
 ds_read_b64_tr_b16 v[112:113], v2 offset:32768
 ds_read_b64_tr_b16 v[114:115], v2 offset:34816
 v_mfma_f32_16x16x32_bf16 v[64:67], v[100:103], a[96:99], v[64:67]
 v_mfma_f32_16x16x32_bf16 v[68:71], v[96:99], a[84:87], 0
 v_mfma_f32_16x16x32_bf16 v[68:71], v[100:103], a[100:103], v[68:71]
 v_mfma_f32_16x16x32_bf16 v[72:75], v[96:99], a[88:91], 0
 ds_read_b64_tr_b16 v[116:117], v2 offset:36864
 ds_read_b64_tr_b16 v[118:119], v2 offset:38912
 v_mfma_f32_16x16x32_bf16 v[72:75], v[100:103], a[104:107], v[72:75]
 v_mfma_f32_16x16x32_bf16 v[76:79], v[96:99], a[92:95], 0
 v_mfma_f32_16x16x32_bf16 v[76:79], v[100:103], a[108:111], v[76:79]
 s_add_u32 m0, s96, 0
 s_add_u32 s84, s99, 196608
 s_waitcnt lgkmcnt(4)
 v_mfma_f32_16x16x32_bf16 v[80:83], v[104:107], a[80:83], 0
 ds_read_b64_tr_b16 v[96:97], v3 offset:32768
 ds_read_b64_tr_b16 v[98:99], v3 offset:34816
 v_mfma_f32_16x16x32_bf16 v[80:83], v[108:111], a[96:99], v[80:83]
 buffer_load_dwordx4 v28, s[56:59], s84 offen offset:0 lds
 v_mfma_f32_16x16x32_bf16 v[84:87], v[104:107], a[84:87], 0
 buffer_load_dwordx4 v29, s[56:59], s84 offen offset:1024 lds
 v_mfma_f32_16x16x32_bf16 v[84:87], v[108:111], a[100:103], v[84:87]
 v_mfma_f32_16x16x32_bf16 v[88:91], v[104:107], a[88:91], 0
 ds_read_b64_tr_b16 v[100:101], v3 offset:36864
 ds_read_b64_tr_b16 v[102:103], v3 offset:38912
 v_mfma_f32_16x16x32_bf16 v[88:91], v[108:111], a[104:107], v[88:91]
 buffer_load_dwordx4 v30, s[56:59], s84 offen offset:2048 lds
 v_mfma_f32_16x16x32_bf16 v[92:95], v[104:107], a[92:95], 0
 buffer_load_dwordx4 v31, s[56:59], s84 offen offset:3072 lds
 v_mfma_f32_16x16x32_bf16 v[92:95], v[108:111], a[108:111], v[92:95]
 s_add_u32 m0, s96, 4096
 s_add_u32 s84, s99, 229376
 s_waitcnt lgkmcnt(4)
 v_mfma_f32_16x16x32_bf16 v[32:35], v[112:115], a[112:115], v[32:35]
 ds_read_b64_tr_b16 v[104:105], v4 offset:32768
 ds_read_b64_tr_b16 v[106:107], v4 offset:34816
 v_mfma_f32_16x16x32_bf16 v[32:35], v[116:119], a[180:183], v[32:35]
 buffer_load_dwordx4 v28, s[56:59], s84 offen offset:0 lds
 v_mfma_f32_16x16x32_bf16 v[36:39], v[112:115], a[116:119], v[36:39]
 s_lshl_b32 s88, s76, 12
 buffer_load_dwordx4 v29, s[56:59], s84 offen offset:1024 lds
 s_add_u32 s88, s88, 65536
 v_add_u32 v17, s88, v20
 v_add_u32 v19, 65536, v17
 v_mfma_f32_16x16x32_bf16 v[36:39], v[116:119], a[184:187], v[36:39]
 v_mfma_f32_16x16x32_bf16 v[40:43], v[112:115], a[120:123], v[40:43]
 ds_read_b64_tr_b16 v[108:109], v4 offset:36864
 ds_read_b64_tr_b16 v[110:111], v4 offset:38912
 v_mfma_f32_16x16x32_bf16 v[40:43], v[116:119], a[188:191], v[40:43]
 buffer_load_dwordx4 v30, s[56:59], s84 offen offset:2048 lds
 v_mfma_f32_16x16x32_bf16 v[44:47], v[112:115], a[124:127], v[44:47]
 s_lshl_b32 s88, s76, 13
 buffer_load_dwordx4 v31, s[56:59], s84 offen offset:3072 lds
 v_mov_b32 v16, 0x3f80
 s_sub_u32 s88, s88, 65536
 v_mfma_f32_16x16x32_bf16 v[44:47], v[116:119], a[192:195], v[44:47]
 s_waitcnt lgkmcnt(4)
 v_mfma_f32_16x16x32_bf16 v[48:51], v[96:99], a[112:115], v[48:51]
 ds_read_b64_tr_b16 v[112:113], v5 offset:32768
 ds_read_b64_tr_b16 v[114:115], v5 offset:34816
 v_mfma_f32_16x16x32_bf16 v[48:51], v[100:103], a[180:183], v[48:51]
 v_mfma_f32_16x16x32_bf16 v[52:55], v[96:99], a[116:119], v[52:55]
 v_add_u32 v10, s88, v2
 v_add_u32 v11, s88, v3
 v_mfma_f32_16x16x32_bf16 v[52:55], v[100:103], a[184:187], v[52:55]
 v_mfma_f32_16x16x32_bf16 v[56:59], v[96:99], a[120:123], v[56:59]
 ds_read_b64_tr_b16 v[116:117], v5 offset:36864
 ds_read_b64_tr_b16 v[118:119], v5 offset:38912
 v_mfma_f32_16x16x32_bf16 v[56:59], v[100:103], a[188:191], v[56:59]
 v_mfma_f32_16x16x32_bf16 v[60:63], v[96:99], a[124:127], v[60:63]
 v_add_u32 v12, s88, v4
 v_add_u32 v13, s88, v5
 v_mfma_f32_16x16x32_bf16 v[60:63], v[100:103], a[192:195], v[60:63]
 s_waitcnt vmcnt(16) lgkmcnt(4)
 s_barrier
 v_mfma_f32_16x16x32_bf16 v[64:67], v[104:107], a[112:115], v[64:67]
 ds_read_b64_tr_b16 v[96:97], v6 offset:0
 ds_read_b64_tr_b16 v[98:99], v6 offset:2048
 v_mfma_f32_16x16x32_bf16 v[64:67], v[108:111], a[180:183], v[64:67]
 v_mfma_f32_16x16x32_bf16 v[68:71], v[104:107], a[116:119], v[68:71]
 v_bfe_u32 v120, v1, 2, 2
 v_lshrrev_b32 v121, 4, v1
 v_and_b32 v124, 1, v1
 v_cmp_eq_u32 vcc, v120, v121
 v_mfma_f32_16x16x32_bf16 v[68:71], v[108:111], a[184:187], v[68:71]
 v_mfma_f32_16x16x32_bf16 v[72:75], v[104:107], a[120:123], v[72:75]
 ds_read_b64_tr_b16 v[100:101], v6 offset:4096
 ds_read_b64_tr_b16 v[102:103], v6 offset:6144
 v_mfma_f32_16x16x32_bf16 v[72:75], v[108:111], a[188:191], v[72:75]
 v_mfma_f32_16x16x32_bf16 v[76:79], v[104:107], a[124:127], v[76:79]
 v_lshlrev_b32 v124, 4, v124
 v_and_b32 v125, 2, v1
 v_lshlrev_b32 v124, v124, v16
 v_cndmask_b32 v124, 0, v124, vcc
 v_mfma_f32_16x16x32_bf16 v[76:79], v[108:111], a[192:195], v[76:79]
 s_add_u32 m0, s96, 32768
 s_add_u32 s84, s99, 262144
 s_waitcnt lgkmcnt(4)
 v_mfma_f32_16x16x32_bf16 v[80:83], v[112:115], a[112:115], v[80:83]
 ds_read_b64_tr_b16 v[104:105], v7 offset:0
 ds_read_b64_tr_b16 v[106:107], v7 offset:2048
 v_mfma_f32_16x16x32_bf16 v[80:83], v[116:119], a[180:183], v[80:83]
 buffer_load_dwordx4 v28, s[56:59], s84 offen offset:0 lds
 v_mfma_f32_16x16x32_bf16 v[84:87], v[112:115], a[116:119], v[84:87]
 buffer_load_dwordx4 v29, s[56:59], s84 offen offset:1024 lds
 v_cmp_eq_u32 vcc, 0, v125
 v_mov_b32 v120, 0
 v_mov_b32 v121, 0
 v_cndmask_b32 v122, 0, v124, vcc
 v_mfma_f32_16x16x32_bf16 v[84:87], v[116:119], a[184:187], v[84:87]
 v_mfma_f32_16x16x32_bf16 v[88:91], v[112:115], a[120:123], v[88:91]
 ds_read_b64_tr_b16 v[108:109], v7 offset:4096
 ds_read_b64_tr_b16 v[110:111], v7 offset:6144
 v_mfma_f32_16x16x32_bf16 v[88:91], v[116:119], a[188:191], v[88:91]
 buffer_load_dwordx4 v30, s[56:59], s84 offen offset:2048 lds
 v_mfma_f32_16x16x32_bf16 v[92:95], v[112:115], a[124:127], v[92:95]
 buffer_load_dwordx4 v31, s[56:59], s84 offen offset:3072 lds
 v_mfma_f32_16x16x32_bf16 v[92:95], v[116:119], a[192:195], v[92:95]
 s_add_u32 m0, s96, 36864
 s_add_u32 s84, s99, 294912
 s_waitcnt lgkmcnt(4)
 v_mfma_f32_16x16x32_bf16 v[32:35], v[96:99], a[196:199], v[32:35]
 ds_read_b64_tr_b16 v[112:113], v8 offset:0
 ds_read_b64_tr_b16 v[114:115], v8 offset:2048
 v_mfma_f32_16x16x32_bf16 v[32:35], v[100:103], a[128:131], v[32:35]
 buffer_load_dwordx4 v28, s[56:59], s84 offen offset:0 lds
 v_mfma_f32_16x16x32_bf16 v[36:39], v[96:99], a[200:203], v[36:39]
 buffer_load_dwordx4 v29, s[56:59], s84 offen offset:1024 lds
 v_mov_b32 v192, 0
 v_mov_b32 v193, 0
 v_mov_b32 v194, 0
 v_mov_b32 v195, 0
 v_mfma_f32_16x16x32_bf16 v[36:39], v[100:103], a[132:135], v[36:39]
 v_mfma_f32_16x16x32_bf16 v[40:43], v[96:99], a[204:207], v[40:43]
 ds_read_b64_tr_b16 v[116:117], v8 offset:4096
 ds_read_b64_tr_b16 v[118:119], v8 offset:6144
 v_mfma_f32_16x16x32_bf16 v[40:43], v[100:103], a[136:139], v[40:43]
 buffer_load_dwordx4 v30, s[56:59], s84 offen offset:2048 lds
 v_mfma_f32_16x16x32_bf16 v[44:47], v[96:99], a[208:211], v[44:47]
 buffer_load_dwordx4 v31, s[56:59], s84 offen offset:3072 lds
 v_mov_b32 v196, 0
 v_mov_b32 v197, 0
 v_mov_b32 v198, 0
 v_mov_b32 v199, 0
 v_mfma_f32_16x16x32_bf16 v[44:47], v[100:103], a[140:143], v[44:47]
 s_waitcnt lgkmcnt(4)
 v_mfma_f32_16x16x32_bf16 v[48:51], v[104:107], a[196:199], v[48:51]
 ds_read_b64_tr_b16 v[96:97], v9 offset:0
 ds_read_b64_tr_b16 v[98:99], v9 offset:2048
 v_mfma_f32_16x16x32_bf16 v[48:51], v[108:111], a[128:131], v[48:51]
 v_mfma_f32_16x16x32_bf16 v[52:55], v[104:107], a[200:203], v[52:55]
 v_mov_b32 v200, 0
 v_mov_b32 v201, 0
 v_mov_b32 v202, 0
 v_mov_b32 v203, 0
 v_mfma_f32_16x16x32_bf16 v[52:55], v[108:111], a[132:135], v[52:55]
 v_mfma_f32_16x16x32_bf16 v[56:59], v[104:107], a[204:207], v[56:59]
 ds_read_b64_tr_b16 v[100:101], v9 offset:4096
 ds_read_b64_tr_b16 v[102:103], v9 offset:6144
 v_mfma_f32_16x16x32_bf16 v[56:59], v[108:111], a[136:139], v[56:59]
 v_mfma_f32_16x16x32_bf16 v[60:63], v[104:107], a[208:211], v[60:63]
 v_mov_b32 v204, 0
 v_mov_b32 v205, 0
 v_mov_b32 v206, 0
 v_mov_b32 v207, 0
 v_mfma_f32_16x16x32_bf16 v[60:63], v[108:111], a[140:143], v[60:63]
 s_add_u32 m0, s83, 0
 s_add_u32 s84, s99, 327680
 s_waitcnt vmcnt(8) lgkmcnt(4)
 s_waitcnt vmcnt(16)
 v_mov_b32 v21, 1
 buffer_store_dword v21, off, s[64:67], s74 offset:128 sc1
 v_mfma_f32_16x16x32_bf16 v[64:67], v[112:115], a[196:199], v[64:67]
 ds_read_b64_tr_b16 v[104:105], v2 offset:0
 ds_read_b64_tr_b16 v[106:107], v2 offset:2048
 v_mfma_f32_16x16x32_bf16 v[64:67], v[116:119], a[128:131], v[64:67]
 buffer_load_dwordx4 v28, s[56:59], s84 offen offset:0 lds
 v_mfma_f32_16x16x32_bf16 v[68:71], v[112:115], a[200:203], v[68:71]
 buffer_load_dwordx4 v29, s[56:59], s84 offen offset:1024 lds
 v_mfma_f32_16x16x32_bf16 v[68:71], v[116:119], a[132:135], v[68:71]
 v_mfma_f32_16x16x32_bf16 v[72:75], v[112:115], a[204:207], v[72:75]
 ds_read_b64_tr_b16 v[108:109], v2 offset:4096
 ds_read_b64_tr_b16 v[110:111], v2 offset:6144
 v_mfma_f32_16x16x32_bf16 v[72:75], v[116:119], a[136:139], v[72:75]
 buffer_load_dwordx4 v30, s[56:59], s84 offen offset:2048 lds
 v_mfma_f32_16x16x32_bf16 v[76:79], v[112:115], a[208:211], v[76:79]
 buffer_load_dwordx4 v31, s[56:59], s84 offen offset:3072 lds
 v_mfma_f32_16x16x32_bf16 v[76:79], v[116:119], a[140:143], v[76:79]
 s_add_u32 m0, s83, 4096
 s_add_u32 s84, s99, 360448
 s_waitcnt lgkmcnt(4)
 v_mfma_f32_16x16x32_bf16 v[80:83], v[96:99], a[196:199], v[80:83]
 ds_read_b64_tr_b16 v[112:113], v3 offset:0
 ds_read_b64_tr_b16 v[114:115], v3 offset:2048
 v_mfma_f32_16x16x32_bf16 v[80:83], v[100:103], a[128:131], v[80:83]
 buffer_load_dwordx4 v28, s[56:59], s84 offen offset:0 lds
 v_mfma_f32_16x16x32_bf16 v[84:87], v[96:99], a[200:203], v[84:87]
 buffer_load_dwordx4 v29, s[56:59], s84 offen offset:1024 lds
 v_mfma_f32_16x16x32_bf16 v[84:87], v[100:103], a[132:135], v[84:87]
 v_mfma_f32_16x16x32_bf16 v[88:91], v[96:99], a[204:207], v[88:91]
 ds_read_b64_tr_b16 v[116:117], v3 offset:4096
 ds_read_b64_tr_b16 v[118:119], v3 offset:6144
 v_mfma_f32_16x16x32_bf16 v[88:91], v[100:103], a[136:139], v[88:91]
 buffer_load_dwordx4 v30, s[56:59], s84 offen offset:2048 lds
 v_mfma_f32_16x16x32_bf16 v[92:95], v[96:99], a[208:211], v[92:95]
 buffer_load_dwordx4 v31, s[56:59], s84 offen offset:3072 lds
 v_mfma_f32_16x16x32_bf16 v[92:95], v[100:103], a[140:143], v[92:95]
 s_add_u32 m0, s83, 8192
 s_add_u32 s84, s99, 393216
 s_waitcnt lgkmcnt(4)
 v_mfma_f32_16x16x32_bf16 v[32:35], v[104:107], a[148:151], v[32:35]
 ds_read_b64_tr_b16 v[96:97], v4 offset:0
 ds_read_b64_tr_b16 v[98:99], v4 offset:2048
 v_mfma_f32_16x16x32_bf16 v[32:35], v[108:111], a[164:167], v[32:35]
 s_lshl_b32 s91, s79, 3
 s_add_u32 s91, s91, s80
 s_lshl_b32 s86, s91, 7
 s_add_u32 s86, s86, 25165824
 v_and_b32 v14, 7, v1
 v_lshlrev_b32 v14, 2, v14
 s_lshl_b32 s92, s91, 16
 s_lshl_b32 s91, s76, 11
 s_add_u32 s92, s92, s91
 s_add_u32 s92, s92, 8388608
 buffer_load_dword v15, v14, s[64:67], s86 offen sc1
 buffer_load_dwordx4 v28, s[56:59], s84 offen offset:0 lds
 v_mfma_f32_16x16x32_bf16 v[36:39], v[104:107], a[152:155], v[36:39]
 buffer_load_dwordx4 v29, s[56:59], s84 offen offset:1024 lds
 v_mfma_f32_16x16x32_bf16 v[36:39], v[108:111], a[168:171], v[36:39]
 v_mfma_f32_16x16x32_bf16 v[40:43], v[104:107], a[156:159], v[40:43]
 ds_read_b64_tr_b16 v[100:101], v4 offset:4096
 ds_read_b64_tr_b16 v[102:103], v4 offset:6144
 v_mfma_f32_16x16x32_bf16 v[40:43], v[108:111], a[172:175], v[40:43]
 buffer_load_dwordx4 v30, s[56:59], s84 offen offset:2048 lds
 v_mfma_f32_16x16x32_bf16 v[44:47], v[104:107], a[160:163], v[44:47]
 buffer_load_dwordx4 v31, s[56:59], s84 offen offset:3072 lds
 v_mfma_f32_16x16x32_bf16 v[44:47], v[108:111], a[176:179], v[44:47]
 s_add_u32 m0, s83, 12288
 s_add_u32 s84, s99, 425984
 s_waitcnt lgkmcnt(4)
 v_mfma_f32_16x16x32_bf16 v[48:51], v[112:115], a[148:151], v[48:51]
 ds_read_b64_tr_b16 v[104:105], v5 offset:0
 ds_read_b64_tr_b16 v[106:107], v5 offset:2048
 v_mfma_f32_16x16x32_bf16 v[48:51], v[116:119], a[164:167], v[48:51]
 buffer_load_dwordx4 v28, s[56:59], s84 offen offset:0 lds
 v_mfma_f32_16x16x32_bf16 v[52:55], v[112:115], a[152:155], v[52:55]
 buffer_load_dwordx4 v29, s[56:59], s84 offen offset:1024 lds
 v_mfma_f32_16x16x32_bf16 v[52:55], v[116:119], a[168:171], v[52:55]
 v_mfma_f32_16x16x32_bf16 v[56:59], v[112:115], a[156:159], v[56:59]
 ds_read_b64_tr_b16 v[108:109], v5 offset:4096
 ds_read_b64_tr_b16 v[110:111], v5 offset:6144
 v_mfma_f32_16x16x32_bf16 v[56:59], v[116:119], a[172:175], v[56:59]
 buffer_load_dwordx4 v30, s[56:59], s84 offen offset:2048 lds
 v_mfma_f32_16x16x32_bf16 v[60:63], v[112:115], a[160:163], v[60:63]
 buffer_load_dwordx4 v31, s[56:59], s84 offen offset:3072 lds
 v_mfma_f32_16x16x32_bf16 v[60:63], v[116:119], a[176:179], v[60:63]
 s_waitcnt vmcnt(18) lgkmcnt(4)
 v_mfma_f32_16x16x32_bf16 v[64:67], v[96:99], a[148:151], v[64:67]
 ds_read_b64_tr_b16 v[112:113], v2 offset:32768
 ds_read_b64_tr_b16 v[114:115], v2 offset:34816
 v_mfma_f32_16x16x32_bf16 v[64:67], v[100:103], a[164:167], v[64:67]
 v_mfma_f32_16x16x32_bf16 v[68:71], v[96:99], a[152:155], v[68:71]
 v_mfma_f32_16x16x32_bf16 v[68:71], v[100:103], a[168:171], v[68:71]
 v_mfma_f32_16x16x32_bf16 v[72:75], v[96:99], a[156:159], v[72:75]
 ds_read_b64_tr_b16 v[116:117], v2 offset:36864
 ds_read_b64_tr_b16 v[118:119], v2 offset:38912
 v_mfma_f32_16x16x32_bf16 v[72:75], v[100:103], a[172:175], v[72:75]
 v_mfma_f32_16x16x32_bf16 v[76:79], v[96:99], a[160:163], v[76:79]
 v_mfma_f32_16x16x32_bf16 v[76:79], v[100:103], a[176:179], v[76:79]
 s_waitcnt lgkmcnt(4)
 v_mfma_f32_16x16x32_bf16 v[80:83], v[104:107], a[148:151], v[80:83]
 ds_read_b64_tr_b16 v[96:97], v3 offset:32768
 ds_read_b64_tr_b16 v[98:99], v3 offset:34816
 v_mfma_f32_16x16x32_bf16 v[80:83], v[108:111], a[164:167], v[80:83]
 v_mfma_f32_16x16x32_bf16 v[84:87], v[104:107], a[152:155], v[84:87]
 v_mfma_f32_16x16x32_bf16 v[84:87], v[108:111], a[168:171], v[84:87]
 v_mfma_f32_16x16x32_bf16 v[88:91], v[104:107], a[156:159], v[88:91]
 ds_read_b64_tr_b16 v[100:101], v3 offset:36864
 ds_read_b64_tr_b16 v[102:103], v3 offset:38912
 v_mfma_f32_16x16x32_bf16 v[88:91], v[108:111], a[172:175], v[88:91]
 v_mfma_f32_16x16x32_bf16 v[92:95], v[104:107], a[160:163], v[92:95]
 v_mfma_f32_16x16x32_bf16 v[92:95], v[108:111], a[176:179], v[92:95]
 s_waitcnt lgkmcnt(4)
 v_mfma_f32_16x16x32_bf16 v[32:35], v[112:115], a[212:215], v[32:35]
 ds_read_b64_tr_b16 v[104:105], v4 offset:32768
 ds_read_b64_tr_b16 v[106:107], v4 offset:34816
 v_mfma_f32_16x16x32_bf16 v[32:35], v[116:119], a[228:231], v[32:35]
 v_mfma_f32_16x16x32_bf16 v[36:39], v[112:115], a[216:219], v[36:39]
 v_mfma_f32_16x16x32_bf16 v[36:39], v[116:119], a[232:235], v[36:39]
 v_mfma_f32_16x16x32_bf16 v[40:43], v[112:115], a[220:223], v[40:43]
 ds_read_b64_tr_b16 v[108:109], v4 offset:36864
 ds_read_b64_tr_b16 v[110:111], v4 offset:38912
 v_mfma_f32_16x16x32_bf16 v[40:43], v[116:119], a[236:239], v[40:43]
 v_mfma_f32_16x16x32_bf16 v[44:47], v[112:115], a[224:227], v[44:47]
 v_mfma_f32_16x16x32_bf16 v[44:47], v[116:119], a[240:243], v[44:47]
 s_waitcnt lgkmcnt(4)
 v_mfma_f32_16x16x32_bf16 v[48:51], v[96:99], a[212:215], v[48:51]
 ds_read_b64_tr_b16 v[112:113], v5 offset:32768
 ds_read_b64_tr_b16 v[114:115], v5 offset:34816
 v_mfma_f32_16x16x32_bf16 v[48:51], v[100:103], a[228:231], v[48:51]
 v_mfma_f32_16x16x32_bf16 v[52:55], v[96:99], a[216:219], v[52:55]
 v_mfma_f32_16x16x32_bf16 v[52:55], v[100:103], a[232:235], v[52:55]
 v_mfma_f32_16x16x32_bf16 v[56:59], v[96:99], a[220:223], v[56:59]
 ds_read_b64_tr_b16 v[116:117], v5 offset:36864
 ds_read_b64_tr_b16 v[118:119], v5 offset:38912
 v_mfma_f32_16x16x32_bf16 v[56:59], v[100:103], a[236:239], v[56:59]
 v_mfma_f32_16x16x32_bf16 v[60:63], v[96:99], a[224:227], v[60:63]
 v_mfma_f32_16x16x32_bf16 v[60:63], v[100:103], a[240:243], v[60:63]
 s_waitcnt vmcnt(0) lgkmcnt(4)
 s_waitcnt vmcnt(8)
 s_mov_b32 s85, 0
 v_cmp_eq_u32 vcc, 1, v15
 s_nop 0
 s_and_b32 s75, vcc_lo, 0xff
 s_andn2_b32 s75, s75, s85
 s_or_b32 s85, s85, s75
 s_cmp_eq_u32 s85, 0xff
 s_cbranch_scc0 L_late
 v_mfma_f32_16x16x32_bf16 v[64:67], v[104:107], a[212:215], v[64:67]
 ds_read_b64_tr_b16 v[96:97], v10 offset:0
 ds_read_b64_tr_b16 v[98:99], v10 offset:2048
 v_mfma_f32_16x16x32_bf16 v[64:67], v[108:111], a[228:231], v[64:67]
 v_mfma_f32_16x16x32_bf16 v[68:71], v[104:107], a[216:219], v[68:71]
 buffer_load_dwordx4 v[128:131], v20, s[64:67], s92 offen offset:0 sc1
 buffer_load_dwordx4 v[132:135], v20, s[64:67], s92 offen offset:1024 sc1
 v_mfma_f32_16x16x32_bf16 v[68:71], v[108:111], a[232:235], v[68:71]
 v_mfma_f32_16x16x32_bf16 v[72:75], v[104:107], a[220:223], v[72:75]
 ds_read_b64_tr_b16 v[100:101], v10 offset:4096
 ds_read_b64_tr_b16 v[102:103], v10 offset:6144
 v_mfma_f32_16x16x32_bf16 v[72:75], v[108:111], a[236:239], v[72:75]
 v_mfma_f32_16x16x32_bf16 v[76:79], v[104:107], a[224:227], v[76:79]
 s_add_u32 s92, s92, 8192
 buffer_load_dwordx4 v[136:139], v20, s[64:67], s92 offen offset:0 sc1
 buffer_load_dwordx4 v[140:143], v20, s[64:67], s92 offen offset:1024 sc1
 v_mfma_f32_16x16x32_bf16 v[76:79], v[108:111], a[240:243], v[76:79]
 s_waitcnt lgkmcnt(4)
 v_mfma_f32_16x16x32_bf16 v[80:83], v[112:115], a[212:215], v[80:83]
 ds_read_b64_tr_b16 v[104:105], v10 offset:8192
 ds_read_b64_tr_b16 v[106:107], v10 offset:10240
 v_mfma_f32_16x16x32_bf16 v[80:83], v[116:119], a[228:231], v[80:83]
 v_mfma_f32_16x16x32_bf16 v[84:87], v[112:115], a[216:219], v[84:87]
 s_add_u32 s92, s92, 8192
 buffer_load_dwordx4 v[144:147], v20, s[64:67], s92 offen offset:0 sc1
 buffer_load_dwordx4 v[148:151], v20, s[64:67], s92 offen offset:1024 sc1
 v_mfma_f32_16x16x32_bf16 v[84:87], v[116:119], a[232:235], v[84:87]
 v_mfma_f32_16x16x32_bf16 v[88:91], v[112:115], a[220:223], v[88:91]
 ds_read_b64_tr_b16 v[108:109], v10 offset:12288
 ds_read_b64_tr_b16 v[110:111], v10 offset:14336
 v_mfma_f32_16x16x32_bf16 v[88:91], v[116:119], a[236:239], v[88:91]
 v_mfma_f32_16x16x32_bf16 v[92:95], v[112:115], a[224:227], v[92:95]
 s_add_u32 s92, s92, 8192
 buffer_load_dwordx4 v[152:155], v20, s[64:67], s92 offen offset:0 sc1
 buffer_load_dwordx4 v[156:159], v20, s[64:67], s92 offen offset:1024 sc1
 v_mfma_f32_16x16x32_bf16 v[92:95], v[116:119], a[240:243], v[92:95]
 s_waitcnt lgkmcnt(4)
 s_barrier
 v_mfma_f32_16x16x32_bf16 v[32:35], v[96:99], a[0:3], v[32:35]
 ds_read_b64_tr_b16 v[112:113], v11 offset:0
 ds_read_b64_tr_b16 v[114:115], v11 offset:2048
 v_mfma_f32_16x16x32_bf16 v[32:35], v[100:103], a[16:19], v[32:35]
 v_mfma_f32_16x16x32_bf16 v[36:39], v[96:99], a[4:7], v[36:39]
 s_add_u32 s92, s92, 8192
 buffer_load_dwordx4 v[160:163], v20, s[64:67], s92 offen offset:0 sc1
 v_mfma_f32_16x16x32_bf16 v[36:39], v[100:103], a[20:23], v[36:39]
 v_mfma_f32_16x16x32_bf16 v[40:43], v[96:99], a[8:11], v[40:43]
 ds_read_b64_tr_b16 v[116:117], v11 offset:4096
 ds_read_b64_tr_b16 v[118:119], v11 offset:6144
 v_mfma_f32_16x16x32_bf16 v[40:43], v[100:103], a[24:27], v[40:43]
 v_mfma_f32_16x16x32_bf16 v[44:47], v[96:99], a[12:15], v[44:47]
 buffer_load_dwordx4 v[164:167], v20, s[64:67], s92 offen offset:1024 sc1
 v_mfma_f32_16x16x32_bf16 v[44:47], v[100:103], a[28:31], v[44:47]
 s_waitcnt lgkmcnt(4)
 v_mfma_f32_16x16x32_bf16 v[32:35], v[104:107], a[32:35], v[32:35]
 ds_read_b64_tr_b16 v[96:97], v11 offset:8192
 ds_read_b64_tr_b16 v[98:99], v11 offset:10240
 v_mfma_f32_16x16x32_bf16 v[32:35], v[108:111], a[48:51], v[32:35]
 v_mfma_f32_16x16x32_bf16 v[36:39], v[104:107], a[36:39], v[36:39]
 s_add_u32 s92, s92, 8192
 buffer_load_dwordx4 v[168:171], v20, s[64:67], s92 offen offset:0 sc1
 v_mfma_f32_16x16x32_bf16 v[36:39], v[108:111], a[52:55], v[36:39]
 v_mfma_f32_16x16x32_bf16 v[40:43], v[104:107], a[40:43], v[40:43]
 ds_read_b64_tr_b16 v[100:101], v11 offset:12288
 ds_read_b64_tr_b16 v[102:103], v11 offset:14336
 v_mfma_f32_16x16x32_bf16 v[40:43], v[108:111], a[56:59], v[40:43]
 v_mfma_f32_16x16x32_bf16 v[44:47], v[104:107], a[44:47], v[44:47]
 buffer_load_dwordx4 v[172:175], v20, s[64:67], s92 offen offset:1024 sc1
 v_mfma_f32_16x16x32_bf16 v[44:47], v[108:111], a[60:63], v[44:47]
 s_waitcnt lgkmcnt(4)
 v_mfma_f32_16x16x32_bf16 v[48:51], v[112:115], a[0:3], v[48:51]
 ds_read_b64_tr_b16 v[104:105], v12 offset:0
 ds_read_b64_tr_b16 v[106:107], v12 offset:2048
 v_mfma_f32_16x16x32_bf16 v[48:51], v[116:119], a[16:19], v[48:51]
 v_mfma_f32_16x16x32_bf16 v[52:55], v[112:115], a[4:7], v[52:55]
 s_add_u32 s92, s92, 8192
 buffer_load_dwordx4 v[176:179], v20, s[64:67], s92 offen offset:0 sc1
 v_mfma_f32_16x16x32_bf16 v[52:55], v[116:119], a[20:23], v[52:55]
 v_mfma_f32_16x16x32_bf16 v[56:59], v[112:115], a[8:11], v[56:59]
 ds_read_b64_tr_b16 v[108:109], v12 offset:4096
 ds_read_b64_tr_b16 v[110:111], v12 offset:6144
 v_mfma_f32_16x16x32_bf16 v[56:59], v[116:119], a[24:27], v[56:59]
 v_mfma_f32_16x16x32_bf16 v[60:63], v[112:115], a[12:15], v[60:63]
 buffer_load_dwordx4 v[180:183], v20, s[64:67], s92 offen offset:1024 sc1
 ds_write_b128 v17, v[32:35] offset:0
 v_mfma_f32_16x16x32_bf16 v[60:63], v[116:119], a[28:31], v[60:63]
 s_waitcnt lgkmcnt(5)
 v_mfma_f32_16x16x32_bf16 v[48:51], v[96:99], a[32:35], v[48:51]
 ds_read_b64_tr_b16 v[112:113], v12 offset:8192
 ds_read_b64_tr_b16 v[114:115], v12 offset:10240
 v_mfma_f32_16x16x32_bf16 v[48:51], v[100:103], a[48:51], v[48:51]
 v_mfma_f32_16x16x32_bf16 v[52:55], v[96:99], a[36:39], v[52:55]
 s_add_u32 s92, s92, 8192
 buffer_load_dwordx4 v[184:187], v20, s[64:67], s92 offen offset:0 sc1
 ds_write_b128 v17, v[36:39] offset:16384
 v_mfma_f32_16x16x32_bf16 v[52:55], v[100:103], a[52:55], v[52:55]
 v_mfma_f32_16x16x32_bf16 v[56:59], v[96:99], a[40:43], v[56:59]
 ds_read_b64_tr_b16 v[116:117], v12 offset:12288
 ds_read_b64_tr_b16 v[118:119], v12 offset:14336
 v_mfma_f32_16x16x32_bf16 v[56:59], v[100:103], a[56:59], v[56:59]
 v_mfma_f32_16x16x32_bf16 v[60:63], v[96:99], a[44:47], v[60:63]
 buffer_load_dwordx4 v[188:191], v20, s[64:67], s92 offen offset:1024 sc1
 ds_write_b128 v19, v[40:43] offset:0
 v_mfma_f32_16x16x32_bf16 v[60:63], v[100:103], a[60:63], v[60:63]
 s_waitcnt lgkmcnt(7)
 v_mfma_f32_16x16x32_bf16 v[64:67], v[104:107], a[0:3], v[64:67]
 ds_read_b64_tr_b16 v[96:97], v13 offset:0
 ds_read_b64_tr_b16 v[98:99], v13 offset:2048
 v_mfma_f32_16x16x32_bf16 v[64:67], v[108:111], a[16:19], v[64:67]
 v_mfma_f32_16x16x32_bf16 v[68:71], v[104:107], a[4:7], v[68:71]
 ds_write_b128 v19, v[44:47] offset:16384
 v_mfma_f32_16x16x32_bf16 v[68:71], v[108:111], a[20:23], v[68:71]
 v_mfma_f32_16x16x32_bf16 v[72:75], v[104:107], a[8:11], v[72:75]
 ds_read_b64_tr_b16 v[100:101], v13 offset:4096
 ds_read_b64_tr_b16 v[102:103], v13 offset:6144
 v_mfma_f32_16x16x32_bf16 v[72:75], v[108:111], a[24:27], v[72:75]
 v_mfma_f32_16x16x32_bf16 v[76:79], v[104:107], a[12:15], v[76:79]
 ds_write_b128 v17, v[48:51] offset:1024
 v_mfma_f32_16x16x32_bf16 v[76:79], v[108:111], a[28:31], v[76:79]
 s_waitcnt lgkmcnt(7)
 v_mfma_f32_16x16x32_bf16 v[64:67], v[112:115], a[32:35], v[64:67]
 ds_read_b64_tr_b16 v[104:105], v13 offset:8192
 ds_read_b64_tr_b16 v[106:107], v13 offset:10240
 v_mfma_f32_16x16x32_bf16 v[64:67], v[116:119], a[48:51], v[64:67]
 v_mfma_f32_16x16x32_bf16 v[68:71], v[112:115], a[36:39], v[68:71]
 ds_write_b128 v17, v[52:55] offset:17408
 v_mfma_f32_16x16x32_bf16 v[68:71], v[116:119], a[52:55], v[68:71]
 v_mfma_f32_16x16x32_bf16 v[72:75], v[112:115], a[40:43], v[72:75]
 ds_read_b64_tr_b16 v[108:109], v13 offset:12288
 ds_read_b64_tr_b16 v[110:111], v13 offset:14336
 v_mfma_f32_16x16x32_bf16 v[72:75], v[116:119], a[56:59], v[72:75]
 v_mfma_f32_16x16x32_bf16 v[76:79], v[112:115], a[44:47], v[76:79]
 ds_write_b128 v19, v[56:59] offset:1024
 v_mfma_f32_16x16x32_bf16 v[76:79], v[116:119], a[60:63], v[76:79]
 s_waitcnt lgkmcnt(7)
 v_mfma_f32_16x16x32_bf16 v[80:83], v[96:99], a[0:3], v[80:83]
 v_mfma_f32_16x16x32_bf16 v[80:83], v[100:103], a[16:19], v[80:83]
 v_mfma_f32_16x16x32_bf16 v[84:87], v[96:99], a[4:7], v[84:87]
 ds_write_b128 v19, v[60:63] offset:17408
 v_mfma_f32_16x16x32_bf16 v[84:87], v[100:103], a[20:23], v[84:87]
 v_mfma_f32_16x16x32_bf16 v[88:91], v[96:99], a[8:11], v[88:91]
 v_mfma_f32_16x16x32_bf16 v[88:91], v[100:103], a[24:27], v[88:91]
 v_mfma_f32_16x16x32_bf16 v[92:95], v[96:99], a[12:15], v[92:95]
 ds_write_b128 v17, v[64:67] offset:2048
 v_mfma_f32_16x16x32_bf16 v[92:95], v[100:103], a[28:31], v[92:95]
 s_waitcnt lgkmcnt(3)
 v_mfma_f32_16x16x32_bf16 v[80:83], v[104:107], a[32:35], v[80:83]
 v_mfma_f32_16x16x32_bf16 v[80:83], v[108:111], a[48:51], v[80:83]
 v_mfma_f32_16x16x32_bf16 v[84:87], v[104:107], a[36:39], v[84:87]
 ds_write_b128 v17, v[68:71] offset:18432
 v_mfma_f32_16x16x32_bf16 v[84:87], v[108:111], a[52:55], v[84:87]
 v_mfma_f32_16x16x32_bf16 v[88:91], v[104:107], a[40:43], v[88:91]
 v_mfma_f32_16x16x32_bf16 v[88:91], v[108:111], a[56:59], v[88:91]
 v_mfma_f32_16x16x32_bf16 v[92:95], v[104:107], a[44:47], v[92:95]
 ds_write_b128 v19, v[72:75] offset:2048
 v_mfma_f32_16x16x32_bf16 v[92:95], v[108:111], a[60:63], v[92:95]
 v_sub_u32 v123, v124, v122
 v_mov_b32 v124, 0
 v_mov_b32 v125, 0
 s_lshl_b32 s88, s76, 14
 s_cmp_ge_u32 s76, 2
 s_cselect_b32 s89, 32768, 0
 s_add_u32 s88, s88, 65536
 s_add_u32 s88, s88, s89
 v_add_u32 v18, s88, v20
 v_mfma_f32_16x16x32_bf16 v[208:211], v[122:125], v[24:27], 0
 ds_write_b128 v19, v[76:79] offset:18432
 v_mfma_f32_16x16x32_bf16 v[212:215], v[120:123], v[24:27], 0
 ds_write_b128 v17, v[80:83] offset:3072
 v_mfma_f32_16x16x32_bf16 v[216:219], v[122:125], a[244:247], 0
 ds_write_b128 v17, v[84:87] offset:19456
 v_mfma_f32_16x16x32_bf16 v[220:223], v[120:123], a[244:247], 0
 s_waitcnt vmcnt(14)
 ds_write_b128 v19, v[88:91] offset:3072
 v_mfma_f32_16x16x32_bf16 v[192:195], v[122:125], v[128:131], v[192:195]
 ds_write_b128 v19, v[92:95] offset:19456
 v_mfma_f32_16x16x32_bf16 v[196:199], v[120:123], v[128:131], v[196:199]
 v_mfma_f32_16x16x32_bf16 v[200:203], v[122:125], v[132:135], v[200:203]
 v_mfma_f32_16x16x32_bf16 v[204:207], v[120:123], v[132:135], v[204:207]
 s_waitcnt vmcnt(12)
 v_mfma_f32_16x16x32_bf16 v[192:195], v[122:125], v[136:139], v[192:195]
 v_mfma_f32_16x16x32_bf16 v[196:199], v[120:123], v[136:139], v[196:199]
 v_mfma_f32_16x16x32_bf16 v[200:203], v[122:125], v[140:143], v[200:203]
 v_mfma_f32_16x16x32_bf16 v[204:207], v[120:123], v[140:143], v[204:207]
 s_waitcnt vmcnt(10)
 v_mfma_f32_16x16x32_bf16 v[192:195], v[122:125], v[144:147], v[192:195]
 v_mfma_f32_16x16x32_bf16 v[196:199], v[120:123], v[144:147], v[196:199]
 v_mfma_f32_16x16x32_bf16 v[200:203], v[122:125], v[148:151], v[200:203]
 v_mfma_f32_16x16x32_bf16 v[204:207], v[120:123], v[148:151], v[204:207]
 s_waitcnt vmcnt(8)
 v_mfma_f32_16x16x32_bf16 v[192:195], v[122:125], v[152:155], v[192:195]
 s_waitcnt lgkmcnt(0)
 s_barrier
 v_mfma_f32_16x16x32_bf16 v[196:199], v[120:123], v[152:155], v[196:199]
 ds_read_b128 v[32:35], v18 offset:0
 ds_read_b128 v[36:39], v18 offset:1024
 v_mfma_f32_16x16x32_bf16 v[200:203], v[122:125], v[156:159], v[200:203]
 ds_read_b128 v[40:43], v18 offset:2048
 ds_read_b128 v[44:47], v18 offset:3072
 v_mfma_f32_16x16x32_bf16 v[204:207], v[120:123], v[156:159], v[204:207]
 s_waitcnt vmcnt(6)
 v_mfma_f32_16x16x32_bf16 v[192:195], v[122:125], v[160:163], v[192:195]
 ds_read_b128 v[48:51], v18 offset:4096
 ds_read_b128 v[52:55], v18 offset:5120
 v_mfma_f32_16x16x32_bf16 v[196:199], v[120:123], v[160:163], v[196:199]
 ds_read_b128 v[56:59], v18 offset:6144
 ds_read_b128 v[60:63], v18 offset:7168
 v_mfma_f32_16x16x32_bf16 v[200:203], v[122:125], v[164:167], v[200:203]
 ds_read_b128 v[64:67], v18 offset:8192
 ds_read_b128 v[68:71], v18 offset:9216
 v_mfma_f32_16x16x32_bf16 v[204:207], v[120:123], v[164:167], v[204:207]
 s_waitcnt vmcnt(4)
 v_mfma_f32_16x16x32_bf16 v[192:195], v[122:125], v[168:171], v[192:195]
 ds_read_b128 v[72:75], v18 offset:10240
 ds_read_b128 v[76:79], v18 offset:11264
 v_mfma_f32_16x16x32_bf16 v[196:199], v[120:123], v[168:171], v[196:199]
 ds_read_b128 v[80:83], v18 offset:12288
 ds_read_b128 v[84:87], v18 offset:13312
 v_mfma_f32_16x16x32_bf16 v[200:203], v[122:125], v[172:175], v[200:203]
 ds_read_b128 v[88:91], v18 offset:14336
 ds_read_b128 v[92:95], v18 offset:15360
 v_mfma_f32_16x16x32_bf16 v[204:207], v[120:123], v[172:175], v[204:207]
 s_waitcnt vmcnt(2)
 v_mfma_f32_16x16x32_bf16 v[192:195], v[122:125], v[176:179], v[192:195]
 v_mfma_f32_16x16x32_bf16 v[196:199], v[120:123], v[176:179], v[196:199]
 v_mfma_f32_16x16x32_bf16 v[200:203], v[122:125], v[180:183], v[200:203]
 v_mfma_f32_16x16x32_bf16 v[204:207], v[120:123], v[180:183], v[204:207]
 s_waitcnt vmcnt(0)
 v_mfma_f32_16x16x32_bf16 v[192:195], v[122:125], v[184:187], v[192:195]
 v_mfma_f32_16x16x32_bf16 v[196:199], v[120:123], v[184:187], v[196:199]
L_pg17:
 s_cbranch_execz L_site2
 v_mfma_f32_16x16x32_bf16 v[200:203], v[122:125], v[188:191], v[200:203]
 v_mfma_f32_16x16x32_bf16 v[204:207], v[120:123], v[188:191], v[204:207]
 s_waitcnt lgkmcnt(0)
 v_pk_add_f32 v[32:33], v[32:33], v[48:49]
 v_pk_add_f32 v[34:35], v[34:35], v[50:51]
 v_pk_add_f32 v[36:37], v[36:37], v[52:53]
 v_pk_add_f32 v[38:39], v[38:39], v[54:55]
 v_pk_add_f32 v[40:41], v[40:41], v[56:57]
 v_pk_add_f32 v[42:43], v[42:43], v[58:59]
 v_pk_add_f32 v[44:45], v[44:45], v[60:61]
 v_pk_add_f32 v[46:47], v[46:47], v[62:63]
 v_pk_add_f32 v[64:65], v[64:65], v[80:81]
 v_pk_add_f32 v[66:67], v[66:67], v[82:83]
 v_pk_add_f32 v[68:69], v[68:69], v[84:85]
 v_pk_add_f32 v[70:71], v[70:71], v[86:87]
 v_pk_add_f32 v[72:73], v[72:73], v[88:89]
 v_pk_add_f32 v[74:75], v[74:75], v[90:91]
 v_pk_add_f32 v[76:77], v[76:77], v[92:93]
 v_pk_add_f32 v[78:79], v[78:79], v[94:95]
 v_mov_b32 v96, 0xbfb8aa3b
 v_pk_add_f32 v[32:33], v[32:33], v[64:65]
 v_pk_add_f32 v[34:35], v[34:35], v[66:67]
 v_pk_add_f32 v[36:37], v[36:37], v[68:69]
 v_pk_add_f32 v[38:39], v[38:39], v[70:71]
 v_pk_add_f32 v[40:41], v[40:41], v[72:73]
 v_pk_add_f32 v[42:43], v[42:43], v[74:75]
 v_pk_add_f32 v[44:45], v[44:45], v[76:77]
 v_pk_add_f32 v[46:47], v[46:47], v[78:79]
 v_pk_mul_f32 v[48:49], v[32:33], v[96:97] op_sel_hi:[1,0]
 v_pk_mul_f32 v[50:51], v[34:35], v[96:97] op_sel_hi:[1,0]
 v_pk_mul_f32 v[52:53], v[36:37], v[96:97] op_sel_hi:[1,0]
 v_pk_mul_f32 v[54:55], v[38:39], v[96:97] op_sel_hi:[1,0]
 v_pk_mul_f32 v[56:57], v[40:41], v[96:97] op_sel_hi:[1,0]
 v_pk_mul_f32 v[58:59], v[42:43], v[96:97] op_sel_hi:[1,0]
 v_pk_mul_f32 v[60:61], v[44:45], v[96:97] op_sel_hi:[1,0]
 v_pk_mul_f32 v[62:63], v[46:47], v[96:97] op_sel_hi:[1,0]
 v_exp_f32 v48, v48
 v_exp_f32 v49, v49
 v_exp_f32 v50, v50
 v_exp_f32 v51, v51
 v_exp_f32 v52, v52
 v_exp_f32 v53, v53
 v_exp_f32 v54, v54
 v_exp_f32 v55, v55
 v_exp_f32 v56, v56
 v_exp_f32 v57, v57
 v_exp_f32 v58, v58
 v_exp_f32 v59, v59
 v_exp_f32 v60, v60
 v_exp_f32 v61, v61
 v_exp_f32 v62, v62
 v_exp_f32 v63, v63
 s_nop 0
 v_pk_add_f32 v[48:49], v[48:49], 1.0 op_sel_hi:[1,0]
 v_pk_add_f32 v[50:51], v[50:51], 1.0 op_sel_hi:[1,0]
 v_pk_add_f32 v[52:53], v[52:53], 1.0 op_sel_hi:[1,0]
 v_pk_add_f32 v[54:55], v[54:55], 1.0 op_sel_hi:[1,0]
 v_pk_add_f32 v[56:57], v[56:57], 1.0 op_sel_hi:[1,0]
 v_pk_add_f32 v[58:59], v[58:59], 1.0 op_sel_hi:[1,0]
 v_pk_add_f32 v[60:61], v[60:61], 1.0 op_sel_hi:[1,0]
 v_pk_add_f32 v[62:63], v[62:63], 1.0 op_sel_hi:[1,0]
 v_rcp_f32 v48, v48
 v_rcp_f32 v49, v49
 v_rcp_f32 v50, v50
 v_rcp_f32 v51, v51
 v_rcp_f32 v52, v52
 v_rcp_f32 v53, v53
 v_rcp_f32 v54, v54
 v_rcp_f32 v55, v55
 v_rcp_f32 v56, v56
 v_rcp_f32 v57, v57
 v_rcp_f32 v58, v58
 v_rcp_f32 v59, v59
 v_rcp_f32 v60, v60
 v_rcp_f32 v61, v61
 v_rcp_f32 v62, v62
 v_rcp_f32 v63, v63
 s_nop 0
 v_pk_mul_f32 v[32:33], v[32:33], v[48:49]
 v_pk_mul_f32 v[34:35], v[34:35], v[50:51]
 v_pk_mul_f32 v[36:37], v[36:37], v[52:53]
 v_pk_mul_f32 v[38:39], v[38:39], v[54:55]
 v_pk_mul_f32 v[40:41], v[40:41], v[56:57]
 v_pk_mul_f32 v[42:43], v[42:43], v[58:59]
 v_pk_mul_f32 v[44:45], v[44:45], v[60:61]
 v_pk_mul_f32 v[46:47], v[46:47], v[62:63]
 v_pk_fma_f32 v[192:193], v[192:193], v[32:33], v[208:209]
 v_pk_fma_f32 v[194:195], v[194:195], v[34:35], v[210:211]
 v_cvt_pk_bf16_f32 v96, v192, v193
 v_cvt_pk_bf16_f32 v97, v194, v195
 buffer_store_dwordx2 v[96:97], v22, s[60:63], s73 offen offset:0
 v_pk_fma_f32 v[196:197], v[196:197], v[36:37], v[212:213]
 v_pk_fma_f32 v[198:199], v[198:199], v[38:39], v[214:215]
 v_cvt_pk_bf16_f32 v98, v196, v197
 v_cvt_pk_bf16_f32 v99, v198, v199
 buffer_store_dwordx2 v[98:99], v22, s[60:63], s73 offen offset:32
 v_pk_fma_f32 v[200:201], v[200:201], v[40:41], v[216:217]
 v_pk_fma_f32 v[202:203], v[202:203], v[42:43], v[218:219]
 v_cvt_pk_bf16_f32 v100, v200, v201
 v_cvt_pk_bf16_f32 v101, v202, v203
 buffer_store_dwordx2 v[100:101], v22, s[60:63], s73 offen offset:64
 v_pk_fma_f32 v[204:205], v[204:205], v[44:45], v[220:221]
 v_pk_fma_f32 v[206:207], v[206:207], v[46:47], v[222:223]
 v_cvt_pk_bf16_f32 v102, v204, v205
 v_cvt_pk_bf16_f32 v103, v206, v207
 buffer_store_dwordx2 v[102:103], v22, s[60:63], s73 offen offset:96
 s_endpgm
L_late:
 v_mfma_f32_16x16x32_bf16 v[64:67], v[104:107], a[212:215], v[64:67]
 ds_read_b64_tr_b16 v[96:97], v10 offset:0
 ds_read_b64_tr_b16 v[98:99], v10 offset:2048
 v_mfma_f32_16x16x32_bf16 v[64:67], v[108:111], a[228:231], v[64:67]
 v_mfma_f32_16x16x32_bf16 v[68:71], v[104:107], a[216:219], v[68:71]
 s_bitcmp1_b32 s75, 0
 s_cbranch_scc0 L_ia0
 s_add_u32 s88, s92, 0
 buffer_load_dwordx4 v[128:131], v20, s[64:67], s88 offen offset:0 sc1
 buffer_load_dwordx4 v[132:135], v20, s[64:67], s88 offen offset:1024 sc1
L_ia0:
 s_bitcmp1_b32 s75, 1
 s_cbranch_scc0 L_ia1
 s_add_u32 s88, s92, 8192
 buffer_load_dwordx4 v[136:139], v20, s[64:67], s88 offen offset:0 sc1
 buffer_load_dwordx4 v[140:143], v20, s[64:67], s88 offen offset:1024 sc1
L_ia1:
 s_bitcmp1_b32 s75, 2
 s_cbranch_scc0 L_ia2
 s_add_u32 s88, s92, 16384
 buffer_load_dwordx4 v[144:147], v20, s[64:67], s88 offen offset:0 sc1
 buffer_load_dwordx4 v[148:151], v20, s[64:67], s88 offen offset:1024 sc1
L_ia2:
 s_bitcmp1_b32 s75, 3
 s_cbranch_scc0 L_ia3
 s_add_u32 s88, s92, 24576
 buffer_load_dwordx4 v[152:155], v20, s[64:67], s88 offen offset:0 sc1
 buffer_load_dwordx4 v[156:159], v20, s[64:67], s88 offen offset:1024 sc1
L_ia3:
 v_mfma_f32_16x16x32_bf16 v[68:71], v[108:111], a[232:235], v[68:71]
 v_mfma_f32_16x16x32_bf16 v[72:75], v[104:107], a[220:223], v[72:75]
 ds_read_b64_tr_b16 v[100:101], v10 offset:4096
 ds_read_b64_tr_b16 v[102:103], v10 offset:6144
 v_mfma_f32_16x16x32_bf16 v[72:75], v[108:111], a[236:239], v[72:75]
 v_mfma_f32_16x16x32_bf16 v[76:79], v[104:107], a[224:227], v[76:79]
 v_mfma_f32_16x16x32_bf16 v[76:79], v[108:111], a[240:243], v[76:79]
 s_waitcnt lgkmcnt(4)
 v_mfma_f32_16x16x32_bf16 v[80:83], v[112:115], a[212:215], v[80:83]
 ds_read_b64_tr_b16 v[104:105], v10 offset:8192
 ds_read_b64_tr_b16 v[106:107], v10 offset:10240
 v_mfma_f32_16x16x32_bf16 v[80:83], v[116:119], a[228:231], v[80:83]
 v_mfma_f32_16x16x32_bf16 v[84:87], v[112:115], a[216:219], v[84:87]
 v_mfma_f32_16x16x32_bf16 v[84:87], v[116:119], a[232:235], v[84:87]
 v_mfma_f32_16x16x32_bf16 v[88:91], v[112:115], a[220:223], v[88:91]
 ds_read_b64_tr_b16 v[108:109], v10 offset:12288
 ds_read_b64_tr_b16 v[110:111], v10 offset:14336
 v_mfma_f32_16x16x32_bf16 v[88:91], v[116:119], a[236:239], v[88:91]
 v_mfma_f32_16x16x32_bf16 v[92:95], v[112:115], a[224:227], v[92:95]
 v_mfma_f32_16x16x32_bf16 v[92:95], v[116:119], a[240:243], v[92:95]
 s_waitcnt lgkmcnt(4)
 s_barrier
 v_mfma_f32_16x16x32_bf16 v[32:35], v[96:99], a[0:3], v[32:35]
 ds_read_b64_tr_b16 v[112:113], v11 offset:0
 ds_read_b64_tr_b16 v[114:115], v11 offset:2048
 v_mfma_f32_16x16x32_bf16 v[32:35], v[100:103], a[16:19], v[32:35]
 v_mfma_f32_16x16x32_bf16 v[36:39], v[96:99], a[4:7], v[36:39]
 v_mfma_f32_16x16x32_bf16 v[36:39], v[100:103], a[20:23], v[36:39]
 v_mfma_f32_16x16x32_bf16 v[40:43], v[96:99], a[8:11], v[40:43]
 ds_read_b64_tr_b16 v[116:117], v11 offset:4096
 ds_read_b64_tr_b16 v[118:119], v11 offset:6144
 v_mfma_f32_16x16x32_bf16 v[40:43], v[100:103], a[24:27], v[40:43]
 v_mfma_f32_16x16x32_bf16 v[44:47], v[96:99], a[12:15], v[44:47]
 v_mfma_f32_16x16x32_bf16 v[44:47], v[100:103], a[28:31], v[44:47]
 s_waitcnt lgkmcnt(4)
 v_mfma_f32_16x16x32_bf16 v[32:35], v[104:107], a[32:35], v[32:35]
 ds_read_b64_tr_b16 v[96:97], v11 offset:8192
 ds_read_b64_tr_b16 v[98:99], v11 offset:10240
 v_mfma_f32_16x16x32_bf16 v[32:35], v[108:111], a[48:51], v[32:35]
 v_mfma_f32_16x16x32_bf16 v[36:39], v[104:107], a[36:39], v[36:39]
 v_mfma_f32_16x16x32_bf16 v[36:39], v[108:111], a[52:55], v[36:39]
 v_mfma_f32_16x16x32_bf16 v[40:43], v[104:107], a[40:43], v[40:43]
 ds_read_b64_tr_b16 v[100:101], v11 offset:12288
 ds_read_b64_tr_b16 v[102:103], v11 offset:14336
 v_mfma_f32_16x16x32_bf16 v[40:43], v[108:111], a[56:59], v[40:43]
 v_mfma_f32_16x16x32_bf16 v[44:47], v[104:107], a[44:47], v[44:47]
 v_mfma_f32_16x16x32_bf16 v[44:47], v[108:111], a[60:63], v[44:47]
 s_waitcnt lgkmcnt(4)
 v_mfma_f32_16x16x32_bf16 v[48:51], v[112:115], a[0:3], v[48:51]
 ds_read_b64_tr_b16 v[104:105], v12 offset:0
 ds_read_b64_tr_b16 v[106:107], v12 offset:2048
 v_mfma_f32_16x16x32_bf16 v[48:51], v[116:119], a[16:19], v[48:51]
 v_mfma_f32_16x16x32_bf16 v[52:55], v[112:115], a[4:7], v[52:55]
 s_bitcmp1_b32 s75, 4
 s_cbranch_scc0 L_ia4
 s_add_u32 s88, s92, 32768
 buffer_load_dwordx4 v[160:163], v20, s[64:67], s88 offen offset:0 sc1
 buffer_load_dwordx4 v[164:167], v20, s[64:67], s88 offen offset:1024 sc1
L_ia4:
 s_bitcmp1_b32 s75, 5
 s_cbranch_scc0 L_ia5
 s_add_u32 s88, s92, 40960
 buffer_load_dwordx4 v[168:171], v20, s[64:67], s88 offen offset:0 sc1
 buffer_load_dwordx4 v[172:175], v20, s[64:67], s88 offen offset:1024 sc1
L_ia5:
 s_bitcmp1_b32 s75, 6
 s_cbranch_scc0 L_ia6
 s_add_u32 s88, s92, 49152
 buffer_load_dwordx4 v[176:179], v20, s[64:67], s88 offen offset:0 sc1
 buffer_load_dwordx4 v[180:183], v20, s[64:67], s88 offen offset:1024 sc1
L_ia6:
 s_bitcmp1_b32 s75, 7
 s_cbranch_scc0 L_ia7
 s_add_u32 s88, s92, 57344
 buffer_load_dwordx4 v[184:187], v20, s[64:67], s88 offen offset:0 sc1
 buffer_load_dwordx4 v[188:191], v20, s[64:67], s88 offen offset:1024 sc1
L_ia7:
 v_mfma_f32_16x16x32_bf16 v[52:55], v[116:119], a[20:23], v[52:55]
 v_mfma_f32_16x16x32_bf16 v[56:59], v[112:115], a[8:11], v[56:59]
 ds_read_b64_tr_b16 v[108:109], v12 offset:4096
 ds_read_b64_tr_b16 v[110:111], v12 offset:6144
 v_mfma_f32_16x16x32_bf16 v[56:59], v[116:119], a[24:27], v[56:59]
 v_mfma_f32_16x16x32_bf16 v[60:63], v[112:115], a[12:15], v[60:63]
 ds_write_b128 v17, v[32:35] offset:0
 v_mfma_f32_16x16x32_bf16 v[60:63], v[116:119], a[28:31], v[60:63]
 s_waitcnt lgkmcnt(5)
 v_mfma_f32_16x16x32_bf16 v[48:51], v[96:99], a[32:35], v[48:51]
 ds_read_b64_tr_b16 v[112:113], v12 offset:8192
 ds_read_b64_tr_b16 v[114:115], v12 offset:10240
 v_mfma_f32_16x16x32_bf16 v[48:51], v[100:103], a[48:51], v[48:51]
 v_mfma_f32_16x16x32_bf16 v[52:55], v[96:99], a[36:39], v[52:55]
 ds_write_b128 v17, v[36:39] offset:16384
 v_mfma_f32_16x16x32_bf16 v[52:55], v[100:103], a[52:55], v[52:55]
 v_mfma_f32_16x16x32_bf16 v[56:59], v[96:99], a[40:43], v[56:59]
 ds_read_b64_tr_b16 v[116:117], v12 offset:12288
 ds_read_b64_tr_b16 v[118:119], v12 offset:14336
 v_mfma_f32_16x16x32_bf16 v[56:59], v[100:103], a[56:59], v[56:59]
 v_mfma_f32_16x16x32_bf16 v[60:63], v[96:99], a[44:47], v[60:63]
 ds_write_b128 v19, v[40:43] offset:0
 v_mfma_f32_16x16x32_bf16 v[60:63], v[100:103], a[60:63], v[60:63]
 s_waitcnt lgkmcnt(7)
 v_mfma_f32_16x16x32_bf16 v[64:67], v[104:107], a[0:3], v[64:67]
 ds_read_b64_tr_b16 v[96:97], v13 offset:0
 ds_read_b64_tr_b16 v[98:99], v13 offset:2048
 v_mfma_f32_16x16x32_bf16 v[64:67], v[108:111], a[16:19], v[64:67]
 v_mfma_f32_16x16x32_bf16 v[68:71], v[104:107], a[4:7], v[68:71]
 buffer_load_dword v15, v14, s[64:67], s86 offen sc1
 ds_write_b128 v19, v[44:47] offset:16384
 v_mfma_f32_16x16x32_bf16 v[68:71], v[108:111], a[20:23], v[68:71]
 v_mfma_f32_16x16x32_bf16 v[72:75], v[104:107], a[8:11], v[72:75]
 ds_read_b64_tr_b16 v[100:101], v13 offset:4096
 ds_read_b64_tr_b16 v[102:103], v13 offset:6144
 v_mfma_f32_16x16x32_bf16 v[72:75], v[108:111], a[24:27], v[72:75]
 v_mfma_f32_16x16x32_bf16 v[76:79], v[104:107], a[12:15], v[76:79]
 ds_write_b128 v17, v[48:51] offset:1024
 v_mfma_f32_16x16x32_bf16 v[76:79], v[108:111], a[28:31], v[76:79]
 s_waitcnt lgkmcnt(7)
 v_mfma_f32_16x16x32_bf16 v[64:67], v[112:115], a[32:35], v[64:67]
 ds_read_b64_tr_b16 v[104:105], v13 offset:8192
 ds_read_b64_tr_b16 v[106:107], v13 offset:10240
 v_mfma_f32_16x16x32_bf16 v[64:67], v[116:119], a[48:51], v[64:67]
 v_mfma_f32_16x16x32_bf16 v[68:71], v[112:115], a[36:39], v[68:71]
 ds_write_b128 v17, v[52:55] offset:17408
 v_mfma_f32_16x16x32_bf16 v[68:71], v[116:119], a[52:55], v[68:71]
 v_mfma_f32_16x16x32_bf16 v[72:75], v[112:115], a[40:43], v[72:75]
 ds_read_b64_tr_b16 v[108:109], v13 offset:12288
 ds_read_b64_tr_b16 v[110:111], v13 offset:14336
 v_mfma_f32_16x16x32_bf16 v[72:75], v[116:119], a[56:59], v[72:75]
 v_mfma_f32_16x16x32_bf16 v[76:79], v[112:115], a[44:47], v[76:79]
 ds_write_b128 v19, v[56:59] offset:1024
 v_mfma_f32_16x16x32_bf16 v[76:79], v[116:119], a[60:63], v[76:79]
 s_waitcnt lgkmcnt(7)
 v_mfma_f32_16x16x32_bf16 v[80:83], v[96:99], a[0:3], v[80:83]
 v_mfma_f32_16x16x32_bf16 v[80:83], v[100:103], a[16:19], v[80:83]
 v_mfma_f32_16x16x32_bf16 v[84:87], v[96:99], a[4:7], v[84:87]
 ds_write_b128 v19, v[60:63] offset:17408
 v_mfma_f32_16x16x32_bf16 v[84:87], v[100:103], a[20:23], v[84:87]
 v_mfma_f32_16x16x32_bf16 v[88:91], v[96:99], a[8:11], v[88:91]
 v_mfma_f32_16x16x32_bf16 v[88:91], v[100:103], a[24:27], v[88:91]
 v_mfma_f32_16x16x32_bf16 v[92:95], v[96:99], a[12:15], v[92:95]
 ds_write_b128 v17, v[64:67] offset:2048
 v_mfma_f32_16x16x32_bf16 v[92:95], v[100:103], a[28:31], v[92:95]
 s_waitcnt lgkmcnt(3)
 v_mfma_f32_16x16x32_bf16 v[80:83], v[104:107], a[32:35], v[80:83]
 v_mfma_f32_16x16x32_bf16 v[80:83], v[108:111], a[48:51], v[80:83]
 v_mfma_f32_16x16x32_bf16 v[84:87], v[104:107], a[36:39], v[84:87]
 ds_write_b128 v17, v[68:71] offset:18432
 v_mfma_f32_16x16x32_bf16 v[84:87], v[108:111], a[52:55], v[84:87]
 v_mfma_f32_16x16x32_bf16 v[88:91], v[104:107], a[40:43], v[88:91]
 v_mfma_f32_16x16x32_bf16 v[88:91], v[108:111], a[56:59], v[88:91]
 v_mfma_f32_16x16x32_bf16 v[92:95], v[104:107], a[44:47], v[92:95]
 ds_write_b128 v19, v[72:75] offset:2048
 v_mfma_f32_16x16x32_bf16 v[92:95], v[108:111], a[60:63], v[92:95]
 v_sub_u32 v123, v124, v122
 v_mov_b32 v124, 0
 v_mov_b32 v125, 0
 s_lshl_b32 s88, s76, 14
 s_cmp_ge_u32 s76, 2
 s_cselect_b32 s89, 32768, 0
 s_add_u32 s88, s88, 65536
 s_add_u32 s88, s88, s89
 v_add_u32 v18, s88, v20
 v_mfma_f32_16x16x32_bf16 v[208:211], v[122:125], v[24:27], 0
 ds_write_b128 v19, v[76:79] offset:18432
 v_mfma_f32_16x16x32_bf16 v[212:215], v[120:123], v[24:27], 0
 ds_write_b128 v17, v[80:83] offset:3072
 v_mfma_f32_16x16x32_bf16 v[216:219], v[122:125], a[244:247], 0
 ds_write_b128 v17, v[84:87] offset:19456
 v_mfma_f32_16x16x32_bf16 v[220:223], v[120:123], a[244:247], 0
 ds_write_b128 v19, v[88:91] offset:3072
 ds_write_b128 v19, v[92:95] offset:19456
 s_waitcnt vmcnt(0)
 s_bitcmp1_b32 s75, 0
 s_cbranch_scc0 L_sa0
 v_mfma_f32_16x16x32_bf16 v[192:195], v[122:125], v[128:131], v[192:195]
 v_mfma_f32_16x16x32_bf16 v[196:199], v[120:123], v[128:131], v[196:199]
 v_mfma_f32_16x16x32_bf16 v[200:203], v[122:125], v[132:135], v[200:203]
 v_mfma_f32_16x16x32_bf16 v[204:207], v[120:123], v[132:135], v[204:207]
L_sa0:
 s_bitcmp1_b32 s75, 1
 s_cbranch_scc0 L_sa1
 v_mfma_f32_16x16x32_bf16 v[192:195], v[122:125], v[136:139], v[192:195]
 v_mfma_f32_16x16x32_bf16 v[196:199], v[120:123], v[136:139], v[196:199]
 v_mfma_f32_16x16x32_bf16 v[200:203], v[122:125], v[140:143], v[200:203]
 v_mfma_f32_16x16x32_bf16 v[204:207], v[120:123], v[140:143], v[204:207]
L_sa1:
 s_bitcmp1_b32 s75, 2
 s_cbranch_scc0 L_sa2
 v_mfma_f32_16x16x32_bf16 v[192:195], v[122:125], v[144:147], v[192:195]
 v_mfma_f32_16x16x32_bf16 v[196:199], v[120:123], v[144:147], v[196:199]
 v_mfma_f32_16x16x32_bf16 v[200:203], v[122:125], v[148:151], v[200:203]
 v_mfma_f32_16x16x32_bf16 v[204:207], v[120:123], v[148:151], v[204:207]
L_sa2:
 s_bitcmp1_b32 s75, 3
 s_cbranch_scc0 L_sa3
 v_mfma_f32_16x16x32_bf16 v[192:195], v[122:125], v[152:155], v[192:195]
 v_mfma_f32_16x16x32_bf16 v[196:199], v[120:123], v[152:155], v[196:199]
 v_mfma_f32_16x16x32_bf16 v[200:203], v[122:125], v[156:159], v[200:203]
 v_mfma_f32_16x16x32_bf16 v[204:207], v[120:123], v[156:159], v[204:207]
L_sa3:
 s_bitcmp1_b32 s75, 4
 s_cbranch_scc0 L_sa4
 v_mfma_f32_16x16x32_bf16 v[192:195], v[122:125], v[160:163], v[192:195]
 v_mfma_f32_16x16x32_bf16 v[196:199], v[120:123], v[160:163], v[196:199]
 v_mfma_f32_16x16x32_bf16 v[200:203], v[122:125], v[164:167], v[200:203]
 v_mfma_f32_16x16x32_bf16 v[204:207], v[120:123], v[164:167], v[204:207]
L_sa4:
 s_bitcmp1_b32 s75, 5
 s_cbranch_scc0 L_sa5
 v_mfma_f32_16x16x32_bf16 v[192:195], v[122:125], v[168:171], v[192:195]
 v_mfma_f32_16x16x32_bf16 v[196:199], v[120:123], v[168:171], v[196:199]
 v_mfma_f32_16x16x32_bf16 v[200:203], v[122:125], v[172:175], v[200:203]
 v_mfma_f32_16x16x32_bf16 v[204:207], v[120:123], v[172:175], v[204:207]
L_sa5:
 s_bitcmp1_b32 s75, 6
 s_cbranch_scc0 L_sa6
 v_mfma_f32_16x16x32_bf16 v[192:195], v[122:125], v[176:179], v[192:195]
 v_mfma_f32_16x16x32_bf16 v[196:199], v[120:123], v[176:179], v[196:199]
 v_mfma_f32_16x16x32_bf16 v[200:203], v[122:125], v[180:183], v[200:203]
 v_mfma_f32_16x16x32_bf16 v[204:207], v[120:123], v[180:183], v[204:207]
L_sa6:
 s_bitcmp1_b32 s75, 7
 s_cbranch_scc0 L_sa7
 v_mfma_f32_16x16x32_bf16 v[192:195], v[122:125], v[184:187], v[192:195]
 v_mfma_f32_16x16x32_bf16 v[196:199], v[120:123], v[184:187], v[196:199]
 v_mfma_f32_16x16x32_bf16 v[200:203], v[122:125], v[188:191], v[200:203]
 v_mfma_f32_16x16x32_bf16 v[204:207], v[120:123], v[188:191], v[204:207]
L_sa7:
 v_cmp_eq_u32 vcc, 1, v15
 s_nop 0
 s_and_b32 s75, vcc_lo, 0xff
 s_andn2_b32 s75, s75, s85
 s_or_b32 s85, s85, s75
 s_bitcmp1_b32 s75, 0
 s_cbranch_scc0 L_ib0
 s_add_u32 s88, s92, 0
 buffer_load_dwordx4 v[128:131], v20, s[64:67], s88 offen offset:0 sc1
 buffer_load_dwordx4 v[132:135], v20, s[64:67], s88 offen offset:1024 sc1
L_ib0:
 s_bitcmp1_b32 s75, 1
 s_cbranch_scc0 L_ib1
 s_add_u32 s88, s92, 8192
 buffer_load_dwordx4 v[136:139], v20, s[64:67], s88 offen offset:0 sc1
 buffer_load_dwordx4 v[140:143], v20, s[64:67], s88 offen offset:1024 sc1
L_ib1:
 s_bitcmp1_b32 s75, 2
 s_cbranch_scc0 L_ib2
 s_add_u32 s88, s92, 16384
 buffer_load_dwordx4 v[144:147], v20, s[64:67], s88 offen offset:0 sc1
 buffer_load_dwordx4 v[148:151], v20, s[64:67], s88 offen offset:1024 sc1
L_ib2:
 s_bitcmp1_b32 s75, 3
 s_cbranch_scc0 L_ib3
 s_add_u32 s88, s92, 24576
 buffer_load_dwordx4 v[152:155], v20, s[64:67], s88 offen offset:0 sc1
 buffer_load_dwordx4 v[156:159], v20, s[64:67], s88 offen offset:1024 sc1
L_ib3:
 s_bitcmp1_b32 s75, 4
 s_cbranch_scc0 L_ib4
 s_add_u32 s88, s92, 32768
 buffer_load_dwordx4 v[160:163], v20, s[64:67], s88 offen offset:0 sc1
 buffer_load_dwordx4 v[164:167], v20, s[64:67], s88 offen offset:1024 sc1
L_ib4:
 s_bitcmp1_b32 s75, 5
 s_cbranch_scc0 L_ib5
 s_add_u32 s88, s92, 40960
 buffer_load_dwordx4 v[168:171], v20, s[64:67], s88 offen offset:0 sc1
 buffer_load_dwordx4 v[172:175], v20, s[64:67], s88 offen offset:1024 sc1
L_ib5:
 s_bitcmp1_b32 s75, 6
 s_cbranch_scc0 L_ib6
 s_add_u32 s88, s92, 49152
 buffer_load_dwordx4 v[176:179], v20, s[64:67], s88 offen offset:0 sc1
 buffer_load_dwordx4 v[180:183], v20, s[64:67], s88 offen offset:1024 sc1
L_ib6:
 s_bitcmp1_b32 s75, 7
 s_cbranch_scc0 L_ib7
 s_add_u32 s88, s92, 57344
 buffer_load_dwordx4 v[184:187], v20, s[64:67], s88 offen offset:0 sc1
 buffer_load_dwordx4 v[188:191], v20, s[64:67], s88 offen offset:1024 sc1
L_ib7:
 s_waitcnt lgkmcnt(0)
 s_barrier
 ds_read_b128 v[32:35], v18 offset:0
 ds_read_b128 v[36:39], v18 offset:1024
 ds_read_b128 v[40:43], v18 offset:2048
 ds_read_b128 v[44:47], v18 offset:3072
 ds_read_b128 v[48:51], v18 offset:4096
 ds_read_b128 v[52:55], v18 offset:5120
 ds_read_b128 v[56:59], v18 offset:6144
 ds_read_b128 v[60:63], v18 offset:7168
 ds_read_b128 v[64:67], v18 offset:8192
 ds_read_b128 v[68:71], v18 offset:9216
 ds_read_b128 v[72:75], v18 offset:10240
 ds_read_b128 v[76:79], v18 offset:11264
 ds_read_b128 v[80:83], v18 offset:12288
 ds_read_b128 v[84:87], v18 offset:13312
 ds_read_b128 v[88:91], v18 offset:14336
 ds_read_b128 v[92:95], v18 offset:15360
 s_waitcnt lgkmcnt(0)
 v_pk_add_f32 v[32:33], v[32:33], v[48:49]
 v_pk_add_f32 v[34:35], v[34:35], v[50:51]
 v_pk_add_f32 v[36:37], v[36:37], v[52:53]
 v_pk_add_f32 v[38:39], v[38:39], v[54:55]
 v_pk_add_f32 v[40:41], v[40:41], v[56:57]
 v_pk_add_f32 v[42:43], v[42:43], v[58:59]
 v_pk_add_f32 v[44:45], v[44:45], v[60:61]
 v_pk_add_f32 v[46:47], v[46:47], v[62:63]
 v_pk_add_f32 v[64:65], v[64:65], v[80:81]
 v_pk_add_f32 v[66:67], v[66:67], v[82:83]
 v_pk_add_f32 v[68:69], v[68:69], v[84:85]
 v_pk_add_f32 v[70:71], v[70:71], v[86:87]
 v_pk_add_f32 v[72:73], v[72:73], v[88:89]
 v_pk_add_f32 v[74:75], v[74:75], v[90:91]
 v_pk_add_f32 v[76:77], v[76:77], v[92:93]
 v_pk_add_f32 v[78:79], v[78:79], v[94:95]
 v_mov_b32 v96, 0xbfb8aa3b
 v_pk_add_f32 v[32:33], v[32:33], v[64:65]
 v_pk_add_f32 v[34:35], v[34:35], v[66:67]
 v_pk_add_f32 v[36:37], v[36:37], v[68:69]
 v_pk_add_f32 v[38:39], v[38:39], v[70:71]
 v_pk_add_f32 v[40:41], v[40:41], v[72:73]
 v_pk_add_f32 v[42:43], v[42:43], v[74:75]
 v_pk_add_f32 v[44:45], v[44:45], v[76:77]
 v_pk_add_f32 v[46:47], v[46:47], v[78:79]
 v_pk_mul_f32 v[48:49], v[32:33], v[96:97] op_sel_hi:[1,0]
 v_pk_mul_f32 v[50:51], v[34:35], v[96:97] op_sel_hi:[1,0]
 v_pk_mul_f32 v[52:53], v[36:37], v[96:97] op_sel_hi:[1,0]
 v_pk_mul_f32 v[54:55], v[38:39], v[96:97] op_sel_hi:[1,0]
 v_pk_mul_f32 v[56:57], v[40:41], v[96:97] op_sel_hi:[1,0]
 v_pk_mul_f32 v[58:59], v[42:43], v[96:97] op_sel_hi:[1,0]
 v_pk_mul_f32 v[60:61], v[44:45], v[96:97] op_sel_hi:[1,0]
 v_pk_mul_f32 v[62:63], v[46:47], v[96:97] op_sel_hi:[1,0]
 v_exp_f32 v48, v48
 v_exp_f32 v49, v49
 v_exp_f32 v50, v50
 v_exp_f32 v51, v51
 v_exp_f32 v52, v52
 v_exp_f32 v53, v53
 v_exp_f32 v54, v54
 v_exp_f32 v55, v55
 v_exp_f32 v56, v56
 v_exp_f32 v57, v57
 v_exp_f32 v58, v58
 v_exp_f32 v59, v59
 v_exp_f32 v60, v60
 v_exp_f32 v61, v61
 v_exp_f32 v62, v62
 v_exp_f32 v63, v63
 s_nop 0
 v_pk_add_f32 v[48:49], v[48:49], 1.0 op_sel_hi:[1,0]
 v_pk_add_f32 v[50:51], v[50:51], 1.0 op_sel_hi:[1,0]
 v_pk_add_f32 v[52:53], v[52:53], 1.0 op_sel_hi:[1,0]
 v_pk_add_f32 v[54:55], v[54:55], 1.0 op_sel_hi:[1,0]
 v_pk_add_f32 v[56:57], v[56:57], 1.0 op_sel_hi:[1,0]
 v_pk_add_f32 v[58:59], v[58:59], 1.0 op_sel_hi:[1,0]
 v_pk_add_f32 v[60:61], v[60:61], 1.0 op_sel_hi:[1,0]
 v_pk_add_f32 v[62:63], v[62:63], 1.0 op_sel_hi:[1,0]
 v_rcp_f32 v48, v48
 v_rcp_f32 v49, v49
 v_rcp_f32 v50, v50
 v_rcp_f32 v51, v51
 v_rcp_f32 v52, v52
 v_rcp_f32 v53, v53
 v_rcp_f32 v54, v54
 v_rcp_f32 v55, v55
 v_rcp_f32 v56, v56
 v_rcp_f32 v57, v57
 v_rcp_f32 v58, v58
 v_rcp_f32 v59, v59
 v_rcp_f32 v60, v60
 v_rcp_f32 v61, v61
 v_rcp_f32 v62, v62
 v_rcp_f32 v63, v63
 s_nop 0
 v_pk_mul_f32 v[32:33], v[32:33], v[48:49]
 v_pk_mul_f32 v[34:35], v[34:35], v[50:51]
 v_pk_mul_f32 v[36:37], v[36:37], v[52:53]
 v_pk_mul_f32 v[38:39], v[38:39], v[54:55]
 v_pk_mul_f32 v[40:41], v[40:41], v[56:57]
 v_pk_mul_f32 v[42:43], v[42:43], v[58:59]
 v_pk_mul_f32 v[44:45], v[44:45], v[60:61]
 v_pk_mul_f32 v[46:47], v[46:47], v[62:63]
 s_cmp_eq_u32 s75, 0
 s_cselect_b32 s89, s85, 0
 s_cmp_eq_u32 s89, 0xff
 s_cbranch_scc1 L_sp_done
 s_mov_b32 s90, 0x200000
L_sp_spin:
 buffer_load_dword v15, v14, s[64:67], s86 offen sc1
 s_waitcnt vmcnt(0)
 s_bitcmp1_b32 s75, 0
 s_cbranch_scc0 L_sc0
 v_mfma_f32_16x16x32_bf16 v[192:195], v[122:125], v[128:131], v[192:195]
 v_mfma_f32_16x16x32_bf16 v[196:199], v[120:123], v[128:131], v[196:199]
 v_mfma_f32_16x16x32_bf16 v[200:203], v[122:125], v[132:135], v[200:203]
 v_mfma_f32_16x16x32_bf16 v[204:207], v[120:123], v[132:135], v[204:207]
L_sc0:
 s_bitcmp1_b32 s75, 1
 s_cbranch_scc0 L_sc1
 v_mfma_f32_16x16x32_bf16 v[192:195], v[122:125], v[136:139], v[192:195]
 v_mfma_f32_16x16x32_bf16 v[196:199], v[120:123], v[136:139], v[196:199]
 v_mfma_f32_16x16x32_bf16 v[200:203], v[122:125], v[140:143], v[200:203]
 v_mfma_f32_16x16x32_bf16 v[204:207], v[120:123], v[140:143], v[204:207]
L_sc1:
 s_bitcmp1_b32 s75, 2
 s_cbranch_scc0 L_sc2
 v_mfma_f32_16x16x32_bf16 v[192:195], v[122:125], v[144:147], v[192:195]
 v_mfma_f32_16x16x32_bf16 v[196:199], v[120:123], v[144:147], v[196:199]
 v_mfma_f32_16x16x32_bf16 v[200:203], v[122:125], v[148:151], v[200:203]
 v_mfma_f32_16x16x32_bf16 v[204:207], v[120:123], v[148:151], v[204:207]
L_sc2:
 s_bitcmp1_b32 s75, 3
 s_cbranch_scc0 L_sc3
 v_mfma_f32_16x16x32_bf16 v[192:195], v[122:125], v[152:155], v[192:195]
 v_mfma_f32_16x16x32_bf16 v[196:199], v[120:123], v[152:155], v[196:199]
 v_mfma_f32_16x16x32_bf16 v[200:203], v[122:125], v[156:159], v[200:203]
 v_mfma_f32_16x16x32_bf16 v[204:207], v[120:123], v[156:159], v[204:207]
L_sc3:
 s_bitcmp1_b32 s75, 4
 s_cbranch_scc0 L_sc4
 v_mfma_f32_16x16x32_bf16 v[192:195], v[122:125], v[160:163], v[192:195]
 v_mfma_f32_16x16x32_bf16 v[196:199], v[120:123], v[160:163], v[196:199]
 v_mfma_f32_16x16x32_bf16 v[200:203], v[122:125], v[164:167], v[200:203]
 v_mfma_f32_16x16x32_bf16 v[204:207], v[120:123], v[164:167], v[204:207]
L_sc4:
 s_bitcmp1_b32 s75, 5
 s_cbranch_scc0 L_sc5
 v_mfma_f32_16x16x32_bf16 v[192:195], v[122:125], v[168:171], v[192:195]
 v_mfma_f32_16x16x32_bf16 v[196:199], v[120:123], v[168:171], v[196:199]
 v_mfma_f32_16x16x32_bf16 v[200:203], v[122:125], v[172:175], v[200:203]
 v_mfma_f32_16x16x32_bf16 v[204:207], v[120:123], v[172:175], v[204:207]
L_sc5:
 s_bitcmp1_b32 s75, 6
 s_cbranch_scc0 L_sc6
 v_mfma_f32_16x16x32_bf16 v[192:195], v[122:125], v[176:179], v[192:195]
 v_mfma_f32_16x16x32_bf16 v[196:199], v[120:123], v[176:179], v[196:199]
 v_mfma_f32_16x16x32_bf16 v[200:203], v[122:125], v[180:183], v[200:203]
 v_mfma_f32_16x16x32_bf16 v[204:207], v[120:123], v[180:183], v[204:207]
L_sc6:
 s_bitcmp1_b32 s75, 7
 s_cbranch_scc0 L_sc7
 v_mfma_f32_16x16x32_bf16 v[192:195], v[122:125], v[184:187], v[192:195]
 v_mfma_f32_16x16x32_bf16 v[196:199], v[120:123], v[184:187], v[196:199]
 v_mfma_f32_16x16x32_bf16 v[200:203], v[122:125], v[188:191], v[200:203]
 v_mfma_f32_16x16x32_bf16 v[204:207], v[120:123], v[188:191], v[204:207]
L_sc7:
 s_cmp_eq_u32 s85, 0xff
 s_cbranch_scc1 L_sp_last
L_sp_tight:
 v_cmp_eq_u32 vcc, 1, v15
 s_sub_u32 s90, s90, 1
 s_cbranch_scc1 L_sp_last
 s_and_b32 s75, vcc_lo, 0xff
 s_andn2_b32 s75, s75, s85
 s_cbranch_scc1 L_sp_new
 buffer_load_dword v15, v14, s[64:67], s86 offen sc1
 s_waitcnt vmcnt(0)
 s_branch L_sp_tight
L_sp_new:
 s_or_b32 s85, s85, s75
 s_bitcmp1_b32 s75, 0
 s_cbranch_scc0 L_ic0
 s_add_u32 s88, s92, 0
 buffer_load_dwordx4 v[128:131], v20, s[64:67], s88 offen offset:0 sc1
 buffer_load_dwordx4 v[132:135], v20, s[64:67], s88 offen offset:1024 sc1
L_ic0:
 s_bitcmp1_b32 s75, 1
 s_cbranch_scc0 L_ic1
 s_add_u32 s88, s92, 8192
 buffer_load_dwordx4 v[136:139], v20, s[64:67], s88 offen offset:0 sc1
 buffer_load_dwordx4 v[140:143], v20, s[64:67], s88 offen offset:1024 sc1
L_ic1:
 s_bitcmp1_b32 s75, 2
 s_cbranch_scc0 L_ic2
 s_add_u32 s88, s92, 16384
 buffer_load_dwordx4 v[144:147], v20, s[64:67], s88 offen offset:0 sc1
 buffer_load_dwordx4 v[148:151], v20, s[64:67], s88 offen offset:1024 sc1
L_ic2:
 s_bitcmp1_b32 s75, 3
 s_cbranch_scc0 L_ic3
 s_add_u32 s88, s92, 24576
 buffer_load_dwordx4 v[152:155], v20, s[64:67], s88 offen offset:0 sc1
 buffer_load_dwordx4 v[156:159], v20, s[64:67], s88 offen offset:1024 sc1
L_ic3:
 s_bitcmp1_b32 s75, 4
 s_cbranch_scc0 L_ic4
 s_add_u32 s88, s92, 32768
 buffer_load_dwordx4 v[160:163], v20, s[64:67], s88 offen offset:0 sc1
 buffer_load_dwordx4 v[164:167], v20, s[64:67], s88 offen offset:1024 sc1
L_ic4:
 s_bitcmp1_b32 s75, 5
 s_cbranch_scc0 L_ic5
 s_add_u32 s88, s92, 40960
 buffer_load_dwordx4 v[168:171], v20, s[64:67], s88 offen offset:0 sc1
 buffer_load_dwordx4 v[172:175], v20, s[64:67], s88 offen offset:1024 sc1
L_ic5:
 s_bitcmp1_b32 s75, 6
 s_cbranch_scc0 L_ic6
 s_add_u32 s88, s92, 49152
 buffer_load_dwordx4 v[176:179], v20, s[64:67], s88 offen offset:0 sc1
 buffer_load_dwordx4 v[180:183], v20, s[64:67], s88 offen offset:1024 sc1
L_ic6:
 s_bitcmp1_b32 s75, 7
 s_cbranch_scc0 L_ic7
 s_add_u32 s88, s92, 57344
 buffer_load_dwordx4 v[184:187], v20, s[64:67], s88 offen offset:0 sc1
 buffer_load_dwordx4 v[188:191], v20, s[64:67], s88 offen offset:1024 sc1
L_ic7:
 s_sub_u32 s90, s90, 1
 s_cbranch_scc0 L_sp_spin
 s_waitcnt vmcnt(0)
L_sp_last:
 s_nop 7
L_sp_done:
 v_pk_fma_f32 v[192:193], v[192:193], v[32:33], v[208:209]
 v_pk_fma_f32 v[194:195], v[194:195], v[34:35], v[210:211]
 v_cvt_pk_bf16_f32 v96, v192, v193
L_pg18:
 s_nop 0
 v_cvt_pk_bf16_f32 v97, v194, v195
 buffer_store_dwordx2 v[96:97], v22, s[60:63], s73 offen offset:0
 v_pk_fma_f32 v[196:197], v[196:197], v[36:37], v[212:213]
 v_pk_fma_f32 v[198:199], v[198:199], v[38:39], v[214:215]
 v_cvt_pk_bf16_f32 v98, v196, v197
 v_cvt_pk_bf16_f32 v99, v198, v199
 buffer_store_dwordx2 v[98:99], v22, s[60:63], s73 offen offset:32
 v_pk_fma_f32 v[200:201], v[200:201], v[40:41], v[216:217]
 v_pk_fma_f32 v[202:203], v[202:203], v[42:43], v[218:219]
 v_cvt_pk_bf16_f32 v100, v200, v201
 v_cvt_pk_bf16_f32 v101, v202, v203
 buffer_store_dwordx2 v[100:101], v22, s[60:63], s73 offen offset:64
 v_pk_fma_f32 v[204:205], v[204:205], v[44:45], v[220:221]
 v_pk_fma_f32 v[206:207], v[206:207], v[46:47], v[222:223]
 v_cvt_pk_bf16_f32 v102, v204, v205
 v_cvt_pk_bf16_f32 v103, v206, v207
 buffer_store_dwordx2 v[102:103], v22, s[60:63], s73 offen offset:96
 s_endpgm
L_fallback:
 s_mov_b32 s81, 1
 s_mov_b32 s92, 0x40000000
 s_mov_b32 s93, 0x40000000
 s_waitcnt vmcnt(0) lgkmcnt(0)
 s_barrier
 v_and_b32 v10, 15, v1
 v_lshrrev_b32 v11, 4, v1
 v_lshlrev_b32 v11, 4, v11
 v_lshl_or_b32 v10, v10, 8, v11
 s_mov_b32 s84, 0
 v_mov_b32 v24, 0xff800000
 v_mov_b32 v25, 0xff800000
 v_mov_b32 v26, 0xff800000
 v_mov_b32 v27, 0xff800000
L_maxloop:
 buffer_load_dwordx4 v[160:163], v10, s[32:35], s84 offen offset:0
 buffer_load_dwordx4 v[164:167], v10, s[32:35], s84 offen offset:64
 buffer_load_dwordx4 v[168:171], v10, s[32:35], s84 offen offset:128
 buffer_load_dwordx4 v[172:175], v10, s[32:35], s84 offen offset:192
 s_waitcnt vmcnt(0)
 v_mfma_f32_16x16x32_bf16 v[128:131], v[160:163], v[64:67], 0
 v_mfma_f32_16x16x32_bf16 v[132:135], v[160:163], v[68:71], 0
 v_mfma_f32_16x16x32_bf16 v[136:139], v[160:163], v[72:75], 0
 v_mfma_f32_16x16x32_bf16 v[140:143], v[160:163], v[76:79], 0
 v_mfma_f32_16x16x32_bf16 v[128:131], v[164:167], v[80:83], v[128:131]
 v_mfma_f32_16x16x32_bf16 v[132:135], v[164:167], v[84:87], v[132:135]
 v_mfma_f32_16x16x32_bf16 v[136:139], v[164:167], v[88:91], v[136:139]
 v_mfma_f32_16x16x32_bf16 v[140:143], v[164:167], v[92:95], v[140:143]
 v_mfma_f32_16x16x32_bf16 v[128:131], v[168:171], v[96:99], v[128:131]
 v_mfma_f32_16x16x32_bf16 v[132:135], v[168:171], v[100:103], v[132:135]
 v_mfma_f32_16x16x32_bf16 v[136:139], v[168:171], v[104:107], v[136:139]
 v_mfma_f32_16x16x32_bf16 v[140:143], v[168:171], v[108:111], v[140:143]
 v_mfma_f32_16x16x32_bf16 v[128:131], v[172:175], v[112:115], v[128:131]
 v_mfma_f32_16x16x32_bf16 v[132:135], v[172:175], v[116:119], v[132:135]
 v_mfma_f32_16x16x32_bf16 v[136:139], v[172:175], v[120:123], v[136:139]
 v_mfma_f32_16x16x32_bf16 v[140:143], v[172:175], v[124:127], v[140:143]
 s_add_u32 s84, s84, 4096
 s_nop 7
 v_max3_f32 v24, v128, v129, v24
 v_max3_f32 v24, v130, v131, v24
 v_max3_f32 v25, v132, v133, v25
 v_max3_f32 v25, v134, v135, v25
 v_max3_f32 v26, v136, v137, v26
 v_max3_f32 v26, v138, v139, v26
 v_max3_f32 v27, v140, v141, v27
 v_max3_f32 v27, v142, v143, v27
 s_cmp_lt_u32 s84, 0x80000
 s_cbranch_scc1 L_maxloop
 v_accvgpr_read_b32 v10, a250
 v_accvgpr_read_b32 v2, a249
 s_nop 0
 s_mov_b32 s85, s87
 s_add_u32 s86, s87, 16384
 v_xor_b32 v11, 64, v10
 v_xor_b32 v12, 128, v10
 v_xor_b32 v13, 192, v10
 v_xor_b32 v3, 32, v2
 v_xor_b32 v4, 64, v2
 v_xor_b32 v5, 96, v2
 v_xor_b32 v6, 128, v2
 v_xor_b32 v7, 160, v2
 v_xor_b32 v8, 192, v2
 v_xor_b32 v9, 224, v2
 s_add_u32 m0, s87, 49152
 s_nop 0
 buffer_load_dwordx4 v16, s[32:35], s85 offen offset:0 lds
 buffer_load_dwordx4 v17, s[32:35], s85 offen offset:1024 lds
 buffer_load_dwordx4 v18, s[32:35], s85 offen offset:2048 lds
 buffer_load_dwordx4 v19, s[32:35], s85 offen offset:3072 lds
 s_add_u32 m0, s87, 0
 s_nop 0
 buffer_load_dwordx4 v16, s[32:35], s86 offen offset:0 lds
 buffer_load_dwordx4 v17, s[32:35], s86 offen offset:1024 lds
 buffer_load_dwordx4 v18, s[32:35], s86 offen offset:2048 lds
 buffer_load_dwordx4 v19, s[32:35], s86 offen offset:3072 lds
 s_add_u32 m0, s87, 65536
 s_nop 0
 buffer_load_dwordx4 v14, s[36:39], s85 offen offset:0 lds
 buffer_load_dwordx4 v15, s[36:39], s85 offen offset:1024 lds
 buffer_load_dwordx4 v14, s[36:39], s85 offen offset:2048 lds
 buffer_load_dwordx4 v15, s[36:39], s85 offen offset:3072 lds
 v_mov_b32 v21, 0
 s_waitcnt vmcnt(0)
 s_barrier
 ds_read_b128 a[228:231], v10 offset:49152
 ds_read_b128 a[232:235], v11 offset:49152
 ds_read_b128 a[236:239], v10 offset:53248
 s_waitcnt lgkmcnt(2)
 v_mfma_f32_16x16x32_bf16 v[128:131], a[228:231], v[64:67], 0
 ds_read_b128 a[240:243], v11 offset:53248
 v_mfma_f32_16x16x32_bf16 v[132:135], a[228:231], v[68:71], 0
 v_mfma_f32_16x16x32_bf16 v[136:139], a[228:231], v[72:75], 0
 v_mfma_f32_16x16x32_bf16 v[140:143], a[228:231], v[76:79], 0
 s_waitcnt lgkmcnt(2)
 v_mfma_f32_16x16x32_bf16 v[128:131], a[232:235], v[80:83], v[128:131]
 ds_read_b128 a[228:231], v12 offset:49152
 v_mfma_f32_16x16x32_bf16 v[132:135], a[232:235], v[84:87], v[132:135]
 v_mfma_f32_16x16x32_bf16 v[136:139], a[232:235], v[88:91], v[136:139]
 v_mfma_f32_16x16x32_bf16 v[140:143], a[232:235], v[92:95], v[140:143]
 s_waitcnt lgkmcnt(2)
 v_mfma_f32_16x16x32_bf16 v[144:147], a[236:239], v[64:67], 0
 ds_read_b128 a[232:235], v13 offset:49152
 v_mfma_f32_16x16x32_bf16 v[148:151], a[236:239], v[68:71], 0
 v_mfma_f32_16x16x32_bf16 v[152:155], a[236:239], v[72:75], 0
 v_mfma_f32_16x16x32_bf16 v[156:159], a[236:239], v[76:79], 0
 s_waitcnt lgkmcnt(2)
 v_mfma_f32_16x16x32_bf16 v[144:147], a[240:243], v[80:83], v[144:147]
 ds_read_b128 a[236:239], v12 offset:53248
 v_mfma_f32_16x16x32_bf16 v[148:151], a[240:243], v[84:87], v[148:151]
 v_mfma_f32_16x16x32_bf16 v[152:155], a[240:243], v[88:91], v[152:155]
 v_mfma_f32_16x16x32_bf16 v[156:159], a[240:243], v[92:95], v[156:159]
 s_waitcnt lgkmcnt(2)
 s_branch L_attn
L_idle:
 s_waitcnt vmcnt(0)
 v_lshrrev_b32 v52, 3, v1
 v_and_b32 v53, 7, v1
 v_min_u32 v53, 6, v53
 s_lshl_b32 s88, s3, 3
 v_add_u32 v52, s88, v52
 v_mul_u32_u24 v52, 3584, v52
 v_lshl_add_u32 v52, v53, 7, v52
 s_lshr_b32 s89, s77, 1
 s_mul_i32 s88, s89, 896
 v_add_u32 v52, s88, v52
 v_lshrrev_b32 v53, 4, v1
 s_lshl_b32 s88, s3, 2
 v_add_u32 v53, s88, v53
 v_lshlrev_b32 v53, 13, v53
 v_and_b32 v54, 15, v1
 v_lshl_or_b32 v53, v54, 7, v53
 s_lshl_b32 s89, s89, 11
 v_add_u32 v53, s89, v53
 v_and_b32 v54, 7, v1
 v_lshrrev_b32 v53, 3, v1
 s_lshl_b32 s88, s3, 5
 v_add_u32 v53, s88, v53
 v_lshlrev_b32 v53, 13, v53
 v_lshl_or_b32 v53, v54, 8, v53
 v_add_u32 v53, s89, v53
 v_lshlrev_b32 v54, 7, v1
 v_and_b32 v55, 31, v1
 v_lshlrev_b32 v55, 7, v55
 v_lshrrev_b32 v54, 5, v1
 v_lshl_or_b32 v54, v54, 19, v55
 s_lshl_b32 s88, s3, 12
 s_sub_u32 s32, s32, 0x80000
 s_subb_u32 s33, s33, 0
 s_add_u32 s34, s34, 0x80000
 buffer_load_dword v64, v54, s[32:35], s88 offen
 s_add_u32 s32, s32, 0x80000
 s_addc_u32 s33, s33, 0
 s_sub_u32 s34, s34, 0x80000
 s_sub_u32 s36, s36, 0x80000
 s_subb_u32 s37, s37, 0
 s_add_u32 s38, s38, 0x80000
 buffer_load_dword v65, v54, s[36:39], s88 offen
 s_add_u32 s36, s36, 0x80000
 s_addc_u32 s37, s37, 0
 s_sub_u32 s38, s38, 0x80000
 s_and_b32 s95, s3, 14
 s_lshl_b32 s84, s95, 18
 s_add_u32 m0, s83, 32768
 s_nop 0
 buffer_load_dwordx4 v10, s[40:43], s84 offen offset:0 lds
 buffer_load_dwordx4 v11, s[40:43], s84 offen offset:1024 lds
 buffer_load_dwordx4 v12, s[40:43], s84 offen offset:2048 lds
 buffer_load_dwordx4 v13, s[40:43], s84 offen offset:3072 lds
 s_add_u32 s95, s95, 1
 s_lshl_b32 s99, s95, 18
 s_add_u32 m0, s83, 36864
 s_nop 0
 buffer_load_dwordx4 v10, s[40:43], s99 offen offset:0 lds
 buffer_load_dwordx4 v11, s[40:43], s99 offen offset:1024 lds
 buffer_load_dwordx4 v12, s[40:43], s99 offen offset:2048 lds
 buffer_load_dwordx4 v13, s[40:43], s99 offen offset:3072 lds
 s_add_u32 s95, s95, 15
 s_and_b32 s95, s95, 15
 s_lshl_b32 s84, s95, 18
 s_add_u32 s84, s84, 128
 s_add_u32 m0, s83, 0
 s_nop 0
 buffer_load_dwordx4 v10, s[40:43], s84 offen offset:0 lds
 buffer_load_dwordx4 v11, s[40:43], s84 offen offset:1024 lds
 buffer_load_dwordx4 v12, s[40:43], s84 offen offset:2048 lds
 buffer_load_dwordx4 v13, s[40:43], s84 offen offset:3072 lds
 s_add_u32 s95, s95, 1
 s_lshl_b32 s99, s95, 18
 s_add_u32 s99, s99, 128
 s_add_u32 m0, s83, 4096
 s_nop 0
 buffer_load_dwordx4 v10, s[40:43], s99 offen offset:0 lds
 buffer_load_dwordx4 v11, s[40:43], s99 offen offset:1024 lds
 buffer_load_dwordx4 v12, s[40:43], s99 offen offset:2048 lds
 buffer_load_dwordx4 v13, s[40:43], s99 offen offset:3072 lds
 s_add_u32 s95, s95, 1
 s_and_b32 s95, s95, 15
 s_lshl_b32 s84, s95, 18
 s_add_u32 m0, s83, 16384
 s_nop 0
 buffer_load_dwordx4 v10, s[40:43], s84 offen offset:0 lds
 buffer_load_dwordx4 v11, s[40:43], s84 offen offset:1024 lds
 buffer_load_dwordx4 v12, s[40:43], s84 offen offset:2048 lds
 buffer_load_dwordx4 v13, s[40:43], s84 offen offset:3072 lds
 s_add_u32 s95, s95, 1
 s_lshl_b32 s99, s95, 18
 s_add_u32 m0, s83, 20480
 s_nop 0
 buffer_load_dwordx4 v10, s[40:43], s99 offen offset:0 lds
 buffer_load_dwordx4 v11, s[40:43], s99 offen offset:1024 lds
 buffer_load_dwordx4 v12, s[40:43], s99 offen offset:2048 lds
 buffer_load_dwordx4 v13, s[40:43], s99 offen offset:3072 lds
 ds_read_b128 a[192:195], v14 offset:0
 ds_read_b128 a[196:199], v14 offset:16384
 ds_read_b128 a[200:203], v14 offset:32768
 ds_read_b128 a[204:207], v14 offset:49152
 ds_read_b128 a[208:211], v15 offset:1024
 ds_read_b128 a[212:215], v15 offset:17408
 ds_read_b128 a[216:219], v15 offset:33792
 ds_read_b128 a[220:223], v15 offset:50176
 s_waitcnt vmcnt(0)
 ds_read_b64_tr_b16 a[160:161], v2 offset:32768
 ds_read_b64_tr_b16 a[162:163], v2 offset:33280
 ds_read_b64_tr_b16 a[164:165], v2 offset:36864
 ds_read_b64_tr_b16 a[166:167], v2 offset:37376
 ds_read_b64_tr_b16 a[168:169], v3 offset:32768
 ds_read_b64_tr_b16 a[170:171], v3 offset:33280
 ds_read_b64_tr_b16 a[172:173], v3 offset:36864
 ds_read_b64_tr_b16 a[174:175], v3 offset:37376
 ds_read_b64_tr_b16 a[176:177], v4 offset:32768
 ds_read_b64_tr_b16 a[178:179], v4 offset:33280
 ds_read_b64_tr_b16 a[180:181], v4 offset:36864
 ds_read_b64_tr_b16 a[182:183], v4 offset:37376
 s_waitcnt lgkmcnt(0)
 s_branch L_p2
L_end:
 s_endpgm
.section .rodata,"a"
.p2align 6
.amdhsa_kernel recurrent_scan__gqa_block_cached__glu_gated_glu__prompt_kernel
  .amdhsa_next_free_vgpr 512
  .amdhsa_next_free_sgpr 102
  .amdhsa_accum_offset 256
  .amdhsa_group_segment_fixed_size 0
  .amdhsa_kernarg_size 96
  .amdhsa_user_sgpr_count 2
  .amdhsa_user_sgpr_kernarg_segment_ptr 1
  .amdhsa_system_sgpr_workgroup_id_x 1
.end_amdhsa_kernel
```
